```python
import torch

def _softmax(x, axis=-1):
    return torch.softmax(x, dim=axis)
def _gelu(x):
    return torch.nn.functional.gelu(x, approximate="tanh")
def _silu(x):
    return torch.nn.functional.silu(x)
def _sigmoid(x):
    return torch.sigmoid(x)
def _layernorm(x, axis=-1, eps=1e-5):
    m = x.mean(dim=axis, keepdim=True)
    v = x.var(dim=axis, keepdim=True, unbiased=False)
    return (x - m) / torch.sqrt(v + eps)
def _scatter_add(tgt, idx, src, axis=0):
    return tgt.clone().index_add_(axis, idx, src)
def _segment_sum(src, seg, n):
    out = torch.zeros((n,) + src.shape[1:], dtype=src.dtype)
    return out.index_add_(0, seg, src)
def _pad(x, pw):
    flat = tuple(v for pair in reversed(pw) for v in pair)
    return torch.nn.functional.pad(x, flat)

kernel_name = 'recurrent_scan__spectral_gfnet__mixer_channel_mlp__prompt'

def setup_inputs():

    _w = (lambda a: (lambda t: t.to(torch.bfloat16) if t.is_floating_point() else t)(torch.as_tensor(a)))
    def _A_setup():
        B, S, D = 1, 2048, 576
        Df = D // 2 + 1
        return {
            "x": _w((lambda *s: torch.randn(*s, dtype=torch.bfloat16) * 0.05)(B, S, D)),
            "w_r": _w((lambda *s: torch.randn(*s, dtype=torch.bfloat16) * 0.8)(S, Df) * 0.02),
            "w_i": _w((lambda *s: torch.randn(*s, dtype=torch.bfloat16) * 0.8)(S, Df) * 0.02),
        }
    _A_in = _A_setup()

    def _B_setup():
        B, S, D, F = 1, 2048, 576, 4608
        return {
            "x": _w((lambda *s: torch.randn(*s, dtype=torch.bfloat16) * 0.05)(B, S, D)),
            "w1": _w((lambda *s: torch.randn(*s, dtype=torch.bfloat16) * 0.8)(D, F) * (D ** -0.5)),
            "b1": _w((lambda *s: torch.randn(*s, dtype=torch.bfloat16) * 0.8)(F)),
            "w2": _w((lambda *s: torch.randn(*s, dtype=torch.bfloat16) * 0.8)(F, D) * (F ** -0.5)),
            "b2": _w((lambda *s: torch.randn(*s, dtype=torch.bfloat16) * 0.2)(D)),
        }
    _B_in = _B_setup()

    return {
        "A_x": _A_in["x"],
        "A_w_r": _A_in["w_r"],
        "A_w_i": _A_in["w_i"],
        "B_x": _B_in["x"],
        "B_w1": _B_in["w1"],
        "B_b1": _B_in["b1"],
        "B_w2": _B_in["w2"],
        "B_b2": _B_in["b2"],
    }

def reference(A_x, A_w_r, A_w_i, B_x, B_w1, B_b1, B_w2, B_b2):
    def _A_ref(x, w_r, w_i):
        B, S, D = x.shape
        X = (lambda x, axes=(-2,-1): torch.fft.rfft2(x.float(), dim=axes))(x, axes=(-2, -1))
        W = w_r + 1j * w_i
        X = X * W
        y = (lambda x, s, axes=(-2,-1): torch.fft.irfft2(x, s=s, dim=axes).to(torch.bfloat16))(X, (S, D), axes=(-2, -1))
        return y

    def _B_ref(x, w1, b1, w2, b2):
        y = _layernorm(x, axis=-1)
        h = _gelu(torch.einsum("bsd,df->bsf", y, w1) + b1)
        return torch.einsum("bsf,fd->bsd", h, w2) + b2

    x = A_x
    xn = _layernorm(x, axis=-1)
    s = _A_ref(xn, A_w_r, A_w_i)
    g = _silu(_B_ref(xn, B_w1, B_b1, B_w2, B_b2))
    return x + s * g
```

```asm
; @launch kernel=k0_kernel grid=(512,1,1) block=(256,1,1) lds=75776
; @launch kernel=k1_kernel grid=(456,1,1) block=(256,1,1) lds=75776
; @launch kernel=k2_kernel grid=(410,1,1) block=(256,1,1) lds=73728
; @launch kernel=k3_kernel grid=(256,1,1) block=(384,1,1) lds=36864
.amdgcn_target "amdgcn-amd-amdhsa--gfx950"
.text
.globl k0_kernel
.p2align 8
.type k0_kernel,@function
k0_kernel:
s_cmp_ge_u32 s2, 256
s_cbranch_scc1 K0_pf
s_load_dwordx2 s[4:5], s[0:1], 0
s_load_dwordx2 s[6:7], s[0:1], 80
s_and_b32 s16, s2, 1
s_lshr_b32 s21, s2, 1
s_and_b32 s22, s21, 1
s_lshr_b32 s23, s21, 1
s_and_b32 s24, s23, 31
s_lshr_b32 s23, s23, 5
s_lshl_b32 s25, s16, 1
s_add_u32 s25, s25, s22
s_lshl_b32 s25, s25, 8
s_lshl_b32 s23, s23, 10
s_add_u32 s25, s25, s23
s_add_u32 s25, s25, s24
s_mul_i32 s25, s25, 1152
v_lshrrev_b32 v3, 5, v0
v_mul_u32_u24 v1, 36864, v3
v_and_b32 v2, 31, v0
v_lshl_add_u32 v1, v2, 2, v1
s_waitcnt lgkmcnt(0)
s_mov_b32 s8, s4
s_and_b32 s9, s5, 0xffff
s_mov_b32 s10, 2359296
s_mov_b32 s11, 0x00020000
buffer_load_dword v4, v1, s[8:11], s25 offen offset:0
buffer_load_dword v5, v1, s[8:11], s25 offen offset:128
buffer_load_dword v6, v1, s[8:11], s25 offen offset:256
buffer_load_dword v7, v1, s[8:11], s25 offen offset:384
buffer_load_dword v8, v1, s[8:11], s25 offen offset:512
buffer_load_dword v9, v1, s[8:11], s25 offen offset:640
buffer_load_dword v10, v1, s[8:11], s25 offen offset:768
buffer_load_dword v11, v1, s[8:11], s25 offen offset:896
buffer_load_dword v12, v1, s[8:11], s25 offen offset:1024
s_mov_b32 s12, s6
s_and_b32 s13, s7, 0xffff
s_mov_b32 s14, 268435456
s_mov_b32 s15, 0x00020000
v_lshrrev_b32 v45, 2, v2
v_lshlrev_b32 v45, 7, v45
v_lshl_add_u32 v45, v3, 4, v45
v_and_b32 v46, 3, v0
v_lshl_add_u32 v45, v46, 2, v45
v_lshlrev_b32 v47, 4, v0
v_lshrrev_b32 v48, 3, v0
v_lshlrev_b32 v48, 8, v48
v_and_b32 v46, 7, v0
v_lshl_add_u32 v48, v46, 4, v48
v_cmp_gt_u32 vcc, 64, v0
v_mov_b32 v49, 0x7ff00000
s_nop 1
v_cndmask_b32 v49, v49, v48, vcc
s_mul_i32 s26, s21, 18432
s_lshl_b32 s27, s16, 7
s_add_u32 s26, s26, s27
s_mov_b32 s17, 0x3ae38e39
s_mov_b32 s18, 0x3727c5ac
s_mov_b32 s20, 0
s_mov_b64 s[28:29], -1
s_waitcnt vmcnt(0)
v_lshlrev_b32 v16, 16, v4
v_and_b32 v17, 0xffff0000, v4
v_lshlrev_b32 v18, 16, v5
v_and_b32 v19, 0xffff0000, v5
v_lshlrev_b32 v20, 16, v6
v_and_b32 v21, 0xffff0000, v6
v_lshlrev_b32 v22, 16, v7
v_and_b32 v23, 0xffff0000, v7
v_lshlrev_b32 v24, 16, v8
v_and_b32 v25, 0xffff0000, v8
v_lshlrev_b32 v26, 16, v9
v_and_b32 v27, 0xffff0000, v9
v_lshlrev_b32 v28, 16, v10
v_and_b32 v29, 0xffff0000, v10
v_lshlrev_b32 v30, 16, v11
v_and_b32 v31, 0xffff0000, v11
v_lshlrev_b32 v32, 16, v12
v_and_b32 v33, 0xffff0000, v12
LN_loop_1:
v_add_f32 v40, v16, v17
v_add_f32 v41, v18, v19
v_add_f32 v40, v40, v20
v_add_f32 v41, v41, v21
v_add_f32 v40, v40, v22
v_add_f32 v41, v41, v23
v_add_f32 v40, v40, v24
v_add_f32 v41, v41, v25
v_add_f32 v40, v40, v26
v_add_f32 v41, v41, v27
v_add_f32 v40, v40, v28
v_add_f32 v41, v41, v29
v_add_f32 v40, v40, v30
v_add_f32 v41, v41, v31
v_add_f32 v40, v40, v32
v_add_f32 v41, v41, v33
v_add_f32 v40, v40, v41
s_nop 1
v_add_f32_dpp v40, v40, v40 row_ror:8 row_mask:0xf bank_mask:0xf
s_nop 1
v_add_f32_dpp v40, v40, v40 row_ror:4 row_mask:0xf bank_mask:0xf
s_nop 1
v_add_f32_dpp v40, v40, v40 row_ror:2 row_mask:0xf bank_mask:0xf
s_nop 1
v_add_f32_dpp v40, v40, v40 row_ror:1 row_mask:0xf bank_mask:0xf
v_mov_b32 v41, v40
s_nop 1
v_permlane16_swap_b32 v40, v41
s_nop 1
v_add_f32 v40, v40, v41
v_mul_f32 v40, s17, v40
v_sub_f32 v42, v16, v40
v_sub_f32 v44, v17, v40
v_mul_f32 v43, v42, v42
v_mul_f32 v41, v44, v44
v_sub_f32 v42, v18, v40
v_sub_f32 v44, v19, v40
v_fmac_f32 v43, v42, v42
v_fmac_f32 v41, v44, v44
v_sub_f32 v42, v20, v40
v_sub_f32 v44, v21, v40
v_fmac_f32 v43, v42, v42
v_fmac_f32 v41, v44, v44
v_sub_f32 v42, v22, v40
v_sub_f32 v44, v23, v40
v_fmac_f32 v43, v42, v42
v_fmac_f32 v41, v44, v44
v_sub_f32 v42, v24, v40
v_sub_f32 v44, v25, v40
v_fmac_f32 v43, v42, v42
v_fmac_f32 v41, v44, v44
v_sub_f32 v42, v26, v40
v_sub_f32 v44, v27, v40
v_fmac_f32 v43, v42, v42
v_fmac_f32 v41, v44, v44
v_sub_f32 v42, v28, v40
v_sub_f32 v44, v29, v40
v_fmac_f32 v43, v42, v42
v_fmac_f32 v41, v44, v44
v_sub_f32 v42, v30, v40
v_sub_f32 v44, v31, v40
v_fmac_f32 v43, v42, v42
v_fmac_f32 v41, v44, v44
v_sub_f32 v42, v32, v40
v_sub_f32 v44, v33, v40
v_fmac_f32 v43, v42, v42
v_fmac_f32 v41, v44, v44
v_add_f32 v43, v43, v41
s_nop 1
v_add_f32_dpp v43, v43, v43 row_ror:8 row_mask:0xf bank_mask:0xf
s_nop 1
v_add_f32_dpp v43, v43, v43 row_ror:4 row_mask:0xf bank_mask:0xf
s_nop 1
v_add_f32_dpp v43, v43, v43 row_ror:2 row_mask:0xf bank_mask:0xf
s_nop 1
v_add_f32_dpp v43, v43, v43 row_ror:1 row_mask:0xf bank_mask:0xf
v_mov_b32 v41, v43
s_nop 1
v_permlane16_swap_b32 v43, v41
s_nop 1
v_add_f32 v43, v43, v41
v_mul_f32 v43, s17, v43
v_cvt_pk_bf16_f32 v41, v40, v43
v_lshlrev_b32 v40, 16, v41
v_and_b32 v43, 0xffff0000, v41
v_add_f32 v43, s18, v43
v_cvt_pk_bf16_f32 v43, v43, v43
v_lshlrev_b32 v43, 16, v43
v_sqrt_f32 v43, v43
s_nop 0
v_cvt_pk_bf16_f32 v43, v43, v43
v_lshlrev_b32 v43, 16, v43
v_rcp_f32 v43, v43
s_nop 0
v_sub_f32 v16, v16, v40
v_sub_f32 v17, v17, v40
v_cvt_pk_bf16_f32 v44, v16, v17
v_lshlrev_b32 v16, 16, v44
v_and_b32 v17, 0xffff0000, v44
v_mul_f32 v16, v16, v43
v_mul_f32 v17, v17, v43
v_cvt_pk_bf16_f32 v4, v16, v17
v_lshlrev_b32 v16, 16, v4
v_and_b32 v17, 0xffff0000, v4
v_cvt_pk_f16_f32 v44, v16, v17
v_cndmask_b32 v44, v4, v44, s[28:29]
ds_write_b32 v45, v44 offset:0
v_sub_f32 v18, v18, v40
v_sub_f32 v19, v19, v40
v_cvt_pk_bf16_f32 v44, v18, v19
v_lshlrev_b32 v18, 16, v44
v_and_b32 v19, 0xffff0000, v44
v_mul_f32 v18, v18, v43
v_mul_f32 v19, v19, v43
v_cvt_pk_bf16_f32 v5, v18, v19
v_lshlrev_b32 v18, 16, v5
v_and_b32 v19, 0xffff0000, v5
v_cvt_pk_f16_f32 v44, v18, v19
v_cndmask_b32 v44, v5, v44, s[28:29]
ds_write_b32 v45, v44 offset:1024
v_sub_f32 v20, v20, v40
v_sub_f32 v21, v21, v40
v_cvt_pk_bf16_f32 v44, v20, v21
v_lshlrev_b32 v20, 16, v44
v_and_b32 v21, 0xffff0000, v44
v_mul_f32 v20, v20, v43
v_mul_f32 v21, v21, v43
v_cvt_pk_bf16_f32 v6, v20, v21
v_lshlrev_b32 v20, 16, v6
v_and_b32 v21, 0xffff0000, v6
v_cvt_pk_f16_f32 v44, v20, v21
v_cndmask_b32 v44, v6, v44, s[28:29]
ds_write_b32 v45, v44 offset:2048
v_sub_f32 v22, v22, v40
v_sub_f32 v23, v23, v40
v_cvt_pk_bf16_f32 v44, v22, v23
v_lshlrev_b32 v22, 16, v44
v_and_b32 v23, 0xffff0000, v44
v_mul_f32 v22, v22, v43
v_mul_f32 v23, v23, v43
v_cvt_pk_bf16_f32 v7, v22, v23
v_lshlrev_b32 v22, 16, v7
v_and_b32 v23, 0xffff0000, v7
v_cvt_pk_f16_f32 v44, v22, v23
v_cndmask_b32 v44, v7, v44, s[28:29]
ds_write_b32 v45, v44 offset:3072
v_sub_f32 v24, v24, v40
v_sub_f32 v25, v25, v40
v_cvt_pk_bf16_f32 v44, v24, v25
v_lshlrev_b32 v24, 16, v44
v_and_b32 v25, 0xffff0000, v44
v_mul_f32 v24, v24, v43
v_mul_f32 v25, v25, v43
v_cvt_pk_bf16_f32 v8, v24, v25
v_lshlrev_b32 v24, 16, v8
v_and_b32 v25, 0xffff0000, v8
v_cvt_pk_f16_f32 v44, v24, v25
v_cndmask_b32 v44, v8, v44, s[28:29]
ds_write_b32 v45, v44 offset:4096
v_sub_f32 v26, v26, v40
v_sub_f32 v27, v27, v40
v_cvt_pk_bf16_f32 v44, v26, v27
v_lshlrev_b32 v26, 16, v44
v_and_b32 v27, 0xffff0000, v44
v_mul_f32 v26, v26, v43
v_mul_f32 v27, v27, v43
v_cvt_pk_bf16_f32 v9, v26, v27
v_lshlrev_b32 v26, 16, v9
v_and_b32 v27, 0xffff0000, v9
v_cvt_pk_f16_f32 v44, v26, v27
v_cndmask_b32 v44, v9, v44, s[28:29]
ds_write_b32 v45, v44 offset:5120
v_sub_f32 v28, v28, v40
v_sub_f32 v29, v29, v40
v_cvt_pk_bf16_f32 v44, v28, v29
v_lshlrev_b32 v28, 16, v44
v_and_b32 v29, 0xffff0000, v44
v_mul_f32 v28, v28, v43
v_mul_f32 v29, v29, v43
v_cvt_pk_bf16_f32 v10, v28, v29
v_lshlrev_b32 v28, 16, v10
v_and_b32 v29, 0xffff0000, v10
v_cvt_pk_f16_f32 v44, v28, v29
v_cndmask_b32 v44, v10, v44, s[28:29]
ds_write_b32 v45, v44 offset:6144
v_sub_f32 v30, v30, v40
v_sub_f32 v31, v31, v40
v_cvt_pk_bf16_f32 v44, v30, v31
v_lshlrev_b32 v30, 16, v44
v_and_b32 v31, 0xffff0000, v44
v_mul_f32 v30, v30, v43
v_mul_f32 v31, v31, v43
v_cvt_pk_bf16_f32 v11, v30, v31
v_lshlrev_b32 v30, 16, v11
v_and_b32 v31, 0xffff0000, v11
v_cvt_pk_f16_f32 v44, v30, v31
v_cndmask_b32 v44, v11, v44, s[28:29]
ds_write_b32 v45, v44 offset:7168
v_sub_f32 v32, v32, v40
v_sub_f32 v33, v33, v40
v_cvt_pk_bf16_f32 v44, v32, v33
v_lshlrev_b32 v32, 16, v44
v_and_b32 v33, 0xffff0000, v44
v_mul_f32 v32, v32, v43
v_mul_f32 v33, v33, v43
v_cvt_pk_bf16_f32 v12, v32, v33
v_lshlrev_b32 v32, 16, v12
v_and_b32 v33, 0xffff0000, v12
v_cvt_pk_f16_f32 v44, v32, v33
v_cndmask_b32 v44, v12, v44, s[28:29]
ds_write_b32 v45, v44 offset:8192
v_add_u32 v45, 9216, v45
s_mov_b64 s[28:29], 0
s_add_u32 s20, s20, 1
s_cmp_lt_u32 s20, 2
s_cbranch_scc1 LN_loop_1
s_waitcnt lgkmcnt(0)
s_barrier
ds_read_b128 v[4:7], v47 offset:0
ds_read_b128 v[8:11], v47 offset:4096
ds_read_b128 v[12:15], v47 offset:8192
ds_read_b128 v[16:19], v47 offset:9216
ds_read_b128 v[20:23], v47 offset:13312
ds_read_b128 v[24:27], v47 offset:17408
s_add_u32 s27, s26, 0
s_waitcnt lgkmcnt(5)
buffer_store_dwordx4 v[4:7], v48, s[12:15], s27 offen sc1
s_add_u32 s27, s26, 8192
s_waitcnt lgkmcnt(4)
buffer_store_dwordx4 v[8:11], v48, s[12:15], s27 offen sc1
s_add_u32 s27, s26, 16384
s_waitcnt lgkmcnt(3)
buffer_store_dwordx4 v[12:15], v49, s[12:15], s27 offen sc1
s_add_u32 s27, s26, 4194304
s_waitcnt lgkmcnt(2)
buffer_store_dwordx4 v[16:19], v48, s[12:15], s27 offen sc1
s_add_u32 s27, s26, 4202496
s_waitcnt lgkmcnt(1)
buffer_store_dwordx4 v[20:23], v48, s[12:15], s27 offen sc1
s_add_u32 s27, s26, 4210688
s_waitcnt lgkmcnt(0)
buffer_store_dwordx4 v[24:27], v49, s[12:15], s27 offen sc1
s_endpgm
K0_pf:
s_sub_u32 s3, s2, 256
s_cmp_ge_u32 s3, 64
s_cbranch_scc1 K0_code
s_load_dwordx2 s[4:5], s[0:1], 8
s_load_dwordx2 s[6:7], s[0:1], 16
s_load_dwordx2 s[16:17], s[0:1], 80
s_and_b32 s31, s3, 31
s_lshr_b32 s32, s3, 5
v_lshrrev_b32 v1, 6, v0
v_and_b32 v2, 63, v0
v_readfirstlane_b32 s24, v1
v_lshlrev_b32 v3, 4, v2
s_mul_i32 s25, s31, 36992
s_lshl_b32 s26, s24, 10
s_add_u32 s25, s25, s26
s_waitcnt lgkmcnt(0)
s_mov_b32 s8, s4
s_and_b32 s9, s5, 0xffff
s_mov_b32 s10, 1183744
s_mov_b32 s11, 0x00020000
s_mov_b32 s12, s6
s_and_b32 s13, s7, 0xffff
s_mov_b32 s14, 1183744
s_mov_b32 s15, 0x00020000
s_mov_b32 s20, s16
s_and_b32 s21, s17, 0xffff
s_mov_b32 s22, 10756096
s_mov_b32 s23, 0x00020000
s_add_u32 s27, s26, 0
s_mov_b32 m0, s27
s_add_u32 s28, s25, 0
buffer_load_dwordx4 v3, s[8:11], s28 offen lds
s_add_u32 s27, s27, 37888
s_mov_b32 m0, s27
s_nop 0
buffer_load_dwordx4 v3, s[12:15], s28 offen lds
s_add_u32 s27, s26, 4096
s_mov_b32 m0, s27
s_add_u32 s28, s25, 4096
buffer_load_dwordx4 v3, s[8:11], s28 offen lds
s_add_u32 s27, s27, 37888
s_mov_b32 m0, s27
s_nop 0
buffer_load_dwordx4 v3, s[12:15], s28 offen lds
s_add_u32 s27, s26, 8192
s_mov_b32 m0, s27
s_add_u32 s28, s25, 8192
buffer_load_dwordx4 v3, s[8:11], s28 offen lds
s_add_u32 s27, s27, 37888
s_mov_b32 m0, s27
s_nop 0
buffer_load_dwordx4 v3, s[12:15], s28 offen lds
s_add_u32 s27, s26, 12288
s_mov_b32 m0, s27
s_add_u32 s28, s25, 12288
buffer_load_dwordx4 v3, s[8:11], s28 offen lds
s_add_u32 s27, s27, 37888
s_mov_b32 m0, s27
s_nop 0
buffer_load_dwordx4 v3, s[12:15], s28 offen lds
s_add_u32 s27, s26, 16384
s_mov_b32 m0, s27
s_add_u32 s28, s25, 16384
buffer_load_dwordx4 v3, s[8:11], s28 offen lds
s_add_u32 s27, s27, 37888
s_mov_b32 m0, s27
s_nop 0
buffer_load_dwordx4 v3, s[12:15], s28 offen lds
s_add_u32 s27, s26, 20480
s_mov_b32 m0, s27
s_add_u32 s28, s25, 20480
buffer_load_dwordx4 v3, s[8:11], s28 offen lds
s_add_u32 s27, s27, 37888
s_mov_b32 m0, s27
s_nop 0
buffer_load_dwordx4 v3, s[12:15], s28 offen lds
s_add_u32 s27, s26, 24576
s_mov_b32 m0, s27
s_add_u32 s28, s25, 24576
buffer_load_dwordx4 v3, s[8:11], s28 offen lds
s_add_u32 s27, s27, 37888
s_mov_b32 m0, s27
s_nop 0
buffer_load_dwordx4 v3, s[12:15], s28 offen lds
s_add_u32 s27, s26, 28672
s_mov_b32 m0, s27
s_add_u32 s28, s25, 28672
buffer_load_dwordx4 v3, s[8:11], s28 offen lds
s_add_u32 s27, s27, 37888
s_mov_b32 m0, s27
s_nop 0
buffer_load_dwordx4 v3, s[12:15], s28 offen lds
s_add_u32 s27, s26, 32768
s_mov_b32 m0, s27
s_add_u32 s28, s25, 32768
buffer_load_dwordx4 v3, s[8:11], s28 offen lds
s_add_u32 s27, s27, 37888
s_mov_b32 m0, s27
s_nop 0
buffer_load_dwordx4 v3, s[12:15], s28 offen lds
s_cmp_lg_u32 s24, 0
s_cbranch_scc1 WT_skip_11
s_add_u32 s27, s26, 36864
s_mov_b32 m0, s27
s_add_u32 s28, s25, 36864
buffer_load_dwordx4 v3, s[8:11], s28 offen lds
s_add_u32 s27, s27, 37888
s_mov_b32 m0, s27
s_nop 0
buffer_load_dwordx4 v3, s[12:15], s28 offen lds
WT_skip_11:
v_mul_u32_u24 v4, 578, v2
s_mul_i32 s27, s32, 160
s_mul_i32 s28, s24, 40
s_add_u32 s30, s27, s28
s_lshl_b32 s27, s30, 1
v_add_u32 v4, s27, v4
v_and_b32 v5, 1, v2
v_lshrrev_b32 v6, 1, v2
v_lshlrev_b32 v5, 12, v5
v_lshl_add_u32 v5, v6, 2, v5
s_lshr_b32 s28, s31, 3
s_lshl_b32 s28, s28, 2
s_and_b32 s29, s31, 3
s_add_u32 s28, s28, s29
s_lshl_b32 s28, s28, 8
s_lshr_b32 s29, s31, 2
s_and_b32 s29, s29, 1
s_lshl_b32 s29, s29, 7
s_add_u32 s28, s28, s29
s_lshl_b32 s29, s30, 13
s_add_u32 s28, s28, s29
s_add_u32 s28, s28, 8388608
s_mov_b32 s30, 0
v_mov_b32 v24, 0
s_waitcnt vmcnt(0)
s_barrier
WT_loop_12:
ds_read_u16 v8, v4 offset:0
ds_read_u16 v9, v4 offset:37888
ds_read_u16 v10, v4 offset:2
ds_read_u16 v11, v4 offset:37890
ds_read_u16 v12, v4 offset:4
ds_read_u16 v13, v4 offset:37892
ds_read_u16 v14, v4 offset:6
ds_read_u16 v15, v4 offset:37894
s_waitcnt lgkmcnt(6)
v_lshl_or_b32 v16, v9, 16, v8
buffer_store_dword v16, v5, s[20:23], s28 offen
v_and_b32 v25, 0x7fff7fff, v16
v_pk_max_u16 v24, v24, v25
s_add_u32 s28, s28, 8192
s_waitcnt lgkmcnt(4)
v_lshl_or_b32 v17, v11, 16, v10
buffer_store_dword v17, v5, s[20:23], s28 offen
v_and_b32 v25, 0x7fff7fff, v17
v_pk_max_u16 v24, v24, v25
s_add_u32 s28, s28, 8192
s_waitcnt lgkmcnt(2)
v_lshl_or_b32 v18, v13, 16, v12
buffer_store_dword v18, v5, s[20:23], s28 offen
v_and_b32 v25, 0x7fff7fff, v18
v_pk_max_u16 v24, v24, v25
s_add_u32 s28, s28, 8192
s_waitcnt lgkmcnt(0)
v_lshl_or_b32 v19, v15, 16, v14
buffer_store_dword v19, v5, s[20:23], s28 offen
v_and_b32 v25, 0x7fff7fff, v19
v_pk_max_u16 v24, v24, v25
s_add_u32 s28, s28, 8192
v_add_u32 v4, 8, v4
s_add_u32 s30, s30, 1
s_cmp_lt_u32 s30, 10
s_cbranch_scc1 WT_loop_12
v_lshrrev_b32 v25, 16, v24
v_and_b32 v24, 0xffff, v24
v_max_u32 v24, v24, v25
s_nop 1
v_max_u32_dpp v24, v24, v24 row_ror:8 row_mask:0xf bank_mask:0xf
s_nop 1
v_max_u32_dpp v24, v24, v24 row_ror:4 row_mask:0xf bank_mask:0xf
s_nop 1
v_max_u32_dpp v24, v24, v24 row_ror:2 row_mask:0xf bank_mask:0xf
s_nop 1
v_max_u32_dpp v24, v24, v24 row_ror:1 row_mask:0xf bank_mask:0xf
v_mov_b32 v25, v24
s_nop 1
v_permlane16_swap_b32 v24, v25
s_nop 1
v_max_u32 v24, v24, v25
v_mov_b32 v25, v24
s_nop 1
v_permlane32_swap_b32 v24, v25
s_nop 1
v_max_u32 v24, v24, v25
s_mov_b32 s12, s16
s_and_b32 s13, s17, 0xffff
s_mov_b32 s14, 268435456
s_mov_b32 s15, 0x00020000
s_lshl_b32 s27, s3, 2
s_add_u32 s27, s27, s24
s_lshl_b32 s27, s27, 2
s_add_u32 s27, s27, 25231360
v_mov_b32 v25, 0
s_mov_b64 exec, 1
buffer_store_dword v24, v25, s[12:15], s27 offen
s_endpgm
K0_code:
s_cmp_ge_u32 s2, 328
s_cbranch_scc1 K0_st
s_cmp_lg_u32 s2, 320
s_cbranch_scc1 K0_end
s_getpc_b64 s[4:5]
s_add_u32 s4, s4, k1_kernel@rel32@lo+4
s_addc_u32 s5, s5, k1_kernel@rel32@hi+12
v_lshlrev_b32 v2, 6, v0
global_load_dword v1, v2, s[4:5]
v_add_u32 v2, 16384, v2
global_load_dword v1, v2, s[4:5]
v_add_u32 v2, 16384, v2
global_load_dword v1, v2, s[4:5]
v_add_u32 v2, 16384, v2
global_load_dword v1, v2, s[4:5]
s_endpgm
K0_st:
s_sub_u32 s3, s2, 328
s_cmp_ge_u32 s3, 184
s_cbranch_scc1 K0_end
v_lshlrev_b32 v1, 4, v0
s_load_dwordx2 s[4:5], s[0:1], 32
s_waitcnt lgkmcnt(0)
s_mov_b32 s8, s4
s_and_b32 s9, s5, 0xffff
s_mov_b32 s10, 5308416
s_mov_b32 s11, 0x00020000
s_mul_i32 s12, s3, 32768
buffer_load_dwordx4 v[8:11], v1, s[8:11], s12 offen
s_add_u32 s12, s12, 4096
buffer_load_dwordx4 v[12:15], v1, s[8:11], s12 offen
s_add_u32 s12, s12, 4096
buffer_load_dwordx4 v[16:19], v1, s[8:11], s12 offen
s_add_u32 s12, s12, 4096
buffer_load_dwordx4 v[20:23], v1, s[8:11], s12 offen
s_add_u32 s12, s12, 4096
buffer_load_dwordx4 v[24:27], v1, s[8:11], s12 offen
s_add_u32 s12, s12, 4096
buffer_load_dwordx4 v[28:31], v1, s[8:11], s12 offen
s_add_u32 s12, s12, 4096
buffer_load_dwordx4 v[32:35], v1, s[8:11], s12 offen
s_add_u32 s12, s12, 4096
buffer_load_dwordx4 v[36:39], v1, s[8:11], s12 offen
s_add_u32 s12, s12, 4096
s_getpc_b64 s[4:5]
s_add_u32 s4, s4, tab_tf@rel32@lo+4
s_addc_u32 s5, s5, tab_tf@rel32@hi+12
s_mov_b32 s8, s4
s_and_b32 s9, s5, 0xffff
s_mov_b32 s10, 331776
s_mov_b32 s11, 0x00020000
s_mul_i32 s12, s3, 4096
buffer_load_dwordx4 v[40:43], v1, s[8:11], s12 offen
s_add_u32 s12, s12, 4096
s_load_dwordx2 s[4:5], s[0:1], 40
s_waitcnt lgkmcnt(0)
s_mov_b32 s8, s4
s_and_b32 s9, s5, 0xffff
s_mov_b32 s10, 9216
s_mov_b32 s11, 0x00020000
s_mul_i32 s12, s3, 4096
buffer_load_dwordx4 v[44:47], v1, s[8:11], s12 offen
s_add_u32 s12, s12, 4096
s_load_dwordx2 s[4:5], s[0:1], 48
s_waitcnt lgkmcnt(0)
s_mov_b32 s8, s4
s_and_b32 s9, s5, 0xffff
s_mov_b32 s10, 5308416
s_mov_b32 s11, 0x00020000
s_mul_i32 s12, s3, 32768
buffer_load_dwordx4 v[48:51], v1, s[8:11], s12 offen
s_add_u32 s12, s12, 4096
buffer_load_dwordx4 v[52:55], v1, s[8:11], s12 offen
s_add_u32 s12, s12, 4096
buffer_load_dwordx4 v[56:59], v1, s[8:11], s12 offen
s_add_u32 s12, s12, 4096
buffer_load_dwordx4 v[8:11], v1, s[8:11], s12 offen
s_add_u32 s12, s12, 4096
buffer_load_dwordx4 v[12:15], v1, s[8:11], s12 offen
s_add_u32 s12, s12, 4096
buffer_load_dwordx4 v[16:19], v1, s[8:11], s12 offen
s_add_u32 s12, s12, 4096
buffer_load_dwordx4 v[20:23], v1, s[8:11], s12 offen
s_add_u32 s12, s12, 4096
buffer_load_dwordx4 v[24:27], v1, s[8:11], s12 offen
s_add_u32 s12, s12, 4096
s_getpc_b64 s[4:5]
s_add_u32 s4, s4, tab_ti@rel32@lo+4
s_addc_u32 s5, s5, tab_ti@rel32@hi+12
s_mov_b32 s8, s4
s_and_b32 s9, s5, 0xffff
s_mov_b32 s10, 331776
s_mov_b32 s11, 0x00020000
s_mul_i32 s12, s3, 4096
buffer_load_dwordx4 v[28:31], v1, s[8:11], s12 offen
s_add_u32 s12, s12, 4096
s_getpc_b64 s[4:5]
s_add_u32 s4, s4, tab_cf@rel32@lo+4
s_addc_u32 s5, s5, tab_cf@rel32@hi+12
s_mov_b32 s8, s4
s_and_b32 s9, s5, 0xffff
s_mov_b32 s10, 73728
s_mov_b32 s11, 0x00020000
s_mul_i32 s12, s3, 4096
buffer_load_dwordx4 v[32:35], v1, s[8:11], s12 offen
s_add_u32 s12, s12, 4096
s_load_dwordx2 s[4:5], s[0:1], 56
s_waitcnt lgkmcnt(0)
s_mov_b32 s8, s4
s_and_b32 s9, s5, 0xffff
s_mov_b32 s10, 1152
s_mov_b32 s11, 0x00020000
s_mul_i32 s12, s3, 4096
buffer_load_dwordx4 v[36:39], v1, s[8:11], s12 offen
s_add_u32 s12, s12, 4096
K0_end:
s_endpgm
.globl k1_kernel
.p2align 8
.type k1_kernel,@function
k1_kernel:
s_cmp_ge_u32 s2, 256
s_cbranch_scc1 K1_b
s_load_dwordx2 s[4:5], s[0:1], 32
s_load_dwordx2 s[6:7], s[0:1], 80
s_load_dwordx2 s[16:17], s[0:1], 40
v_lshrrev_b32 v224, 6, v0
v_and_b32 v252, 63, v0
v_readfirstlane_b32 s24, v224
s_and_b32 s25, s2, 7
s_lshr_b32 s26, s2, 3
s_and_b32 s27, s25, 1
s_lshl_b32 s27, s27, 2
s_and_b32 s28, s26, 3
s_add_u32 s27, s27, s28
s_lshr_b32 s28, s25, 1
s_lshl_b32 s28, s28, 3
s_lshr_b32 s29, s26, 2
s_add_u32 s28, s28, s29
s_setprio 2
s_lshl_b32 s35, s24, 6
v_add_u32 v224, s35, v252
v_mul_u32_u24 v225, 3641, v224
v_lshrrev_b32 v225, 16, v225
v_mul_u32_u24 v226, 18, v225
v_sub_u32 v224, v224, v226
v_lshrrev_b32 v226, 1, v225
v_xor_b32 v226, v226, v225
v_and_b32 v226, 4, v226
v_mul_u32_u24 v226, 3, v226
v_xor_b32 v225, v225, v226
v_mul_u32_u24 v225, 9216, v225
v_lshl_add_u32 v245, v224, 4, v225
v_add_u32 v224, s35, v252
v_add_u32 v224, 256, v224
v_mul_u32_u24 v225, 3641, v224
v_lshrrev_b32 v225, 16, v225
v_mul_u32_u24 v226, 18, v225
v_sub_u32 v224, v224, v226
v_lshrrev_b32 v226, 1, v225
v_xor_b32 v226, v226, v225
v_and_b32 v226, 4, v226
v_mul_u32_u24 v226, 3, v226
v_xor_b32 v225, v225, v226
v_mul_u32_u24 v225, 9216, v225
v_lshl_add_u32 v246, v224, 4, v225
v_add_u32 v224, s35, v252
v_add_u32 v224, 512, v224
v_mul_u32_u24 v225, 3641, v224
v_lshrrev_b32 v225, 16, v225
v_mul_u32_u24 v226, 18, v225
v_sub_u32 v224, v224, v226
v_lshrrev_b32 v226, 1, v225
v_xor_b32 v226, v226, v225
v_and_b32 v226, 4, v226
v_mul_u32_u24 v226, 3, v226
v_xor_b32 v225, v225, v226
v_mul_u32_u24 v225, 9216, v225
v_lshl_add_u32 v247, v224, 4, v225
v_add_u32 v224, s35, v252
v_add_u32 v224, 768, v224
v_mul_u32_u24 v225, 3641, v224
v_lshrrev_b32 v225, 16, v225
v_mul_u32_u24 v226, 18, v225
v_sub_u32 v224, v224, v226
v_lshrrev_b32 v226, 1, v225
v_xor_b32 v226, v226, v225
v_and_b32 v226, 4, v226
v_mul_u32_u24 v226, 3, v226
v_xor_b32 v225, v225, v226
v_mul_u32_u24 v225, 9216, v225
v_lshl_add_u32 v248, v224, 4, v225
v_add_u32 v224, s35, v252
v_add_u32 v224, 1024, v224
v_mul_u32_u24 v225, 3641, v224
v_lshrrev_b32 v225, 16, v225
v_mul_u32_u24 v226, 18, v225
v_sub_u32 v224, v224, v226
v_lshrrev_b32 v226, 1, v225
v_xor_b32 v226, v226, v225
v_and_b32 v226, 4, v226
v_mul_u32_u24 v226, 3, v226
v_xor_b32 v225, v225, v226
v_mul_u32_u24 v225, 9216, v225
v_lshl_add_u32 v249, v224, 4, v225
s_lshl_b32 s34, s24, 10
v_lshrrev_b32 v224, 2, v252
v_and_b32 v225, 8, v224
v_add_u32 v224, v224, v225
v_mul_u32_u24 v224, 288, v224
v_and_b32 v225, 3, v252
v_lshl_add_u32 v250, v225, 3, v224
v_add_u32 v251, 36864, v250
s_lshl_b32 s30, s27, 3
s_mul_i32 s29, s24, 2
s_add_u32 s30, s30, s29
s_mul_i32 s40, s30, 18432
s_add_u32 s40, s40, 4194304
s_add_u32 s41, s40, 1179648
s_add_u32 s42, s40, 18432
s_add_u32 s43, s40, 1198080
v_lshlrev_b32 v244, 4, v252
s_mul_i32 s32, s28, 288
v_lshrrev_b32 v253, 4, v252
v_lshlrev_b32 v253, 3, v253
s_waitcnt lgkmcnt(0)
s_mov_b32 s8, s4
s_and_b32 s9, s5, 0xffff
s_mov_b32 s10, 5308416
s_mov_b32 s11, 0x00020000
s_mov_b32 s12, s6
s_and_b32 s13, s7, 0xffff
s_mov_b32 s14, 268435456
s_mov_b32 s15, 0x00020000
s_mov_b32 s20, s16
s_and_b32 s21, s17, 0xffff
s_mov_b32 s22, 9216
s_mov_b32 s23, 0x00020000
s_add_u32 s33, s32, 0
s_cmp_ge_u32 s24, 2
s_cbranch_scc1 dsk_13
s_add_u32 m0, s34, 16384
s_nop 0
buffer_load_dwordx4 v249, s[8:11], s33 offen lds
dsk_13:
s_add_u32 m0, s34, 0
s_nop 0
buffer_load_dwordx4 v245, s[8:11], s33 offen lds
s_add_u32 m0, s34, 4096
s_nop 0
buffer_load_dwordx4 v246, s[8:11], s33 offen lds
s_add_u32 m0, s34, 8192
s_nop 0
buffer_load_dwordx4 v247, s[8:11], s33 offen lds
s_add_u32 m0, s34, 12288
s_nop 0
buffer_load_dwordx4 v248, s[8:11], s33 offen lds
buffer_load_dwordx2 v[72:73], v253, s[20:23], s32 offen offset:0
buffer_load_dwordx2 v[76:77], v253, s[20:23], s32 offen offset:32
buffer_load_dwordx2 v[80:81], v253, s[20:23], s32 offen offset:64
buffer_load_dwordx2 v[84:85], v253, s[20:23], s32 offen offset:96
buffer_load_dwordx2 v[88:89], v253, s[20:23], s32 offen offset:128
buffer_load_dwordx2 v[92:93], v253, s[20:23], s32 offen offset:160
buffer_load_dwordx2 v[96:97], v253, s[20:23], s32 offen offset:192
buffer_load_dwordx2 v[100:101], v253, s[20:23], s32 offen offset:224
buffer_load_dwordx2 v[104:105], v253, s[20:23], s32 offen offset:256
buffer_load_dwordx4 v[144:147], v244, s[12:15], s40 offen offset:0
buffer_load_dwordx4 v[148:151], v244, s[12:15], s41 offen offset:0
buffer_load_dwordx4 v[152:155], v244, s[12:15], s42 offen offset:0
buffer_load_dwordx4 v[156:159], v244, s[12:15], s43 offen offset:0
buffer_load_dwordx4 v[160:163], v244, s[12:15], s40 offen offset:1024
buffer_load_dwordx4 v[164:167], v244, s[12:15], s41 offen offset:1024
buffer_load_dwordx4 v[168:171], v244, s[12:15], s42 offen offset:1024
buffer_load_dwordx4 v[172:175], v244, s[12:15], s43 offen offset:1024
s_add_u32 s33, s32, 589824
s_cmp_ge_u32 s24, 2
s_cbranch_scc1 dsk_14
s_add_u32 m0, s34, 34816
s_nop 0
buffer_load_dwordx4 v249, s[8:11], s33 offen lds
dsk_14:
s_add_u32 m0, s34, 18432
s_nop 0
buffer_load_dwordx4 v245, s[8:11], s33 offen lds
s_add_u32 m0, s34, 22528
s_nop 0
buffer_load_dwordx4 v246, s[8:11], s33 offen lds
s_add_u32 m0, s34, 26624
s_nop 0
buffer_load_dwordx4 v247, s[8:11], s33 offen lds
s_add_u32 m0, s34, 30720
s_nop 0
buffer_load_dwordx4 v248, s[8:11], s33 offen lds
s_waitcnt vmcnt(12)
v_lshlrev_b32 v108, 16, v72
v_and_b32 v109, 0xffff0000, v72
v_lshlrev_b32 v110, 16, v73
v_and_b32 v111, 0xffff0000, v73
v_lshlrev_b32 v112, 16, v76
v_and_b32 v113, 0xffff0000, v76
v_lshlrev_b32 v114, 16, v77
v_and_b32 v115, 0xffff0000, v77
v_lshlrev_b32 v116, 16, v80
v_and_b32 v117, 0xffff0000, v80
v_lshlrev_b32 v118, 16, v81
v_and_b32 v119, 0xffff0000, v81
v_lshlrev_b32 v120, 16, v84
v_and_b32 v121, 0xffff0000, v84
v_lshlrev_b32 v122, 16, v85
v_and_b32 v123, 0xffff0000, v85
v_lshlrev_b32 v124, 16, v88
v_and_b32 v125, 0xffff0000, v88
v_lshlrev_b32 v126, 16, v89
v_and_b32 v127, 0xffff0000, v89
v_lshlrev_b32 v128, 16, v92
v_and_b32 v129, 0xffff0000, v92
v_lshlrev_b32 v130, 16, v93
v_and_b32 v131, 0xffff0000, v93
v_lshlrev_b32 v132, 16, v96
v_and_b32 v133, 0xffff0000, v96
v_lshlrev_b32 v134, 16, v97
v_and_b32 v135, 0xffff0000, v97
v_lshlrev_b32 v136, 16, v100
v_and_b32 v137, 0xffff0000, v100
v_lshlrev_b32 v138, 16, v101
v_and_b32 v139, 0xffff0000, v101
v_lshlrev_b32 v140, 16, v104
v_and_b32 v141, 0xffff0000, v104
v_lshlrev_b32 v142, 16, v105
v_and_b32 v143, 0xffff0000, v105
s_barrier
ds_read_b64_tr_b16 v[224:225], v250 offset:0
ds_read_b64_tr_b16 v[226:227], v250 offset:2304
ds_read_b64_tr_b16 v[228:229], v250 offset:32
ds_read_b64_tr_b16 v[230:231], v250 offset:2336
ds_read_b64_tr_b16 v[232:233], v250 offset:64
ds_read_b64_tr_b16 v[234:235], v250 offset:2368
ds_read_b64_tr_b16 v[236:237], v250 offset:96
ds_read_b64_tr_b16 v[238:239], v250 offset:2400
s_waitcnt vmcnt(8)
s_waitcnt lgkmcnt(6)
v_mfma_f32_16x16x32_bf16 v[0:3], v[224:227], v[144:147], v[108:111]
v_mfma_f32_16x16x32_bf16 v[36:39], v[224:227], v[148:151], v[108:111]
buffer_load_dwordx4 v[176:179], v244, s[12:15], s40 offen offset:2048
v_mfma_f32_16x16x32_bf16 v[72:75], v[224:227], v[152:155], v[108:111]
v_mfma_f32_16x16x32_bf16 v[108:111], v[224:227], v[156:159], v[108:111]
buffer_load_dwordx4 v[180:183], v244, s[12:15], s41 offen offset:2048
ds_read_b64_tr_b16 v[240:241], v250 offset:128
ds_read_b64_tr_b16 v[242:243], v250 offset:2432
s_waitcnt lgkmcnt(6)
v_mfma_f32_16x16x32_bf16 v[4:7], v[228:231], v[144:147], v[112:115]
v_mfma_f32_16x16x32_bf16 v[40:43], v[228:231], v[148:151], v[112:115]
buffer_load_dwordx4 v[184:187], v244, s[12:15], s42 offen offset:2048
v_mfma_f32_16x16x32_bf16 v[76:79], v[228:231], v[152:155], v[112:115]
v_mfma_f32_16x16x32_bf16 v[112:115], v[228:231], v[156:159], v[112:115]
buffer_load_dwordx4 v[188:191], v244, s[12:15], s43 offen offset:2048
ds_read_b64_tr_b16 v[224:225], v250 offset:160
ds_read_b64_tr_b16 v[226:227], v250 offset:2464
s_waitcnt lgkmcnt(6)
v_mfma_f32_16x16x32_bf16 v[8:11], v[232:235], v[144:147], v[116:119]
v_mfma_f32_16x16x32_bf16 v[44:47], v[232:235], v[148:151], v[116:119]
s_add_u32 s33, s32, 1179648
s_cmp_ge_u32 s24, 2
s_cbranch_scc1 dsk_15
s_add_u32 m0, s34, 53248
s_nop 0
buffer_load_dwordx4 v249, s[8:11], s33 offen lds
dsk_15:
v_mfma_f32_16x16x32_bf16 v[80:83], v[232:235], v[152:155], v[116:119]
v_mfma_f32_16x16x32_bf16 v[116:119], v[232:235], v[156:159], v[116:119]
s_add_u32 m0, s34, 36864
s_nop 0
buffer_load_dwordx4 v245, s[8:11], s33 offen lds
ds_read_b64_tr_b16 v[228:229], v250 offset:192
ds_read_b64_tr_b16 v[230:231], v250 offset:2496
s_waitcnt lgkmcnt(6)
v_mfma_f32_16x16x32_bf16 v[12:15], v[236:239], v[144:147], v[120:123]
v_mfma_f32_16x16x32_bf16 v[48:51], v[236:239], v[148:151], v[120:123]
s_add_u32 m0, s34, 40960
s_nop 0
buffer_load_dwordx4 v246, s[8:11], s33 offen lds
v_mfma_f32_16x16x32_bf16 v[84:87], v[236:239], v[152:155], v[120:123]
v_mfma_f32_16x16x32_bf16 v[120:123], v[236:239], v[156:159], v[120:123]
s_add_u32 m0, s34, 45056
s_nop 0
buffer_load_dwordx4 v247, s[8:11], s33 offen lds
ds_read_b64_tr_b16 v[232:233], v250 offset:224
ds_read_b64_tr_b16 v[234:235], v250 offset:2528
s_waitcnt lgkmcnt(6)
v_mfma_f32_16x16x32_bf16 v[16:19], v[240:243], v[144:147], v[124:127]
v_mfma_f32_16x16x32_bf16 v[52:55], v[240:243], v[148:151], v[124:127]
s_add_u32 m0, s34, 49152
s_nop 0
buffer_load_dwordx4 v248, s[8:11], s33 offen lds
v_mfma_f32_16x16x32_bf16 v[88:91], v[240:243], v[152:155], v[124:127]
v_mfma_f32_16x16x32_bf16 v[124:127], v[240:243], v[156:159], v[124:127]
buffer_load_dwordx4 v[192:195], v244, s[12:15], s40 offen offset:3072
s_add_u32 s40, s40, 4096
ds_read_b64_tr_b16 v[236:237], v250 offset:256
ds_read_b64_tr_b16 v[238:239], v250 offset:2560
s_waitcnt lgkmcnt(6)
v_mfma_f32_16x16x32_bf16 v[20:23], v[224:227], v[144:147], v[128:131]
v_mfma_f32_16x16x32_bf16 v[56:59], v[224:227], v[148:151], v[128:131]
buffer_load_dwordx4 v[196:199], v244, s[12:15], s41 offen offset:3072
s_add_u32 s41, s41, 4096
v_mfma_f32_16x16x32_bf16 v[92:95], v[224:227], v[152:155], v[128:131]
v_mfma_f32_16x16x32_bf16 v[128:131], v[224:227], v[156:159], v[128:131]
buffer_load_dwordx4 v[200:203], v244, s[12:15], s42 offen offset:3072
s_add_u32 s42, s42, 4096
ds_read_b64_tr_b16 v[240:241], v250 offset:9216
ds_read_b64_tr_b16 v[242:243], v250 offset:11520
s_waitcnt lgkmcnt(6)
v_mfma_f32_16x16x32_bf16 v[24:27], v[228:231], v[144:147], v[132:135]
v_mfma_f32_16x16x32_bf16 v[60:63], v[228:231], v[148:151], v[132:135]
buffer_load_dwordx4 v[204:207], v244, s[12:15], s43 offen offset:3072
s_add_u32 s43, s43, 4096
v_mfma_f32_16x16x32_bf16 v[96:99], v[228:231], v[152:155], v[132:135]
v_mfma_f32_16x16x32_bf16 v[132:135], v[228:231], v[156:159], v[132:135]
s_add_u32 s33, s32, 1769472
s_cmp_ge_u32 s24, 2
s_cbranch_scc1 dsk_16
s_add_u32 m0, s34, 71680
s_nop 0
buffer_load_dwordx4 v249, s[8:11], s33 offen lds
dsk_16:
ds_read_b64_tr_b16 v[224:225], v250 offset:9248
ds_read_b64_tr_b16 v[226:227], v250 offset:11552
s_waitcnt lgkmcnt(6)
v_mfma_f32_16x16x32_bf16 v[28:31], v[232:235], v[144:147], v[136:139]
v_mfma_f32_16x16x32_bf16 v[64:67], v[232:235], v[148:151], v[136:139]
s_add_u32 m0, s34, 55296
s_nop 0
buffer_load_dwordx4 v245, s[8:11], s33 offen lds
v_mfma_f32_16x16x32_bf16 v[100:103], v[232:235], v[152:155], v[136:139]
v_mfma_f32_16x16x32_bf16 v[136:139], v[232:235], v[156:159], v[136:139]
s_add_u32 m0, s34, 59392
s_nop 0
buffer_load_dwordx4 v246, s[8:11], s33 offen lds
ds_read_b64_tr_b16 v[228:229], v250 offset:9280
ds_read_b64_tr_b16 v[230:231], v250 offset:11584
s_waitcnt lgkmcnt(6)
v_mfma_f32_16x16x32_bf16 v[32:35], v[236:239], v[144:147], v[140:143]
v_mfma_f32_16x16x32_bf16 v[68:71], v[236:239], v[148:151], v[140:143]
s_add_u32 m0, s34, 63488
s_nop 0
buffer_load_dwordx4 v247, s[8:11], s33 offen lds
v_mfma_f32_16x16x32_bf16 v[104:107], v[236:239], v[152:155], v[140:143]
v_mfma_f32_16x16x32_bf16 v[140:143], v[236:239], v[156:159], v[140:143]
ds_read_b64_tr_b16 v[232:233], v250 offset:9312
ds_read_b64_tr_b16 v[234:235], v250 offset:11616
s_waitcnt vmcnt(19)
s_waitcnt lgkmcnt(6)
v_mfma_f32_16x16x32_bf16 v[0:3], v[240:243], v[160:163], v[0:3]
v_mfma_f32_16x16x32_bf16 v[36:39], v[240:243], v[164:167], v[36:39]
s_add_u32 m0, s34, 67584
s_nop 0
buffer_load_dwordx4 v248, s[8:11], s33 offen lds
v_mfma_f32_16x16x32_bf16 v[72:75], v[240:243], v[168:171], v[72:75]
v_mfma_f32_16x16x32_bf16 v[108:111], v[240:243], v[172:175], v[108:111]
buffer_load_dwordx4 v[208:211], v244, s[12:15], s40 offen offset:0
ds_read_b64_tr_b16 v[236:237], v250 offset:9344
ds_read_b64_tr_b16 v[238:239], v250 offset:11648
s_waitcnt lgkmcnt(6)
v_mfma_f32_16x16x32_bf16 v[4:7], v[224:227], v[160:163], v[4:7]
v_mfma_f32_16x16x32_bf16 v[40:43], v[224:227], v[164:167], v[40:43]
buffer_load_dwordx4 v[212:215], v244, s[12:15], s41 offen offset:0
v_mfma_f32_16x16x32_bf16 v[76:79], v[224:227], v[168:171], v[76:79]
v_mfma_f32_16x16x32_bf16 v[112:115], v[224:227], v[172:175], v[112:115]
ds_read_b64_tr_b16 v[240:241], v250 offset:9376
ds_read_b64_tr_b16 v[242:243], v250 offset:11680
s_waitcnt lgkmcnt(6)
v_mfma_f32_16x16x32_bf16 v[8:11], v[228:231], v[160:163], v[8:11]
v_mfma_f32_16x16x32_bf16 v[44:47], v[228:231], v[164:167], v[44:47]
buffer_load_dwordx4 v[216:219], v244, s[12:15], s42 offen offset:0
v_mfma_f32_16x16x32_bf16 v[80:83], v[228:231], v[168:171], v[80:83]
v_mfma_f32_16x16x32_bf16 v[116:119], v[228:231], v[172:175], v[116:119]
ds_read_b64_tr_b16 v[224:225], v250 offset:9408
ds_read_b64_tr_b16 v[226:227], v250 offset:11712
s_waitcnt lgkmcnt(6)
v_mfma_f32_16x16x32_bf16 v[12:15], v[232:235], v[160:163], v[12:15]
v_mfma_f32_16x16x32_bf16 v[48:51], v[232:235], v[164:167], v[48:51]
buffer_load_dwordx4 v[220:223], v244, s[12:15], s43 offen offset:0
v_mfma_f32_16x16x32_bf16 v[84:87], v[232:235], v[168:171], v[84:87]
v_mfma_f32_16x16x32_bf16 v[120:123], v[232:235], v[172:175], v[120:123]
ds_read_b64_tr_b16 v[228:229], v250 offset:9440
ds_read_b64_tr_b16 v[230:231], v250 offset:11744
s_waitcnt lgkmcnt(6)
v_mfma_f32_16x16x32_bf16 v[16:19], v[236:239], v[160:163], v[16:19]
v_mfma_f32_16x16x32_bf16 v[52:55], v[236:239], v[164:167], v[52:55]
buffer_load_dwordx4 v[144:147], v244, s[12:15], s40 offen offset:1024
v_mfma_f32_16x16x32_bf16 v[88:91], v[236:239], v[168:171], v[88:91]
v_mfma_f32_16x16x32_bf16 v[124:127], v[236:239], v[172:175], v[124:127]
ds_read_b64_tr_b16 v[232:233], v250 offset:9472
ds_read_b64_tr_b16 v[234:235], v250 offset:11776
s_waitcnt lgkmcnt(6)
v_mfma_f32_16x16x32_bf16 v[20:23], v[240:243], v[160:163], v[20:23]
v_mfma_f32_16x16x32_bf16 v[56:59], v[240:243], v[164:167], v[56:59]
buffer_load_dwordx4 v[148:151], v244, s[12:15], s41 offen offset:1024
v_mfma_f32_16x16x32_bf16 v[92:95], v[240:243], v[168:171], v[92:95]
v_mfma_f32_16x16x32_bf16 v[128:131], v[240:243], v[172:175], v[128:131]
s_waitcnt lgkmcnt(4)
v_mfma_f32_16x16x32_bf16 v[24:27], v[224:227], v[160:163], v[24:27]
v_mfma_f32_16x16x32_bf16 v[60:63], v[224:227], v[164:167], v[60:63]
buffer_load_dwordx4 v[152:155], v244, s[12:15], s42 offen offset:1024
v_mfma_f32_16x16x32_bf16 v[96:99], v[224:227], v[168:171], v[96:99]
v_mfma_f32_16x16x32_bf16 v[132:135], v[224:227], v[172:175], v[132:135]
s_waitcnt lgkmcnt(0) vmcnt(23)
s_barrier
ds_read_b64_tr_b16 v[236:237], v250 offset:18432
ds_read_b64_tr_b16 v[238:239], v250 offset:20736
ds_read_b64_tr_b16 v[240:241], v250 offset:18464
ds_read_b64_tr_b16 v[242:243], v250 offset:20768
v_mfma_f32_16x16x32_bf16 v[28:31], v[228:231], v[160:163], v[28:31]
v_mfma_f32_16x16x32_bf16 v[64:67], v[228:231], v[164:167], v[64:67]
buffer_load_dwordx4 v[156:159], v244, s[12:15], s43 offen offset:1024
v_mfma_f32_16x16x32_bf16 v[100:103], v[228:231], v[168:171], v[100:103]
v_mfma_f32_16x16x32_bf16 v[136:139], v[228:231], v[172:175], v[136:139]
ds_read_b64_tr_b16 v[224:225], v250 offset:18496
ds_read_b64_tr_b16 v[226:227], v250 offset:20800
v_mfma_f32_16x16x32_bf16 v[32:35], v[232:235], v[160:163], v[32:35]
v_mfma_f32_16x16x32_bf16 v[68:71], v[232:235], v[164:167], v[68:71]
s_add_u32 s33, s32, 2359296
s_cmp_ge_u32 s24, 2
s_cbranch_scc1 dsk_17
s_add_u32 m0, s34, 16384
s_nop 0
buffer_load_dwordx4 v249, s[8:11], s33 offen lds
dsk_17:
v_mfma_f32_16x16x32_bf16 v[104:107], v[232:235], v[168:171], v[104:107]
v_mfma_f32_16x16x32_bf16 v[140:143], v[232:235], v[172:175], v[140:143]
ds_read_b64_tr_b16 v[228:229], v250 offset:18528
ds_read_b64_tr_b16 v[230:231], v250 offset:20832
s_waitcnt vmcnt(20)
s_waitcnt lgkmcnt(6)
v_mfma_f32_16x16x32_bf16 v[0:3], v[236:239], v[176:179], v[0:3]
v_mfma_f32_16x16x32_bf16 v[36:39], v[236:239], v[180:183], v[36:39]
s_add_u32 m0, s34, 0
s_nop 0
buffer_load_dwordx4 v245, s[8:11], s33 offen lds
v_mfma_f32_16x16x32_bf16 v[72:75], v[236:239], v[184:187], v[72:75]
v_mfma_f32_16x16x32_bf16 v[108:111], v[236:239], v[188:191], v[108:111]
s_add_u32 m0, s34, 4096
s_nop 0
buffer_load_dwordx4 v246, s[8:11], s33 offen lds
ds_read_b64_tr_b16 v[232:233], v250 offset:18560
ds_read_b64_tr_b16 v[234:235], v250 offset:20864
s_waitcnt lgkmcnt(6)
v_mfma_f32_16x16x32_bf16 v[4:7], v[240:243], v[176:179], v[4:7]
v_mfma_f32_16x16x32_bf16 v[40:43], v[240:243], v[180:183], v[40:43]
s_add_u32 m0, s34, 8192
s_nop 0
buffer_load_dwordx4 v247, s[8:11], s33 offen lds
v_mfma_f32_16x16x32_bf16 v[76:79], v[240:243], v[184:187], v[76:79]
v_mfma_f32_16x16x32_bf16 v[112:115], v[240:243], v[188:191], v[112:115]
ds_read_b64_tr_b16 v[236:237], v250 offset:18592
ds_read_b64_tr_b16 v[238:239], v250 offset:20896
s_waitcnt lgkmcnt(6)
v_mfma_f32_16x16x32_bf16 v[8:11], v[224:227], v[176:179], v[8:11]
v_mfma_f32_16x16x32_bf16 v[44:47], v[224:227], v[180:183], v[44:47]
s_add_u32 m0, s34, 12288
s_nop 0
buffer_load_dwordx4 v248, s[8:11], s33 offen lds
v_mfma_f32_16x16x32_bf16 v[80:83], v[224:227], v[184:187], v[80:83]
v_mfma_f32_16x16x32_bf16 v[116:119], v[224:227], v[188:191], v[116:119]
ds_read_b64_tr_b16 v[240:241], v250 offset:18624
ds_read_b64_tr_b16 v[242:243], v250 offset:20928
s_waitcnt lgkmcnt(6)
v_mfma_f32_16x16x32_bf16 v[12:15], v[228:231], v[176:179], v[12:15]
v_mfma_f32_16x16x32_bf16 v[48:51], v[228:231], v[180:183], v[48:51]
buffer_load_dwordx4 v[160:163], v244, s[12:15], s40 offen offset:2048
v_mfma_f32_16x16x32_bf16 v[84:87], v[228:231], v[184:187], v[84:87]
v_mfma_f32_16x16x32_bf16 v[120:123], v[228:231], v[188:191], v[120:123]
ds_read_b64_tr_b16 v[224:225], v250 offset:18656
ds_read_b64_tr_b16 v[226:227], v250 offset:20960
s_waitcnt lgkmcnt(6)
v_mfma_f32_16x16x32_bf16 v[16:19], v[232:235], v[176:179], v[16:19]
v_mfma_f32_16x16x32_bf16 v[52:55], v[232:235], v[180:183], v[52:55]
buffer_load_dwordx4 v[164:167], v244, s[12:15], s41 offen offset:2048
v_mfma_f32_16x16x32_bf16 v[88:91], v[232:235], v[184:187], v[88:91]
v_mfma_f32_16x16x32_bf16 v[124:127], v[232:235], v[188:191], v[124:127]
ds_read_b64_tr_b16 v[228:229], v250 offset:18688
ds_read_b64_tr_b16 v[230:231], v250 offset:20992
s_waitcnt lgkmcnt(6)
v_mfma_f32_16x16x32_bf16 v[20:23], v[236:239], v[176:179], v[20:23]
v_mfma_f32_16x16x32_bf16 v[56:59], v[236:239], v[180:183], v[56:59]
buffer_load_dwordx4 v[168:171], v244, s[12:15], s42 offen offset:2048
v_mfma_f32_16x16x32_bf16 v[92:95], v[236:239], v[184:187], v[92:95]
v_mfma_f32_16x16x32_bf16 v[128:131], v[236:239], v[188:191], v[128:131]
ds_read_b64_tr_b16 v[232:233], v250 offset:27648
ds_read_b64_tr_b16 v[234:235], v250 offset:29952
s_waitcnt lgkmcnt(6)
v_mfma_f32_16x16x32_bf16 v[24:27], v[240:243], v[176:179], v[24:27]
v_mfma_f32_16x16x32_bf16 v[60:63], v[240:243], v[180:183], v[60:63]
buffer_load_dwordx4 v[172:175], v244, s[12:15], s43 offen offset:2048
v_mfma_f32_16x16x32_bf16 v[96:99], v[240:243], v[184:187], v[96:99]
v_mfma_f32_16x16x32_bf16 v[132:135], v[240:243], v[188:191], v[132:135]
ds_read_b64_tr_b16 v[236:237], v250 offset:27680
ds_read_b64_tr_b16 v[238:239], v250 offset:29984
s_waitcnt lgkmcnt(6)
v_mfma_f32_16x16x32_bf16 v[28:31], v[224:227], v[176:179], v[28:31]
v_mfma_f32_16x16x32_bf16 v[64:67], v[224:227], v[180:183], v[64:67]
v_mfma_f32_16x16x32_bf16 v[100:103], v[224:227], v[184:187], v[100:103]
v_mfma_f32_16x16x32_bf16 v[136:139], v[224:227], v[188:191], v[136:139]
ds_read_b64_tr_b16 v[240:241], v250 offset:27712
ds_read_b64_tr_b16 v[242:243], v250 offset:30016
s_waitcnt lgkmcnt(6)
v_mfma_f32_16x16x32_bf16 v[32:35], v[228:231], v[176:179], v[32:35]
v_mfma_f32_16x16x32_bf16 v[68:71], v[228:231], v[180:183], v[68:71]
v_mfma_f32_16x16x32_bf16 v[104:107], v[228:231], v[184:187], v[104:107]
v_mfma_f32_16x16x32_bf16 v[140:143], v[228:231], v[188:191], v[140:143]
ds_read_b64_tr_b16 v[224:225], v250 offset:27744
ds_read_b64_tr_b16 v[226:227], v250 offset:30048
s_waitcnt vmcnt(20)
s_waitcnt lgkmcnt(6)
v_mfma_f32_16x16x32_bf16 v[0:3], v[232:235], v[192:195], v[0:3]
v_mfma_f32_16x16x32_bf16 v[36:39], v[232:235], v[196:199], v[36:39]
buffer_load_dwordx4 v[176:179], v244, s[12:15], s40 offen offset:3072
s_add_u32 s40, s40, 4096
v_mfma_f32_16x16x32_bf16 v[72:75], v[232:235], v[200:203], v[72:75]
v_mfma_f32_16x16x32_bf16 v[108:111], v[232:235], v[204:207], v[108:111]
ds_read_b64_tr_b16 v[228:229], v250 offset:27776
ds_read_b64_tr_b16 v[230:231], v250 offset:30080
s_waitcnt lgkmcnt(6)
v_mfma_f32_16x16x32_bf16 v[4:7], v[236:239], v[192:195], v[4:7]
v_mfma_f32_16x16x32_bf16 v[40:43], v[236:239], v[196:199], v[40:43]
buffer_load_dwordx4 v[180:183], v244, s[12:15], s41 offen offset:3072
s_add_u32 s41, s41, 4096
v_mfma_f32_16x16x32_bf16 v[76:79], v[236:239], v[200:203], v[76:79]
v_mfma_f32_16x16x32_bf16 v[112:115], v[236:239], v[204:207], v[112:115]
ds_read_b64_tr_b16 v[232:233], v250 offset:27808
ds_read_b64_tr_b16 v[234:235], v250 offset:30112
s_waitcnt lgkmcnt(6)
v_mfma_f32_16x16x32_bf16 v[8:11], v[240:243], v[192:195], v[8:11]
v_mfma_f32_16x16x32_bf16 v[44:47], v[240:243], v[196:199], v[44:47]
buffer_load_dwordx4 v[184:187], v244, s[12:15], s42 offen offset:3072
s_add_u32 s42, s42, 4096
v_mfma_f32_16x16x32_bf16 v[80:83], v[240:243], v[200:203], v[80:83]
v_mfma_f32_16x16x32_bf16 v[116:119], v[240:243], v[204:207], v[116:119]
ds_read_b64_tr_b16 v[236:237], v250 offset:27840
ds_read_b64_tr_b16 v[238:239], v250 offset:30144
s_waitcnt lgkmcnt(6)
v_mfma_f32_16x16x32_bf16 v[12:15], v[224:227], v[192:195], v[12:15]
v_mfma_f32_16x16x32_bf16 v[48:51], v[224:227], v[196:199], v[48:51]
buffer_load_dwordx4 v[188:191], v244, s[12:15], s43 offen offset:3072
s_add_u32 s43, s43, 4096
v_mfma_f32_16x16x32_bf16 v[84:87], v[224:227], v[200:203], v[84:87]
v_mfma_f32_16x16x32_bf16 v[120:123], v[224:227], v[204:207], v[120:123]
ds_read_b64_tr_b16 v[240:241], v250 offset:27872
ds_read_b64_tr_b16 v[242:243], v250 offset:30176
s_waitcnt lgkmcnt(6)
v_mfma_f32_16x16x32_bf16 v[16:19], v[228:231], v[192:195], v[16:19]
v_mfma_f32_16x16x32_bf16 v[52:55], v[228:231], v[196:199], v[52:55]
v_mfma_f32_16x16x32_bf16 v[88:91], v[228:231], v[200:203], v[88:91]
v_mfma_f32_16x16x32_bf16 v[124:127], v[228:231], v[204:207], v[124:127]
ds_read_b64_tr_b16 v[224:225], v250 offset:27904
ds_read_b64_tr_b16 v[226:227], v250 offset:30208
s_waitcnt lgkmcnt(6)
v_mfma_f32_16x16x32_bf16 v[20:23], v[232:235], v[192:195], v[20:23]
v_mfma_f32_16x16x32_bf16 v[56:59], v[232:235], v[196:199], v[56:59]
v_mfma_f32_16x16x32_bf16 v[92:95], v[232:235], v[200:203], v[92:95]
v_mfma_f32_16x16x32_bf16 v[128:131], v[232:235], v[204:207], v[128:131]
s_waitcnt lgkmcnt(4)
v_mfma_f32_16x16x32_bf16 v[24:27], v[236:239], v[192:195], v[24:27]
v_mfma_f32_16x16x32_bf16 v[60:63], v[236:239], v[196:199], v[60:63]
v_mfma_f32_16x16x32_bf16 v[96:99], v[236:239], v[200:203], v[96:99]
v_mfma_f32_16x16x32_bf16 v[132:135], v[236:239], v[204:207], v[132:135]
s_waitcnt lgkmcnt(0)
s_barrier
ds_read_b64_tr_b16 v[228:229], v251 offset:0
ds_read_b64_tr_b16 v[230:231], v251 offset:2304
ds_read_b64_tr_b16 v[232:233], v251 offset:32
ds_read_b64_tr_b16 v[234:235], v251 offset:2336
v_mfma_f32_16x16x32_bf16 v[28:31], v[240:243], v[192:195], v[28:31]
v_mfma_f32_16x16x32_bf16 v[64:67], v[240:243], v[196:199], v[64:67]
s_add_u32 s33, s32, 2949120
s_cmp_ge_u32 s24, 2
s_cbranch_scc1 dsk_18
s_add_u32 m0, s34, 34816
s_nop 0
buffer_load_dwordx4 v249, s[8:11], s33 offen lds
dsk_18:
v_mfma_f32_16x16x32_bf16 v[100:103], v[240:243], v[200:203], v[100:103]
v_mfma_f32_16x16x32_bf16 v[136:139], v[240:243], v[204:207], v[136:139]
ds_read_b64_tr_b16 v[236:237], v251 offset:64
ds_read_b64_tr_b16 v[238:239], v251 offset:2368
v_mfma_f32_16x16x32_bf16 v[32:35], v[224:227], v[192:195], v[32:35]
v_mfma_f32_16x16x32_bf16 v[68:71], v[224:227], v[196:199], v[68:71]
s_add_u32 m0, s34, 18432
s_nop 0
buffer_load_dwordx4 v245, s[8:11], s33 offen lds
v_mfma_f32_16x16x32_bf16 v[104:107], v[224:227], v[200:203], v[104:107]
v_mfma_f32_16x16x32_bf16 v[140:143], v[224:227], v[204:207], v[140:143]
ds_read_b64_tr_b16 v[240:241], v251 offset:96
ds_read_b64_tr_b16 v[242:243], v251 offset:2400
s_waitcnt vmcnt(17)
s_waitcnt lgkmcnt(6)
v_mfma_f32_16x16x32_bf16 v[0:3], v[228:231], v[208:211], v[0:3]
v_mfma_f32_16x16x32_bf16 v[36:39], v[228:231], v[212:215], v[36:39]
s_add_u32 m0, s34, 22528
s_nop 0
buffer_load_dwordx4 v246, s[8:11], s33 offen lds
v_mfma_f32_16x16x32_bf16 v[72:75], v[228:231], v[216:219], v[72:75]
v_mfma_f32_16x16x32_bf16 v[108:111], v[228:231], v[220:223], v[108:111]
ds_read_b64_tr_b16 v[224:225], v251 offset:128
ds_read_b64_tr_b16 v[226:227], v251 offset:2432
s_waitcnt lgkmcnt(6)
v_mfma_f32_16x16x32_bf16 v[4:7], v[232:235], v[208:211], v[4:7]
v_mfma_f32_16x16x32_bf16 v[40:43], v[232:235], v[212:215], v[40:43]
s_add_u32 m0, s34, 26624
s_nop 0
buffer_load_dwordx4 v247, s[8:11], s33 offen lds
v_mfma_f32_16x16x32_bf16 v[76:79], v[232:235], v[216:219], v[76:79]
v_mfma_f32_16x16x32_bf16 v[112:115], v[232:235], v[220:223], v[112:115]
ds_read_b64_tr_b16 v[228:229], v251 offset:160
ds_read_b64_tr_b16 v[230:231], v251 offset:2464
s_waitcnt lgkmcnt(6)
v_mfma_f32_16x16x32_bf16 v[8:11], v[236:239], v[208:211], v[8:11]
v_mfma_f32_16x16x32_bf16 v[44:47], v[236:239], v[212:215], v[44:47]
s_add_u32 m0, s34, 30720
s_nop 0
buffer_load_dwordx4 v248, s[8:11], s33 offen lds
v_mfma_f32_16x16x32_bf16 v[80:83], v[236:239], v[216:219], v[80:83]
v_mfma_f32_16x16x32_bf16 v[116:119], v[236:239], v[220:223], v[116:119]
ds_read_b64_tr_b16 v[232:233], v251 offset:192
ds_read_b64_tr_b16 v[234:235], v251 offset:2496
s_waitcnt lgkmcnt(6)
v_mfma_f32_16x16x32_bf16 v[12:15], v[240:243], v[208:211], v[12:15]
v_mfma_f32_16x16x32_bf16 v[48:51], v[240:243], v[212:215], v[48:51]
buffer_load_dwordx4 v[192:195], v244, s[12:15], s40 offen offset:0
v_mfma_f32_16x16x32_bf16 v[84:87], v[240:243], v[216:219], v[84:87]
v_mfma_f32_16x16x32_bf16 v[120:123], v[240:243], v[220:223], v[120:123]
ds_read_b64_tr_b16 v[236:237], v251 offset:224
ds_read_b64_tr_b16 v[238:239], v251 offset:2528
s_waitcnt lgkmcnt(6)
v_mfma_f32_16x16x32_bf16 v[16:19], v[224:227], v[208:211], v[16:19]
v_mfma_f32_16x16x32_bf16 v[52:55], v[224:227], v[212:215], v[52:55]
buffer_load_dwordx4 v[196:199], v244, s[12:15], s41 offen offset:0
v_mfma_f32_16x16x32_bf16 v[88:91], v[224:227], v[216:219], v[88:91]
v_mfma_f32_16x16x32_bf16 v[124:127], v[224:227], v[220:223], v[124:127]
ds_read_b64_tr_b16 v[240:241], v251 offset:256
ds_read_b64_tr_b16 v[242:243], v251 offset:2560
s_waitcnt lgkmcnt(6)
v_mfma_f32_16x16x32_bf16 v[20:23], v[228:231], v[208:211], v[20:23]
v_mfma_f32_16x16x32_bf16 v[56:59], v[228:231], v[212:215], v[56:59]
buffer_load_dwordx4 v[200:203], v244, s[12:15], s42 offen offset:0
v_mfma_f32_16x16x32_bf16 v[92:95], v[228:231], v[216:219], v[92:95]
v_mfma_f32_16x16x32_bf16 v[128:131], v[228:231], v[220:223], v[128:131]
ds_read_b64_tr_b16 v[224:225], v251 offset:9216
ds_read_b64_tr_b16 v[226:227], v251 offset:11520
s_waitcnt lgkmcnt(6)
v_mfma_f32_16x16x32_bf16 v[24:27], v[232:235], v[208:211], v[24:27]
v_mfma_f32_16x16x32_bf16 v[60:63], v[232:235], v[212:215], v[60:63]
buffer_load_dwordx4 v[204:207], v244, s[12:15], s43 offen offset:0
v_mfma_f32_16x16x32_bf16 v[96:99], v[232:235], v[216:219], v[96:99]
v_mfma_f32_16x16x32_bf16 v[132:135], v[232:235], v[220:223], v[132:135]
ds_read_b64_tr_b16 v[228:229], v251 offset:9248
ds_read_b64_tr_b16 v[230:231], v251 offset:11552
s_waitcnt lgkmcnt(6)
v_mfma_f32_16x16x32_bf16 v[28:31], v[236:239], v[208:211], v[28:31]
v_mfma_f32_16x16x32_bf16 v[64:67], v[236:239], v[212:215], v[64:67]
v_mfma_f32_16x16x32_bf16 v[100:103], v[236:239], v[216:219], v[100:103]
v_mfma_f32_16x16x32_bf16 v[136:139], v[236:239], v[220:223], v[136:139]
ds_read_b64_tr_b16 v[232:233], v251 offset:9280
ds_read_b64_tr_b16 v[234:235], v251 offset:11584
s_waitcnt lgkmcnt(6)
v_mfma_f32_16x16x32_bf16 v[32:35], v[240:243], v[208:211], v[32:35]
v_mfma_f32_16x16x32_bf16 v[68:71], v[240:243], v[212:215], v[68:71]
v_mfma_f32_16x16x32_bf16 v[104:107], v[240:243], v[216:219], v[104:107]
v_mfma_f32_16x16x32_bf16 v[140:143], v[240:243], v[220:223], v[140:143]
ds_read_b64_tr_b16 v[236:237], v251 offset:9312
ds_read_b64_tr_b16 v[238:239], v251 offset:11616
s_waitcnt vmcnt(20)
s_waitcnt lgkmcnt(6)
v_mfma_f32_16x16x32_bf16 v[0:3], v[224:227], v[144:147], v[0:3]
v_mfma_f32_16x16x32_bf16 v[36:39], v[224:227], v[148:151], v[36:39]
buffer_load_dwordx4 v[208:211], v244, s[12:15], s40 offen offset:1024
v_mfma_f32_16x16x32_bf16 v[72:75], v[224:227], v[152:155], v[72:75]
v_mfma_f32_16x16x32_bf16 v[108:111], v[224:227], v[156:159], v[108:111]
ds_read_b64_tr_b16 v[240:241], v251 offset:9344
ds_read_b64_tr_b16 v[242:243], v251 offset:11648
s_waitcnt lgkmcnt(6)
v_mfma_f32_16x16x32_bf16 v[4:7], v[228:231], v[144:147], v[4:7]
v_mfma_f32_16x16x32_bf16 v[40:43], v[228:231], v[148:151], v[40:43]
buffer_load_dwordx4 v[212:215], v244, s[12:15], s41 offen offset:1024
v_mfma_f32_16x16x32_bf16 v[76:79], v[228:231], v[152:155], v[76:79]
v_mfma_f32_16x16x32_bf16 v[112:115], v[228:231], v[156:159], v[112:115]
ds_read_b64_tr_b16 v[224:225], v251 offset:9376
ds_read_b64_tr_b16 v[226:227], v251 offset:11680
s_waitcnt lgkmcnt(6)
v_mfma_f32_16x16x32_bf16 v[8:11], v[232:235], v[144:147], v[8:11]
v_mfma_f32_16x16x32_bf16 v[44:47], v[232:235], v[148:151], v[44:47]
buffer_load_dwordx4 v[216:219], v244, s[12:15], s42 offen offset:1024
v_mfma_f32_16x16x32_bf16 v[80:83], v[232:235], v[152:155], v[80:83]
v_mfma_f32_16x16x32_bf16 v[116:119], v[232:235], v[156:159], v[116:119]
ds_read_b64_tr_b16 v[228:229], v251 offset:9408
ds_read_b64_tr_b16 v[230:231], v251 offset:11712
s_waitcnt lgkmcnt(6)
v_mfma_f32_16x16x32_bf16 v[12:15], v[236:239], v[144:147], v[12:15]
v_mfma_f32_16x16x32_bf16 v[48:51], v[236:239], v[148:151], v[48:51]
buffer_load_dwordx4 v[220:223], v244, s[12:15], s43 offen offset:1024
v_mfma_f32_16x16x32_bf16 v[84:87], v[236:239], v[152:155], v[84:87]
v_mfma_f32_16x16x32_bf16 v[120:123], v[236:239], v[156:159], v[120:123]
ds_read_b64_tr_b16 v[232:233], v251 offset:9440
ds_read_b64_tr_b16 v[234:235], v251 offset:11744
s_waitcnt lgkmcnt(6)
v_mfma_f32_16x16x32_bf16 v[16:19], v[240:243], v[144:147], v[16:19]
v_mfma_f32_16x16x32_bf16 v[52:55], v[240:243], v[148:151], v[52:55]
v_mfma_f32_16x16x32_bf16 v[88:91], v[240:243], v[152:155], v[88:91]
v_mfma_f32_16x16x32_bf16 v[124:127], v[240:243], v[156:159], v[124:127]
ds_read_b64_tr_b16 v[236:237], v251 offset:9472
ds_read_b64_tr_b16 v[238:239], v251 offset:11776
s_waitcnt lgkmcnt(6)
v_mfma_f32_16x16x32_bf16 v[20:23], v[224:227], v[144:147], v[20:23]
v_mfma_f32_16x16x32_bf16 v[56:59], v[224:227], v[148:151], v[56:59]
v_mfma_f32_16x16x32_bf16 v[92:95], v[224:227], v[152:155], v[92:95]
v_mfma_f32_16x16x32_bf16 v[128:131], v[224:227], v[156:159], v[128:131]
s_waitcnt lgkmcnt(4)
v_mfma_f32_16x16x32_bf16 v[24:27], v[228:231], v[144:147], v[24:27]
v_mfma_f32_16x16x32_bf16 v[60:63], v[228:231], v[148:151], v[60:63]
v_mfma_f32_16x16x32_bf16 v[96:99], v[228:231], v[152:155], v[96:99]
v_mfma_f32_16x16x32_bf16 v[132:135], v[228:231], v[156:159], v[132:135]
s_waitcnt lgkmcnt(0)
s_barrier
ds_read_b64_tr_b16 v[240:241], v251 offset:18432
ds_read_b64_tr_b16 v[242:243], v251 offset:20736
ds_read_b64_tr_b16 v[224:225], v251 offset:18464
ds_read_b64_tr_b16 v[226:227], v251 offset:20768
v_mfma_f32_16x16x32_bf16 v[28:31], v[232:235], v[144:147], v[28:31]
v_mfma_f32_16x16x32_bf16 v[64:67], v[232:235], v[148:151], v[64:67]
s_add_u32 s33, s32, 3538944
s_cmp_ge_u32 s24, 2
s_cbranch_scc1 dsk_19
s_add_u32 m0, s34, 53248
s_nop 0
buffer_load_dwordx4 v249, s[8:11], s33 offen lds
dsk_19:
v_mfma_f32_16x16x32_bf16 v[100:103], v[232:235], v[152:155], v[100:103]
v_mfma_f32_16x16x32_bf16 v[136:139], v[232:235], v[156:159], v[136:139]
ds_read_b64_tr_b16 v[228:229], v251 offset:18496
ds_read_b64_tr_b16 v[230:231], v251 offset:20800
v_mfma_f32_16x16x32_bf16 v[32:35], v[236:239], v[144:147], v[32:35]
v_mfma_f32_16x16x32_bf16 v[68:71], v[236:239], v[148:151], v[68:71]
s_add_u32 m0, s34, 36864
s_nop 0
buffer_load_dwordx4 v245, s[8:11], s33 offen lds
v_mfma_f32_16x16x32_bf16 v[104:107], v[236:239], v[152:155], v[104:107]
v_mfma_f32_16x16x32_bf16 v[140:143], v[236:239], v[156:159], v[140:143]
ds_read_b64_tr_b16 v[232:233], v251 offset:18528
ds_read_b64_tr_b16 v[234:235], v251 offset:20832
s_waitcnt vmcnt(17)
s_waitcnt lgkmcnt(6)
v_mfma_f32_16x16x32_bf16 v[0:3], v[240:243], v[160:163], v[0:3]
v_mfma_f32_16x16x32_bf16 v[36:39], v[240:243], v[164:167], v[36:39]
s_add_u32 m0, s34, 40960
s_nop 0
buffer_load_dwordx4 v246, s[8:11], s33 offen lds
v_mfma_f32_16x16x32_bf16 v[72:75], v[240:243], v[168:171], v[72:75]
v_mfma_f32_16x16x32_bf16 v[108:111], v[240:243], v[172:175], v[108:111]
ds_read_b64_tr_b16 v[236:237], v251 offset:18560
ds_read_b64_tr_b16 v[238:239], v251 offset:20864
s_waitcnt lgkmcnt(6)
v_mfma_f32_16x16x32_bf16 v[4:7], v[224:227], v[160:163], v[4:7]
v_mfma_f32_16x16x32_bf16 v[40:43], v[224:227], v[164:167], v[40:43]
s_add_u32 m0, s34, 45056
s_nop 0
buffer_load_dwordx4 v247, s[8:11], s33 offen lds
v_mfma_f32_16x16x32_bf16 v[76:79], v[224:227], v[168:171], v[76:79]
v_mfma_f32_16x16x32_bf16 v[112:115], v[224:227], v[172:175], v[112:115]
ds_read_b64_tr_b16 v[240:241], v251 offset:18592
ds_read_b64_tr_b16 v[242:243], v251 offset:20896
s_waitcnt lgkmcnt(6)
v_mfma_f32_16x16x32_bf16 v[8:11], v[228:231], v[160:163], v[8:11]
v_mfma_f32_16x16x32_bf16 v[44:47], v[228:231], v[164:167], v[44:47]
s_add_u32 m0, s34, 49152
s_nop 0
buffer_load_dwordx4 v248, s[8:11], s33 offen lds
v_mfma_f32_16x16x32_bf16 v[80:83], v[228:231], v[168:171], v[80:83]
v_mfma_f32_16x16x32_bf16 v[116:119], v[228:231], v[172:175], v[116:119]
ds_read_b64_tr_b16 v[224:225], v251 offset:18624
ds_read_b64_tr_b16 v[226:227], v251 offset:20928
s_waitcnt lgkmcnt(6)
v_mfma_f32_16x16x32_bf16 v[12:15], v[232:235], v[160:163], v[12:15]
v_mfma_f32_16x16x32_bf16 v[48:51], v[232:235], v[164:167], v[48:51]
buffer_load_dwordx4 v[144:147], v244, s[12:15], s40 offen offset:2048
v_mfma_f32_16x16x32_bf16 v[84:87], v[232:235], v[168:171], v[84:87]
v_mfma_f32_16x16x32_bf16 v[120:123], v[232:235], v[172:175], v[120:123]
ds_read_b64_tr_b16 v[228:229], v251 offset:18656
ds_read_b64_tr_b16 v[230:231], v251 offset:20960
s_waitcnt lgkmcnt(6)
v_mfma_f32_16x16x32_bf16 v[16:19], v[236:239], v[160:163], v[16:19]
v_mfma_f32_16x16x32_bf16 v[52:55], v[236:239], v[164:167], v[52:55]
buffer_load_dwordx4 v[148:151], v244, s[12:15], s41 offen offset:2048
v_mfma_f32_16x16x32_bf16 v[88:91], v[236:239], v[168:171], v[88:91]
v_mfma_f32_16x16x32_bf16 v[124:127], v[236:239], v[172:175], v[124:127]
ds_read_b64_tr_b16 v[232:233], v251 offset:18688
ds_read_b64_tr_b16 v[234:235], v251 offset:20992
s_waitcnt lgkmcnt(6)
v_mfma_f32_16x16x32_bf16 v[20:23], v[240:243], v[160:163], v[20:23]
v_mfma_f32_16x16x32_bf16 v[56:59], v[240:243], v[164:167], v[56:59]
buffer_load_dwordx4 v[152:155], v244, s[12:15], s42 offen offset:2048
v_mfma_f32_16x16x32_bf16 v[92:95], v[240:243], v[168:171], v[92:95]
v_mfma_f32_16x16x32_bf16 v[128:131], v[240:243], v[172:175], v[128:131]
ds_read_b64_tr_b16 v[236:237], v251 offset:27648
ds_read_b64_tr_b16 v[238:239], v251 offset:29952
s_waitcnt lgkmcnt(6)
v_mfma_f32_16x16x32_bf16 v[24:27], v[224:227], v[160:163], v[24:27]
v_mfma_f32_16x16x32_bf16 v[60:63], v[224:227], v[164:167], v[60:63]
buffer_load_dwordx4 v[156:159], v244, s[12:15], s43 offen offset:2048
v_mfma_f32_16x16x32_bf16 v[96:99], v[224:227], v[168:171], v[96:99]
v_mfma_f32_16x16x32_bf16 v[132:135], v[224:227], v[172:175], v[132:135]
ds_read_b64_tr_b16 v[240:241], v251 offset:27680
ds_read_b64_tr_b16 v[242:243], v251 offset:29984
s_waitcnt lgkmcnt(6)
v_mfma_f32_16x16x32_bf16 v[28:31], v[228:231], v[160:163], v[28:31]
v_mfma_f32_16x16x32_bf16 v[64:67], v[228:231], v[164:167], v[64:67]
v_mfma_f32_16x16x32_bf16 v[100:103], v[228:231], v[168:171], v[100:103]
v_mfma_f32_16x16x32_bf16 v[136:139], v[228:231], v[172:175], v[136:139]
ds_read_b64_tr_b16 v[224:225], v251 offset:27712
ds_read_b64_tr_b16 v[226:227], v251 offset:30016
s_waitcnt lgkmcnt(6)
v_mfma_f32_16x16x32_bf16 v[32:35], v[232:235], v[160:163], v[32:35]
v_mfma_f32_16x16x32_bf16 v[68:71], v[232:235], v[164:167], v[68:71]
v_mfma_f32_16x16x32_bf16 v[104:107], v[232:235], v[168:171], v[104:107]
v_mfma_f32_16x16x32_bf16 v[140:143], v[232:235], v[172:175], v[140:143]
ds_read_b64_tr_b16 v[228:229], v251 offset:27744
ds_read_b64_tr_b16 v[230:231], v251 offset:30048
s_waitcnt vmcnt(20)
s_waitcnt lgkmcnt(6)
v_mfma_f32_16x16x32_bf16 v[0:3], v[236:239], v[176:179], v[0:3]
v_mfma_f32_16x16x32_bf16 v[36:39], v[236:239], v[180:183], v[36:39]
buffer_load_dwordx4 v[160:163], v244, s[12:15], s40 offen offset:3072
s_add_u32 s40, s40, 4096
v_mfma_f32_16x16x32_bf16 v[72:75], v[236:239], v[184:187], v[72:75]
v_mfma_f32_16x16x32_bf16 v[108:111], v[236:239], v[188:191], v[108:111]
ds_read_b64_tr_b16 v[232:233], v251 offset:27776
ds_read_b64_tr_b16 v[234:235], v251 offset:30080
s_waitcnt lgkmcnt(6)
v_mfma_f32_16x16x32_bf16 v[4:7], v[240:243], v[176:179], v[4:7]
v_mfma_f32_16x16x32_bf16 v[40:43], v[240:243], v[180:183], v[40:43]
buffer_load_dwordx4 v[164:167], v244, s[12:15], s41 offen offset:3072
s_add_u32 s41, s41, 4096
v_mfma_f32_16x16x32_bf16 v[76:79], v[240:243], v[184:187], v[76:79]
v_mfma_f32_16x16x32_bf16 v[112:115], v[240:243], v[188:191], v[112:115]
ds_read_b64_tr_b16 v[236:237], v251 offset:27808
ds_read_b64_tr_b16 v[238:239], v251 offset:30112
s_waitcnt lgkmcnt(6)
v_mfma_f32_16x16x32_bf16 v[8:11], v[224:227], v[176:179], v[8:11]
v_mfma_f32_16x16x32_bf16 v[44:47], v[224:227], v[180:183], v[44:47]
buffer_load_dwordx4 v[168:171], v244, s[12:15], s42 offen offset:3072
s_add_u32 s42, s42, 4096
v_mfma_f32_16x16x32_bf16 v[80:83], v[224:227], v[184:187], v[80:83]
v_mfma_f32_16x16x32_bf16 v[116:119], v[224:227], v[188:191], v[116:119]
ds_read_b64_tr_b16 v[240:241], v251 offset:27840
ds_read_b64_tr_b16 v[242:243], v251 offset:30144
s_waitcnt lgkmcnt(6)
v_mfma_f32_16x16x32_bf16 v[12:15], v[228:231], v[176:179], v[12:15]
v_mfma_f32_16x16x32_bf16 v[48:51], v[228:231], v[180:183], v[48:51]
buffer_load_dwordx4 v[172:175], v244, s[12:15], s43 offen offset:3072
s_add_u32 s43, s43, 4096
v_mfma_f32_16x16x32_bf16 v[84:87], v[228:231], v[184:187], v[84:87]
v_mfma_f32_16x16x32_bf16 v[120:123], v[228:231], v[188:191], v[120:123]
ds_read_b64_tr_b16 v[224:225], v251 offset:27872
ds_read_b64_tr_b16 v[226:227], v251 offset:30176
s_waitcnt lgkmcnt(6)
v_mfma_f32_16x16x32_bf16 v[16:19], v[232:235], v[176:179], v[16:19]
v_mfma_f32_16x16x32_bf16 v[52:55], v[232:235], v[180:183], v[52:55]
v_mfma_f32_16x16x32_bf16 v[88:91], v[232:235], v[184:187], v[88:91]
v_mfma_f32_16x16x32_bf16 v[124:127], v[232:235], v[188:191], v[124:127]
ds_read_b64_tr_b16 v[228:229], v251 offset:27904
ds_read_b64_tr_b16 v[230:231], v251 offset:30208
s_waitcnt lgkmcnt(6)
v_mfma_f32_16x16x32_bf16 v[20:23], v[236:239], v[176:179], v[20:23]
v_mfma_f32_16x16x32_bf16 v[56:59], v[236:239], v[180:183], v[56:59]
v_mfma_f32_16x16x32_bf16 v[92:95], v[236:239], v[184:187], v[92:95]
v_mfma_f32_16x16x32_bf16 v[128:131], v[236:239], v[188:191], v[128:131]
s_waitcnt lgkmcnt(4)
v_mfma_f32_16x16x32_bf16 v[24:27], v[240:243], v[176:179], v[24:27]
v_mfma_f32_16x16x32_bf16 v[60:63], v[240:243], v[180:183], v[60:63]
v_mfma_f32_16x16x32_bf16 v[96:99], v[240:243], v[184:187], v[96:99]
v_mfma_f32_16x16x32_bf16 v[132:135], v[240:243], v[188:191], v[132:135]
s_waitcnt lgkmcnt(0)
s_barrier
ds_read_b64_tr_b16 v[232:233], v250 offset:0
ds_read_b64_tr_b16 v[234:235], v250 offset:2304
ds_read_b64_tr_b16 v[236:237], v250 offset:32
ds_read_b64_tr_b16 v[238:239], v250 offset:2336
v_mfma_f32_16x16x32_bf16 v[28:31], v[224:227], v[176:179], v[28:31]
v_mfma_f32_16x16x32_bf16 v[64:67], v[224:227], v[180:183], v[64:67]
s_add_u32 s33, s32, 4128768
s_cmp_ge_u32 s24, 2
s_cbranch_scc1 dsk_20
s_add_u32 m0, s34, 71680
s_nop 0
buffer_load_dwordx4 v249, s[8:11], s33 offen lds
dsk_20:
v_mfma_f32_16x16x32_bf16 v[100:103], v[224:227], v[184:187], v[100:103]
v_mfma_f32_16x16x32_bf16 v[136:139], v[224:227], v[188:191], v[136:139]
ds_read_b64_tr_b16 v[240:241], v250 offset:64
ds_read_b64_tr_b16 v[242:243], v250 offset:2368
v_mfma_f32_16x16x32_bf16 v[32:35], v[228:231], v[176:179], v[32:35]
v_mfma_f32_16x16x32_bf16 v[68:71], v[228:231], v[180:183], v[68:71]
s_add_u32 m0, s34, 55296
s_nop 0
buffer_load_dwordx4 v245, s[8:11], s33 offen lds
v_mfma_f32_16x16x32_bf16 v[104:107], v[228:231], v[184:187], v[104:107]
v_mfma_f32_16x16x32_bf16 v[140:143], v[228:231], v[188:191], v[140:143]
ds_read_b64_tr_b16 v[224:225], v250 offset:96
ds_read_b64_tr_b16 v[226:227], v250 offset:2400
s_waitcnt vmcnt(17)
s_waitcnt lgkmcnt(6)
v_mfma_f32_16x16x32_bf16 v[0:3], v[232:235], v[192:195], v[0:3]
v_mfma_f32_16x16x32_bf16 v[36:39], v[232:235], v[196:199], v[36:39]
s_add_u32 m0, s34, 59392
s_nop 0
buffer_load_dwordx4 v246, s[8:11], s33 offen lds
v_mfma_f32_16x16x32_bf16 v[72:75], v[232:235], v[200:203], v[72:75]
v_mfma_f32_16x16x32_bf16 v[108:111], v[232:235], v[204:207], v[108:111]
ds_read_b64_tr_b16 v[228:229], v250 offset:128
ds_read_b64_tr_b16 v[230:231], v250 offset:2432
s_waitcnt lgkmcnt(6)
v_mfma_f32_16x16x32_bf16 v[4:7], v[236:239], v[192:195], v[4:7]
v_mfma_f32_16x16x32_bf16 v[40:43], v[236:239], v[196:199], v[40:43]
s_add_u32 m0, s34, 63488
s_nop 0
buffer_load_dwordx4 v247, s[8:11], s33 offen lds
v_mfma_f32_16x16x32_bf16 v[76:79], v[236:239], v[200:203], v[76:79]
v_mfma_f32_16x16x32_bf16 v[112:115], v[236:239], v[204:207], v[112:115]
ds_read_b64_tr_b16 v[232:233], v250 offset:160
ds_read_b64_tr_b16 v[234:235], v250 offset:2464
s_waitcnt lgkmcnt(6)
v_mfma_f32_16x16x32_bf16 v[8:11], v[240:243], v[192:195], v[8:11]
v_mfma_f32_16x16x32_bf16 v[44:47], v[240:243], v[196:199], v[44:47]
s_add_u32 m0, s34, 67584
s_nop 0
buffer_load_dwordx4 v248, s[8:11], s33 offen lds
v_mfma_f32_16x16x32_bf16 v[80:83], v[240:243], v[200:203], v[80:83]
v_mfma_f32_16x16x32_bf16 v[116:119], v[240:243], v[204:207], v[116:119]
ds_read_b64_tr_b16 v[236:237], v250 offset:192
ds_read_b64_tr_b16 v[238:239], v250 offset:2496
s_waitcnt lgkmcnt(6)
v_mfma_f32_16x16x32_bf16 v[12:15], v[224:227], v[192:195], v[12:15]
v_mfma_f32_16x16x32_bf16 v[48:51], v[224:227], v[196:199], v[48:51]
buffer_load_dwordx4 v[176:179], v244, s[12:15], s40 offen offset:0
v_mfma_f32_16x16x32_bf16 v[84:87], v[224:227], v[200:203], v[84:87]
v_mfma_f32_16x16x32_bf16 v[120:123], v[224:227], v[204:207], v[120:123]
ds_read_b64_tr_b16 v[240:241], v250 offset:224
ds_read_b64_tr_b16 v[242:243], v250 offset:2528
s_waitcnt lgkmcnt(6)
v_mfma_f32_16x16x32_bf16 v[16:19], v[228:231], v[192:195], v[16:19]
v_mfma_f32_16x16x32_bf16 v[52:55], v[228:231], v[196:199], v[52:55]
buffer_load_dwordx4 v[180:183], v244, s[12:15], s41 offen offset:0
v_mfma_f32_16x16x32_bf16 v[88:91], v[228:231], v[200:203], v[88:91]
v_mfma_f32_16x16x32_bf16 v[124:127], v[228:231], v[204:207], v[124:127]
ds_read_b64_tr_b16 v[224:225], v250 offset:256
ds_read_b64_tr_b16 v[226:227], v250 offset:2560
s_waitcnt lgkmcnt(6)
v_mfma_f32_16x16x32_bf16 v[20:23], v[232:235], v[192:195], v[20:23]
v_mfma_f32_16x16x32_bf16 v[56:59], v[232:235], v[196:199], v[56:59]
buffer_load_dwordx4 v[184:187], v244, s[12:15], s42 offen offset:0
v_mfma_f32_16x16x32_bf16 v[92:95], v[232:235], v[200:203], v[92:95]
v_mfma_f32_16x16x32_bf16 v[128:131], v[232:235], v[204:207], v[128:131]
ds_read_b64_tr_b16 v[228:229], v250 offset:9216
ds_read_b64_tr_b16 v[230:231], v250 offset:11520
s_waitcnt lgkmcnt(6)
v_mfma_f32_16x16x32_bf16 v[24:27], v[236:239], v[192:195], v[24:27]
v_mfma_f32_16x16x32_bf16 v[60:63], v[236:239], v[196:199], v[60:63]
buffer_load_dwordx4 v[188:191], v244, s[12:15], s43 offen offset:0
v_mfma_f32_16x16x32_bf16 v[96:99], v[236:239], v[200:203], v[96:99]
v_mfma_f32_16x16x32_bf16 v[132:135], v[236:239], v[204:207], v[132:135]
ds_read_b64_tr_b16 v[232:233], v250 offset:9248
ds_read_b64_tr_b16 v[234:235], v250 offset:11552
s_waitcnt lgkmcnt(6)
v_mfma_f32_16x16x32_bf16 v[28:31], v[240:243], v[192:195], v[28:31]
v_mfma_f32_16x16x32_bf16 v[64:67], v[240:243], v[196:199], v[64:67]
v_mfma_f32_16x16x32_bf16 v[100:103], v[240:243], v[200:203], v[100:103]
v_mfma_f32_16x16x32_bf16 v[136:139], v[240:243], v[204:207], v[136:139]
ds_read_b64_tr_b16 v[236:237], v250 offset:9280
ds_read_b64_tr_b16 v[238:239], v250 offset:11584
s_waitcnt lgkmcnt(6)
v_mfma_f32_16x16x32_bf16 v[32:35], v[224:227], v[192:195], v[32:35]
v_mfma_f32_16x16x32_bf16 v[68:71], v[224:227], v[196:199], v[68:71]
v_mfma_f32_16x16x32_bf16 v[104:107], v[224:227], v[200:203], v[104:107]
v_mfma_f32_16x16x32_bf16 v[140:143], v[224:227], v[204:207], v[140:143]
ds_read_b64_tr_b16 v[240:241], v250 offset:9312
ds_read_b64_tr_b16 v[242:243], v250 offset:11616
s_waitcnt vmcnt(20)
s_waitcnt lgkmcnt(6)
v_mfma_f32_16x16x32_bf16 v[0:3], v[228:231], v[208:211], v[0:3]
v_mfma_f32_16x16x32_bf16 v[36:39], v[228:231], v[212:215], v[36:39]
buffer_load_dwordx4 v[192:195], v244, s[12:15], s40 offen offset:1024
v_mfma_f32_16x16x32_bf16 v[72:75], v[228:231], v[216:219], v[72:75]
v_mfma_f32_16x16x32_bf16 v[108:111], v[228:231], v[220:223], v[108:111]
ds_read_b64_tr_b16 v[224:225], v250 offset:9344
ds_read_b64_tr_b16 v[226:227], v250 offset:11648
s_waitcnt lgkmcnt(6)
v_mfma_f32_16x16x32_bf16 v[4:7], v[232:235], v[208:211], v[4:7]
v_mfma_f32_16x16x32_bf16 v[40:43], v[232:235], v[212:215], v[40:43]
buffer_load_dwordx4 v[196:199], v244, s[12:15], s41 offen offset:1024
v_mfma_f32_16x16x32_bf16 v[76:79], v[232:235], v[216:219], v[76:79]
v_mfma_f32_16x16x32_bf16 v[112:115], v[232:235], v[220:223], v[112:115]
ds_read_b64_tr_b16 v[228:229], v250 offset:9376
ds_read_b64_tr_b16 v[230:231], v250 offset:11680
s_waitcnt lgkmcnt(6)
v_mfma_f32_16x16x32_bf16 v[8:11], v[236:239], v[208:211], v[8:11]
v_mfma_f32_16x16x32_bf16 v[44:47], v[236:239], v[212:215], v[44:47]
buffer_load_dwordx4 v[200:203], v244, s[12:15], s42 offen offset:1024
v_mfma_f32_16x16x32_bf16 v[80:83], v[236:239], v[216:219], v[80:83]
v_mfma_f32_16x16x32_bf16 v[116:119], v[236:239], v[220:223], v[116:119]
ds_read_b64_tr_b16 v[232:233], v250 offset:9408
ds_read_b64_tr_b16 v[234:235], v250 offset:11712
s_waitcnt lgkmcnt(6)
v_mfma_f32_16x16x32_bf16 v[12:15], v[240:243], v[208:211], v[12:15]
v_mfma_f32_16x16x32_bf16 v[48:51], v[240:243], v[212:215], v[48:51]
buffer_load_dwordx4 v[204:207], v244, s[12:15], s43 offen offset:1024
v_mfma_f32_16x16x32_bf16 v[84:87], v[240:243], v[216:219], v[84:87]
v_mfma_f32_16x16x32_bf16 v[120:123], v[240:243], v[220:223], v[120:123]
ds_read_b64_tr_b16 v[236:237], v250 offset:9440
ds_read_b64_tr_b16 v[238:239], v250 offset:11744
s_waitcnt lgkmcnt(6)
v_mfma_f32_16x16x32_bf16 v[16:19], v[224:227], v[208:211], v[16:19]
v_mfma_f32_16x16x32_bf16 v[52:55], v[224:227], v[212:215], v[52:55]
v_mfma_f32_16x16x32_bf16 v[88:91], v[224:227], v[216:219], v[88:91]
v_mfma_f32_16x16x32_bf16 v[124:127], v[224:227], v[220:223], v[124:127]
ds_read_b64_tr_b16 v[240:241], v250 offset:9472
ds_read_b64_tr_b16 v[242:243], v250 offset:11776
s_waitcnt lgkmcnt(6)
v_mfma_f32_16x16x32_bf16 v[20:23], v[228:231], v[208:211], v[20:23]
v_mfma_f32_16x16x32_bf16 v[56:59], v[228:231], v[212:215], v[56:59]
v_mfma_f32_16x16x32_bf16 v[92:95], v[228:231], v[216:219], v[92:95]
v_mfma_f32_16x16x32_bf16 v[128:131], v[228:231], v[220:223], v[128:131]
s_waitcnt lgkmcnt(4)
v_mfma_f32_16x16x32_bf16 v[24:27], v[232:235], v[208:211], v[24:27]
v_mfma_f32_16x16x32_bf16 v[60:63], v[232:235], v[212:215], v[60:63]
v_mfma_f32_16x16x32_bf16 v[96:99], v[232:235], v[216:219], v[96:99]
v_mfma_f32_16x16x32_bf16 v[132:135], v[232:235], v[220:223], v[132:135]
s_waitcnt lgkmcnt(0)
s_barrier
ds_read_b64_tr_b16 v[224:225], v250 offset:18432
ds_read_b64_tr_b16 v[226:227], v250 offset:20736
ds_read_b64_tr_b16 v[228:229], v250 offset:18464
ds_read_b64_tr_b16 v[230:231], v250 offset:20768
v_mfma_f32_16x16x32_bf16 v[28:31], v[236:239], v[208:211], v[28:31]
v_mfma_f32_16x16x32_bf16 v[64:67], v[236:239], v[212:215], v[64:67]
s_add_u32 s33, s32, 4718592
s_cmp_ge_u32 s24, 2
s_cbranch_scc1 dsk_21
s_add_u32 m0, s34, 16384
s_nop 0
buffer_load_dwordx4 v249, s[8:11], s33 offen lds
dsk_21:
v_mfma_f32_16x16x32_bf16 v[100:103], v[236:239], v[216:219], v[100:103]
v_mfma_f32_16x16x32_bf16 v[136:139], v[236:239], v[220:223], v[136:139]
ds_read_b64_tr_b16 v[232:233], v250 offset:18496
ds_read_b64_tr_b16 v[234:235], v250 offset:20800
v_mfma_f32_16x16x32_bf16 v[32:35], v[240:243], v[208:211], v[32:35]
v_mfma_f32_16x16x32_bf16 v[68:71], v[240:243], v[212:215], v[68:71]
s_add_u32 m0, s34, 0
s_nop 0
buffer_load_dwordx4 v245, s[8:11], s33 offen lds
v_mfma_f32_16x16x32_bf16 v[104:107], v[240:243], v[216:219], v[104:107]
v_mfma_f32_16x16x32_bf16 v[140:143], v[240:243], v[220:223], v[140:143]
ds_read_b64_tr_b16 v[236:237], v250 offset:18528
ds_read_b64_tr_b16 v[238:239], v250 offset:20832
s_waitcnt vmcnt(17)
s_waitcnt lgkmcnt(6)
v_mfma_f32_16x16x32_bf16 v[0:3], v[224:227], v[144:147], v[0:3]
v_mfma_f32_16x16x32_bf16 v[36:39], v[224:227], v[148:151], v[36:39]
s_add_u32 m0, s34, 4096
s_nop 0
buffer_load_dwordx4 v246, s[8:11], s33 offen lds
v_mfma_f32_16x16x32_bf16 v[72:75], v[224:227], v[152:155], v[72:75]
v_mfma_f32_16x16x32_bf16 v[108:111], v[224:227], v[156:159], v[108:111]
ds_read_b64_tr_b16 v[240:241], v250 offset:18560
ds_read_b64_tr_b16 v[242:243], v250 offset:20864
s_waitcnt lgkmcnt(6)
v_mfma_f32_16x16x32_bf16 v[4:7], v[228:231], v[144:147], v[4:7]
v_mfma_f32_16x16x32_bf16 v[40:43], v[228:231], v[148:151], v[40:43]
s_add_u32 m0, s34, 8192
s_nop 0
buffer_load_dwordx4 v247, s[8:11], s33 offen lds
v_mfma_f32_16x16x32_bf16 v[76:79], v[228:231], v[152:155], v[76:79]
v_mfma_f32_16x16x32_bf16 v[112:115], v[228:231], v[156:159], v[112:115]
ds_read_b64_tr_b16 v[224:225], v250 offset:18592
ds_read_b64_tr_b16 v[226:227], v250 offset:20896
s_waitcnt lgkmcnt(6)
v_mfma_f32_16x16x32_bf16 v[8:11], v[232:235], v[144:147], v[8:11]
v_mfma_f32_16x16x32_bf16 v[44:47], v[232:235], v[148:151], v[44:47]
s_add_u32 m0, s34, 12288
s_nop 0
buffer_load_dwordx4 v248, s[8:11], s33 offen lds
v_mfma_f32_16x16x32_bf16 v[80:83], v[232:235], v[152:155], v[80:83]
v_mfma_f32_16x16x32_bf16 v[116:119], v[232:235], v[156:159], v[116:119]
ds_read_b64_tr_b16 v[228:229], v250 offset:18624
ds_read_b64_tr_b16 v[230:231], v250 offset:20928
s_waitcnt lgkmcnt(6)
v_mfma_f32_16x16x32_bf16 v[12:15], v[236:239], v[144:147], v[12:15]
v_mfma_f32_16x16x32_bf16 v[48:51], v[236:239], v[148:151], v[48:51]
buffer_load_dwordx4 v[208:211], v244, s[12:15], s40 offen offset:2048
v_mfma_f32_16x16x32_bf16 v[84:87], v[236:239], v[152:155], v[84:87]
v_mfma_f32_16x16x32_bf16 v[120:123], v[236:239], v[156:159], v[120:123]
ds_read_b64_tr_b16 v[232:233], v250 offset:18656
ds_read_b64_tr_b16 v[234:235], v250 offset:20960
s_waitcnt lgkmcnt(6)
v_mfma_f32_16x16x32_bf16 v[16:19], v[240:243], v[144:147], v[16:19]
v_mfma_f32_16x16x32_bf16 v[52:55], v[240:243], v[148:151], v[52:55]
buffer_load_dwordx4 v[212:215], v244, s[12:15], s41 offen offset:2048
v_mfma_f32_16x16x32_bf16 v[88:91], v[240:243], v[152:155], v[88:91]
v_mfma_f32_16x16x32_bf16 v[124:127], v[240:243], v[156:159], v[124:127]
ds_read_b64_tr_b16 v[236:237], v250 offset:18688
ds_read_b64_tr_b16 v[238:239], v250 offset:20992
s_waitcnt lgkmcnt(6)
v_mfma_f32_16x16x32_bf16 v[20:23], v[224:227], v[144:147], v[20:23]
v_mfma_f32_16x16x32_bf16 v[56:59], v[224:227], v[148:151], v[56:59]
buffer_load_dwordx4 v[216:219], v244, s[12:15], s42 offen offset:2048
v_mfma_f32_16x16x32_bf16 v[92:95], v[224:227], v[152:155], v[92:95]
v_mfma_f32_16x16x32_bf16 v[128:131], v[224:227], v[156:159], v[128:131]
ds_read_b64_tr_b16 v[240:241], v250 offset:27648
ds_read_b64_tr_b16 v[242:243], v250 offset:29952
s_waitcnt lgkmcnt(6)
v_mfma_f32_16x16x32_bf16 v[24:27], v[228:231], v[144:147], v[24:27]
v_mfma_f32_16x16x32_bf16 v[60:63], v[228:231], v[148:151], v[60:63]
buffer_load_dwordx4 v[220:223], v244, s[12:15], s43 offen offset:2048
v_mfma_f32_16x16x32_bf16 v[96:99], v[228:231], v[152:155], v[96:99]
v_mfma_f32_16x16x32_bf16 v[132:135], v[228:231], v[156:159], v[132:135]
ds_read_b64_tr_b16 v[224:225], v250 offset:27680
ds_read_b64_tr_b16 v[226:227], v250 offset:29984
s_waitcnt lgkmcnt(6)
v_mfma_f32_16x16x32_bf16 v[28:31], v[232:235], v[144:147], v[28:31]
v_mfma_f32_16x16x32_bf16 v[64:67], v[232:235], v[148:151], v[64:67]
v_mfma_f32_16x16x32_bf16 v[100:103], v[232:235], v[152:155], v[100:103]
v_mfma_f32_16x16x32_bf16 v[136:139], v[232:235], v[156:159], v[136:139]
ds_read_b64_tr_b16 v[228:229], v250 offset:27712
ds_read_b64_tr_b16 v[230:231], v250 offset:30016
s_waitcnt lgkmcnt(6)
v_mfma_f32_16x16x32_bf16 v[32:35], v[236:239], v[144:147], v[32:35]
v_mfma_f32_16x16x32_bf16 v[68:71], v[236:239], v[148:151], v[68:71]
v_mfma_f32_16x16x32_bf16 v[104:107], v[236:239], v[152:155], v[104:107]
v_mfma_f32_16x16x32_bf16 v[140:143], v[236:239], v[156:159], v[140:143]
ds_read_b64_tr_b16 v[232:233], v250 offset:27744
ds_read_b64_tr_b16 v[234:235], v250 offset:30048
s_waitcnt vmcnt(20)
s_waitcnt lgkmcnt(6)
v_mfma_f32_16x16x32_bf16 v[0:3], v[240:243], v[160:163], v[0:3]
v_mfma_f32_16x16x32_bf16 v[36:39], v[240:243], v[164:167], v[36:39]
buffer_load_dwordx4 v[144:147], v244, s[12:15], s40 offen offset:3072
s_add_u32 s40, s40, 4096
v_mfma_f32_16x16x32_bf16 v[72:75], v[240:243], v[168:171], v[72:75]
v_mfma_f32_16x16x32_bf16 v[108:111], v[240:243], v[172:175], v[108:111]
ds_read_b64_tr_b16 v[236:237], v250 offset:27776
ds_read_b64_tr_b16 v[238:239], v250 offset:30080
s_waitcnt lgkmcnt(6)
v_mfma_f32_16x16x32_bf16 v[4:7], v[224:227], v[160:163], v[4:7]
v_mfma_f32_16x16x32_bf16 v[40:43], v[224:227], v[164:167], v[40:43]
buffer_load_dwordx4 v[148:151], v244, s[12:15], s41 offen offset:3072
s_add_u32 s41, s41, 4096
v_mfma_f32_16x16x32_bf16 v[76:79], v[224:227], v[168:171], v[76:79]
v_mfma_f32_16x16x32_bf16 v[112:115], v[224:227], v[172:175], v[112:115]
ds_read_b64_tr_b16 v[240:241], v250 offset:27808
ds_read_b64_tr_b16 v[242:243], v250 offset:30112
s_waitcnt lgkmcnt(6)
v_mfma_f32_16x16x32_bf16 v[8:11], v[228:231], v[160:163], v[8:11]
v_mfma_f32_16x16x32_bf16 v[44:47], v[228:231], v[164:167], v[44:47]
buffer_load_dwordx4 v[152:155], v244, s[12:15], s42 offen offset:3072
s_add_u32 s42, s42, 4096
v_mfma_f32_16x16x32_bf16 v[80:83], v[228:231], v[168:171], v[80:83]
v_mfma_f32_16x16x32_bf16 v[116:119], v[228:231], v[172:175], v[116:119]
ds_read_b64_tr_b16 v[224:225], v250 offset:27840
ds_read_b64_tr_b16 v[226:227], v250 offset:30144
s_waitcnt lgkmcnt(6)
v_mfma_f32_16x16x32_bf16 v[12:15], v[232:235], v[160:163], v[12:15]
v_mfma_f32_16x16x32_bf16 v[48:51], v[232:235], v[164:167], v[48:51]
buffer_load_dwordx4 v[156:159], v244, s[12:15], s43 offen offset:3072
s_add_u32 s43, s43, 4096
v_mfma_f32_16x16x32_bf16 v[84:87], v[232:235], v[168:171], v[84:87]
v_mfma_f32_16x16x32_bf16 v[120:123], v[232:235], v[172:175], v[120:123]
ds_read_b64_tr_b16 v[228:229], v250 offset:27872
ds_read_b64_tr_b16 v[230:231], v250 offset:30176
s_waitcnt lgkmcnt(6)
v_mfma_f32_16x16x32_bf16 v[16:19], v[236:239], v[160:163], v[16:19]
v_mfma_f32_16x16x32_bf16 v[52:55], v[236:239], v[164:167], v[52:55]
v_mfma_f32_16x16x32_bf16 v[88:91], v[236:239], v[168:171], v[88:91]
v_mfma_f32_16x16x32_bf16 v[124:127], v[236:239], v[172:175], v[124:127]
ds_read_b64_tr_b16 v[232:233], v250 offset:27904
ds_read_b64_tr_b16 v[234:235], v250 offset:30208
s_waitcnt lgkmcnt(6)
v_mfma_f32_16x16x32_bf16 v[20:23], v[240:243], v[160:163], v[20:23]
v_mfma_f32_16x16x32_bf16 v[56:59], v[240:243], v[164:167], v[56:59]
v_mfma_f32_16x16x32_bf16 v[92:95], v[240:243], v[168:171], v[92:95]
v_mfma_f32_16x16x32_bf16 v[128:131], v[240:243], v[172:175], v[128:131]
s_waitcnt lgkmcnt(4)
v_mfma_f32_16x16x32_bf16 v[24:27], v[224:227], v[160:163], v[24:27]
v_mfma_f32_16x16x32_bf16 v[60:63], v[224:227], v[164:167], v[60:63]
v_mfma_f32_16x16x32_bf16 v[96:99], v[224:227], v[168:171], v[96:99]
v_mfma_f32_16x16x32_bf16 v[132:135], v[224:227], v[172:175], v[132:135]
s_waitcnt lgkmcnt(0)
s_barrier
ds_read_b64_tr_b16 v[236:237], v251 offset:0
ds_read_b64_tr_b16 v[238:239], v251 offset:2304
ds_read_b64_tr_b16 v[240:241], v251 offset:32
ds_read_b64_tr_b16 v[242:243], v251 offset:2336
v_mfma_f32_16x16x32_bf16 v[28:31], v[228:231], v[160:163], v[28:31]
v_mfma_f32_16x16x32_bf16 v[64:67], v[228:231], v[164:167], v[64:67]
v_mfma_f32_16x16x32_bf16 v[100:103], v[228:231], v[168:171], v[100:103]
v_mfma_f32_16x16x32_bf16 v[136:139], v[228:231], v[172:175], v[136:139]
ds_read_b64_tr_b16 v[224:225], v251 offset:64
ds_read_b64_tr_b16 v[226:227], v251 offset:2368
v_mfma_f32_16x16x32_bf16 v[32:35], v[232:235], v[160:163], v[32:35]
v_mfma_f32_16x16x32_bf16 v[68:71], v[232:235], v[164:167], v[68:71]
v_mfma_f32_16x16x32_bf16 v[104:107], v[232:235], v[168:171], v[104:107]
v_mfma_f32_16x16x32_bf16 v[140:143], v[232:235], v[172:175], v[140:143]
ds_read_b64_tr_b16 v[228:229], v251 offset:96
ds_read_b64_tr_b16 v[230:231], v251 offset:2400
s_waitcnt vmcnt(16)
s_waitcnt lgkmcnt(6)
v_mfma_f32_16x16x32_bf16 v[0:3], v[236:239], v[176:179], v[0:3]
v_mfma_f32_16x16x32_bf16 v[36:39], v[236:239], v[180:183], v[36:39]
buffer_load_dwordx4 v[160:163], v244, s[12:15], s40 offen offset:0
v_mfma_f32_16x16x32_bf16 v[72:75], v[236:239], v[184:187], v[72:75]
v_mfma_f32_16x16x32_bf16 v[108:111], v[236:239], v[188:191], v[108:111]
ds_read_b64_tr_b16 v[232:233], v251 offset:128
ds_read_b64_tr_b16 v[234:235], v251 offset:2432
s_waitcnt lgkmcnt(6)
v_mfma_f32_16x16x32_bf16 v[4:7], v[240:243], v[176:179], v[4:7]
v_mfma_f32_16x16x32_bf16 v[40:43], v[240:243], v[180:183], v[40:43]
buffer_load_dwordx4 v[164:167], v244, s[12:15], s41 offen offset:0
v_mfma_f32_16x16x32_bf16 v[76:79], v[240:243], v[184:187], v[76:79]
v_mfma_f32_16x16x32_bf16 v[112:115], v[240:243], v[188:191], v[112:115]
ds_read_b64_tr_b16 v[236:237], v251 offset:160
ds_read_b64_tr_b16 v[238:239], v251 offset:2464
s_waitcnt lgkmcnt(6)
v_mfma_f32_16x16x32_bf16 v[8:11], v[224:227], v[176:179], v[8:11]
v_mfma_f32_16x16x32_bf16 v[44:47], v[224:227], v[180:183], v[44:47]
buffer_load_dwordx4 v[168:171], v244, s[12:15], s42 offen offset:0
v_mfma_f32_16x16x32_bf16 v[80:83], v[224:227], v[184:187], v[80:83]
v_mfma_f32_16x16x32_bf16 v[116:119], v[224:227], v[188:191], v[116:119]
ds_read_b64_tr_b16 v[240:241], v251 offset:192
ds_read_b64_tr_b16 v[242:243], v251 offset:2496
s_waitcnt lgkmcnt(6)
v_mfma_f32_16x16x32_bf16 v[12:15], v[228:231], v[176:179], v[12:15]
v_mfma_f32_16x16x32_bf16 v[48:51], v[228:231], v[180:183], v[48:51]
buffer_load_dwordx4 v[172:175], v244, s[12:15], s43 offen offset:0
v_mfma_f32_16x16x32_bf16 v[84:87], v[228:231], v[184:187], v[84:87]
v_mfma_f32_16x16x32_bf16 v[120:123], v[228:231], v[188:191], v[120:123]
ds_read_b64_tr_b16 v[224:225], v251 offset:224
ds_read_b64_tr_b16 v[226:227], v251 offset:2528
s_waitcnt lgkmcnt(6)
v_mfma_f32_16x16x32_bf16 v[16:19], v[232:235], v[176:179], v[16:19]
v_mfma_f32_16x16x32_bf16 v[52:55], v[232:235], v[180:183], v[52:55]
v_mfma_f32_16x16x32_bf16 v[88:91], v[232:235], v[184:187], v[88:91]
v_mfma_f32_16x16x32_bf16 v[124:127], v[232:235], v[188:191], v[124:127]
ds_read_b64_tr_b16 v[228:229], v251 offset:256
ds_read_b64_tr_b16 v[230:231], v251 offset:2560
s_waitcnt lgkmcnt(6)
v_mfma_f32_16x16x32_bf16 v[20:23], v[236:239], v[176:179], v[20:23]
v_mfma_f32_16x16x32_bf16 v[56:59], v[236:239], v[180:183], v[56:59]
v_mfma_f32_16x16x32_bf16 v[92:95], v[236:239], v[184:187], v[92:95]
v_mfma_f32_16x16x32_bf16 v[128:131], v[236:239], v[188:191], v[128:131]
ds_read_b64_tr_b16 v[232:233], v251 offset:9216
ds_read_b64_tr_b16 v[234:235], v251 offset:11520
s_waitcnt lgkmcnt(6)
v_mfma_f32_16x16x32_bf16 v[24:27], v[240:243], v[176:179], v[24:27]
v_mfma_f32_16x16x32_bf16 v[60:63], v[240:243], v[180:183], v[60:63]
v_mfma_f32_16x16x32_bf16 v[96:99], v[240:243], v[184:187], v[96:99]
v_mfma_f32_16x16x32_bf16 v[132:135], v[240:243], v[188:191], v[132:135]
ds_read_b64_tr_b16 v[236:237], v251 offset:9248
ds_read_b64_tr_b16 v[238:239], v251 offset:11552
s_waitcnt lgkmcnt(6)
v_mfma_f32_16x16x32_bf16 v[28:31], v[224:227], v[176:179], v[28:31]
v_mfma_f32_16x16x32_bf16 v[64:67], v[224:227], v[180:183], v[64:67]
v_mfma_f32_16x16x32_bf16 v[100:103], v[224:227], v[184:187], v[100:103]
v_mfma_f32_16x16x32_bf16 v[136:139], v[224:227], v[188:191], v[136:139]
ds_read_b64_tr_b16 v[240:241], v251 offset:9280
ds_read_b64_tr_b16 v[242:243], v251 offset:11584
s_waitcnt lgkmcnt(6)
v_mfma_f32_16x16x32_bf16 v[32:35], v[228:231], v[176:179], v[32:35]
v_mfma_f32_16x16x32_bf16 v[68:71], v[228:231], v[180:183], v[68:71]
v_mfma_f32_16x16x32_bf16 v[104:107], v[228:231], v[184:187], v[104:107]
v_mfma_f32_16x16x32_bf16 v[140:143], v[228:231], v[188:191], v[140:143]
ds_read_b64_tr_b16 v[224:225], v251 offset:9312
ds_read_b64_tr_b16 v[226:227], v251 offset:11616
s_waitcnt vmcnt(16)
s_waitcnt lgkmcnt(6)
v_mfma_f32_16x16x32_bf16 v[0:3], v[232:235], v[192:195], v[0:3]
v_mfma_f32_16x16x32_bf16 v[36:39], v[232:235], v[196:199], v[36:39]
buffer_load_dwordx4 v[176:179], v244, s[12:15], s40 offen offset:1024
v_mfma_f32_16x16x32_bf16 v[72:75], v[232:235], v[200:203], v[72:75]
v_mfma_f32_16x16x32_bf16 v[108:111], v[232:235], v[204:207], v[108:111]
ds_read_b64_tr_b16 v[228:229], v251 offset:9344
ds_read_b64_tr_b16 v[230:231], v251 offset:11648
s_waitcnt lgkmcnt(6)
v_mfma_f32_16x16x32_bf16 v[4:7], v[236:239], v[192:195], v[4:7]
v_mfma_f32_16x16x32_bf16 v[40:43], v[236:239], v[196:199], v[40:43]
buffer_load_dwordx4 v[180:183], v244, s[12:15], s41 offen offset:1024
v_mfma_f32_16x16x32_bf16 v[76:79], v[236:239], v[200:203], v[76:79]
v_mfma_f32_16x16x32_bf16 v[112:115], v[236:239], v[204:207], v[112:115]
ds_read_b64_tr_b16 v[232:233], v251 offset:9376
ds_read_b64_tr_b16 v[234:235], v251 offset:11680
s_waitcnt lgkmcnt(6)
v_mfma_f32_16x16x32_bf16 v[8:11], v[240:243], v[192:195], v[8:11]
v_mfma_f32_16x16x32_bf16 v[44:47], v[240:243], v[196:199], v[44:47]
buffer_load_dwordx4 v[184:187], v244, s[12:15], s42 offen offset:1024
v_mfma_f32_16x16x32_bf16 v[80:83], v[240:243], v[200:203], v[80:83]
v_mfma_f32_16x16x32_bf16 v[116:119], v[240:243], v[204:207], v[116:119]
ds_read_b64_tr_b16 v[236:237], v251 offset:9408
ds_read_b64_tr_b16 v[238:239], v251 offset:11712
s_waitcnt lgkmcnt(6)
v_mfma_f32_16x16x32_bf16 v[12:15], v[224:227], v[192:195], v[12:15]
v_mfma_f32_16x16x32_bf16 v[48:51], v[224:227], v[196:199], v[48:51]
buffer_load_dwordx4 v[188:191], v244, s[12:15], s43 offen offset:1024
v_mfma_f32_16x16x32_bf16 v[84:87], v[224:227], v[200:203], v[84:87]
v_mfma_f32_16x16x32_bf16 v[120:123], v[224:227], v[204:207], v[120:123]
ds_read_b64_tr_b16 v[240:241], v251 offset:9440
ds_read_b64_tr_b16 v[242:243], v251 offset:11744
s_waitcnt lgkmcnt(6)
v_mfma_f32_16x16x32_bf16 v[16:19], v[228:231], v[192:195], v[16:19]
v_mfma_f32_16x16x32_bf16 v[52:55], v[228:231], v[196:199], v[52:55]
v_mfma_f32_16x16x32_bf16 v[88:91], v[228:231], v[200:203], v[88:91]
v_mfma_f32_16x16x32_bf16 v[124:127], v[228:231], v[204:207], v[124:127]
ds_read_b64_tr_b16 v[224:225], v251 offset:9472
ds_read_b64_tr_b16 v[226:227], v251 offset:11776
s_waitcnt lgkmcnt(6)
v_mfma_f32_16x16x32_bf16 v[20:23], v[232:235], v[192:195], v[20:23]
v_mfma_f32_16x16x32_bf16 v[56:59], v[232:235], v[196:199], v[56:59]
v_mfma_f32_16x16x32_bf16 v[92:95], v[232:235], v[200:203], v[92:95]
v_mfma_f32_16x16x32_bf16 v[128:131], v[232:235], v[204:207], v[128:131]
s_waitcnt lgkmcnt(4)
v_mfma_f32_16x16x32_bf16 v[24:27], v[236:239], v[192:195], v[24:27]
v_mfma_f32_16x16x32_bf16 v[60:63], v[236:239], v[196:199], v[60:63]
v_mfma_f32_16x16x32_bf16 v[96:99], v[236:239], v[200:203], v[96:99]
v_mfma_f32_16x16x32_bf16 v[132:135], v[236:239], v[204:207], v[132:135]
s_waitcnt lgkmcnt(0)
s_barrier
ds_read_b64_tr_b16 v[228:229], v251 offset:18432
ds_read_b64_tr_b16 v[230:231], v251 offset:20736
ds_read_b64_tr_b16 v[232:233], v251 offset:18464
ds_read_b64_tr_b16 v[234:235], v251 offset:20768
v_mfma_f32_16x16x32_bf16 v[28:31], v[240:243], v[192:195], v[28:31]
v_mfma_f32_16x16x32_bf16 v[64:67], v[240:243], v[196:199], v[64:67]
v_mfma_f32_16x16x32_bf16 v[100:103], v[240:243], v[200:203], v[100:103]
v_mfma_f32_16x16x32_bf16 v[136:139], v[240:243], v[204:207], v[136:139]
ds_read_b64_tr_b16 v[236:237], v251 offset:18496
ds_read_b64_tr_b16 v[238:239], v251 offset:20800
v_mfma_f32_16x16x32_bf16 v[32:35], v[224:227], v[192:195], v[32:35]
v_mfma_f32_16x16x32_bf16 v[68:71], v[224:227], v[196:199], v[68:71]
v_mfma_f32_16x16x32_bf16 v[104:107], v[224:227], v[200:203], v[104:107]
v_mfma_f32_16x16x32_bf16 v[140:143], v[224:227], v[204:207], v[140:143]
ds_read_b64_tr_b16 v[240:241], v251 offset:18528
ds_read_b64_tr_b16 v[242:243], v251 offset:20832
s_waitcnt vmcnt(12)
s_waitcnt lgkmcnt(6)
v_mfma_f32_16x16x32_bf16 v[0:3], v[228:231], v[208:211], v[0:3]
v_mfma_f32_16x16x32_bf16 v[36:39], v[228:231], v[212:215], v[36:39]
v_mfma_f32_16x16x32_bf16 v[72:75], v[228:231], v[216:219], v[72:75]
v_mfma_f32_16x16x32_bf16 v[108:111], v[228:231], v[220:223], v[108:111]
ds_read_b64_tr_b16 v[224:225], v251 offset:18560
ds_read_b64_tr_b16 v[226:227], v251 offset:20864
s_waitcnt lgkmcnt(6)
v_mfma_f32_16x16x32_bf16 v[4:7], v[232:235], v[208:211], v[4:7]
v_mfma_f32_16x16x32_bf16 v[40:43], v[232:235], v[212:215], v[40:43]
v_mfma_f32_16x16x32_bf16 v[76:79], v[232:235], v[216:219], v[76:79]
v_mfma_f32_16x16x32_bf16 v[112:115], v[232:235], v[220:223], v[112:115]
ds_read_b64_tr_b16 v[228:229], v251 offset:18592
ds_read_b64_tr_b16 v[230:231], v251 offset:20896
s_waitcnt lgkmcnt(6)
v_mfma_f32_16x16x32_bf16 v[8:11], v[236:239], v[208:211], v[8:11]
v_mfma_f32_16x16x32_bf16 v[44:47], v[236:239], v[212:215], v[44:47]
v_mfma_f32_16x16x32_bf16 v[80:83], v[236:239], v[216:219], v[80:83]
v_mfma_f32_16x16x32_bf16 v[116:119], v[236:239], v[220:223], v[116:119]
ds_read_b64_tr_b16 v[232:233], v251 offset:18624
ds_read_b64_tr_b16 v[234:235], v251 offset:20928
s_waitcnt lgkmcnt(6)
v_mfma_f32_16x16x32_bf16 v[12:15], v[240:243], v[208:211], v[12:15]
v_mfma_f32_16x16x32_bf16 v[48:51], v[240:243], v[212:215], v[48:51]
v_mfma_f32_16x16x32_bf16 v[84:87], v[240:243], v[216:219], v[84:87]
v_mfma_f32_16x16x32_bf16 v[120:123], v[240:243], v[220:223], v[120:123]
ds_read_b64_tr_b16 v[236:237], v251 offset:18656
ds_read_b64_tr_b16 v[238:239], v251 offset:20960
s_waitcnt lgkmcnt(6)
v_mfma_f32_16x16x32_bf16 v[16:19], v[224:227], v[208:211], v[16:19]
v_mfma_f32_16x16x32_bf16 v[52:55], v[224:227], v[212:215], v[52:55]
v_mfma_f32_16x16x32_bf16 v[88:91], v[224:227], v[216:219], v[88:91]
v_mfma_f32_16x16x32_bf16 v[124:127], v[224:227], v[220:223], v[124:127]
ds_read_b64_tr_b16 v[240:241], v251 offset:18688
ds_read_b64_tr_b16 v[242:243], v251 offset:20992
s_waitcnt lgkmcnt(6)
v_mfma_f32_16x16x32_bf16 v[20:23], v[228:231], v[208:211], v[20:23]
v_mfma_f32_16x16x32_bf16 v[56:59], v[228:231], v[212:215], v[56:59]
v_mfma_f32_16x16x32_bf16 v[92:95], v[228:231], v[216:219], v[92:95]
v_mfma_f32_16x16x32_bf16 v[128:131], v[228:231], v[220:223], v[128:131]
ds_read_b64_tr_b16 v[224:225], v251 offset:27648
ds_read_b64_tr_b16 v[226:227], v251 offset:29952
s_waitcnt lgkmcnt(6)
v_mfma_f32_16x16x32_bf16 v[24:27], v[232:235], v[208:211], v[24:27]
v_mfma_f32_16x16x32_bf16 v[60:63], v[232:235], v[212:215], v[60:63]
v_mfma_f32_16x16x32_bf16 v[96:99], v[232:235], v[216:219], v[96:99]
v_mfma_f32_16x16x32_bf16 v[132:135], v[232:235], v[220:223], v[132:135]
ds_read_b64_tr_b16 v[228:229], v251 offset:27680
ds_read_b64_tr_b16 v[230:231], v251 offset:29984
s_waitcnt lgkmcnt(6)
v_mfma_f32_16x16x32_bf16 v[28:31], v[236:239], v[208:211], v[28:31]
v_mfma_f32_16x16x32_bf16 v[64:67], v[236:239], v[212:215], v[64:67]
v_mfma_f32_16x16x32_bf16 v[100:103], v[236:239], v[216:219], v[100:103]
v_mfma_f32_16x16x32_bf16 v[136:139], v[236:239], v[220:223], v[136:139]
ds_read_b64_tr_b16 v[232:233], v251 offset:27712
ds_read_b64_tr_b16 v[234:235], v251 offset:30016
s_waitcnt lgkmcnt(6)
v_mfma_f32_16x16x32_bf16 v[32:35], v[240:243], v[208:211], v[32:35]
v_mfma_f32_16x16x32_bf16 v[68:71], v[240:243], v[212:215], v[68:71]
v_mfma_f32_16x16x32_bf16 v[104:107], v[240:243], v[216:219], v[104:107]
v_mfma_f32_16x16x32_bf16 v[140:143], v[240:243], v[220:223], v[140:143]
ds_read_b64_tr_b16 v[236:237], v251 offset:27744
ds_read_b64_tr_b16 v[238:239], v251 offset:30048
s_waitcnt vmcnt(8)
s_waitcnt lgkmcnt(6)
v_mfma_f32_16x16x32_bf16 v[0:3], v[224:227], v[144:147], v[0:3]
v_mfma_f32_16x16x32_bf16 v[36:39], v[224:227], v[148:151], v[36:39]
v_mfma_f32_16x16x32_bf16 v[72:75], v[224:227], v[152:155], v[72:75]
v_mfma_f32_16x16x32_bf16 v[108:111], v[224:227], v[156:159], v[108:111]
ds_read_b64_tr_b16 v[240:241], v251 offset:27776
ds_read_b64_tr_b16 v[242:243], v251 offset:30080
s_waitcnt lgkmcnt(6)
v_mfma_f32_16x16x32_bf16 v[4:7], v[228:231], v[144:147], v[4:7]
v_mfma_f32_16x16x32_bf16 v[40:43], v[228:231], v[148:151], v[40:43]
v_mfma_f32_16x16x32_bf16 v[76:79], v[228:231], v[152:155], v[76:79]
v_mfma_f32_16x16x32_bf16 v[112:115], v[228:231], v[156:159], v[112:115]
ds_read_b64_tr_b16 v[224:225], v251 offset:27808
ds_read_b64_tr_b16 v[226:227], v251 offset:30112
s_waitcnt lgkmcnt(6)
v_mfma_f32_16x16x32_bf16 v[8:11], v[232:235], v[144:147], v[8:11]
v_mfma_f32_16x16x32_bf16 v[44:47], v[232:235], v[148:151], v[44:47]
v_mfma_f32_16x16x32_bf16 v[80:83], v[232:235], v[152:155], v[80:83]
v_mfma_f32_16x16x32_bf16 v[116:119], v[232:235], v[156:159], v[116:119]
ds_read_b64_tr_b16 v[228:229], v251 offset:27840
ds_read_b64_tr_b16 v[230:231], v251 offset:30144
s_waitcnt lgkmcnt(6)
v_mfma_f32_16x16x32_bf16 v[12:15], v[236:239], v[144:147], v[12:15]
v_mfma_f32_16x16x32_bf16 v[48:51], v[236:239], v[148:151], v[48:51]
v_mfma_f32_16x16x32_bf16 v[84:87], v[236:239], v[152:155], v[84:87]
v_mfma_f32_16x16x32_bf16 v[120:123], v[236:239], v[156:159], v[120:123]
ds_read_b64_tr_b16 v[232:233], v251 offset:27872
ds_read_b64_tr_b16 v[234:235], v251 offset:30176
s_waitcnt lgkmcnt(6)
v_mfma_f32_16x16x32_bf16 v[16:19], v[240:243], v[144:147], v[16:19]
v_mfma_f32_16x16x32_bf16 v[52:55], v[240:243], v[148:151], v[52:55]
v_mfma_f32_16x16x32_bf16 v[88:91], v[240:243], v[152:155], v[88:91]
v_mfma_f32_16x16x32_bf16 v[124:127], v[240:243], v[156:159], v[124:127]
ds_read_b64_tr_b16 v[236:237], v251 offset:27904
ds_read_b64_tr_b16 v[238:239], v251 offset:30208
s_waitcnt lgkmcnt(6)
v_mfma_f32_16x16x32_bf16 v[20:23], v[224:227], v[144:147], v[20:23]
v_mfma_f32_16x16x32_bf16 v[56:59], v[224:227], v[148:151], v[56:59]
v_mfma_f32_16x16x32_bf16 v[92:95], v[224:227], v[152:155], v[92:95]
v_mfma_f32_16x16x32_bf16 v[128:131], v[224:227], v[156:159], v[128:131]
s_waitcnt lgkmcnt(4)
v_mfma_f32_16x16x32_bf16 v[24:27], v[228:231], v[144:147], v[24:27]
v_mfma_f32_16x16x32_bf16 v[60:63], v[228:231], v[148:151], v[60:63]
v_mfma_f32_16x16x32_bf16 v[96:99], v[228:231], v[152:155], v[96:99]
v_mfma_f32_16x16x32_bf16 v[132:135], v[228:231], v[156:159], v[132:135]
s_waitcnt lgkmcnt(0)
s_barrier
ds_read_b64_tr_b16 v[240:241], v250 offset:0
ds_read_b64_tr_b16 v[242:243], v250 offset:2304
ds_read_b64_tr_b16 v[224:225], v250 offset:32
ds_read_b64_tr_b16 v[226:227], v250 offset:2336
v_mfma_f32_16x16x32_bf16 v[28:31], v[232:235], v[144:147], v[28:31]
v_mfma_f32_16x16x32_bf16 v[64:67], v[232:235], v[148:151], v[64:67]
v_mfma_f32_16x16x32_bf16 v[100:103], v[232:235], v[152:155], v[100:103]
v_mfma_f32_16x16x32_bf16 v[136:139], v[232:235], v[156:159], v[136:139]
ds_read_b64_tr_b16 v[228:229], v250 offset:64
ds_read_b64_tr_b16 v[230:231], v250 offset:2368
v_mfma_f32_16x16x32_bf16 v[32:35], v[236:239], v[144:147], v[32:35]
v_mfma_f32_16x16x32_bf16 v[68:71], v[236:239], v[148:151], v[68:71]
v_mfma_f32_16x16x32_bf16 v[104:107], v[236:239], v[152:155], v[104:107]
v_mfma_f32_16x16x32_bf16 v[140:143], v[236:239], v[156:159], v[140:143]
ds_read_b64_tr_b16 v[232:233], v250 offset:96
ds_read_b64_tr_b16 v[234:235], v250 offset:2400
s_waitcnt vmcnt(4)
s_waitcnt lgkmcnt(6)
v_mfma_f32_16x16x32_bf16 v[0:3], v[240:243], v[160:163], v[0:3]
v_mfma_f32_16x16x32_bf16 v[36:39], v[240:243], v[164:167], v[36:39]
v_mfma_f32_16x16x32_bf16 v[72:75], v[240:243], v[168:171], v[72:75]
v_mfma_f32_16x16x32_bf16 v[108:111], v[240:243], v[172:175], v[108:111]
ds_read_b64_tr_b16 v[236:237], v250 offset:128
ds_read_b64_tr_b16 v[238:239], v250 offset:2432
s_waitcnt lgkmcnt(6)
v_mfma_f32_16x16x32_bf16 v[4:7], v[224:227], v[160:163], v[4:7]
v_mfma_f32_16x16x32_bf16 v[40:43], v[224:227], v[164:167], v[40:43]
v_mfma_f32_16x16x32_bf16 v[76:79], v[224:227], v[168:171], v[76:79]
v_mfma_f32_16x16x32_bf16 v[112:115], v[224:227], v[172:175], v[112:115]
ds_read_b64_tr_b16 v[240:241], v250 offset:160
ds_read_b64_tr_b16 v[242:243], v250 offset:2464
s_waitcnt lgkmcnt(6)
v_mfma_f32_16x16x32_bf16 v[8:11], v[228:231], v[160:163], v[8:11]
v_mfma_f32_16x16x32_bf16 v[44:47], v[228:231], v[164:167], v[44:47]
v_mfma_f32_16x16x32_bf16 v[80:83], v[228:231], v[168:171], v[80:83]
v_mfma_f32_16x16x32_bf16 v[116:119], v[228:231], v[172:175], v[116:119]
ds_read_b64_tr_b16 v[224:225], v250 offset:192
ds_read_b64_tr_b16 v[226:227], v250 offset:2496
s_waitcnt lgkmcnt(6)
v_mfma_f32_16x16x32_bf16 v[12:15], v[232:235], v[160:163], v[12:15]
v_mfma_f32_16x16x32_bf16 v[48:51], v[232:235], v[164:167], v[48:51]
v_mfma_f32_16x16x32_bf16 v[84:87], v[232:235], v[168:171], v[84:87]
v_mfma_f32_16x16x32_bf16 v[120:123], v[232:235], v[172:175], v[120:123]
ds_read_b64_tr_b16 v[228:229], v250 offset:224
ds_read_b64_tr_b16 v[230:231], v250 offset:2528
s_waitcnt lgkmcnt(6)
v_mfma_f32_16x16x32_bf16 v[16:19], v[236:239], v[160:163], v[16:19]
v_mfma_f32_16x16x32_bf16 v[52:55], v[236:239], v[164:167], v[52:55]
v_mfma_f32_16x16x32_bf16 v[88:91], v[236:239], v[168:171], v[88:91]
v_mfma_f32_16x16x32_bf16 v[124:127], v[236:239], v[172:175], v[124:127]
ds_read_b64_tr_b16 v[232:233], v250 offset:256
ds_read_b64_tr_b16 v[234:235], v250 offset:2560
s_waitcnt lgkmcnt(6)
v_mfma_f32_16x16x32_bf16 v[20:23], v[240:243], v[160:163], v[20:23]
v_mfma_f32_16x16x32_bf16 v[56:59], v[240:243], v[164:167], v[56:59]
v_mfma_f32_16x16x32_bf16 v[92:95], v[240:243], v[168:171], v[92:95]
v_mfma_f32_16x16x32_bf16 v[128:131], v[240:243], v[172:175], v[128:131]
ds_read_b64_tr_b16 v[236:237], v250 offset:9216
ds_read_b64_tr_b16 v[238:239], v250 offset:11520
s_waitcnt lgkmcnt(6)
v_mfma_f32_16x16x32_bf16 v[24:27], v[224:227], v[160:163], v[24:27]
v_mfma_f32_16x16x32_bf16 v[60:63], v[224:227], v[164:167], v[60:63]
v_mfma_f32_16x16x32_bf16 v[96:99], v[224:227], v[168:171], v[96:99]
v_mfma_f32_16x16x32_bf16 v[132:135], v[224:227], v[172:175], v[132:135]
ds_read_b64_tr_b16 v[240:241], v250 offset:9248
ds_read_b64_tr_b16 v[242:243], v250 offset:11552
s_waitcnt lgkmcnt(6)
v_mfma_f32_16x16x32_bf16 v[28:31], v[228:231], v[160:163], v[28:31]
v_mfma_f32_16x16x32_bf16 v[64:67], v[228:231], v[164:167], v[64:67]
v_mfma_f32_16x16x32_bf16 v[100:103], v[228:231], v[168:171], v[100:103]
v_mfma_f32_16x16x32_bf16 v[136:139], v[228:231], v[172:175], v[136:139]
ds_read_b64_tr_b16 v[224:225], v250 offset:9280
ds_read_b64_tr_b16 v[226:227], v250 offset:11584
s_waitcnt lgkmcnt(6)
v_mfma_f32_16x16x32_bf16 v[32:35], v[232:235], v[160:163], v[32:35]
v_mfma_f32_16x16x32_bf16 v[68:71], v[232:235], v[164:167], v[68:71]
v_mfma_f32_16x16x32_bf16 v[104:107], v[232:235], v[168:171], v[104:107]
v_mfma_f32_16x16x32_bf16 v[140:143], v[232:235], v[172:175], v[140:143]
ds_read_b64_tr_b16 v[228:229], v250 offset:9312
ds_read_b64_tr_b16 v[230:231], v250 offset:11616
s_waitcnt vmcnt(0)
s_waitcnt lgkmcnt(6)
v_mfma_f32_16x16x32_bf16 v[0:3], v[236:239], v[176:179], v[0:3]
v_mfma_f32_16x16x32_bf16 v[36:39], v[236:239], v[180:183], v[36:39]
v_mfma_f32_16x16x32_bf16 v[72:75], v[236:239], v[184:187], v[72:75]
v_mfma_f32_16x16x32_bf16 v[108:111], v[236:239], v[188:191], v[108:111]
ds_read_b64_tr_b16 v[232:233], v250 offset:9344
ds_read_b64_tr_b16 v[234:235], v250 offset:11648
s_waitcnt lgkmcnt(6)
v_mfma_f32_16x16x32_bf16 v[4:7], v[240:243], v[176:179], v[4:7]
v_mfma_f32_16x16x32_bf16 v[40:43], v[240:243], v[180:183], v[40:43]
v_mfma_f32_16x16x32_bf16 v[76:79], v[240:243], v[184:187], v[76:79]
v_mfma_f32_16x16x32_bf16 v[112:115], v[240:243], v[188:191], v[112:115]
ds_read_b64_tr_b16 v[236:237], v250 offset:9376
ds_read_b64_tr_b16 v[238:239], v250 offset:11680
s_waitcnt lgkmcnt(6)
v_mfma_f32_16x16x32_bf16 v[8:11], v[224:227], v[176:179], v[8:11]
v_mfma_f32_16x16x32_bf16 v[44:47], v[224:227], v[180:183], v[44:47]
v_mfma_f32_16x16x32_bf16 v[80:83], v[224:227], v[184:187], v[80:83]
v_mfma_f32_16x16x32_bf16 v[116:119], v[224:227], v[188:191], v[116:119]
ds_read_b64_tr_b16 v[240:241], v250 offset:9408
ds_read_b64_tr_b16 v[242:243], v250 offset:11712
s_waitcnt lgkmcnt(6)
v_mfma_f32_16x16x32_bf16 v[12:15], v[228:231], v[176:179], v[12:15]
v_mfma_f32_16x16x32_bf16 v[48:51], v[228:231], v[180:183], v[48:51]
v_mfma_f32_16x16x32_bf16 v[84:87], v[228:231], v[184:187], v[84:87]
v_mfma_f32_16x16x32_bf16 v[120:123], v[228:231], v[188:191], v[120:123]
ds_read_b64_tr_b16 v[224:225], v250 offset:9440
ds_read_b64_tr_b16 v[226:227], v250 offset:11744
s_waitcnt lgkmcnt(6)
v_mfma_f32_16x16x32_bf16 v[16:19], v[232:235], v[176:179], v[16:19]
v_mfma_f32_16x16x32_bf16 v[52:55], v[232:235], v[180:183], v[52:55]
v_mfma_f32_16x16x32_bf16 v[88:91], v[232:235], v[184:187], v[88:91]
v_mfma_f32_16x16x32_bf16 v[124:127], v[232:235], v[188:191], v[124:127]
ds_read_b64_tr_b16 v[228:229], v250 offset:9472
ds_read_b64_tr_b16 v[230:231], v250 offset:11776
s_waitcnt lgkmcnt(6)
v_mfma_f32_16x16x32_bf16 v[20:23], v[236:239], v[176:179], v[20:23]
v_mfma_f32_16x16x32_bf16 v[56:59], v[236:239], v[180:183], v[56:59]
v_mfma_f32_16x16x32_bf16 v[92:95], v[236:239], v[184:187], v[92:95]
v_mfma_f32_16x16x32_bf16 v[128:131], v[236:239], v[188:191], v[128:131]
s_waitcnt lgkmcnt(4)
v_mfma_f32_16x16x32_bf16 v[24:27], v[240:243], v[176:179], v[24:27]
v_mfma_f32_16x16x32_bf16 v[60:63], v[240:243], v[180:183], v[60:63]
v_mfma_f32_16x16x32_bf16 v[96:99], v[240:243], v[184:187], v[96:99]
v_mfma_f32_16x16x32_bf16 v[132:135], v[240:243], v[188:191], v[132:135]
s_waitcnt lgkmcnt(2)
v_mfma_f32_16x16x32_bf16 v[28:31], v[224:227], v[176:179], v[28:31]
v_mfma_f32_16x16x32_bf16 v[64:67], v[224:227], v[180:183], v[64:67]
v_mfma_f32_16x16x32_bf16 v[100:103], v[224:227], v[184:187], v[100:103]
v_mfma_f32_16x16x32_bf16 v[136:139], v[224:227], v[188:191], v[136:139]
s_waitcnt lgkmcnt(0)
v_mfma_f32_16x16x32_bf16 v[32:35], v[228:231], v[176:179], v[32:35]
v_mfma_f32_16x16x32_bf16 v[68:71], v[228:231], v[180:183], v[68:71]
v_mfma_f32_16x16x32_bf16 v[104:107], v[228:231], v[184:187], v[104:107]
v_mfma_f32_16x16x32_bf16 v[140:143], v[228:231], v[188:191], v[140:143]
s_nop 7
s_nop 3
s_setprio 0
v_mov_b32 v252, 0xc0135761
v_lshrrev_b32 v253, 1, v244
s_mov_b32 s36, 0xbdd2d3e8
s_mul_i32 s37, s30, 147456
s_add_u32 s37, s37, 33554432
s_mul_i32 s38, s28, 4608
s_add_u32 s37, s37, s38
v_mov_b32 v228, v252
v_mov_b32 v229, v252
s_mov_b32 s50, s36
s_mov_b32 s51, s36
s_mov_b32 s52, 1.0
s_mov_b32 s53, 1.0
s_add_u32 s46, s37, 0
s_add_u32 s39, s46, 4096
v_pk_mul_f32 v[144:145], v[0:1], v[0:1]
v_pk_mul_f32 v[146:147], v[2:3], v[2:3]
v_pk_fma_f32 v[144:145], v[144:145], s[50:51], v[228:229]
v_pk_fma_f32 v[146:147], v[146:147], s[50:51], v[228:229]
v_pk_mul_f32 v[144:145], v[144:145], v[0:1]
v_pk_mul_f32 v[146:147], v[146:147], v[2:3]
v_exp_f32 v144, v144
v_exp_f32 v145, v145
v_exp_f32 v146, v146
v_exp_f32 v147, v147
v_pk_add_f32 v[144:145], v[144:145], s[52:53]
v_pk_add_f32 v[146:147], v[146:147], s[52:53]
v_rcp_f32 v144, v144
v_rcp_f32 v145, v145
v_rcp_f32 v146, v146
v_rcp_f32 v147, v147
v_pk_mul_f32 v[0:1], v[0:1], v[144:145]
v_pk_mul_f32 v[2:3], v[2:3], v[146:147]
v_cvt_pk_bf16_f32 v148, v0, v1
v_cvt_pk_bf16_f32 v149, v2, v3
v_pk_mul_f32 v[144:145], v[4:5], v[4:5]
v_pk_mul_f32 v[146:147], v[6:7], v[6:7]
v_pk_fma_f32 v[144:145], v[144:145], s[50:51], v[228:229]
v_pk_fma_f32 v[146:147], v[146:147], s[50:51], v[228:229]
v_pk_mul_f32 v[144:145], v[144:145], v[4:5]
v_pk_mul_f32 v[146:147], v[146:147], v[6:7]
v_exp_f32 v144, v144
v_exp_f32 v145, v145
v_exp_f32 v146, v146
v_exp_f32 v147, v147
v_pk_add_f32 v[144:145], v[144:145], s[52:53]
v_pk_add_f32 v[146:147], v[146:147], s[52:53]
v_rcp_f32 v144, v144
v_rcp_f32 v145, v145
v_rcp_f32 v146, v146
v_rcp_f32 v147, v147
v_pk_mul_f32 v[4:5], v[4:5], v[144:145]
v_pk_mul_f32 v[6:7], v[6:7], v[146:147]
v_cvt_pk_bf16_f32 v150, v4, v5
v_cvt_pk_bf16_f32 v151, v6, v7
buffer_store_dwordx4 v[148:151], v244, s[12:15], s46 offen offset:0 sc1
v_pk_mul_f32 v[152:153], v[8:9], v[8:9]
v_pk_mul_f32 v[154:155], v[10:11], v[10:11]
v_pk_fma_f32 v[152:153], v[152:153], s[50:51], v[228:229]
v_pk_fma_f32 v[154:155], v[154:155], s[50:51], v[228:229]
v_pk_mul_f32 v[152:153], v[152:153], v[8:9]
v_pk_mul_f32 v[154:155], v[154:155], v[10:11]
v_exp_f32 v152, v152
v_exp_f32 v153, v153
v_exp_f32 v154, v154
v_exp_f32 v155, v155
v_pk_add_f32 v[152:153], v[152:153], s[52:53]
v_pk_add_f32 v[154:155], v[154:155], s[52:53]
v_rcp_f32 v152, v152
v_rcp_f32 v153, v153
v_rcp_f32 v154, v154
v_rcp_f32 v155, v155
v_pk_mul_f32 v[8:9], v[8:9], v[152:153]
v_pk_mul_f32 v[10:11], v[10:11], v[154:155]
v_cvt_pk_bf16_f32 v156, v8, v9
v_cvt_pk_bf16_f32 v157, v10, v11
v_pk_mul_f32 v[152:153], v[12:13], v[12:13]
v_pk_mul_f32 v[154:155], v[14:15], v[14:15]
v_pk_fma_f32 v[152:153], v[152:153], s[50:51], v[228:229]
v_pk_fma_f32 v[154:155], v[154:155], s[50:51], v[228:229]
v_pk_mul_f32 v[152:153], v[152:153], v[12:13]
v_pk_mul_f32 v[154:155], v[154:155], v[14:15]
v_exp_f32 v152, v152
v_exp_f32 v153, v153
v_exp_f32 v154, v154
v_exp_f32 v155, v155
v_pk_add_f32 v[152:153], v[152:153], s[52:53]
v_pk_add_f32 v[154:155], v[154:155], s[52:53]
v_rcp_f32 v152, v152
v_rcp_f32 v153, v153
v_rcp_f32 v154, v154
v_rcp_f32 v155, v155
v_pk_mul_f32 v[12:13], v[12:13], v[152:153]
v_pk_mul_f32 v[14:15], v[14:15], v[154:155]
v_cvt_pk_bf16_f32 v158, v12, v13
v_cvt_pk_bf16_f32 v159, v14, v15
buffer_store_dwordx4 v[156:159], v244, s[12:15], s46 offen offset:1024 sc1
v_pk_mul_f32 v[160:161], v[16:17], v[16:17]
v_pk_mul_f32 v[162:163], v[18:19], v[18:19]
v_pk_fma_f32 v[160:161], v[160:161], s[50:51], v[228:229]
v_pk_fma_f32 v[162:163], v[162:163], s[50:51], v[228:229]
v_pk_mul_f32 v[160:161], v[160:161], v[16:17]
v_pk_mul_f32 v[162:163], v[162:163], v[18:19]
v_exp_f32 v160, v160
v_exp_f32 v161, v161
v_exp_f32 v162, v162
v_exp_f32 v163, v163
v_pk_add_f32 v[160:161], v[160:161], s[52:53]
v_pk_add_f32 v[162:163], v[162:163], s[52:53]
v_rcp_f32 v160, v160
v_rcp_f32 v161, v161
v_rcp_f32 v162, v162
v_rcp_f32 v163, v163
v_pk_mul_f32 v[16:17], v[16:17], v[160:161]
v_pk_mul_f32 v[18:19], v[18:19], v[162:163]
v_cvt_pk_bf16_f32 v164, v16, v17
v_cvt_pk_bf16_f32 v165, v18, v19
v_pk_mul_f32 v[160:161], v[20:21], v[20:21]
v_pk_mul_f32 v[162:163], v[22:23], v[22:23]
v_pk_fma_f32 v[160:161], v[160:161], s[50:51], v[228:229]
v_pk_fma_f32 v[162:163], v[162:163], s[50:51], v[228:229]
v_pk_mul_f32 v[160:161], v[160:161], v[20:21]
v_pk_mul_f32 v[162:163], v[162:163], v[22:23]
v_exp_f32 v160, v160
v_exp_f32 v161, v161
v_exp_f32 v162, v162
v_exp_f32 v163, v163
v_pk_add_f32 v[160:161], v[160:161], s[52:53]
v_pk_add_f32 v[162:163], v[162:163], s[52:53]
v_rcp_f32 v160, v160
v_rcp_f32 v161, v161
v_rcp_f32 v162, v162
v_rcp_f32 v163, v163
v_pk_mul_f32 v[20:21], v[20:21], v[160:161]
v_pk_mul_f32 v[22:23], v[22:23], v[162:163]
v_cvt_pk_bf16_f32 v166, v20, v21
v_cvt_pk_bf16_f32 v167, v22, v23
buffer_store_dwordx4 v[164:167], v244, s[12:15], s46 offen offset:2048 sc1
v_pk_mul_f32 v[168:169], v[24:25], v[24:25]
v_pk_mul_f32 v[170:171], v[26:27], v[26:27]
v_pk_fma_f32 v[168:169], v[168:169], s[50:51], v[228:229]
v_pk_fma_f32 v[170:171], v[170:171], s[50:51], v[228:229]
v_pk_mul_f32 v[168:169], v[168:169], v[24:25]
v_pk_mul_f32 v[170:171], v[170:171], v[26:27]
v_exp_f32 v168, v168
v_exp_f32 v169, v169
v_exp_f32 v170, v170
v_exp_f32 v171, v171
v_pk_add_f32 v[168:169], v[168:169], s[52:53]
v_pk_add_f32 v[170:171], v[170:171], s[52:53]
v_rcp_f32 v168, v168
v_rcp_f32 v169, v169
v_rcp_f32 v170, v170
v_rcp_f32 v171, v171
v_pk_mul_f32 v[24:25], v[24:25], v[168:169]
v_pk_mul_f32 v[26:27], v[26:27], v[170:171]
v_cvt_pk_bf16_f32 v172, v24, v25
v_cvt_pk_bf16_f32 v173, v26, v27
v_pk_mul_f32 v[168:169], v[28:29], v[28:29]
v_pk_mul_f32 v[170:171], v[30:31], v[30:31]
v_pk_fma_f32 v[168:169], v[168:169], s[50:51], v[228:229]
v_pk_fma_f32 v[170:171], v[170:171], s[50:51], v[228:229]
v_pk_mul_f32 v[168:169], v[168:169], v[28:29]
v_pk_mul_f32 v[170:171], v[170:171], v[30:31]
v_exp_f32 v168, v168
v_exp_f32 v169, v169
v_exp_f32 v170, v170
v_exp_f32 v171, v171
v_pk_add_f32 v[168:169], v[168:169], s[52:53]
v_pk_add_f32 v[170:171], v[170:171], s[52:53]
v_rcp_f32 v168, v168
v_rcp_f32 v169, v169
v_rcp_f32 v170, v170
v_rcp_f32 v171, v171
v_pk_mul_f32 v[28:29], v[28:29], v[168:169]
v_pk_mul_f32 v[30:31], v[30:31], v[170:171]
v_cvt_pk_bf16_f32 v174, v28, v29
v_cvt_pk_bf16_f32 v175, v30, v31
buffer_store_dwordx4 v[172:175], v244, s[12:15], s46 offen offset:3072 sc1
v_pk_mul_f32 v[176:177], v[32:33], v[32:33]
v_pk_mul_f32 v[178:179], v[34:35], v[34:35]
v_pk_fma_f32 v[176:177], v[176:177], s[50:51], v[228:229]
v_pk_fma_f32 v[178:179], v[178:179], s[50:51], v[228:229]
v_pk_mul_f32 v[176:177], v[176:177], v[32:33]
v_pk_mul_f32 v[178:179], v[178:179], v[34:35]
v_exp_f32 v176, v176
v_exp_f32 v177, v177
v_exp_f32 v178, v178
v_exp_f32 v179, v179
v_pk_add_f32 v[176:177], v[176:177], s[52:53]
v_pk_add_f32 v[178:179], v[178:179], s[52:53]
v_rcp_f32 v176, v176
v_rcp_f32 v177, v177
v_rcp_f32 v178, v178
v_rcp_f32 v179, v179
v_pk_mul_f32 v[32:33], v[32:33], v[176:177]
v_pk_mul_f32 v[34:35], v[34:35], v[178:179]
v_cvt_pk_bf16_f32 v180, v32, v33
v_cvt_pk_bf16_f32 v181, v34, v35
buffer_store_dwordx2 v[180:181], v253, s[12:15], s39 offen sc1
s_add_u32 s46, s37, 9437184
s_add_u32 s39, s46, 4096
v_pk_mul_f32 v[184:185], v[36:37], v[36:37]
v_pk_mul_f32 v[186:187], v[38:39], v[38:39]
v_pk_fma_f32 v[184:185], v[184:185], s[50:51], v[228:229]
v_pk_fma_f32 v[186:187], v[186:187], s[50:51], v[228:229]
v_pk_mul_f32 v[184:185], v[184:185], v[36:37]
v_pk_mul_f32 v[186:187], v[186:187], v[38:39]
v_exp_f32 v184, v184
v_exp_f32 v185, v185
v_exp_f32 v186, v186
v_exp_f32 v187, v187
v_pk_add_f32 v[184:185], v[184:185], s[52:53]
v_pk_add_f32 v[186:187], v[186:187], s[52:53]
v_rcp_f32 v184, v184
v_rcp_f32 v185, v185
v_rcp_f32 v186, v186
v_rcp_f32 v187, v187
v_pk_mul_f32 v[36:37], v[36:37], v[184:185]
v_pk_mul_f32 v[38:39], v[38:39], v[186:187]
v_cvt_pk_bf16_f32 v188, v36, v37
v_cvt_pk_bf16_f32 v189, v38, v39
v_pk_mul_f32 v[184:185], v[40:41], v[40:41]
v_pk_mul_f32 v[186:187], v[42:43], v[42:43]
v_pk_fma_f32 v[184:185], v[184:185], s[50:51], v[228:229]
v_pk_fma_f32 v[186:187], v[186:187], s[50:51], v[228:229]
v_pk_mul_f32 v[184:185], v[184:185], v[40:41]
v_pk_mul_f32 v[186:187], v[186:187], v[42:43]
v_exp_f32 v184, v184
v_exp_f32 v185, v185
v_exp_f32 v186, v186
v_exp_f32 v187, v187
v_pk_add_f32 v[184:185], v[184:185], s[52:53]
v_pk_add_f32 v[186:187], v[186:187], s[52:53]
v_rcp_f32 v184, v184
v_rcp_f32 v185, v185
v_rcp_f32 v186, v186
v_rcp_f32 v187, v187
v_pk_mul_f32 v[40:41], v[40:41], v[184:185]
v_pk_mul_f32 v[42:43], v[42:43], v[186:187]
v_cvt_pk_bf16_f32 v190, v40, v41
v_cvt_pk_bf16_f32 v191, v42, v43
buffer_store_dwordx4 v[188:191], v244, s[12:15], s46 offen offset:0 sc1
v_pk_mul_f32 v[192:193], v[44:45], v[44:45]
v_pk_mul_f32 v[194:195], v[46:47], v[46:47]
v_pk_fma_f32 v[192:193], v[192:193], s[50:51], v[228:229]
v_pk_fma_f32 v[194:195], v[194:195], s[50:51], v[228:229]
v_pk_mul_f32 v[192:193], v[192:193], v[44:45]
v_pk_mul_f32 v[194:195], v[194:195], v[46:47]
v_exp_f32 v192, v192
v_exp_f32 v193, v193
v_exp_f32 v194, v194
v_exp_f32 v195, v195
v_pk_add_f32 v[192:193], v[192:193], s[52:53]
v_pk_add_f32 v[194:195], v[194:195], s[52:53]
v_rcp_f32 v192, v192
v_rcp_f32 v193, v193
v_rcp_f32 v194, v194
v_rcp_f32 v195, v195
v_pk_mul_f32 v[44:45], v[44:45], v[192:193]
v_pk_mul_f32 v[46:47], v[46:47], v[194:195]
v_cvt_pk_bf16_f32 v196, v44, v45
v_cvt_pk_bf16_f32 v197, v46, v47
v_pk_mul_f32 v[192:193], v[48:49], v[48:49]
v_pk_mul_f32 v[194:195], v[50:51], v[50:51]
v_pk_fma_f32 v[192:193], v[192:193], s[50:51], v[228:229]
v_pk_fma_f32 v[194:195], v[194:195], s[50:51], v[228:229]
v_pk_mul_f32 v[192:193], v[192:193], v[48:49]
v_pk_mul_f32 v[194:195], v[194:195], v[50:51]
v_exp_f32 v192, v192
v_exp_f32 v193, v193
v_exp_f32 v194, v194
v_exp_f32 v195, v195
v_pk_add_f32 v[192:193], v[192:193], s[52:53]
v_pk_add_f32 v[194:195], v[194:195], s[52:53]
v_rcp_f32 v192, v192
v_rcp_f32 v193, v193
v_rcp_f32 v194, v194
v_rcp_f32 v195, v195
v_pk_mul_f32 v[48:49], v[48:49], v[192:193]
v_pk_mul_f32 v[50:51], v[50:51], v[194:195]
v_cvt_pk_bf16_f32 v198, v48, v49
v_cvt_pk_bf16_f32 v199, v50, v51
buffer_store_dwordx4 v[196:199], v244, s[12:15], s46 offen offset:1024 sc1
v_pk_mul_f32 v[200:201], v[52:53], v[52:53]
v_pk_mul_f32 v[202:203], v[54:55], v[54:55]
v_pk_fma_f32 v[200:201], v[200:201], s[50:51], v[228:229]
v_pk_fma_f32 v[202:203], v[202:203], s[50:51], v[228:229]
v_pk_mul_f32 v[200:201], v[200:201], v[52:53]
v_pk_mul_f32 v[202:203], v[202:203], v[54:55]
v_exp_f32 v200, v200
v_exp_f32 v201, v201
v_exp_f32 v202, v202
v_exp_f32 v203, v203
v_pk_add_f32 v[200:201], v[200:201], s[52:53]
v_pk_add_f32 v[202:203], v[202:203], s[52:53]
v_rcp_f32 v200, v200
v_rcp_f32 v201, v201
v_rcp_f32 v202, v202
v_rcp_f32 v203, v203
v_pk_mul_f32 v[52:53], v[52:53], v[200:201]
v_pk_mul_f32 v[54:55], v[54:55], v[202:203]
v_cvt_pk_bf16_f32 v204, v52, v53
v_cvt_pk_bf16_f32 v205, v54, v55
v_pk_mul_f32 v[200:201], v[56:57], v[56:57]
v_pk_mul_f32 v[202:203], v[58:59], v[58:59]
v_pk_fma_f32 v[200:201], v[200:201], s[50:51], v[228:229]
v_pk_fma_f32 v[202:203], v[202:203], s[50:51], v[228:229]
v_pk_mul_f32 v[200:201], v[200:201], v[56:57]
v_pk_mul_f32 v[202:203], v[202:203], v[58:59]
v_exp_f32 v200, v200
v_exp_f32 v201, v201
v_exp_f32 v202, v202
v_exp_f32 v203, v203
v_pk_add_f32 v[200:201], v[200:201], s[52:53]
v_pk_add_f32 v[202:203], v[202:203], s[52:53]
v_rcp_f32 v200, v200
v_rcp_f32 v201, v201
v_rcp_f32 v202, v202
v_rcp_f32 v203, v203
v_pk_mul_f32 v[56:57], v[56:57], v[200:201]
v_pk_mul_f32 v[58:59], v[58:59], v[202:203]
v_cvt_pk_bf16_f32 v206, v56, v57
v_cvt_pk_bf16_f32 v207, v58, v59
buffer_store_dwordx4 v[204:207], v244, s[12:15], s46 offen offset:2048 sc1
v_pk_mul_f32 v[208:209], v[60:61], v[60:61]
v_pk_mul_f32 v[210:211], v[62:63], v[62:63]
v_pk_fma_f32 v[208:209], v[208:209], s[50:51], v[228:229]
v_pk_fma_f32 v[210:211], v[210:211], s[50:51], v[228:229]
v_pk_mul_f32 v[208:209], v[208:209], v[60:61]
v_pk_mul_f32 v[210:211], v[210:211], v[62:63]
v_exp_f32 v208, v208
v_exp_f32 v209, v209
v_exp_f32 v210, v210
v_exp_f32 v211, v211
v_pk_add_f32 v[208:209], v[208:209], s[52:53]
v_pk_add_f32 v[210:211], v[210:211], s[52:53]
v_rcp_f32 v208, v208
v_rcp_f32 v209, v209
v_rcp_f32 v210, v210
v_rcp_f32 v211, v211
v_pk_mul_f32 v[60:61], v[60:61], v[208:209]
v_pk_mul_f32 v[62:63], v[62:63], v[210:211]
v_cvt_pk_bf16_f32 v212, v60, v61
v_cvt_pk_bf16_f32 v213, v62, v63
v_pk_mul_f32 v[208:209], v[64:65], v[64:65]
v_pk_mul_f32 v[210:211], v[66:67], v[66:67]
v_pk_fma_f32 v[208:209], v[208:209], s[50:51], v[228:229]
v_pk_fma_f32 v[210:211], v[210:211], s[50:51], v[228:229]
v_pk_mul_f32 v[208:209], v[208:209], v[64:65]
v_pk_mul_f32 v[210:211], v[210:211], v[66:67]
v_exp_f32 v208, v208
v_exp_f32 v209, v209
v_exp_f32 v210, v210
v_exp_f32 v211, v211
v_pk_add_f32 v[208:209], v[208:209], s[52:53]
v_pk_add_f32 v[210:211], v[210:211], s[52:53]
v_rcp_f32 v208, v208
v_rcp_f32 v209, v209
v_rcp_f32 v210, v210
v_rcp_f32 v211, v211
v_pk_mul_f32 v[64:65], v[64:65], v[208:209]
v_pk_mul_f32 v[66:67], v[66:67], v[210:211]
v_cvt_pk_bf16_f32 v214, v64, v65
v_cvt_pk_bf16_f32 v215, v66, v67
buffer_store_dwordx4 v[212:215], v244, s[12:15], s46 offen offset:3072 sc1
v_pk_mul_f32 v[216:217], v[68:69], v[68:69]
v_pk_mul_f32 v[218:219], v[70:71], v[70:71]
v_pk_fma_f32 v[216:217], v[216:217], s[50:51], v[228:229]
v_pk_fma_f32 v[218:219], v[218:219], s[50:51], v[228:229]
v_pk_mul_f32 v[216:217], v[216:217], v[68:69]
v_pk_mul_f32 v[218:219], v[218:219], v[70:71]
v_exp_f32 v216, v216
v_exp_f32 v217, v217
v_exp_f32 v218, v218
v_exp_f32 v219, v219
v_pk_add_f32 v[216:217], v[216:217], s[52:53]
v_pk_add_f32 v[218:219], v[218:219], s[52:53]
v_rcp_f32 v216, v216
v_rcp_f32 v217, v217
v_rcp_f32 v218, v218
v_rcp_f32 v219, v219
v_pk_mul_f32 v[68:69], v[68:69], v[216:217]
v_pk_mul_f32 v[70:71], v[70:71], v[218:219]
v_cvt_pk_bf16_f32 v220, v68, v69
v_cvt_pk_bf16_f32 v221, v70, v71
buffer_store_dwordx2 v[220:221], v253, s[12:15], s39 offen sc1
s_add_u32 s46, s37, 147456
s_add_u32 s39, s46, 4096
v_pk_mul_f32 v[144:145], v[72:73], v[72:73]
v_pk_mul_f32 v[146:147], v[74:75], v[74:75]
v_pk_fma_f32 v[144:145], v[144:145], s[50:51], v[228:229]
v_pk_fma_f32 v[146:147], v[146:147], s[50:51], v[228:229]
v_pk_mul_f32 v[144:145], v[144:145], v[72:73]
v_pk_mul_f32 v[146:147], v[146:147], v[74:75]
v_exp_f32 v144, v144
v_exp_f32 v145, v145
v_exp_f32 v146, v146
v_exp_f32 v147, v147
v_pk_add_f32 v[144:145], v[144:145], s[52:53]
v_pk_add_f32 v[146:147], v[146:147], s[52:53]
v_rcp_f32 v144, v144
v_rcp_f32 v145, v145
v_rcp_f32 v146, v146
v_rcp_f32 v147, v147
v_pk_mul_f32 v[72:73], v[72:73], v[144:145]
v_pk_mul_f32 v[74:75], v[74:75], v[146:147]
v_cvt_pk_bf16_f32 v148, v72, v73
v_cvt_pk_bf16_f32 v149, v74, v75
v_pk_mul_f32 v[144:145], v[76:77], v[76:77]
v_pk_mul_f32 v[146:147], v[78:79], v[78:79]
v_pk_fma_f32 v[144:145], v[144:145], s[50:51], v[228:229]
v_pk_fma_f32 v[146:147], v[146:147], s[50:51], v[228:229]
v_pk_mul_f32 v[144:145], v[144:145], v[76:77]
v_pk_mul_f32 v[146:147], v[146:147], v[78:79]
v_exp_f32 v144, v144
v_exp_f32 v145, v145
v_exp_f32 v146, v146
v_exp_f32 v147, v147
v_pk_add_f32 v[144:145], v[144:145], s[52:53]
v_pk_add_f32 v[146:147], v[146:147], s[52:53]
v_rcp_f32 v144, v144
v_rcp_f32 v145, v145
v_rcp_f32 v146, v146
v_rcp_f32 v147, v147
v_pk_mul_f32 v[76:77], v[76:77], v[144:145]
v_pk_mul_f32 v[78:79], v[78:79], v[146:147]
v_cvt_pk_bf16_f32 v150, v76, v77
v_cvt_pk_bf16_f32 v151, v78, v79
buffer_store_dwordx4 v[148:151], v244, s[12:15], s46 offen offset:0 sc1
v_pk_mul_f32 v[152:153], v[80:81], v[80:81]
v_pk_mul_f32 v[154:155], v[82:83], v[82:83]
v_pk_fma_f32 v[152:153], v[152:153], s[50:51], v[228:229]
v_pk_fma_f32 v[154:155], v[154:155], s[50:51], v[228:229]
v_pk_mul_f32 v[152:153], v[152:153], v[80:81]
v_pk_mul_f32 v[154:155], v[154:155], v[82:83]
v_exp_f32 v152, v152
v_exp_f32 v153, v153
v_exp_f32 v154, v154
v_exp_f32 v155, v155
v_pk_add_f32 v[152:153], v[152:153], s[52:53]
v_pk_add_f32 v[154:155], v[154:155], s[52:53]
v_rcp_f32 v152, v152
v_rcp_f32 v153, v153
v_rcp_f32 v154, v154
v_rcp_f32 v155, v155
v_pk_mul_f32 v[80:81], v[80:81], v[152:153]
v_pk_mul_f32 v[82:83], v[82:83], v[154:155]
v_cvt_pk_bf16_f32 v156, v80, v81
v_cvt_pk_bf16_f32 v157, v82, v83
v_pk_mul_f32 v[152:153], v[84:85], v[84:85]
v_pk_mul_f32 v[154:155], v[86:87], v[86:87]
v_pk_fma_f32 v[152:153], v[152:153], s[50:51], v[228:229]
v_pk_fma_f32 v[154:155], v[154:155], s[50:51], v[228:229]
v_pk_mul_f32 v[152:153], v[152:153], v[84:85]
v_pk_mul_f32 v[154:155], v[154:155], v[86:87]
v_exp_f32 v152, v152
v_exp_f32 v153, v153
v_exp_f32 v154, v154
v_exp_f32 v155, v155
v_pk_add_f32 v[152:153], v[152:153], s[52:53]
v_pk_add_f32 v[154:155], v[154:155], s[52:53]
v_rcp_f32 v152, v152
v_rcp_f32 v153, v153
v_rcp_f32 v154, v154
v_rcp_f32 v155, v155
v_pk_mul_f32 v[84:85], v[84:85], v[152:153]
v_pk_mul_f32 v[86:87], v[86:87], v[154:155]
v_cvt_pk_bf16_f32 v158, v84, v85
v_cvt_pk_bf16_f32 v159, v86, v87
buffer_store_dwordx4 v[156:159], v244, s[12:15], s46 offen offset:1024 sc1
v_pk_mul_f32 v[160:161], v[88:89], v[88:89]
v_pk_mul_f32 v[162:163], v[90:91], v[90:91]
v_pk_fma_f32 v[160:161], v[160:161], s[50:51], v[228:229]
v_pk_fma_f32 v[162:163], v[162:163], s[50:51], v[228:229]
v_pk_mul_f32 v[160:161], v[160:161], v[88:89]
v_pk_mul_f32 v[162:163], v[162:163], v[90:91]
v_exp_f32 v160, v160
v_exp_f32 v161, v161
v_exp_f32 v162, v162
v_exp_f32 v163, v163
v_pk_add_f32 v[160:161], v[160:161], s[52:53]
v_pk_add_f32 v[162:163], v[162:163], s[52:53]
v_rcp_f32 v160, v160
v_rcp_f32 v161, v161
v_rcp_f32 v162, v162
v_rcp_f32 v163, v163
v_pk_mul_f32 v[88:89], v[88:89], v[160:161]
v_pk_mul_f32 v[90:91], v[90:91], v[162:163]
v_cvt_pk_bf16_f32 v164, v88, v89
v_cvt_pk_bf16_f32 v165, v90, v91
v_pk_mul_f32 v[160:161], v[92:93], v[92:93]
v_pk_mul_f32 v[162:163], v[94:95], v[94:95]
v_pk_fma_f32 v[160:161], v[160:161], s[50:51], v[228:229]
v_pk_fma_f32 v[162:163], v[162:163], s[50:51], v[228:229]
v_pk_mul_f32 v[160:161], v[160:161], v[92:93]
v_pk_mul_f32 v[162:163], v[162:163], v[94:95]
v_exp_f32 v160, v160
v_exp_f32 v161, v161
v_exp_f32 v162, v162
v_exp_f32 v163, v163
v_pk_add_f32 v[160:161], v[160:161], s[52:53]
v_pk_add_f32 v[162:163], v[162:163], s[52:53]
v_rcp_f32 v160, v160
v_rcp_f32 v161, v161
v_rcp_f32 v162, v162
v_rcp_f32 v163, v163
v_pk_mul_f32 v[92:93], v[92:93], v[160:161]
v_pk_mul_f32 v[94:95], v[94:95], v[162:163]
v_cvt_pk_bf16_f32 v166, v92, v93
v_cvt_pk_bf16_f32 v167, v94, v95
buffer_store_dwordx4 v[164:167], v244, s[12:15], s46 offen offset:2048 sc1
v_pk_mul_f32 v[168:169], v[96:97], v[96:97]
v_pk_mul_f32 v[170:171], v[98:99], v[98:99]
v_pk_fma_f32 v[168:169], v[168:169], s[50:51], v[228:229]
v_pk_fma_f32 v[170:171], v[170:171], s[50:51], v[228:229]
v_pk_mul_f32 v[168:169], v[168:169], v[96:97]
v_pk_mul_f32 v[170:171], v[170:171], v[98:99]
v_exp_f32 v168, v168
v_exp_f32 v169, v169
v_exp_f32 v170, v170
v_exp_f32 v171, v171
v_pk_add_f32 v[168:169], v[168:169], s[52:53]
v_pk_add_f32 v[170:171], v[170:171], s[52:53]
v_rcp_f32 v168, v168
v_rcp_f32 v169, v169
v_rcp_f32 v170, v170
v_rcp_f32 v171, v171
v_pk_mul_f32 v[96:97], v[96:97], v[168:169]
v_pk_mul_f32 v[98:99], v[98:99], v[170:171]
v_cvt_pk_bf16_f32 v172, v96, v97
v_cvt_pk_bf16_f32 v173, v98, v99
v_pk_mul_f32 v[168:169], v[100:101], v[100:101]
v_pk_mul_f32 v[170:171], v[102:103], v[102:103]
v_pk_fma_f32 v[168:169], v[168:169], s[50:51], v[228:229]
v_pk_fma_f32 v[170:171], v[170:171], s[50:51], v[228:229]
v_pk_mul_f32 v[168:169], v[168:169], v[100:101]
v_pk_mul_f32 v[170:171], v[170:171], v[102:103]
v_exp_f32 v168, v168
v_exp_f32 v169, v169
v_exp_f32 v170, v170
v_exp_f32 v171, v171
v_pk_add_f32 v[168:169], v[168:169], s[52:53]
v_pk_add_f32 v[170:171], v[170:171], s[52:53]
v_rcp_f32 v168, v168
v_rcp_f32 v169, v169
v_rcp_f32 v170, v170
v_rcp_f32 v171, v171
v_pk_mul_f32 v[100:101], v[100:101], v[168:169]
v_pk_mul_f32 v[102:103], v[102:103], v[170:171]
v_cvt_pk_bf16_f32 v174, v100, v101
v_cvt_pk_bf16_f32 v175, v102, v103
buffer_store_dwordx4 v[172:175], v244, s[12:15], s46 offen offset:3072 sc1
v_pk_mul_f32 v[176:177], v[104:105], v[104:105]
v_pk_mul_f32 v[178:179], v[106:107], v[106:107]
v_pk_fma_f32 v[176:177], v[176:177], s[50:51], v[228:229]
v_pk_fma_f32 v[178:179], v[178:179], s[50:51], v[228:229]
v_pk_mul_f32 v[176:177], v[176:177], v[104:105]
v_pk_mul_f32 v[178:179], v[178:179], v[106:107]
v_exp_f32 v176, v176
v_exp_f32 v177, v177
v_exp_f32 v178, v178
v_exp_f32 v179, v179
v_pk_add_f32 v[176:177], v[176:177], s[52:53]
v_pk_add_f32 v[178:179], v[178:179], s[52:53]
v_rcp_f32 v176, v176
v_rcp_f32 v177, v177
v_rcp_f32 v178, v178
v_rcp_f32 v179, v179
v_pk_mul_f32 v[104:105], v[104:105], v[176:177]
v_pk_mul_f32 v[106:107], v[106:107], v[178:179]
v_cvt_pk_bf16_f32 v180, v104, v105
v_cvt_pk_bf16_f32 v181, v106, v107
buffer_store_dwordx2 v[180:181], v253, s[12:15], s39 offen sc1
s_add_u32 s46, s37, 9584640
s_add_u32 s39, s46, 4096
v_pk_mul_f32 v[184:185], v[108:109], v[108:109]
v_pk_mul_f32 v[186:187], v[110:111], v[110:111]
v_pk_fma_f32 v[184:185], v[184:185], s[50:51], v[228:229]
v_pk_fma_f32 v[186:187], v[186:187], s[50:51], v[228:229]
v_pk_mul_f32 v[184:185], v[184:185], v[108:109]
v_pk_mul_f32 v[186:187], v[186:187], v[110:111]
v_exp_f32 v184, v184
v_exp_f32 v185, v185
v_exp_f32 v186, v186
v_exp_f32 v187, v187
v_pk_add_f32 v[184:185], v[184:185], s[52:53]
v_pk_add_f32 v[186:187], v[186:187], s[52:53]
v_rcp_f32 v184, v184
v_rcp_f32 v185, v185
v_rcp_f32 v186, v186
v_rcp_f32 v187, v187
v_pk_mul_f32 v[108:109], v[108:109], v[184:185]
v_pk_mul_f32 v[110:111], v[110:111], v[186:187]
v_cvt_pk_bf16_f32 v188, v108, v109
v_cvt_pk_bf16_f32 v189, v110, v111
v_pk_mul_f32 v[184:185], v[112:113], v[112:113]
v_pk_mul_f32 v[186:187], v[114:115], v[114:115]
v_pk_fma_f32 v[184:185], v[184:185], s[50:51], v[228:229]
v_pk_fma_f32 v[186:187], v[186:187], s[50:51], v[228:229]
v_pk_mul_f32 v[184:185], v[184:185], v[112:113]
v_pk_mul_f32 v[186:187], v[186:187], v[114:115]
v_exp_f32 v184, v184
v_exp_f32 v185, v185
v_exp_f32 v186, v186
v_exp_f32 v187, v187
v_pk_add_f32 v[184:185], v[184:185], s[52:53]
v_pk_add_f32 v[186:187], v[186:187], s[52:53]
v_rcp_f32 v184, v184
v_rcp_f32 v185, v185
v_rcp_f32 v186, v186
v_rcp_f32 v187, v187
v_pk_mul_f32 v[112:113], v[112:113], v[184:185]
v_pk_mul_f32 v[114:115], v[114:115], v[186:187]
v_cvt_pk_bf16_f32 v190, v112, v113
v_cvt_pk_bf16_f32 v191, v114, v115
buffer_store_dwordx4 v[188:191], v244, s[12:15], s46 offen offset:0 sc1
v_pk_mul_f32 v[192:193], v[116:117], v[116:117]
v_pk_mul_f32 v[194:195], v[118:119], v[118:119]
v_pk_fma_f32 v[192:193], v[192:193], s[50:51], v[228:229]
v_pk_fma_f32 v[194:195], v[194:195], s[50:51], v[228:229]
v_pk_mul_f32 v[192:193], v[192:193], v[116:117]
v_pk_mul_f32 v[194:195], v[194:195], v[118:119]
v_exp_f32 v192, v192
v_exp_f32 v193, v193
v_exp_f32 v194, v194
v_exp_f32 v195, v195
v_pk_add_f32 v[192:193], v[192:193], s[52:53]
v_pk_add_f32 v[194:195], v[194:195], s[52:53]
v_rcp_f32 v192, v192
v_rcp_f32 v193, v193
v_rcp_f32 v194, v194
v_rcp_f32 v195, v195
v_pk_mul_f32 v[116:117], v[116:117], v[192:193]
v_pk_mul_f32 v[118:119], v[118:119], v[194:195]
v_cvt_pk_bf16_f32 v196, v116, v117
v_cvt_pk_bf16_f32 v197, v118, v119
v_pk_mul_f32 v[192:193], v[120:121], v[120:121]
v_pk_mul_f32 v[194:195], v[122:123], v[122:123]
v_pk_fma_f32 v[192:193], v[192:193], s[50:51], v[228:229]
v_pk_fma_f32 v[194:195], v[194:195], s[50:51], v[228:229]
v_pk_mul_f32 v[192:193], v[192:193], v[120:121]
v_pk_mul_f32 v[194:195], v[194:195], v[122:123]
v_exp_f32 v192, v192
v_exp_f32 v193, v193
v_exp_f32 v194, v194
v_exp_f32 v195, v195
v_pk_add_f32 v[192:193], v[192:193], s[52:53]
v_pk_add_f32 v[194:195], v[194:195], s[52:53]
v_rcp_f32 v192, v192
v_rcp_f32 v193, v193
v_rcp_f32 v194, v194
v_rcp_f32 v195, v195
v_pk_mul_f32 v[120:121], v[120:121], v[192:193]
v_pk_mul_f32 v[122:123], v[122:123], v[194:195]
v_cvt_pk_bf16_f32 v198, v120, v121
v_cvt_pk_bf16_f32 v199, v122, v123
buffer_store_dwordx4 v[196:199], v244, s[12:15], s46 offen offset:1024 sc1
v_pk_mul_f32 v[200:201], v[124:125], v[124:125]
v_pk_mul_f32 v[202:203], v[126:127], v[126:127]
v_pk_fma_f32 v[200:201], v[200:201], s[50:51], v[228:229]
v_pk_fma_f32 v[202:203], v[202:203], s[50:51], v[228:229]
v_pk_mul_f32 v[200:201], v[200:201], v[124:125]
v_pk_mul_f32 v[202:203], v[202:203], v[126:127]
v_exp_f32 v200, v200
v_exp_f32 v201, v201
v_exp_f32 v202, v202
v_exp_f32 v203, v203
v_pk_add_f32 v[200:201], v[200:201], s[52:53]
v_pk_add_f32 v[202:203], v[202:203], s[52:53]
v_rcp_f32 v200, v200
v_rcp_f32 v201, v201
v_rcp_f32 v202, v202
v_rcp_f32 v203, v203
v_pk_mul_f32 v[124:125], v[124:125], v[200:201]
v_pk_mul_f32 v[126:127], v[126:127], v[202:203]
v_cvt_pk_bf16_f32 v204, v124, v125
v_cvt_pk_bf16_f32 v205, v126, v127
v_pk_mul_f32 v[200:201], v[128:129], v[128:129]
v_pk_mul_f32 v[202:203], v[130:131], v[130:131]
v_pk_fma_f32 v[200:201], v[200:201], s[50:51], v[228:229]
v_pk_fma_f32 v[202:203], v[202:203], s[50:51], v[228:229]
v_pk_mul_f32 v[200:201], v[200:201], v[128:129]
v_pk_mul_f32 v[202:203], v[202:203], v[130:131]
v_exp_f32 v200, v200
v_exp_f32 v201, v201
v_exp_f32 v202, v202
v_exp_f32 v203, v203
v_pk_add_f32 v[200:201], v[200:201], s[52:53]
v_pk_add_f32 v[202:203], v[202:203], s[52:53]
v_rcp_f32 v200, v200
v_rcp_f32 v201, v201
v_rcp_f32 v202, v202
v_rcp_f32 v203, v203
v_pk_mul_f32 v[128:129], v[128:129], v[200:201]
v_pk_mul_f32 v[130:131], v[130:131], v[202:203]
v_cvt_pk_bf16_f32 v206, v128, v129
v_cvt_pk_bf16_f32 v207, v130, v131
buffer_store_dwordx4 v[204:207], v244, s[12:15], s46 offen offset:2048 sc1
v_pk_mul_f32 v[208:209], v[132:133], v[132:133]
v_pk_mul_f32 v[210:211], v[134:135], v[134:135]
v_pk_fma_f32 v[208:209], v[208:209], s[50:51], v[228:229]
v_pk_fma_f32 v[210:211], v[210:211], s[50:51], v[228:229]
v_pk_mul_f32 v[208:209], v[208:209], v[132:133]
v_pk_mul_f32 v[210:211], v[210:211], v[134:135]
v_exp_f32 v208, v208
v_exp_f32 v209, v209
v_exp_f32 v210, v210
v_exp_f32 v211, v211
v_pk_add_f32 v[208:209], v[208:209], s[52:53]
v_pk_add_f32 v[210:211], v[210:211], s[52:53]
v_rcp_f32 v208, v208
v_rcp_f32 v209, v209
v_rcp_f32 v210, v210
v_rcp_f32 v211, v211
v_pk_mul_f32 v[132:133], v[132:133], v[208:209]
v_pk_mul_f32 v[134:135], v[134:135], v[210:211]
v_cvt_pk_bf16_f32 v212, v132, v133
v_cvt_pk_bf16_f32 v213, v134, v135
v_pk_mul_f32 v[208:209], v[136:137], v[136:137]
v_pk_mul_f32 v[210:211], v[138:139], v[138:139]
v_pk_fma_f32 v[208:209], v[208:209], s[50:51], v[228:229]
v_pk_fma_f32 v[210:211], v[210:211], s[50:51], v[228:229]
v_pk_mul_f32 v[208:209], v[208:209], v[136:137]
v_pk_mul_f32 v[210:211], v[210:211], v[138:139]
v_exp_f32 v208, v208
v_exp_f32 v209, v209
v_exp_f32 v210, v210
v_exp_f32 v211, v211
v_pk_add_f32 v[208:209], v[208:209], s[52:53]
v_pk_add_f32 v[210:211], v[210:211], s[52:53]
v_rcp_f32 v208, v208
v_rcp_f32 v209, v209
v_rcp_f32 v210, v210
v_rcp_f32 v211, v211
v_pk_mul_f32 v[136:137], v[136:137], v[208:209]
v_pk_mul_f32 v[138:139], v[138:139], v[210:211]
v_cvt_pk_bf16_f32 v214, v136, v137
v_cvt_pk_bf16_f32 v215, v138, v139
buffer_store_dwordx4 v[212:215], v244, s[12:15], s46 offen offset:3072 sc1
v_pk_mul_f32 v[216:217], v[140:141], v[140:141]
v_pk_mul_f32 v[218:219], v[142:143], v[142:143]
v_pk_fma_f32 v[216:217], v[216:217], s[50:51], v[228:229]
v_pk_fma_f32 v[218:219], v[218:219], s[50:51], v[228:229]
v_pk_mul_f32 v[216:217], v[216:217], v[140:141]
v_pk_mul_f32 v[218:219], v[218:219], v[142:143]
v_exp_f32 v216, v216
v_exp_f32 v217, v217
v_exp_f32 v218, v218
v_exp_f32 v219, v219
v_pk_add_f32 v[216:217], v[216:217], s[52:53]
v_pk_add_f32 v[218:219], v[218:219], s[52:53]
v_rcp_f32 v216, v216
v_rcp_f32 v217, v217
v_rcp_f32 v218, v218
v_rcp_f32 v219, v219
v_pk_mul_f32 v[140:141], v[140:141], v[216:217]
v_pk_mul_f32 v[142:143], v[142:143], v[218:219]
v_cvt_pk_bf16_f32 v220, v140, v141
v_cvt_pk_bf16_f32 v221, v142, v143
buffer_store_dwordx2 v[220:221], v253, s[12:15], s39 offen sc1
s_endpgm
K1_b:
s_cmp_ge_u32 s2, 264
s_cbranch_scc1 K1_rd
s_getpc_b64 s[4:5]
s_add_u32 s4, s4, k1_kernel@rel32@lo+4
s_addc_u32 s5, s5, k1_kernel@rel32@hi+12
v_lshlrev_b32 v2, 6, v0
global_load_dword v1, v2, s[4:5]
v_add_u32 v2, 16384, v2
global_load_dword v1, v2, s[4:5]
s_endpgm
K1_rd:
s_sub_u32 s3, s2, 264
s_cmp_ge_u32 s3, 192
s_cbranch_scc1 K1_pre
s_load_dwordx2 s[6:7], s[0:1], 80
v_lshrrev_b32 v1, 6, v0
v_and_b32 v2, 63, v0
v_readfirstlane_b32 s24, v1
s_and_b32 s25, s3, 31
s_lshr_b32 s26, s3, 5
s_mul_i32 s27, s26, 6
s_add_u32 s27, s27, s24
s_getpc_b64 s[4:5]
s_add_u32 s4, s4, tab_tf@rel32@lo+4
s_addc_u32 s5, s5, tab_tf@rel32@hi+12
s_mov_b32 s8, s4
s_and_b32 s9, s5, 0xffff
s_mov_b32 s10, 331776
s_mov_b32 s11, 0x00020000
s_waitcnt lgkmcnt(0)
s_mov_b32 s12, s6
s_and_b32 s13, s7, 0xffff
s_mov_b32 s14, 268435456
s_mov_b32 s15, 0x00020000
v_lshlrev_b32 v3, 4, v2
s_lshr_b32 s28, s24, 1
s_lshl_b32 s28, s28, 5
s_add_u32 s28, s28, s25
s_lshl_b32 s28, s28, 1
s_and_b32 s29, s24, 1
s_add_u32 s28, s28, s29
s_mul_i32 s28, s28, 18432
s_add_u32 s28, s28, 0
s_mul_i32 s29, s24, 18432
s_mov_b32 s35, 0
s_add_u32 m0, s29, 0
s_add_u32 s31, s28, 0
buffer_load_dwordx4 v3, s[12:15], s31 offen lds
s_add_u32 m0, s29, 1024
s_add_u32 s31, s28, 1024
buffer_load_dwordx4 v3, s[12:15], s31 offen lds
s_add_u32 m0, s29, 2048
s_add_u32 s31, s28, 2048
buffer_load_dwordx4 v3, s[12:15], s31 offen lds
s_add_u32 m0, s29, 3072
s_add_u32 s31, s28, 3072
buffer_load_dwordx4 v3, s[12:15], s31 offen lds
s_add_u32 m0, s29, 4096
s_add_u32 s31, s28, 4096
buffer_load_dwordx4 v3, s[12:15], s31 offen lds
s_add_u32 m0, s29, 5120
s_add_u32 s31, s28, 5120
buffer_load_dwordx4 v3, s[12:15], s31 offen lds
s_add_u32 m0, s29, 6144
s_add_u32 s31, s28, 6144
buffer_load_dwordx4 v3, s[12:15], s31 offen lds
s_add_u32 m0, s29, 7168
s_add_u32 s31, s28, 7168
buffer_load_dwordx4 v3, s[12:15], s31 offen lds
s_add_u32 m0, s29, 8192
s_add_u32 s31, s28, 8192
buffer_load_dwordx4 v3, s[12:15], s31 offen lds
s_add_u32 m0, s29, 9216
s_add_u32 s31, s28, 9216
buffer_load_dwordx4 v3, s[12:15], s31 offen lds
s_add_u32 m0, s29, 10240
s_add_u32 s31, s28, 10240
buffer_load_dwordx4 v3, s[12:15], s31 offen lds
s_add_u32 m0, s29, 11264
s_add_u32 s31, s28, 11264
buffer_load_dwordx4 v3, s[12:15], s31 offen lds
s_add_u32 m0, s29, 12288
s_add_u32 s31, s28, 12288
buffer_load_dwordx4 v3, s[12:15], s31 offen lds
s_add_u32 m0, s29, 13312
s_add_u32 s31, s28, 13312
buffer_load_dwordx4 v3, s[12:15], s31 offen lds
s_add_u32 m0, s29, 14336
s_add_u32 s31, s28, 14336
buffer_load_dwordx4 v3, s[12:15], s31 offen lds
s_add_u32 m0, s29, 15360
s_add_u32 s31, s28, 15360
buffer_load_dwordx4 v3, s[12:15], s31 offen lds
s_add_u32 m0, s29, 16384
s_add_u32 s31, s28, 16384
buffer_load_dwordx4 v3, s[12:15], s31 offen lds
s_add_u32 m0, s29, 17408
s_add_u32 s31, s28, 17408
buffer_load_dwordx4 v3, s[12:15], s31 offen lds
v_add_u32 v4, 36864, v3
RD_pass:
s_mul_i32 s30, s27, 9216
s_add_u32 s31, s30, 0
buffer_load_dwordx4 v[64:67], v3, s[8:11], s31 offen offset:0
buffer_load_dwordx4 v[68:71], v3, s[8:11], s31 offen offset:1024
buffer_load_dwordx4 v[72:75], v3, s[8:11], s31 offen offset:2048
buffer_load_dwordx4 v[76:79], v3, s[8:11], s31 offen offset:3072
s_add_u32 s31, s30, 4096
buffer_load_dwordx4 v[80:83], v3, s[8:11], s31 offen offset:0
buffer_load_dwordx4 v[84:87], v3, s[8:11], s31 offen offset:1024
buffer_load_dwordx4 v[88:91], v3, s[8:11], s31 offen offset:2048
buffer_load_dwordx4 v[92:95], v3, s[8:11], s31 offen offset:3072
s_add_u32 s31, s30, 8192
buffer_load_dwordx4 v[96:99], v3, s[8:11], s31 offen offset:0
s_cmp_lg_u32 s35, 0
s_cbranch_scc1 RD_nobar
s_waitcnt vmcnt(9)
s_barrier
RD_nobar:
ds_read_b128 v[140:143], v3 offset:0
ds_read_b128 v[144:147], v3 offset:9216
ds_read_b128 v[148:151], v3 offset:18432
ds_read_b128 v[152:155], v3 offset:27648
ds_read_b128 v[156:159], v4 offset:0
ds_read_b128 v[160:163], v4 offset:9216
ds_read_b128 v[164:167], v4 offset:18432
ds_read_b128 v[168:171], v4 offset:27648
ds_read_b128 v[172:175], v3 offset:1024
ds_read_b128 v[176:179], v3 offset:10240
ds_read_b128 v[180:183], v3 offset:19456
ds_read_b128 v[184:187], v3 offset:28672
ds_read_b128 v[188:191], v4 offset:1024
ds_read_b128 v[192:195], v4 offset:10240
ds_read_b128 v[196:199], v4 offset:19456
ds_read_b128 v[200:203], v4 offset:28672
s_waitcnt lgkmcnt(8) vmcnt(8)
v_mfma_f32_16x16x32_f16 v[16:19], v[140:143], v[64:67], 0
v_mfma_f32_16x16x32_f16 v[20:23], v[144:147], v[64:67], 0
v_mfma_f32_16x16x32_f16 v[24:27], v[148:151], v[64:67], 0
v_mfma_f32_16x16x32_f16 v[28:31], v[152:155], v[64:67], 0
v_mfma_f32_16x16x32_f16 v[32:35], v[156:159], v[64:67], 0
v_mfma_f32_16x16x32_f16 v[36:39], v[160:163], v[64:67], 0
v_mfma_f32_16x16x32_f16 v[40:43], v[164:167], v[64:67], 0
v_mfma_f32_16x16x32_f16 v[44:47], v[168:171], v[64:67], 0
ds_read_b128 v[140:143], v3 offset:2048
ds_read_b128 v[144:147], v3 offset:11264
ds_read_b128 v[148:151], v3 offset:20480
ds_read_b128 v[152:155], v3 offset:29696
ds_read_b128 v[156:159], v4 offset:2048
ds_read_b128 v[160:163], v4 offset:11264
ds_read_b128 v[164:167], v4 offset:20480
ds_read_b128 v[168:171], v4 offset:29696
s_waitcnt lgkmcnt(8) vmcnt(7)
v_mfma_f32_16x16x32_f16 v[16:19], v[172:175], v[68:71], v[16:19]
v_mfma_f32_16x16x32_f16 v[20:23], v[176:179], v[68:71], v[20:23]
v_mfma_f32_16x16x32_f16 v[24:27], v[180:183], v[68:71], v[24:27]
v_mfma_f32_16x16x32_f16 v[28:31], v[184:187], v[68:71], v[28:31]
v_mfma_f32_16x16x32_f16 v[32:35], v[188:191], v[68:71], v[32:35]
v_mfma_f32_16x16x32_f16 v[36:39], v[192:195], v[68:71], v[36:39]
v_mfma_f32_16x16x32_f16 v[40:43], v[196:199], v[68:71], v[40:43]
v_mfma_f32_16x16x32_f16 v[44:47], v[200:203], v[68:71], v[44:47]
ds_read_b128 v[172:175], v3 offset:3072
ds_read_b128 v[176:179], v3 offset:12288
ds_read_b128 v[180:183], v3 offset:21504
ds_read_b128 v[184:187], v3 offset:30720
ds_read_b128 v[188:191], v4 offset:3072
ds_read_b128 v[192:195], v4 offset:12288
ds_read_b128 v[196:199], v4 offset:21504
ds_read_b128 v[200:203], v4 offset:30720
s_waitcnt lgkmcnt(8) vmcnt(6)
v_mfma_f32_16x16x32_f16 v[16:19], v[140:143], v[72:75], v[16:19]
v_mfma_f32_16x16x32_f16 v[20:23], v[144:147], v[72:75], v[20:23]
v_mfma_f32_16x16x32_f16 v[24:27], v[148:151], v[72:75], v[24:27]
v_mfma_f32_16x16x32_f16 v[28:31], v[152:155], v[72:75], v[28:31]
v_mfma_f32_16x16x32_f16 v[32:35], v[156:159], v[72:75], v[32:35]
v_mfma_f32_16x16x32_f16 v[36:39], v[160:163], v[72:75], v[36:39]
v_mfma_f32_16x16x32_f16 v[40:43], v[164:167], v[72:75], v[40:43]
v_mfma_f32_16x16x32_f16 v[44:47], v[168:171], v[72:75], v[44:47]
ds_read_b128 v[140:143], v3 offset:4096
ds_read_b128 v[144:147], v3 offset:13312
ds_read_b128 v[148:151], v3 offset:22528
ds_read_b128 v[152:155], v3 offset:31744
ds_read_b128 v[156:159], v4 offset:4096
ds_read_b128 v[160:163], v4 offset:13312
ds_read_b128 v[164:167], v4 offset:22528
ds_read_b128 v[168:171], v4 offset:31744
s_waitcnt lgkmcnt(8) vmcnt(5)
v_mfma_f32_16x16x32_f16 v[16:19], v[172:175], v[76:79], v[16:19]
v_mfma_f32_16x16x32_f16 v[20:23], v[176:179], v[76:79], v[20:23]
v_mfma_f32_16x16x32_f16 v[24:27], v[180:183], v[76:79], v[24:27]
v_mfma_f32_16x16x32_f16 v[28:31], v[184:187], v[76:79], v[28:31]
v_mfma_f32_16x16x32_f16 v[32:35], v[188:191], v[76:79], v[32:35]
v_mfma_f32_16x16x32_f16 v[36:39], v[192:195], v[76:79], v[36:39]
v_mfma_f32_16x16x32_f16 v[40:43], v[196:199], v[76:79], v[40:43]
v_mfma_f32_16x16x32_f16 v[44:47], v[200:203], v[76:79], v[44:47]
ds_read_b128 v[172:175], v3 offset:5120
ds_read_b128 v[176:179], v3 offset:14336
ds_read_b128 v[180:183], v3 offset:23552
ds_read_b128 v[184:187], v3 offset:32768
ds_read_b128 v[188:191], v4 offset:5120
ds_read_b128 v[192:195], v4 offset:14336
ds_read_b128 v[196:199], v4 offset:23552
ds_read_b128 v[200:203], v4 offset:32768
s_waitcnt lgkmcnt(8) vmcnt(4)
v_mfma_f32_16x16x32_f16 v[16:19], v[140:143], v[80:83], v[16:19]
v_mfma_f32_16x16x32_f16 v[20:23], v[144:147], v[80:83], v[20:23]
v_mfma_f32_16x16x32_f16 v[24:27], v[148:151], v[80:83], v[24:27]
v_mfma_f32_16x16x32_f16 v[28:31], v[152:155], v[80:83], v[28:31]
v_mfma_f32_16x16x32_f16 v[32:35], v[156:159], v[80:83], v[32:35]
v_mfma_f32_16x16x32_f16 v[36:39], v[160:163], v[80:83], v[36:39]
v_mfma_f32_16x16x32_f16 v[40:43], v[164:167], v[80:83], v[40:43]
v_mfma_f32_16x16x32_f16 v[44:47], v[168:171], v[80:83], v[44:47]
ds_read_b128 v[140:143], v3 offset:6144
ds_read_b128 v[144:147], v3 offset:15360
ds_read_b128 v[148:151], v3 offset:24576
ds_read_b128 v[152:155], v3 offset:33792
ds_read_b128 v[156:159], v4 offset:6144
ds_read_b128 v[160:163], v4 offset:15360
ds_read_b128 v[164:167], v4 offset:24576
ds_read_b128 v[168:171], v4 offset:33792
s_waitcnt lgkmcnt(8) vmcnt(3)
v_mfma_f32_16x16x32_f16 v[16:19], v[172:175], v[84:87], v[16:19]
v_mfma_f32_16x16x32_f16 v[20:23], v[176:179], v[84:87], v[20:23]
v_mfma_f32_16x16x32_f16 v[24:27], v[180:183], v[84:87], v[24:27]
v_mfma_f32_16x16x32_f16 v[28:31], v[184:187], v[84:87], v[28:31]
v_mfma_f32_16x16x32_f16 v[32:35], v[188:191], v[84:87], v[32:35]
v_mfma_f32_16x16x32_f16 v[36:39], v[192:195], v[84:87], v[36:39]
v_mfma_f32_16x16x32_f16 v[40:43], v[196:199], v[84:87], v[40:43]
v_mfma_f32_16x16x32_f16 v[44:47], v[200:203], v[84:87], v[44:47]
ds_read_b128 v[172:175], v3 offset:7168
ds_read_b128 v[176:179], v3 offset:16384
ds_read_b128 v[180:183], v3 offset:25600
ds_read_b128 v[184:187], v3 offset:34816
ds_read_b128 v[188:191], v4 offset:7168
ds_read_b128 v[192:195], v4 offset:16384
ds_read_b128 v[196:199], v4 offset:25600
ds_read_b128 v[200:203], v4 offset:34816
s_waitcnt lgkmcnt(8) vmcnt(2)
v_mfma_f32_16x16x32_f16 v[16:19], v[140:143], v[88:91], v[16:19]
v_mfma_f32_16x16x32_f16 v[20:23], v[144:147], v[88:91], v[20:23]
v_mfma_f32_16x16x32_f16 v[24:27], v[148:151], v[88:91], v[24:27]
v_mfma_f32_16x16x32_f16 v[28:31], v[152:155], v[88:91], v[28:31]
v_mfma_f32_16x16x32_f16 v[32:35], v[156:159], v[88:91], v[32:35]
v_mfma_f32_16x16x32_f16 v[36:39], v[160:163], v[88:91], v[36:39]
v_mfma_f32_16x16x32_f16 v[40:43], v[164:167], v[88:91], v[40:43]
v_mfma_f32_16x16x32_f16 v[44:47], v[168:171], v[88:91], v[44:47]
ds_read_b128 v[140:143], v3 offset:8192
ds_read_b128 v[144:147], v3 offset:17408
ds_read_b128 v[148:151], v3 offset:26624
ds_read_b128 v[152:155], v3 offset:35840
ds_read_b128 v[156:159], v4 offset:8192
ds_read_b128 v[160:163], v4 offset:17408
ds_read_b128 v[164:167], v4 offset:26624
ds_read_b128 v[168:171], v4 offset:35840
s_waitcnt lgkmcnt(8) vmcnt(1)
v_mfma_f32_16x16x32_f16 v[16:19], v[172:175], v[92:95], v[16:19]
v_mfma_f32_16x16x32_f16 v[20:23], v[176:179], v[92:95], v[20:23]
v_mfma_f32_16x16x32_f16 v[24:27], v[180:183], v[92:95], v[24:27]
v_mfma_f32_16x16x32_f16 v[28:31], v[184:187], v[92:95], v[28:31]
v_mfma_f32_16x16x32_f16 v[32:35], v[188:191], v[92:95], v[32:35]
v_mfma_f32_16x16x32_f16 v[36:39], v[192:195], v[92:95], v[36:39]
v_mfma_f32_16x16x32_f16 v[40:43], v[196:199], v[92:95], v[40:43]
v_mfma_f32_16x16x32_f16 v[44:47], v[200:203], v[92:95], v[44:47]
s_waitcnt lgkmcnt(0) vmcnt(0)
v_mfma_f32_16x16x32_f16 v[16:19], v[140:143], v[96:99], v[16:19]
v_mfma_f32_16x16x32_f16 v[20:23], v[144:147], v[96:99], v[20:23]
v_mfma_f32_16x16x32_f16 v[24:27], v[148:151], v[96:99], v[24:27]
v_mfma_f32_16x16x32_f16 v[28:31], v[152:155], v[96:99], v[28:31]
v_mfma_f32_16x16x32_f16 v[32:35], v[156:159], v[96:99], v[32:35]
v_mfma_f32_16x16x32_f16 v[36:39], v[160:163], v[96:99], v[36:39]
v_mfma_f32_16x16x32_f16 v[40:43], v[164:167], v[96:99], v[40:43]
v_mfma_f32_16x16x32_f16 v[44:47], v[168:171], v[96:99], v[44:47]
s_nop 7
s_nop 3
s_cmp_lt_u32 s27, 18
s_cselect_b32 s32, 1.0, -1.0
v_fma_f32 v16, v20, s32, v16
v_fma_f32 v17, v21, s32, v17
v_fma_f32 v18, v22, s32, v18
v_fma_f32 v19, v23, s32, v19
v_fma_f32 v24, v28, s32, v24
v_fma_f32 v25, v29, s32, v25
v_fma_f32 v26, v30, s32, v26
v_fma_f32 v27, v31, s32, v27
v_fma_f32 v32, v36, s32, v32
v_fma_f32 v33, v37, s32, v33
v_fma_f32 v34, v38, s32, v34
v_fma_f32 v35, v39, s32, v35
v_fma_f32 v40, v44, s32, v40
v_fma_f32 v41, v45, s32, v41
v_fma_f32 v42, v46, s32, v42
v_fma_f32 v43, v47, s32, v43
v_add_f32 v48, v16, v32
v_sub_f32 v56, v16, v32
v_add_f32 v49, v17, v33
v_sub_f32 v57, v17, v33
v_add_f32 v50, v18, v34
v_sub_f32 v58, v18, v34
v_add_f32 v51, v19, v35
v_sub_f32 v59, v19, v35
v_add_f32 v52, v24, v40
v_sub_f32 v60, v24, v40
v_add_f32 v53, v25, v41
v_sub_f32 v61, v25, v41
v_add_f32 v54, v26, v42
v_sub_f32 v62, v26, v42
v_add_f32 v55, v27, v43
v_sub_f32 v63, v27, v43
v_cvt_pk_f16_f32 v208, v48, v49
v_cvt_pk_f16_f32 v209, v50, v51
v_cvt_pk_f16_f32 v210, v52, v53
v_cvt_pk_f16_f32 v211, v54, v55
v_cvt_pk_f16_f32 v212, v56, v57
v_cvt_pk_f16_f32 v213, v58, v59
v_cvt_pk_f16_f32 v214, v60, v61
v_cvt_pk_f16_f32 v215, v62, v63
s_mul_i32 s33, s25, 36
s_add_u32 s33, s33, s27
s_lshl_b32 s33, s33, 11
s_add_u32 s33, s33, 12582912
buffer_store_dwordx4 v[208:211], v3, s[12:15], s33 offen sc1
buffer_store_dwordx4 v[212:215], v3, s[12:15], s33 offen offset:1024 sc1
s_cmp_lg_u32 s35, 0
s_cbranch_scc1 RD_end
s_cmp_ge_u32 s24, 2
s_cbranch_scc1 RD_end
s_mov_b32 s35, 1
s_add_u32 s27, s27, 4
s_branch RD_pass
RD_end:
s_endpgm
K1_pre:
K1_end:
s_endpgm
.globl k2_kernel
.p2align 8
.type k2_kernel,@function
k2_kernel:
s_cmp_ge_u32 s2, 256
s_cbranch_scc1 K2_b
s_load_dwordx2 s[4:5], s[0:1], 48
s_load_dwordx2 s[6:7], s[0:1], 80
v_lshrrev_b32 v224, 6, v0
v_and_b32 v252, 63, v0
v_readfirstlane_b32 s24, v224
s_and_b32 s25, s2, 7
s_lshr_b32 s26, s2, 3
s_lshr_b32 s46, s25, 1
s_and_b32 s27, s25, 1
s_lshl_b32 s27, s27, 3
s_and_b32 s28, s26, 7
s_add_u32 s27, s27, s28
s_lshr_b32 s28, s26, 3
s_and_b32 s47, s24, 1
s_lshr_b32 s48, s24, 1
s_setprio 2
s_lshl_b32 s35, s24, 6
v_add_u32 v224, s35, v252
v_mul_u32_u24 v225, 3641, v224
v_lshrrev_b32 v225, 16, v225
v_mul_u32_u24 v226, 18, v225
v_sub_u32 v224, v224, v226
v_lshrrev_b32 v226, 5, v225
v_mul_u32_u24 v226, 544, v226
v_add_u32 v225, v225, v226
v_mul_u32_u24 v225, 1152, v225
v_lshl_add_u32 v245, v224, 4, v225
v_add_u32 v224, s35, v252
v_add_u32 v224, 256, v224
v_mul_u32_u24 v225, 3641, v224
v_lshrrev_b32 v225, 16, v225
v_mul_u32_u24 v226, 18, v225
v_sub_u32 v224, v224, v226
v_lshrrev_b32 v226, 5, v225
v_mul_u32_u24 v226, 544, v226
v_add_u32 v225, v225, v226
v_mul_u32_u24 v225, 1152, v225
v_lshl_add_u32 v246, v224, 4, v225
v_add_u32 v224, s35, v252
v_add_u32 v224, 512, v224
v_mul_u32_u24 v225, 3641, v224
v_lshrrev_b32 v225, 16, v225
v_mul_u32_u24 v226, 18, v225
v_sub_u32 v224, v224, v226
v_lshrrev_b32 v226, 5, v225
v_mul_u32_u24 v226, 544, v226
v_add_u32 v225, v225, v226
v_mul_u32_u24 v225, 1152, v225
v_lshl_add_u32 v247, v224, 4, v225
v_add_u32 v224, s35, v252
v_add_u32 v224, 768, v224
v_mul_u32_u24 v225, 3641, v224
v_lshrrev_b32 v225, 16, v225
v_mul_u32_u24 v226, 18, v225
v_sub_u32 v224, v224, v226
v_lshrrev_b32 v226, 5, v225
v_mul_u32_u24 v226, 544, v226
v_add_u32 v225, v225, v226
v_mul_u32_u24 v225, 1152, v225
v_lshl_add_u32 v248, v224, 4, v225
v_add_u32 v224, s35, v252
v_add_u32 v224, 1024, v224
v_mul_u32_u24 v225, 3641, v224
v_lshrrev_b32 v225, 16, v225
v_mul_u32_u24 v226, 18, v225
v_sub_u32 v224, v224, v226
v_lshrrev_b32 v226, 5, v225
v_mul_u32_u24 v226, 544, v226
v_add_u32 v225, v225, v226
v_mul_u32_u24 v225, 1152, v225
v_lshl_add_u32 v249, v224, 4, v225
s_lshl_b32 s34, s24, 10
v_lshrrev_b32 v224, 2, v252
v_mul_u32_u24 v224, 288, v224
v_and_b32 v225, 3, v252
v_lshl_add_u32 v250, v225, 3, v224
s_mul_i32 s29, s48, 9216
v_add_u32 v250, s29, v250
v_add_u32 v251, 36864, v250
s_lshl_b32 s30, s27, 2
s_lshl_b32 s29, s47, 1
s_add_u32 s30, s30, s29
s_mul_i32 s40, s30, 147456
s_lshl_b32 s29, s46, 1
s_add_u32 s29, s29, s48
s_mul_i32 s29, s29, 18432
s_add_u32 s40, s40, s29
s_add_u32 s40, s40, 33554432
s_add_u32 s41, s40, 9437184
s_add_u32 s42, s40, 147456
s_add_u32 s43, s40, 9584640
v_lshlrev_b32 v244, 4, v252
v_lshlrev_b32 v253, 3, v252
s_mul_i32 s32, s28, 288
s_mul_i32 s29, s46, 1327104
s_add_u32 s32, s32, s29
s_mov_b32 s45, 233017
s_waitcnt lgkmcnt(0)
s_mov_b32 s8, s4
s_and_b32 s9, s5, 0xffff
s_mov_b32 s10, 5308416
s_mov_b32 s11, 0x00020000
s_mov_b32 s12, s6
s_and_b32 s13, s7, 0xffff
s_mov_b32 s14, 268435456
s_mov_b32 s15, 0x00020000
s_add_u32 s33, s32, 0
s_cmp_ge_u32 s24, 2
s_cbranch_scc1 dsk_22
s_add_u32 m0, s34, 16384
s_nop 0
buffer_load_dwordx4 v249, s[8:11], s33 offen lds
dsk_22:
s_add_u32 m0, s34, 0
s_nop 0
buffer_load_dwordx4 v245, s[8:11], s33 offen lds
s_add_u32 m0, s34, 4096
s_nop 0
buffer_load_dwordx4 v246, s[8:11], s33 offen lds
s_add_u32 m0, s34, 8192
s_nop 0
buffer_load_dwordx4 v247, s[8:11], s33 offen lds
s_add_u32 m0, s34, 12288
s_nop 0
buffer_load_dwordx4 v248, s[8:11], s33 offen lds
buffer_load_dwordx4 v[144:147], v244, s[12:15], s40 offen offset:0
buffer_load_dwordx4 v[148:151], v244, s[12:15], s41 offen offset:0
buffer_load_dwordx4 v[152:155], v244, s[12:15], s42 offen offset:0
buffer_load_dwordx4 v[156:159], v244, s[12:15], s43 offen offset:0
s_add_u32 s33, s32, 36864
s_cmp_ge_u32 s24, 2
s_cbranch_scc1 dsk_23
s_add_u32 m0, s34, 34816
s_nop 0
buffer_load_dwordx4 v249, s[8:11], s33 offen lds
dsk_23:
s_add_u32 m0, s34, 18432
s_nop 0
buffer_load_dwordx4 v245, s[8:11], s33 offen lds
s_add_u32 m0, s34, 22528
s_nop 0
buffer_load_dwordx4 v246, s[8:11], s33 offen lds
s_add_u32 m0, s34, 26624
s_nop 0
buffer_load_dwordx4 v247, s[8:11], s33 offen lds
s_add_u32 m0, s34, 30720
s_nop 0
buffer_load_dwordx4 v248, s[8:11], s33 offen lds
buffer_load_dwordx4 v[160:163], v244, s[12:15], s40 offen offset:1024
buffer_load_dwordx4 v[164:167], v244, s[12:15], s41 offen offset:1024
buffer_load_dwordx4 v[168:171], v244, s[12:15], s42 offen offset:1024
buffer_load_dwordx4 v[172:175], v244, s[12:15], s43 offen offset:1024
s_waitcnt vmcnt(12)
s_barrier
ds_read_b64_tr_b16 v[224:225], v250 offset:0
ds_read_b64_tr_b16 v[226:227], v250 offset:4608
ds_read_b64_tr_b16 v[228:229], v250 offset:32
ds_read_b64_tr_b16 v[230:231], v250 offset:4640
ds_read_b64_tr_b16 v[232:233], v250 offset:64
ds_read_b64_tr_b16 v[234:235], v250 offset:4672
ds_read_b64_tr_b16 v[236:237], v250 offset:96
ds_read_b64_tr_b16 v[238:239], v250 offset:4704
s_waitcnt vmcnt(8)
s_waitcnt lgkmcnt(6)
v_mfma_f32_16x16x32_bf16 v[0:3], v[224:227], v[144:147], 0
v_mfma_f32_16x16x32_bf16 v[36:39], v[224:227], v[148:151], 0
s_add_u32 s33, s32, 73728
s_cmp_ge_u32 s24, 2
s_cbranch_scc1 dsk_24
s_add_u32 m0, s34, 53248
s_nop 0
buffer_load_dwordx4 v249, s[8:11], s33 offen lds
dsk_24:
v_mfma_f32_16x16x32_bf16 v[72:75], v[224:227], v[152:155], 0
v_mfma_f32_16x16x32_bf16 v[108:111], v[224:227], v[156:159], 0
s_add_u32 m0, s34, 36864
s_nop 0
buffer_load_dwordx4 v245, s[8:11], s33 offen lds
ds_read_b64_tr_b16 v[240:241], v250 offset:128
ds_read_b64_tr_b16 v[242:243], v250 offset:4736
s_waitcnt lgkmcnt(6)
v_mfma_f32_16x16x32_bf16 v[4:7], v[228:231], v[144:147], 0
v_mfma_f32_16x16x32_bf16 v[40:43], v[228:231], v[148:151], 0
s_add_u32 m0, s34, 40960
s_nop 0
buffer_load_dwordx4 v246, s[8:11], s33 offen lds
v_mfma_f32_16x16x32_bf16 v[76:79], v[228:231], v[152:155], 0
v_mfma_f32_16x16x32_bf16 v[112:115], v[228:231], v[156:159], 0
s_add_u32 m0, s34, 45056
s_nop 0
buffer_load_dwordx4 v247, s[8:11], s33 offen lds
ds_read_b64_tr_b16 v[224:225], v250 offset:160
ds_read_b64_tr_b16 v[226:227], v250 offset:4768
s_waitcnt lgkmcnt(6)
v_mfma_f32_16x16x32_bf16 v[8:11], v[232:235], v[144:147], 0
v_mfma_f32_16x16x32_bf16 v[44:47], v[232:235], v[148:151], 0
s_add_u32 m0, s34, 49152
s_nop 0
buffer_load_dwordx4 v248, s[8:11], s33 offen lds
v_mfma_f32_16x16x32_bf16 v[80:83], v[232:235], v[152:155], 0
v_mfma_f32_16x16x32_bf16 v[116:119], v[232:235], v[156:159], 0
buffer_load_dwordx4 v[176:179], v244, s[12:15], s40 offen offset:2048
ds_read_b64_tr_b16 v[228:229], v250 offset:192
ds_read_b64_tr_b16 v[230:231], v250 offset:4800
s_waitcnt lgkmcnt(6)
v_mfma_f32_16x16x32_bf16 v[12:15], v[236:239], v[144:147], 0
v_mfma_f32_16x16x32_bf16 v[48:51], v[236:239], v[148:151], 0
buffer_load_dwordx4 v[180:183], v244, s[12:15], s41 offen offset:2048
v_mfma_f32_16x16x32_bf16 v[84:87], v[236:239], v[152:155], 0
v_mfma_f32_16x16x32_bf16 v[120:123], v[236:239], v[156:159], 0
buffer_load_dwordx4 v[184:187], v244, s[12:15], s42 offen offset:2048
ds_read_b64_tr_b16 v[232:233], v250 offset:224
ds_read_b64_tr_b16 v[234:235], v250 offset:4832
s_waitcnt lgkmcnt(6)
v_mfma_f32_16x16x32_bf16 v[16:19], v[240:243], v[144:147], 0
v_mfma_f32_16x16x32_bf16 v[52:55], v[240:243], v[148:151], 0
buffer_load_dwordx4 v[188:191], v244, s[12:15], s43 offen offset:2048
v_mfma_f32_16x16x32_bf16 v[88:91], v[240:243], v[152:155], 0
v_mfma_f32_16x16x32_bf16 v[124:127], v[240:243], v[156:159], 0
s_add_u32 s33, s32, 110592
s_cmp_ge_u32 s24, 2
s_cbranch_scc1 dsk_25
s_add_u32 m0, s34, 71680
s_nop 0
buffer_load_dwordx4 v249, s[8:11], s33 offen lds
dsk_25:
ds_read_b64_tr_b16 v[236:237], v250 offset:256
ds_read_b64_tr_b16 v[238:239], v250 offset:4864
s_waitcnt lgkmcnt(6)
v_mfma_f32_16x16x32_bf16 v[20:23], v[224:227], v[144:147], 0
v_mfma_f32_16x16x32_bf16 v[56:59], v[224:227], v[148:151], 0
s_add_u32 m0, s34, 55296
s_nop 0
buffer_load_dwordx4 v245, s[8:11], s33 offen lds
v_mfma_f32_16x16x32_bf16 v[92:95], v[224:227], v[152:155], 0
v_mfma_f32_16x16x32_bf16 v[128:131], v[224:227], v[156:159], 0
s_add_u32 m0, s34, 59392
s_nop 0
buffer_load_dwordx4 v246, s[8:11], s33 offen lds
s_waitcnt lgkmcnt(4)
v_mfma_f32_16x16x32_bf16 v[24:27], v[228:231], v[144:147], 0
v_mfma_f32_16x16x32_bf16 v[60:63], v[228:231], v[148:151], 0
s_add_u32 m0, s34, 63488
s_nop 0
buffer_load_dwordx4 v247, s[8:11], s33 offen lds
v_mfma_f32_16x16x32_bf16 v[96:99], v[228:231], v[152:155], 0
v_mfma_f32_16x16x32_bf16 v[132:135], v[228:231], v[156:159], 0
s_add_u32 m0, s34, 67584
s_nop 0
buffer_load_dwordx4 v248, s[8:11], s33 offen lds
s_waitcnt lgkmcnt(0) vmcnt(16)
s_barrier
ds_read_b64_tr_b16 v[240:241], v250 offset:18432
ds_read_b64_tr_b16 v[242:243], v250 offset:23040
ds_read_b64_tr_b16 v[224:225], v250 offset:18464
ds_read_b64_tr_b16 v[226:227], v250 offset:23072
v_mfma_f32_16x16x32_bf16 v[28:31], v[232:235], v[144:147], 0
v_mfma_f32_16x16x32_bf16 v[64:67], v[232:235], v[148:151], 0
buffer_load_dwordx4 v[192:195], v244, s[12:15], s40 offen offset:3072
s_add_u32 s40, s40, 4608
v_mfma_f32_16x16x32_bf16 v[100:103], v[232:235], v[152:155], 0
v_mfma_f32_16x16x32_bf16 v[136:139], v[232:235], v[156:159], 0
buffer_load_dwordx4 v[196:199], v244, s[12:15], s41 offen offset:3072
s_add_u32 s41, s41, 4608
ds_read_b64_tr_b16 v[228:229], v250 offset:18496
ds_read_b64_tr_b16 v[230:231], v250 offset:23104
v_mfma_f32_16x16x32_bf16 v[32:35], v[236:239], v[144:147], 0
v_mfma_f32_16x16x32_bf16 v[68:71], v[236:239], v[148:151], 0
buffer_load_dwordx4 v[200:203], v244, s[12:15], s42 offen offset:3072
s_add_u32 s42, s42, 4608
v_mfma_f32_16x16x32_bf16 v[104:107], v[236:239], v[152:155], 0
v_mfma_f32_16x16x32_bf16 v[140:143], v[236:239], v[156:159], 0
buffer_load_dwordx4 v[204:207], v244, s[12:15], s43 offen offset:3072
s_add_u32 s43, s43, 4608
ds_read_b64_tr_b16 v[232:233], v250 offset:18528
ds_read_b64_tr_b16 v[234:235], v250 offset:23136
s_waitcnt vmcnt(16)
s_waitcnt lgkmcnt(6)
v_mfma_f32_16x16x32_bf16 v[0:3], v[240:243], v[160:163], v[0:3]
v_mfma_f32_16x16x32_bf16 v[36:39], v[240:243], v[164:167], v[36:39]
buffer_load_dwordx4 v[208:211], v244, s[12:15], s40 offen offset:0
v_mfma_f32_16x16x32_bf16 v[72:75], v[240:243], v[168:171], v[72:75]
v_mfma_f32_16x16x32_bf16 v[108:111], v[240:243], v[172:175], v[108:111]
buffer_load_dwordx4 v[212:215], v244, s[12:15], s41 offen offset:0
ds_read_b64_tr_b16 v[236:237], v250 offset:18560
ds_read_b64_tr_b16 v[238:239], v250 offset:23168
s_waitcnt lgkmcnt(6)
v_mfma_f32_16x16x32_bf16 v[4:7], v[224:227], v[160:163], v[4:7]
v_mfma_f32_16x16x32_bf16 v[40:43], v[224:227], v[164:167], v[40:43]
buffer_load_dwordx4 v[216:219], v244, s[12:15], s42 offen offset:0
v_mfma_f32_16x16x32_bf16 v[76:79], v[224:227], v[168:171], v[76:79]
v_mfma_f32_16x16x32_bf16 v[112:115], v[224:227], v[172:175], v[112:115]
buffer_load_dwordx4 v[220:223], v244, s[12:15], s43 offen offset:0
ds_read_b64_tr_b16 v[240:241], v250 offset:18592
ds_read_b64_tr_b16 v[242:243], v250 offset:23200
s_waitcnt lgkmcnt(6)
v_mfma_f32_16x16x32_bf16 v[8:11], v[228:231], v[160:163], v[8:11]
v_mfma_f32_16x16x32_bf16 v[44:47], v[228:231], v[164:167], v[44:47]
s_add_u32 s33, s32, 165888
s_cmp_ge_u32 s24, 2
s_cbranch_scc1 dsk_26
s_add_u32 m0, s34, 16384
s_nop 0
buffer_load_dwordx4 v249, s[8:11], s33 offen lds
dsk_26:
v_mfma_f32_16x16x32_bf16 v[80:83], v[228:231], v[168:171], v[80:83]
v_mfma_f32_16x16x32_bf16 v[116:119], v[228:231], v[172:175], v[116:119]
s_add_u32 m0, s34, 0
s_nop 0
buffer_load_dwordx4 v245, s[8:11], s33 offen lds
ds_read_b64_tr_b16 v[224:225], v250 offset:18624
ds_read_b64_tr_b16 v[226:227], v250 offset:23232
s_waitcnt lgkmcnt(6)
v_mfma_f32_16x16x32_bf16 v[12:15], v[232:235], v[160:163], v[12:15]
v_mfma_f32_16x16x32_bf16 v[48:51], v[232:235], v[164:167], v[48:51]
s_add_u32 m0, s34, 4096
s_nop 0
buffer_load_dwordx4 v246, s[8:11], s33 offen lds
v_mfma_f32_16x16x32_bf16 v[84:87], v[232:235], v[168:171], v[84:87]
v_mfma_f32_16x16x32_bf16 v[120:123], v[232:235], v[172:175], v[120:123]
s_add_u32 m0, s34, 8192
s_nop 0
buffer_load_dwordx4 v247, s[8:11], s33 offen lds
ds_read_b64_tr_b16 v[228:229], v250 offset:18656
ds_read_b64_tr_b16 v[230:231], v250 offset:23264
s_waitcnt lgkmcnt(6)
v_mfma_f32_16x16x32_bf16 v[16:19], v[236:239], v[160:163], v[16:19]
v_mfma_f32_16x16x32_bf16 v[52:55], v[236:239], v[164:167], v[52:55]
s_add_u32 m0, s34, 12288
s_nop 0
buffer_load_dwordx4 v248, s[8:11], s33 offen lds
v_mfma_f32_16x16x32_bf16 v[88:91], v[236:239], v[168:171], v[88:91]
v_mfma_f32_16x16x32_bf16 v[124:127], v[236:239], v[172:175], v[124:127]
buffer_load_dwordx4 v[144:147], v244, s[12:15], s40 offen offset:1024
ds_read_b64_tr_b16 v[232:233], v250 offset:18688
ds_read_b64_tr_b16 v[234:235], v250 offset:23296
s_waitcnt lgkmcnt(6)
v_mfma_f32_16x16x32_bf16 v[20:23], v[240:243], v[160:163], v[20:23]
v_mfma_f32_16x16x32_bf16 v[56:59], v[240:243], v[164:167], v[56:59]
buffer_load_dwordx4 v[148:151], v244, s[12:15], s41 offen offset:1024
v_mfma_f32_16x16x32_bf16 v[92:95], v[240:243], v[168:171], v[92:95]
v_mfma_f32_16x16x32_bf16 v[128:131], v[240:243], v[172:175], v[128:131]
s_waitcnt lgkmcnt(4)
v_mfma_f32_16x16x32_bf16 v[24:27], v[224:227], v[160:163], v[24:27]
v_mfma_f32_16x16x32_bf16 v[60:63], v[224:227], v[164:167], v[60:63]
buffer_load_dwordx4 v[152:155], v244, s[12:15], s42 offen offset:1024
v_mfma_f32_16x16x32_bf16 v[96:99], v[224:227], v[168:171], v[96:99]
v_mfma_f32_16x16x32_bf16 v[132:135], v[224:227], v[172:175], v[132:135]
s_waitcnt lgkmcnt(0) vmcnt(23)
s_barrier
ds_read_b64_tr_b16 v[236:237], v251 offset:0
ds_read_b64_tr_b16 v[238:239], v251 offset:4608
ds_read_b64_tr_b16 v[240:241], v251 offset:32
ds_read_b64_tr_b16 v[242:243], v251 offset:4640
v_mfma_f32_16x16x32_bf16 v[28:31], v[228:231], v[160:163], v[28:31]
v_mfma_f32_16x16x32_bf16 v[64:67], v[228:231], v[164:167], v[64:67]
buffer_load_dwordx4 v[156:159], v244, s[12:15], s43 offen offset:1024
v_mfma_f32_16x16x32_bf16 v[100:103], v[228:231], v[168:171], v[100:103]
v_mfma_f32_16x16x32_bf16 v[136:139], v[228:231], v[172:175], v[136:139]
s_add_u32 s33, s32, 202752
s_cmp_ge_u32 s24, 2
s_cbranch_scc1 dsk_27
s_add_u32 m0, s34, 34816
s_nop 0
buffer_load_dwordx4 v249, s[8:11], s33 offen lds
dsk_27:
ds_read_b64_tr_b16 v[224:225], v251 offset:64
ds_read_b64_tr_b16 v[226:227], v251 offset:4672
v_mfma_f32_16x16x32_bf16 v[32:35], v[232:235], v[160:163], v[32:35]
v_mfma_f32_16x16x32_bf16 v[68:71], v[232:235], v[164:167], v[68:71]
s_add_u32 m0, s34, 18432
s_nop 0
buffer_load_dwordx4 v245, s[8:11], s33 offen lds
v_mfma_f32_16x16x32_bf16 v[104:107], v[232:235], v[168:171], v[104:107]
v_mfma_f32_16x16x32_bf16 v[140:143], v[232:235], v[172:175], v[140:143]
ds_read_b64_tr_b16 v[228:229], v251 offset:96
ds_read_b64_tr_b16 v[230:231], v251 offset:4704
s_waitcnt vmcnt(21)
s_waitcnt lgkmcnt(6)
v_mfma_f32_16x16x32_bf16 v[0:3], v[236:239], v[176:179], v[0:3]
v_mfma_f32_16x16x32_bf16 v[36:39], v[236:239], v[180:183], v[36:39]
s_add_u32 m0, s34, 22528
s_nop 0
buffer_load_dwordx4 v246, s[8:11], s33 offen lds
v_mfma_f32_16x16x32_bf16 v[72:75], v[236:239], v[184:187], v[72:75]
v_mfma_f32_16x16x32_bf16 v[108:111], v[236:239], v[188:191], v[108:111]
s_add_u32 m0, s34, 26624
s_nop 0
buffer_load_dwordx4 v247, s[8:11], s33 offen lds
ds_read_b64_tr_b16 v[232:233], v251 offset:128
ds_read_b64_tr_b16 v[234:235], v251 offset:4736
s_waitcnt lgkmcnt(6)
v_mfma_f32_16x16x32_bf16 v[4:7], v[240:243], v[176:179], v[4:7]
v_mfma_f32_16x16x32_bf16 v[40:43], v[240:243], v[180:183], v[40:43]
s_add_u32 m0, s34, 30720
s_nop 0
buffer_load_dwordx4 v248, s[8:11], s33 offen lds
v_mfma_f32_16x16x32_bf16 v[76:79], v[240:243], v[184:187], v[76:79]
v_mfma_f32_16x16x32_bf16 v[112:115], v[240:243], v[188:191], v[112:115]
buffer_load_dwordx4 v[160:163], v244, s[12:15], s40 offen offset:2048
ds_read_b64_tr_b16 v[236:237], v251 offset:160
ds_read_b64_tr_b16 v[238:239], v251 offset:4768
s_waitcnt lgkmcnt(6)
v_mfma_f32_16x16x32_bf16 v[8:11], v[224:227], v[176:179], v[8:11]
v_mfma_f32_16x16x32_bf16 v[44:47], v[224:227], v[180:183], v[44:47]
buffer_load_dwordx4 v[164:167], v244, s[12:15], s41 offen offset:2048
v_mfma_f32_16x16x32_bf16 v[80:83], v[224:227], v[184:187], v[80:83]
v_mfma_f32_16x16x32_bf16 v[116:119], v[224:227], v[188:191], v[116:119]
ds_read_b64_tr_b16 v[240:241], v251 offset:192
ds_read_b64_tr_b16 v[242:243], v251 offset:4800
s_waitcnt lgkmcnt(6)
v_mfma_f32_16x16x32_bf16 v[12:15], v[228:231], v[176:179], v[12:15]
v_mfma_f32_16x16x32_bf16 v[48:51], v[228:231], v[180:183], v[48:51]
buffer_load_dwordx4 v[168:171], v244, s[12:15], s42 offen offset:2048
v_mfma_f32_16x16x32_bf16 v[84:87], v[228:231], v[184:187], v[84:87]
v_mfma_f32_16x16x32_bf16 v[120:123], v[228:231], v[188:191], v[120:123]
ds_read_b64_tr_b16 v[224:225], v251 offset:224
ds_read_b64_tr_b16 v[226:227], v251 offset:4832
s_waitcnt lgkmcnt(6)
v_mfma_f32_16x16x32_bf16 v[16:19], v[232:235], v[176:179], v[16:19]
v_mfma_f32_16x16x32_bf16 v[52:55], v[232:235], v[180:183], v[52:55]
buffer_load_dwordx4 v[172:175], v244, s[12:15], s43 offen offset:2048
v_mfma_f32_16x16x32_bf16 v[88:91], v[232:235], v[184:187], v[88:91]
v_mfma_f32_16x16x32_bf16 v[124:127], v[232:235], v[188:191], v[124:127]
ds_read_b64_tr_b16 v[228:229], v251 offset:256
ds_read_b64_tr_b16 v[230:231], v251 offset:4864
s_waitcnt lgkmcnt(6)
v_mfma_f32_16x16x32_bf16 v[20:23], v[236:239], v[176:179], v[20:23]
v_mfma_f32_16x16x32_bf16 v[56:59], v[236:239], v[180:183], v[56:59]
v_mfma_f32_16x16x32_bf16 v[92:95], v[236:239], v[184:187], v[92:95]
v_mfma_f32_16x16x32_bf16 v[128:131], v[236:239], v[188:191], v[128:131]
s_waitcnt lgkmcnt(4)
v_mfma_f32_16x16x32_bf16 v[24:27], v[240:243], v[176:179], v[24:27]
v_mfma_f32_16x16x32_bf16 v[60:63], v[240:243], v[180:183], v[60:63]
v_mfma_f32_16x16x32_bf16 v[96:99], v[240:243], v[184:187], v[96:99]
v_mfma_f32_16x16x32_bf16 v[132:135], v[240:243], v[188:191], v[132:135]
s_waitcnt lgkmcnt(0) vmcnt(24)
s_barrier
ds_read_b64_tr_b16 v[232:233], v251 offset:18432
ds_read_b64_tr_b16 v[234:235], v251 offset:23040
ds_read_b64_tr_b16 v[236:237], v251 offset:18464
ds_read_b64_tr_b16 v[238:239], v251 offset:23072
v_mfma_f32_16x16x32_bf16 v[28:31], v[224:227], v[176:179], v[28:31]
v_mfma_f32_16x16x32_bf16 v[64:67], v[224:227], v[180:183], v[64:67]
s_add_u32 s33, s32, 239616
s_cmp_ge_u32 s24, 2
s_cbranch_scc1 dsk_28
s_add_u32 m0, s34, 53248
s_nop 0
buffer_load_dwordx4 v249, s[8:11], s33 offen lds
dsk_28:
v_mfma_f32_16x16x32_bf16 v[100:103], v[224:227], v[184:187], v[100:103]
v_mfma_f32_16x16x32_bf16 v[136:139], v[224:227], v[188:191], v[136:139]
s_add_u32 m0, s34, 36864
s_nop 0
buffer_load_dwordx4 v245, s[8:11], s33 offen lds
ds_read_b64_tr_b16 v[240:241], v251 offset:18496
ds_read_b64_tr_b16 v[242:243], v251 offset:23104
v_mfma_f32_16x16x32_bf16 v[32:35], v[228:231], v[176:179], v[32:35]
v_mfma_f32_16x16x32_bf16 v[68:71], v[228:231], v[180:183], v[68:71]
s_add_u32 m0, s34, 40960
s_nop 0
buffer_load_dwordx4 v246, s[8:11], s33 offen lds
v_mfma_f32_16x16x32_bf16 v[104:107], v[228:231], v[184:187], v[104:107]
v_mfma_f32_16x16x32_bf16 v[140:143], v[228:231], v[188:191], v[140:143]
ds_read_b64_tr_b16 v[224:225], v251 offset:18528
ds_read_b64_tr_b16 v[226:227], v251 offset:23136
s_waitcnt vmcnt(22)
s_waitcnt lgkmcnt(6)
v_mfma_f32_16x16x32_bf16 v[0:3], v[232:235], v[192:195], v[0:3]
v_mfma_f32_16x16x32_bf16 v[36:39], v[232:235], v[196:199], v[36:39]
s_add_u32 m0, s34, 45056
s_nop 0
buffer_load_dwordx4 v247, s[8:11], s33 offen lds
v_mfma_f32_16x16x32_bf16 v[72:75], v[232:235], v[200:203], v[72:75]
v_mfma_f32_16x16x32_bf16 v[108:111], v[232:235], v[204:207], v[108:111]
s_add_u32 m0, s34, 49152
s_nop 0
buffer_load_dwordx4 v248, s[8:11], s33 offen lds
ds_read_b64_tr_b16 v[228:229], v251 offset:18560
ds_read_b64_tr_b16 v[230:231], v251 offset:23168
s_waitcnt lgkmcnt(6)
v_mfma_f32_16x16x32_bf16 v[4:7], v[236:239], v[192:195], v[4:7]
v_mfma_f32_16x16x32_bf16 v[40:43], v[236:239], v[196:199], v[40:43]
buffer_load_dwordx4 v[176:179], v244, s[12:15], s40 offen offset:3072
s_add_u32 s40, s40, 4608
v_mfma_f32_16x16x32_bf16 v[76:79], v[236:239], v[200:203], v[76:79]
v_mfma_f32_16x16x32_bf16 v[112:115], v[236:239], v[204:207], v[112:115]
ds_read_b64_tr_b16 v[232:233], v251 offset:18592
ds_read_b64_tr_b16 v[234:235], v251 offset:23200
s_waitcnt lgkmcnt(6)
v_mfma_f32_16x16x32_bf16 v[8:11], v[240:243], v[192:195], v[8:11]
v_mfma_f32_16x16x32_bf16 v[44:47], v[240:243], v[196:199], v[44:47]
buffer_load_dwordx4 v[180:183], v244, s[12:15], s41 offen offset:3072
s_add_u32 s41, s41, 4608
v_mfma_f32_16x16x32_bf16 v[80:83], v[240:243], v[200:203], v[80:83]
v_mfma_f32_16x16x32_bf16 v[116:119], v[240:243], v[204:207], v[116:119]
ds_read_b64_tr_b16 v[236:237], v251 offset:18624
ds_read_b64_tr_b16 v[238:239], v251 offset:23232
s_waitcnt lgkmcnt(6)
v_mfma_f32_16x16x32_bf16 v[12:15], v[224:227], v[192:195], v[12:15]
v_mfma_f32_16x16x32_bf16 v[48:51], v[224:227], v[196:199], v[48:51]
buffer_load_dwordx4 v[184:187], v244, s[12:15], s42 offen offset:3072
s_add_u32 s42, s42, 4608
v_mfma_f32_16x16x32_bf16 v[84:87], v[224:227], v[200:203], v[84:87]
v_mfma_f32_16x16x32_bf16 v[120:123], v[224:227], v[204:207], v[120:123]
ds_read_b64_tr_b16 v[240:241], v251 offset:18656
ds_read_b64_tr_b16 v[242:243], v251 offset:23264
s_waitcnt lgkmcnt(6)
v_mfma_f32_16x16x32_bf16 v[16:19], v[228:231], v[192:195], v[16:19]
v_mfma_f32_16x16x32_bf16 v[52:55], v[228:231], v[196:199], v[52:55]
buffer_load_dwordx4 v[188:191], v244, s[12:15], s43 offen offset:3072
s_add_u32 s43, s43, 4608
v_mfma_f32_16x16x32_bf16 v[88:91], v[228:231], v[200:203], v[88:91]
v_mfma_f32_16x16x32_bf16 v[124:127], v[228:231], v[204:207], v[124:127]
ds_read_b64_tr_b16 v[224:225], v251 offset:18688
ds_read_b64_tr_b16 v[226:227], v251 offset:23296
s_waitcnt lgkmcnt(6)
v_mfma_f32_16x16x32_bf16 v[20:23], v[232:235], v[192:195], v[20:23]
v_mfma_f32_16x16x32_bf16 v[56:59], v[232:235], v[196:199], v[56:59]
v_mfma_f32_16x16x32_bf16 v[92:95], v[232:235], v[200:203], v[92:95]
v_mfma_f32_16x16x32_bf16 v[128:131], v[232:235], v[204:207], v[128:131]
s_waitcnt lgkmcnt(4)
v_mfma_f32_16x16x32_bf16 v[24:27], v[236:239], v[192:195], v[24:27]
v_mfma_f32_16x16x32_bf16 v[60:63], v[236:239], v[196:199], v[60:63]
v_mfma_f32_16x16x32_bf16 v[96:99], v[236:239], v[200:203], v[96:99]
v_mfma_f32_16x16x32_bf16 v[132:135], v[236:239], v[204:207], v[132:135]
s_waitcnt lgkmcnt(0) vmcnt(20)
s_barrier
ds_read_b64_tr_b16 v[228:229], v250 offset:0
ds_read_b64_tr_b16 v[230:231], v250 offset:4608
ds_read_b64_tr_b16 v[232:233], v250 offset:32
ds_read_b64_tr_b16 v[234:235], v250 offset:4640
v_mfma_f32_16x16x32_bf16 v[28:31], v[240:243], v[192:195], v[28:31]
v_mfma_f32_16x16x32_bf16 v[64:67], v[240:243], v[196:199], v[64:67]
s_add_u32 s33, s32, 276480
s_cmp_ge_u32 s24, 2
s_cbranch_scc1 dsk_29
s_add_u32 m0, s34, 71680
s_nop 0
buffer_load_dwordx4 v249, s[8:11], s33 offen lds
dsk_29:
v_mfma_f32_16x16x32_bf16 v[100:103], v[240:243], v[200:203], v[100:103]
v_mfma_f32_16x16x32_bf16 v[136:139], v[240:243], v[204:207], v[136:139]
s_add_u32 m0, s34, 55296
s_nop 0
buffer_load_dwordx4 v245, s[8:11], s33 offen lds
ds_read_b64_tr_b16 v[236:237], v250 offset:64
ds_read_b64_tr_b16 v[238:239], v250 offset:4672
v_mfma_f32_16x16x32_bf16 v[32:35], v[224:227], v[192:195], v[32:35]
v_mfma_f32_16x16x32_bf16 v[68:71], v[224:227], v[196:199], v[68:71]
s_add_u32 m0, s34, 59392
s_nop 0
buffer_load_dwordx4 v246, s[8:11], s33 offen lds
v_mfma_f32_16x16x32_bf16 v[104:107], v[224:227], v[200:203], v[104:107]
v_mfma_f32_16x16x32_bf16 v[140:143], v[224:227], v[204:207], v[140:143]
ds_read_b64_tr_b16 v[240:241], v250 offset:96
ds_read_b64_tr_b16 v[242:243], v250 offset:4704
s_waitcnt lgkmcnt(6)
v_mfma_f32_16x16x32_bf16 v[0:3], v[228:231], v[208:211], v[0:3]
v_mfma_f32_16x16x32_bf16 v[36:39], v[228:231], v[212:215], v[36:39]
s_add_u32 m0, s34, 63488
s_nop 0
buffer_load_dwordx4 v247, s[8:11], s33 offen lds
v_mfma_f32_16x16x32_bf16 v[72:75], v[228:231], v[216:219], v[72:75]
v_mfma_f32_16x16x32_bf16 v[108:111], v[228:231], v[220:223], v[108:111]
s_add_u32 m0, s34, 67584
s_nop 0
buffer_load_dwordx4 v248, s[8:11], s33 offen lds
ds_read_b64_tr_b16 v[224:225], v250 offset:128
ds_read_b64_tr_b16 v[226:227], v250 offset:4736
s_waitcnt lgkmcnt(6)
v_mfma_f32_16x16x32_bf16 v[4:7], v[232:235], v[208:211], v[4:7]
v_mfma_f32_16x16x32_bf16 v[40:43], v[232:235], v[212:215], v[40:43]
buffer_load_dwordx4 v[192:195], v244, s[12:15], s40 offen offset:0
v_mfma_f32_16x16x32_bf16 v[76:79], v[232:235], v[216:219], v[76:79]
v_mfma_f32_16x16x32_bf16 v[112:115], v[232:235], v[220:223], v[112:115]
ds_read_b64_tr_b16 v[228:229], v250 offset:160
ds_read_b64_tr_b16 v[230:231], v250 offset:4768
s_waitcnt lgkmcnt(6)
v_mfma_f32_16x16x32_bf16 v[8:11], v[236:239], v[208:211], v[8:11]
v_mfma_f32_16x16x32_bf16 v[44:47], v[236:239], v[212:215], v[44:47]
buffer_load_dwordx4 v[196:199], v244, s[12:15], s41 offen offset:0
v_mfma_f32_16x16x32_bf16 v[80:83], v[236:239], v[216:219], v[80:83]
v_mfma_f32_16x16x32_bf16 v[116:119], v[236:239], v[220:223], v[116:119]
ds_read_b64_tr_b16 v[232:233], v250 offset:192
ds_read_b64_tr_b16 v[234:235], v250 offset:4800
s_waitcnt lgkmcnt(6)
v_mfma_f32_16x16x32_bf16 v[12:15], v[240:243], v[208:211], v[12:15]
v_mfma_f32_16x16x32_bf16 v[48:51], v[240:243], v[212:215], v[48:51]
buffer_load_dwordx4 v[200:203], v244, s[12:15], s42 offen offset:0
v_mfma_f32_16x16x32_bf16 v[84:87], v[240:243], v[216:219], v[84:87]
v_mfma_f32_16x16x32_bf16 v[120:123], v[240:243], v[220:223], v[120:123]
ds_read_b64_tr_b16 v[236:237], v250 offset:224
ds_read_b64_tr_b16 v[238:239], v250 offset:4832
s_waitcnt lgkmcnt(6)
v_mfma_f32_16x16x32_bf16 v[16:19], v[224:227], v[208:211], v[16:19]
v_mfma_f32_16x16x32_bf16 v[52:55], v[224:227], v[212:215], v[52:55]
buffer_load_dwordx4 v[204:207], v244, s[12:15], s43 offen offset:0
v_mfma_f32_16x16x32_bf16 v[88:91], v[224:227], v[216:219], v[88:91]
v_mfma_f32_16x16x32_bf16 v[124:127], v[224:227], v[220:223], v[124:127]
ds_read_b64_tr_b16 v[240:241], v250 offset:256
ds_read_b64_tr_b16 v[242:243], v250 offset:4864
s_waitcnt lgkmcnt(6)
v_mfma_f32_16x16x32_bf16 v[20:23], v[228:231], v[208:211], v[20:23]
v_mfma_f32_16x16x32_bf16 v[56:59], v[228:231], v[212:215], v[56:59]
v_mfma_f32_16x16x32_bf16 v[92:95], v[228:231], v[216:219], v[92:95]
v_mfma_f32_16x16x32_bf16 v[128:131], v[228:231], v[220:223], v[128:131]
s_waitcnt lgkmcnt(4)
v_mfma_f32_16x16x32_bf16 v[24:27], v[232:235], v[208:211], v[24:27]
v_mfma_f32_16x16x32_bf16 v[60:63], v[232:235], v[212:215], v[60:63]
v_mfma_f32_16x16x32_bf16 v[96:99], v[232:235], v[216:219], v[96:99]
v_mfma_f32_16x16x32_bf16 v[132:135], v[232:235], v[220:223], v[132:135]
s_waitcnt lgkmcnt(0) vmcnt(20)
s_barrier
ds_read_b64_tr_b16 v[224:225], v250 offset:18432
ds_read_b64_tr_b16 v[226:227], v250 offset:23040
ds_read_b64_tr_b16 v[228:229], v250 offset:18464
ds_read_b64_tr_b16 v[230:231], v250 offset:23072
v_mfma_f32_16x16x32_bf16 v[28:31], v[236:239], v[208:211], v[28:31]
v_mfma_f32_16x16x32_bf16 v[64:67], v[236:239], v[212:215], v[64:67]
s_add_u32 s33, s32, 331776
s_cmp_ge_u32 s24, 2
s_cbranch_scc1 dsk_30
s_add_u32 m0, s34, 16384
s_nop 0
buffer_load_dwordx4 v249, s[8:11], s33 offen lds
dsk_30:
v_mfma_f32_16x16x32_bf16 v[100:103], v[236:239], v[216:219], v[100:103]
v_mfma_f32_16x16x32_bf16 v[136:139], v[236:239], v[220:223], v[136:139]
s_add_u32 m0, s34, 0
s_nop 0
buffer_load_dwordx4 v245, s[8:11], s33 offen lds
ds_read_b64_tr_b16 v[232:233], v250 offset:18496
ds_read_b64_tr_b16 v[234:235], v250 offset:23104
v_mfma_f32_16x16x32_bf16 v[32:35], v[240:243], v[208:211], v[32:35]
v_mfma_f32_16x16x32_bf16 v[68:71], v[240:243], v[212:215], v[68:71]
s_add_u32 m0, s34, 4096
s_nop 0
buffer_load_dwordx4 v246, s[8:11], s33 offen lds
v_mfma_f32_16x16x32_bf16 v[104:107], v[240:243], v[216:219], v[104:107]
v_mfma_f32_16x16x32_bf16 v[140:143], v[240:243], v[220:223], v[140:143]
ds_read_b64_tr_b16 v[236:237], v250 offset:18528
ds_read_b64_tr_b16 v[238:239], v250 offset:23136
s_waitcnt lgkmcnt(6)
v_mfma_f32_16x16x32_bf16 v[0:3], v[224:227], v[144:147], v[0:3]
v_mfma_f32_16x16x32_bf16 v[36:39], v[224:227], v[148:151], v[36:39]
s_add_u32 m0, s34, 8192
s_nop 0
buffer_load_dwordx4 v247, s[8:11], s33 offen lds
v_mfma_f32_16x16x32_bf16 v[72:75], v[224:227], v[152:155], v[72:75]
v_mfma_f32_16x16x32_bf16 v[108:111], v[224:227], v[156:159], v[108:111]
s_add_u32 m0, s34, 12288
s_nop 0
buffer_load_dwordx4 v248, s[8:11], s33 offen lds
ds_read_b64_tr_b16 v[240:241], v250 offset:18560
ds_read_b64_tr_b16 v[242:243], v250 offset:23168
s_waitcnt lgkmcnt(6)
v_mfma_f32_16x16x32_bf16 v[4:7], v[228:231], v[144:147], v[4:7]
v_mfma_f32_16x16x32_bf16 v[40:43], v[228:231], v[148:151], v[40:43]
buffer_load_dwordx4 v[208:211], v244, s[12:15], s40 offen offset:1024
v_mfma_f32_16x16x32_bf16 v[76:79], v[228:231], v[152:155], v[76:79]
v_mfma_f32_16x16x32_bf16 v[112:115], v[228:231], v[156:159], v[112:115]
ds_read_b64_tr_b16 v[224:225], v250 offset:18592
ds_read_b64_tr_b16 v[226:227], v250 offset:23200
s_waitcnt lgkmcnt(6)
v_mfma_f32_16x16x32_bf16 v[8:11], v[232:235], v[144:147], v[8:11]
v_mfma_f32_16x16x32_bf16 v[44:47], v[232:235], v[148:151], v[44:47]
buffer_load_dwordx4 v[212:215], v244, s[12:15], s41 offen offset:1024
v_mfma_f32_16x16x32_bf16 v[80:83], v[232:235], v[152:155], v[80:83]
v_mfma_f32_16x16x32_bf16 v[116:119], v[232:235], v[156:159], v[116:119]
ds_read_b64_tr_b16 v[228:229], v250 offset:18624
ds_read_b64_tr_b16 v[230:231], v250 offset:23232
s_waitcnt lgkmcnt(6)
v_mfma_f32_16x16x32_bf16 v[12:15], v[236:239], v[144:147], v[12:15]
v_mfma_f32_16x16x32_bf16 v[48:51], v[236:239], v[148:151], v[48:51]
buffer_load_dwordx4 v[216:219], v244, s[12:15], s42 offen offset:1024
v_mfma_f32_16x16x32_bf16 v[84:87], v[236:239], v[152:155], v[84:87]
v_mfma_f32_16x16x32_bf16 v[120:123], v[236:239], v[156:159], v[120:123]
ds_read_b64_tr_b16 v[232:233], v250 offset:18656
ds_read_b64_tr_b16 v[234:235], v250 offset:23264
s_waitcnt lgkmcnt(6)
v_mfma_f32_16x16x32_bf16 v[16:19], v[240:243], v[144:147], v[16:19]
v_mfma_f32_16x16x32_bf16 v[52:55], v[240:243], v[148:151], v[52:55]
buffer_load_dwordx4 v[220:223], v244, s[12:15], s43 offen offset:1024
v_mfma_f32_16x16x32_bf16 v[88:91], v[240:243], v[152:155], v[88:91]
v_mfma_f32_16x16x32_bf16 v[124:127], v[240:243], v[156:159], v[124:127]
ds_read_b64_tr_b16 v[236:237], v250 offset:18688
ds_read_b64_tr_b16 v[238:239], v250 offset:23296
s_waitcnt lgkmcnt(6)
v_mfma_f32_16x16x32_bf16 v[20:23], v[224:227], v[144:147], v[20:23]
v_mfma_f32_16x16x32_bf16 v[56:59], v[224:227], v[148:151], v[56:59]
v_mfma_f32_16x16x32_bf16 v[92:95], v[224:227], v[152:155], v[92:95]
v_mfma_f32_16x16x32_bf16 v[128:131], v[224:227], v[156:159], v[128:131]
s_waitcnt lgkmcnt(4)
v_mfma_f32_16x16x32_bf16 v[24:27], v[228:231], v[144:147], v[24:27]
v_mfma_f32_16x16x32_bf16 v[60:63], v[228:231], v[148:151], v[60:63]
v_mfma_f32_16x16x32_bf16 v[96:99], v[228:231], v[152:155], v[96:99]
v_mfma_f32_16x16x32_bf16 v[132:135], v[228:231], v[156:159], v[132:135]
s_waitcnt lgkmcnt(0) vmcnt(20)
s_barrier
ds_read_b64_tr_b16 v[240:241], v251 offset:0
ds_read_b64_tr_b16 v[242:243], v251 offset:4608
ds_read_b64_tr_b16 v[224:225], v251 offset:32
ds_read_b64_tr_b16 v[226:227], v251 offset:4640
v_mfma_f32_16x16x32_bf16 v[28:31], v[232:235], v[144:147], v[28:31]
v_mfma_f32_16x16x32_bf16 v[64:67], v[232:235], v[148:151], v[64:67]
s_add_u32 s33, s32, 368640
s_cmp_ge_u32 s24, 2
s_cbranch_scc1 dsk_31
s_add_u32 m0, s34, 34816
s_nop 0
buffer_load_dwordx4 v249, s[8:11], s33 offen lds
dsk_31:
v_mfma_f32_16x16x32_bf16 v[100:103], v[232:235], v[152:155], v[100:103]
v_mfma_f32_16x16x32_bf16 v[136:139], v[232:235], v[156:159], v[136:139]
s_add_u32 m0, s34, 18432
s_nop 0
buffer_load_dwordx4 v245, s[8:11], s33 offen lds
ds_read_b64_tr_b16 v[228:229], v251 offset:64
ds_read_b64_tr_b16 v[230:231], v251 offset:4672
v_mfma_f32_16x16x32_bf16 v[32:35], v[236:239], v[144:147], v[32:35]
v_mfma_f32_16x16x32_bf16 v[68:71], v[236:239], v[148:151], v[68:71]
s_add_u32 m0, s34, 22528
s_nop 0
buffer_load_dwordx4 v246, s[8:11], s33 offen lds
v_mfma_f32_16x16x32_bf16 v[104:107], v[236:239], v[152:155], v[104:107]
v_mfma_f32_16x16x32_bf16 v[140:143], v[236:239], v[156:159], v[140:143]
ds_read_b64_tr_b16 v[232:233], v251 offset:96
ds_read_b64_tr_b16 v[234:235], v251 offset:4704
s_waitcnt lgkmcnt(6)
v_mfma_f32_16x16x32_bf16 v[0:3], v[240:243], v[160:163], v[0:3]
v_mfma_f32_16x16x32_bf16 v[36:39], v[240:243], v[164:167], v[36:39]
s_add_u32 m0, s34, 26624
s_nop 0
buffer_load_dwordx4 v247, s[8:11], s33 offen lds
v_mfma_f32_16x16x32_bf16 v[72:75], v[240:243], v[168:171], v[72:75]
v_mfma_f32_16x16x32_bf16 v[108:111], v[240:243], v[172:175], v[108:111]
s_add_u32 m0, s34, 30720
s_nop 0
buffer_load_dwordx4 v248, s[8:11], s33 offen lds
ds_read_b64_tr_b16 v[236:237], v251 offset:128
ds_read_b64_tr_b16 v[238:239], v251 offset:4736
s_waitcnt lgkmcnt(6)
v_mfma_f32_16x16x32_bf16 v[4:7], v[224:227], v[160:163], v[4:7]
v_mfma_f32_16x16x32_bf16 v[40:43], v[224:227], v[164:167], v[40:43]
buffer_load_dwordx4 v[144:147], v244, s[12:15], s40 offen offset:2048
v_mfma_f32_16x16x32_bf16 v[76:79], v[224:227], v[168:171], v[76:79]
v_mfma_f32_16x16x32_bf16 v[112:115], v[224:227], v[172:175], v[112:115]
ds_read_b64_tr_b16 v[240:241], v251 offset:160
ds_read_b64_tr_b16 v[242:243], v251 offset:4768
s_waitcnt lgkmcnt(6)
v_mfma_f32_16x16x32_bf16 v[8:11], v[228:231], v[160:163], v[8:11]
v_mfma_f32_16x16x32_bf16 v[44:47], v[228:231], v[164:167], v[44:47]
buffer_load_dwordx4 v[148:151], v244, s[12:15], s41 offen offset:2048
v_mfma_f32_16x16x32_bf16 v[80:83], v[228:231], v[168:171], v[80:83]
v_mfma_f32_16x16x32_bf16 v[116:119], v[228:231], v[172:175], v[116:119]
ds_read_b64_tr_b16 v[224:225], v251 offset:192
ds_read_b64_tr_b16 v[226:227], v251 offset:4800
s_waitcnt lgkmcnt(6)
v_mfma_f32_16x16x32_bf16 v[12:15], v[232:235], v[160:163], v[12:15]
v_mfma_f32_16x16x32_bf16 v[48:51], v[232:235], v[164:167], v[48:51]
buffer_load_dwordx4 v[152:155], v244, s[12:15], s42 offen offset:2048
v_mfma_f32_16x16x32_bf16 v[84:87], v[232:235], v[168:171], v[84:87]
v_mfma_f32_16x16x32_bf16 v[120:123], v[232:235], v[172:175], v[120:123]
ds_read_b64_tr_b16 v[228:229], v251 offset:224
ds_read_b64_tr_b16 v[230:231], v251 offset:4832
s_waitcnt lgkmcnt(6)
v_mfma_f32_16x16x32_bf16 v[16:19], v[236:239], v[160:163], v[16:19]
v_mfma_f32_16x16x32_bf16 v[52:55], v[236:239], v[164:167], v[52:55]
buffer_load_dwordx4 v[156:159], v244, s[12:15], s43 offen offset:2048
v_mfma_f32_16x16x32_bf16 v[88:91], v[236:239], v[168:171], v[88:91]
v_mfma_f32_16x16x32_bf16 v[124:127], v[236:239], v[172:175], v[124:127]
ds_read_b64_tr_b16 v[232:233], v251 offset:256
ds_read_b64_tr_b16 v[234:235], v251 offset:4864
s_waitcnt lgkmcnt(6)
v_mfma_f32_16x16x32_bf16 v[20:23], v[240:243], v[160:163], v[20:23]
v_mfma_f32_16x16x32_bf16 v[56:59], v[240:243], v[164:167], v[56:59]
v_mfma_f32_16x16x32_bf16 v[92:95], v[240:243], v[168:171], v[92:95]
v_mfma_f32_16x16x32_bf16 v[128:131], v[240:243], v[172:175], v[128:131]
s_waitcnt lgkmcnt(4)
v_mfma_f32_16x16x32_bf16 v[24:27], v[224:227], v[160:163], v[24:27]
v_mfma_f32_16x16x32_bf16 v[60:63], v[224:227], v[164:167], v[60:63]
v_mfma_f32_16x16x32_bf16 v[96:99], v[224:227], v[168:171], v[96:99]
v_mfma_f32_16x16x32_bf16 v[132:135], v[224:227], v[172:175], v[132:135]
s_waitcnt lgkmcnt(0) vmcnt(20)
s_barrier
ds_read_b64_tr_b16 v[236:237], v251 offset:18432
ds_read_b64_tr_b16 v[238:239], v251 offset:23040
ds_read_b64_tr_b16 v[240:241], v251 offset:18464
ds_read_b64_tr_b16 v[242:243], v251 offset:23072
v_mfma_f32_16x16x32_bf16 v[28:31], v[228:231], v[160:163], v[28:31]
v_mfma_f32_16x16x32_bf16 v[64:67], v[228:231], v[164:167], v[64:67]
s_add_u32 s33, s32, 405504
s_cmp_ge_u32 s24, 2
s_cbranch_scc1 dsk_32
s_add_u32 m0, s34, 53248
s_nop 0
buffer_load_dwordx4 v249, s[8:11], s33 offen lds
dsk_32:
v_mfma_f32_16x16x32_bf16 v[100:103], v[228:231], v[168:171], v[100:103]
v_mfma_f32_16x16x32_bf16 v[136:139], v[228:231], v[172:175], v[136:139]
s_add_u32 m0, s34, 36864
s_nop 0
buffer_load_dwordx4 v245, s[8:11], s33 offen lds
ds_read_b64_tr_b16 v[224:225], v251 offset:18496
ds_read_b64_tr_b16 v[226:227], v251 offset:23104
v_mfma_f32_16x16x32_bf16 v[32:35], v[232:235], v[160:163], v[32:35]
v_mfma_f32_16x16x32_bf16 v[68:71], v[232:235], v[164:167], v[68:71]
s_add_u32 m0, s34, 40960
s_nop 0
buffer_load_dwordx4 v246, s[8:11], s33 offen lds
v_mfma_f32_16x16x32_bf16 v[104:107], v[232:235], v[168:171], v[104:107]
v_mfma_f32_16x16x32_bf16 v[140:143], v[232:235], v[172:175], v[140:143]
ds_read_b64_tr_b16 v[228:229], v251 offset:18528
ds_read_b64_tr_b16 v[230:231], v251 offset:23136
s_waitcnt lgkmcnt(6)
v_mfma_f32_16x16x32_bf16 v[0:3], v[236:239], v[176:179], v[0:3]
v_mfma_f32_16x16x32_bf16 v[36:39], v[236:239], v[180:183], v[36:39]
s_add_u32 m0, s34, 45056
s_nop 0
buffer_load_dwordx4 v247, s[8:11], s33 offen lds
v_mfma_f32_16x16x32_bf16 v[72:75], v[236:239], v[184:187], v[72:75]
v_mfma_f32_16x16x32_bf16 v[108:111], v[236:239], v[188:191], v[108:111]
s_add_u32 m0, s34, 49152
s_nop 0
buffer_load_dwordx4 v248, s[8:11], s33 offen lds
ds_read_b64_tr_b16 v[232:233], v251 offset:18560
ds_read_b64_tr_b16 v[234:235], v251 offset:23168
s_waitcnt lgkmcnt(6)
v_mfma_f32_16x16x32_bf16 v[4:7], v[240:243], v[176:179], v[4:7]
v_mfma_f32_16x16x32_bf16 v[40:43], v[240:243], v[180:183], v[40:43]
buffer_load_dwordx4 v[160:163], v244, s[12:15], s40 offen offset:3072
s_add_u32 s40, s40, 4608
v_mfma_f32_16x16x32_bf16 v[76:79], v[240:243], v[184:187], v[76:79]
v_mfma_f32_16x16x32_bf16 v[112:115], v[240:243], v[188:191], v[112:115]
ds_read_b64_tr_b16 v[236:237], v251 offset:18592
ds_read_b64_tr_b16 v[238:239], v251 offset:23200
s_waitcnt lgkmcnt(6)
v_mfma_f32_16x16x32_bf16 v[8:11], v[224:227], v[176:179], v[8:11]
v_mfma_f32_16x16x32_bf16 v[44:47], v[224:227], v[180:183], v[44:47]
buffer_load_dwordx4 v[164:167], v244, s[12:15], s41 offen offset:3072
s_add_u32 s41, s41, 4608
v_mfma_f32_16x16x32_bf16 v[80:83], v[224:227], v[184:187], v[80:83]
v_mfma_f32_16x16x32_bf16 v[116:119], v[224:227], v[188:191], v[116:119]
ds_read_b64_tr_b16 v[240:241], v251 offset:18624
ds_read_b64_tr_b16 v[242:243], v251 offset:23232
s_waitcnt lgkmcnt(6)
v_mfma_f32_16x16x32_bf16 v[12:15], v[228:231], v[176:179], v[12:15]
v_mfma_f32_16x16x32_bf16 v[48:51], v[228:231], v[180:183], v[48:51]
buffer_load_dwordx4 v[168:171], v244, s[12:15], s42 offen offset:3072
s_add_u32 s42, s42, 4608
v_mfma_f32_16x16x32_bf16 v[84:87], v[228:231], v[184:187], v[84:87]
v_mfma_f32_16x16x32_bf16 v[120:123], v[228:231], v[188:191], v[120:123]
ds_read_b64_tr_b16 v[224:225], v251 offset:18656
ds_read_b64_tr_b16 v[226:227], v251 offset:23264
s_waitcnt lgkmcnt(6)
v_mfma_f32_16x16x32_bf16 v[16:19], v[232:235], v[176:179], v[16:19]
v_mfma_f32_16x16x32_bf16 v[52:55], v[232:235], v[180:183], v[52:55]
buffer_load_dwordx4 v[172:175], v244, s[12:15], s43 offen offset:3072
s_add_u32 s43, s43, 4608
v_mfma_f32_16x16x32_bf16 v[88:91], v[232:235], v[184:187], v[88:91]
v_mfma_f32_16x16x32_bf16 v[124:127], v[232:235], v[188:191], v[124:127]
ds_read_b64_tr_b16 v[228:229], v251 offset:18688
ds_read_b64_tr_b16 v[230:231], v251 offset:23296
s_waitcnt lgkmcnt(6)
v_mfma_f32_16x16x32_bf16 v[20:23], v[236:239], v[176:179], v[20:23]
v_mfma_f32_16x16x32_bf16 v[56:59], v[236:239], v[180:183], v[56:59]
v_mfma_f32_16x16x32_bf16 v[92:95], v[236:239], v[184:187], v[92:95]
v_mfma_f32_16x16x32_bf16 v[128:131], v[236:239], v[188:191], v[128:131]
s_waitcnt lgkmcnt(4)
v_mfma_f32_16x16x32_bf16 v[24:27], v[240:243], v[176:179], v[24:27]
v_mfma_f32_16x16x32_bf16 v[60:63], v[240:243], v[180:183], v[60:63]
v_mfma_f32_16x16x32_bf16 v[96:99], v[240:243], v[184:187], v[96:99]
v_mfma_f32_16x16x32_bf16 v[132:135], v[240:243], v[188:191], v[132:135]
s_waitcnt lgkmcnt(0) vmcnt(20)
s_barrier
ds_read_b64_tr_b16 v[232:233], v250 offset:0
ds_read_b64_tr_b16 v[234:235], v250 offset:4608
ds_read_b64_tr_b16 v[236:237], v250 offset:32
ds_read_b64_tr_b16 v[238:239], v250 offset:4640
v_mfma_f32_16x16x32_bf16 v[28:31], v[224:227], v[176:179], v[28:31]
v_mfma_f32_16x16x32_bf16 v[64:67], v[224:227], v[180:183], v[64:67]
s_add_u32 s33, s32, 442368
s_cmp_ge_u32 s24, 2
s_cbranch_scc1 dsk_33
s_add_u32 m0, s34, 71680
s_nop 0
buffer_load_dwordx4 v249, s[8:11], s33 offen lds
dsk_33:
v_mfma_f32_16x16x32_bf16 v[100:103], v[224:227], v[184:187], v[100:103]
v_mfma_f32_16x16x32_bf16 v[136:139], v[224:227], v[188:191], v[136:139]
s_add_u32 m0, s34, 55296
s_nop 0
buffer_load_dwordx4 v245, s[8:11], s33 offen lds
ds_read_b64_tr_b16 v[240:241], v250 offset:64
ds_read_b64_tr_b16 v[242:243], v250 offset:4672
v_mfma_f32_16x16x32_bf16 v[32:35], v[228:231], v[176:179], v[32:35]
v_mfma_f32_16x16x32_bf16 v[68:71], v[228:231], v[180:183], v[68:71]
s_add_u32 m0, s34, 59392
s_nop 0
buffer_load_dwordx4 v246, s[8:11], s33 offen lds
v_mfma_f32_16x16x32_bf16 v[104:107], v[228:231], v[184:187], v[104:107]
v_mfma_f32_16x16x32_bf16 v[140:143], v[228:231], v[188:191], v[140:143]
ds_read_b64_tr_b16 v[224:225], v250 offset:96
ds_read_b64_tr_b16 v[226:227], v250 offset:4704
s_waitcnt lgkmcnt(6)
v_mfma_f32_16x16x32_bf16 v[0:3], v[232:235], v[192:195], v[0:3]
v_mfma_f32_16x16x32_bf16 v[36:39], v[232:235], v[196:199], v[36:39]
s_add_u32 m0, s34, 63488
s_nop 0
buffer_load_dwordx4 v247, s[8:11], s33 offen lds
v_mfma_f32_16x16x32_bf16 v[72:75], v[232:235], v[200:203], v[72:75]
v_mfma_f32_16x16x32_bf16 v[108:111], v[232:235], v[204:207], v[108:111]
s_add_u32 m0, s34, 67584
s_nop 0
buffer_load_dwordx4 v248, s[8:11], s33 offen lds
ds_read_b64_tr_b16 v[228:229], v250 offset:128
ds_read_b64_tr_b16 v[230:231], v250 offset:4736
s_waitcnt lgkmcnt(6)
v_mfma_f32_16x16x32_bf16 v[4:7], v[236:239], v[192:195], v[4:7]
v_mfma_f32_16x16x32_bf16 v[40:43], v[236:239], v[196:199], v[40:43]
buffer_load_dwordx4 v[176:179], v244, s[12:15], s40 offen offset:0
v_mfma_f32_16x16x32_bf16 v[76:79], v[236:239], v[200:203], v[76:79]
v_mfma_f32_16x16x32_bf16 v[112:115], v[236:239], v[204:207], v[112:115]
ds_read_b64_tr_b16 v[232:233], v250 offset:160
ds_read_b64_tr_b16 v[234:235], v250 offset:4768
s_waitcnt lgkmcnt(6)
v_mfma_f32_16x16x32_bf16 v[8:11], v[240:243], v[192:195], v[8:11]
v_mfma_f32_16x16x32_bf16 v[44:47], v[240:243], v[196:199], v[44:47]
buffer_load_dwordx4 v[180:183], v244, s[12:15], s41 offen offset:0
v_mfma_f32_16x16x32_bf16 v[80:83], v[240:243], v[200:203], v[80:83]
v_mfma_f32_16x16x32_bf16 v[116:119], v[240:243], v[204:207], v[116:119]
ds_read_b64_tr_b16 v[236:237], v250 offset:192
ds_read_b64_tr_b16 v[238:239], v250 offset:4800
s_waitcnt lgkmcnt(6)
v_mfma_f32_16x16x32_bf16 v[12:15], v[224:227], v[192:195], v[12:15]
v_mfma_f32_16x16x32_bf16 v[48:51], v[224:227], v[196:199], v[48:51]
buffer_load_dwordx4 v[184:187], v244, s[12:15], s42 offen offset:0
v_mfma_f32_16x16x32_bf16 v[84:87], v[224:227], v[200:203], v[84:87]
v_mfma_f32_16x16x32_bf16 v[120:123], v[224:227], v[204:207], v[120:123]
ds_read_b64_tr_b16 v[240:241], v250 offset:224
ds_read_b64_tr_b16 v[242:243], v250 offset:4832
s_waitcnt lgkmcnt(6)
v_mfma_f32_16x16x32_bf16 v[16:19], v[228:231], v[192:195], v[16:19]
v_mfma_f32_16x16x32_bf16 v[52:55], v[228:231], v[196:199], v[52:55]
buffer_load_dwordx4 v[188:191], v244, s[12:15], s43 offen offset:0
v_mfma_f32_16x16x32_bf16 v[88:91], v[228:231], v[200:203], v[88:91]
v_mfma_f32_16x16x32_bf16 v[124:127], v[228:231], v[204:207], v[124:127]
ds_read_b64_tr_b16 v[224:225], v250 offset:256
ds_read_b64_tr_b16 v[226:227], v250 offset:4864
s_waitcnt lgkmcnt(6)
v_mfma_f32_16x16x32_bf16 v[20:23], v[232:235], v[192:195], v[20:23]
v_mfma_f32_16x16x32_bf16 v[56:59], v[232:235], v[196:199], v[56:59]
v_mfma_f32_16x16x32_bf16 v[92:95], v[232:235], v[200:203], v[92:95]
v_mfma_f32_16x16x32_bf16 v[128:131], v[232:235], v[204:207], v[128:131]
s_waitcnt lgkmcnt(4)
v_mfma_f32_16x16x32_bf16 v[24:27], v[236:239], v[192:195], v[24:27]
v_mfma_f32_16x16x32_bf16 v[60:63], v[236:239], v[196:199], v[60:63]
v_mfma_f32_16x16x32_bf16 v[96:99], v[236:239], v[200:203], v[96:99]
v_mfma_f32_16x16x32_bf16 v[132:135], v[236:239], v[204:207], v[132:135]
s_waitcnt lgkmcnt(0) vmcnt(20)
s_barrier
ds_read_b64_tr_b16 v[228:229], v250 offset:18432
ds_read_b64_tr_b16 v[230:231], v250 offset:23040
ds_read_b64_tr_b16 v[232:233], v250 offset:18464
ds_read_b64_tr_b16 v[234:235], v250 offset:23072
v_mfma_f32_16x16x32_bf16 v[28:31], v[240:243], v[192:195], v[28:31]
v_mfma_f32_16x16x32_bf16 v[64:67], v[240:243], v[196:199], v[64:67]
s_add_u32 s33, s32, 497664
s_cmp_ge_u32 s24, 2
s_cbranch_scc1 dsk_34
s_add_u32 m0, s34, 16384
s_nop 0
buffer_load_dwordx4 v249, s[8:11], s33 offen lds
dsk_34:
v_mfma_f32_16x16x32_bf16 v[100:103], v[240:243], v[200:203], v[100:103]
v_mfma_f32_16x16x32_bf16 v[136:139], v[240:243], v[204:207], v[136:139]
s_add_u32 m0, s34, 0
s_nop 0
buffer_load_dwordx4 v245, s[8:11], s33 offen lds
ds_read_b64_tr_b16 v[236:237], v250 offset:18496
ds_read_b64_tr_b16 v[238:239], v250 offset:23104
v_mfma_f32_16x16x32_bf16 v[32:35], v[224:227], v[192:195], v[32:35]
v_mfma_f32_16x16x32_bf16 v[68:71], v[224:227], v[196:199], v[68:71]
s_add_u32 m0, s34, 4096
s_nop 0
buffer_load_dwordx4 v246, s[8:11], s33 offen lds
v_mfma_f32_16x16x32_bf16 v[104:107], v[224:227], v[200:203], v[104:107]
v_mfma_f32_16x16x32_bf16 v[140:143], v[224:227], v[204:207], v[140:143]
ds_read_b64_tr_b16 v[240:241], v250 offset:18528
ds_read_b64_tr_b16 v[242:243], v250 offset:23136
s_waitcnt lgkmcnt(6)
v_mfma_f32_16x16x32_bf16 v[0:3], v[228:231], v[208:211], v[0:3]
v_mfma_f32_16x16x32_bf16 v[36:39], v[228:231], v[212:215], v[36:39]
s_add_u32 m0, s34, 8192
s_nop 0
buffer_load_dwordx4 v247, s[8:11], s33 offen lds
v_mfma_f32_16x16x32_bf16 v[72:75], v[228:231], v[216:219], v[72:75]
v_mfma_f32_16x16x32_bf16 v[108:111], v[228:231], v[220:223], v[108:111]
s_add_u32 m0, s34, 12288
s_nop 0
buffer_load_dwordx4 v248, s[8:11], s33 offen lds
ds_read_b64_tr_b16 v[224:225], v250 offset:18560
ds_read_b64_tr_b16 v[226:227], v250 offset:23168
s_waitcnt lgkmcnt(6)
v_mfma_f32_16x16x32_bf16 v[4:7], v[232:235], v[208:211], v[4:7]
v_mfma_f32_16x16x32_bf16 v[40:43], v[232:235], v[212:215], v[40:43]
buffer_load_dwordx4 v[192:195], v244, s[12:15], s40 offen offset:1024
v_mfma_f32_16x16x32_bf16 v[76:79], v[232:235], v[216:219], v[76:79]
v_mfma_f32_16x16x32_bf16 v[112:115], v[232:235], v[220:223], v[112:115]
ds_read_b64_tr_b16 v[228:229], v250 offset:18592
ds_read_b64_tr_b16 v[230:231], v250 offset:23200
s_waitcnt lgkmcnt(6)
v_mfma_f32_16x16x32_bf16 v[8:11], v[236:239], v[208:211], v[8:11]
v_mfma_f32_16x16x32_bf16 v[44:47], v[236:239], v[212:215], v[44:47]
buffer_load_dwordx4 v[196:199], v244, s[12:15], s41 offen offset:1024
v_mfma_f32_16x16x32_bf16 v[80:83], v[236:239], v[216:219], v[80:83]
v_mfma_f32_16x16x32_bf16 v[116:119], v[236:239], v[220:223], v[116:119]
ds_read_b64_tr_b16 v[232:233], v250 offset:18624
ds_read_b64_tr_b16 v[234:235], v250 offset:23232
s_waitcnt lgkmcnt(6)
v_mfma_f32_16x16x32_bf16 v[12:15], v[240:243], v[208:211], v[12:15]
v_mfma_f32_16x16x32_bf16 v[48:51], v[240:243], v[212:215], v[48:51]
buffer_load_dwordx4 v[200:203], v244, s[12:15], s42 offen offset:1024
v_mfma_f32_16x16x32_bf16 v[84:87], v[240:243], v[216:219], v[84:87]
v_mfma_f32_16x16x32_bf16 v[120:123], v[240:243], v[220:223], v[120:123]
ds_read_b64_tr_b16 v[236:237], v250 offset:18656
ds_read_b64_tr_b16 v[238:239], v250 offset:23264
s_waitcnt lgkmcnt(6)
v_mfma_f32_16x16x32_bf16 v[16:19], v[224:227], v[208:211], v[16:19]
v_mfma_f32_16x16x32_bf16 v[52:55], v[224:227], v[212:215], v[52:55]
buffer_load_dwordx4 v[204:207], v244, s[12:15], s43 offen offset:1024
v_mfma_f32_16x16x32_bf16 v[88:91], v[224:227], v[216:219], v[88:91]
v_mfma_f32_16x16x32_bf16 v[124:127], v[224:227], v[220:223], v[124:127]
ds_read_b64_tr_b16 v[240:241], v250 offset:18688
ds_read_b64_tr_b16 v[242:243], v250 offset:23296
s_waitcnt lgkmcnt(6)
v_mfma_f32_16x16x32_bf16 v[20:23], v[228:231], v[208:211], v[20:23]
v_mfma_f32_16x16x32_bf16 v[56:59], v[228:231], v[212:215], v[56:59]
v_mfma_f32_16x16x32_bf16 v[92:95], v[228:231], v[216:219], v[92:95]
v_mfma_f32_16x16x32_bf16 v[128:131], v[228:231], v[220:223], v[128:131]
s_waitcnt lgkmcnt(4)
v_mfma_f32_16x16x32_bf16 v[24:27], v[232:235], v[208:211], v[24:27]
v_mfma_f32_16x16x32_bf16 v[60:63], v[232:235], v[212:215], v[60:63]
v_mfma_f32_16x16x32_bf16 v[96:99], v[232:235], v[216:219], v[96:99]
v_mfma_f32_16x16x32_bf16 v[132:135], v[232:235], v[220:223], v[132:135]
s_waitcnt lgkmcnt(0) vmcnt(20)
s_barrier
ds_read_b64_tr_b16 v[224:225], v251 offset:0
ds_read_b64_tr_b16 v[226:227], v251 offset:4608
ds_read_b64_tr_b16 v[228:229], v251 offset:32
ds_read_b64_tr_b16 v[230:231], v251 offset:4640
v_mfma_f32_16x16x32_bf16 v[28:31], v[236:239], v[208:211], v[28:31]
v_mfma_f32_16x16x32_bf16 v[64:67], v[236:239], v[212:215], v[64:67]
s_add_u32 s33, s32, 534528
s_cmp_ge_u32 s24, 2
s_cbranch_scc1 dsk_35
s_add_u32 m0, s34, 34816
s_nop 0
buffer_load_dwordx4 v249, s[8:11], s33 offen lds
dsk_35:
v_mfma_f32_16x16x32_bf16 v[100:103], v[236:239], v[216:219], v[100:103]
v_mfma_f32_16x16x32_bf16 v[136:139], v[236:239], v[220:223], v[136:139]
s_add_u32 m0, s34, 18432
s_nop 0
buffer_load_dwordx4 v245, s[8:11], s33 offen lds
ds_read_b64_tr_b16 v[232:233], v251 offset:64
ds_read_b64_tr_b16 v[234:235], v251 offset:4672
v_mfma_f32_16x16x32_bf16 v[32:35], v[240:243], v[208:211], v[32:35]
v_mfma_f32_16x16x32_bf16 v[68:71], v[240:243], v[212:215], v[68:71]
s_add_u32 m0, s34, 22528
s_nop 0
buffer_load_dwordx4 v246, s[8:11], s33 offen lds
v_mfma_f32_16x16x32_bf16 v[104:107], v[240:243], v[216:219], v[104:107]
v_mfma_f32_16x16x32_bf16 v[140:143], v[240:243], v[220:223], v[140:143]
ds_read_b64_tr_b16 v[236:237], v251 offset:96
ds_read_b64_tr_b16 v[238:239], v251 offset:4704
s_waitcnt lgkmcnt(6)
v_mfma_f32_16x16x32_bf16 v[0:3], v[224:227], v[144:147], v[0:3]
v_mfma_f32_16x16x32_bf16 v[36:39], v[224:227], v[148:151], v[36:39]
s_add_u32 m0, s34, 26624
s_nop 0
buffer_load_dwordx4 v247, s[8:11], s33 offen lds
v_mfma_f32_16x16x32_bf16 v[72:75], v[224:227], v[152:155], v[72:75]
v_mfma_f32_16x16x32_bf16 v[108:111], v[224:227], v[156:159], v[108:111]
s_add_u32 m0, s34, 30720
s_nop 0
buffer_load_dwordx4 v248, s[8:11], s33 offen lds
ds_read_b64_tr_b16 v[240:241], v251 offset:128
ds_read_b64_tr_b16 v[242:243], v251 offset:4736
s_waitcnt lgkmcnt(6)
v_mfma_f32_16x16x32_bf16 v[4:7], v[228:231], v[144:147], v[4:7]
v_mfma_f32_16x16x32_bf16 v[40:43], v[228:231], v[148:151], v[40:43]
buffer_load_dwordx4 v[208:211], v244, s[12:15], s40 offen offset:2048
v_mfma_f32_16x16x32_bf16 v[76:79], v[228:231], v[152:155], v[76:79]
v_mfma_f32_16x16x32_bf16 v[112:115], v[228:231], v[156:159], v[112:115]
ds_read_b64_tr_b16 v[224:225], v251 offset:160
ds_read_b64_tr_b16 v[226:227], v251 offset:4768
s_waitcnt lgkmcnt(6)
v_mfma_f32_16x16x32_bf16 v[8:11], v[232:235], v[144:147], v[8:11]
v_mfma_f32_16x16x32_bf16 v[44:47], v[232:235], v[148:151], v[44:47]
buffer_load_dwordx4 v[212:215], v244, s[12:15], s41 offen offset:2048
v_mfma_f32_16x16x32_bf16 v[80:83], v[232:235], v[152:155], v[80:83]
v_mfma_f32_16x16x32_bf16 v[116:119], v[232:235], v[156:159], v[116:119]
ds_read_b64_tr_b16 v[228:229], v251 offset:192
ds_read_b64_tr_b16 v[230:231], v251 offset:4800
s_waitcnt lgkmcnt(6)
v_mfma_f32_16x16x32_bf16 v[12:15], v[236:239], v[144:147], v[12:15]
v_mfma_f32_16x16x32_bf16 v[48:51], v[236:239], v[148:151], v[48:51]
buffer_load_dwordx4 v[216:219], v244, s[12:15], s42 offen offset:2048
v_mfma_f32_16x16x32_bf16 v[84:87], v[236:239], v[152:155], v[84:87]
v_mfma_f32_16x16x32_bf16 v[120:123], v[236:239], v[156:159], v[120:123]
ds_read_b64_tr_b16 v[232:233], v251 offset:224
ds_read_b64_tr_b16 v[234:235], v251 offset:4832
s_waitcnt lgkmcnt(6)
v_mfma_f32_16x16x32_bf16 v[16:19], v[240:243], v[144:147], v[16:19]
v_mfma_f32_16x16x32_bf16 v[52:55], v[240:243], v[148:151], v[52:55]
buffer_load_dwordx4 v[220:223], v244, s[12:15], s43 offen offset:2048
v_mfma_f32_16x16x32_bf16 v[88:91], v[240:243], v[152:155], v[88:91]
v_mfma_f32_16x16x32_bf16 v[124:127], v[240:243], v[156:159], v[124:127]
ds_read_b64_tr_b16 v[236:237], v251 offset:256
ds_read_b64_tr_b16 v[238:239], v251 offset:4864
s_waitcnt lgkmcnt(6)
v_mfma_f32_16x16x32_bf16 v[20:23], v[224:227], v[144:147], v[20:23]
v_mfma_f32_16x16x32_bf16 v[56:59], v[224:227], v[148:151], v[56:59]
v_mfma_f32_16x16x32_bf16 v[92:95], v[224:227], v[152:155], v[92:95]
v_mfma_f32_16x16x32_bf16 v[128:131], v[224:227], v[156:159], v[128:131]
s_waitcnt lgkmcnt(4)
v_mfma_f32_16x16x32_bf16 v[24:27], v[228:231], v[144:147], v[24:27]
v_mfma_f32_16x16x32_bf16 v[60:63], v[228:231], v[148:151], v[60:63]
v_mfma_f32_16x16x32_bf16 v[96:99], v[228:231], v[152:155], v[96:99]
v_mfma_f32_16x16x32_bf16 v[132:135], v[228:231], v[156:159], v[132:135]
s_waitcnt lgkmcnt(0) vmcnt(20)
s_barrier
ds_read_b64_tr_b16 v[240:241], v251 offset:18432
ds_read_b64_tr_b16 v[242:243], v251 offset:23040
ds_read_b64_tr_b16 v[224:225], v251 offset:18464
ds_read_b64_tr_b16 v[226:227], v251 offset:23072
v_mfma_f32_16x16x32_bf16 v[28:31], v[232:235], v[144:147], v[28:31]
v_mfma_f32_16x16x32_bf16 v[64:67], v[232:235], v[148:151], v[64:67]
s_add_u32 s33, s32, 571392
s_cmp_ge_u32 s24, 2
s_cbranch_scc1 dsk_36
s_add_u32 m0, s34, 53248
s_nop 0
buffer_load_dwordx4 v249, s[8:11], s33 offen lds
dsk_36:
v_mfma_f32_16x16x32_bf16 v[100:103], v[232:235], v[152:155], v[100:103]
v_mfma_f32_16x16x32_bf16 v[136:139], v[232:235], v[156:159], v[136:139]
s_add_u32 m0, s34, 36864
s_nop 0
buffer_load_dwordx4 v245, s[8:11], s33 offen lds
ds_read_b64_tr_b16 v[228:229], v251 offset:18496
ds_read_b64_tr_b16 v[230:231], v251 offset:23104
v_mfma_f32_16x16x32_bf16 v[32:35], v[236:239], v[144:147], v[32:35]
v_mfma_f32_16x16x32_bf16 v[68:71], v[236:239], v[148:151], v[68:71]
s_add_u32 m0, s34, 40960
s_nop 0
buffer_load_dwordx4 v246, s[8:11], s33 offen lds
v_mfma_f32_16x16x32_bf16 v[104:107], v[236:239], v[152:155], v[104:107]
v_mfma_f32_16x16x32_bf16 v[140:143], v[236:239], v[156:159], v[140:143]
ds_read_b64_tr_b16 v[232:233], v251 offset:18528
ds_read_b64_tr_b16 v[234:235], v251 offset:23136
s_waitcnt lgkmcnt(6)
v_mfma_f32_16x16x32_bf16 v[0:3], v[240:243], v[160:163], v[0:3]
v_mfma_f32_16x16x32_bf16 v[36:39], v[240:243], v[164:167], v[36:39]
s_add_u32 m0, s34, 45056
s_nop 0
buffer_load_dwordx4 v247, s[8:11], s33 offen lds
v_mfma_f32_16x16x32_bf16 v[72:75], v[240:243], v[168:171], v[72:75]
v_mfma_f32_16x16x32_bf16 v[108:111], v[240:243], v[172:175], v[108:111]
s_add_u32 m0, s34, 49152
s_nop 0
buffer_load_dwordx4 v248, s[8:11], s33 offen lds
ds_read_b64_tr_b16 v[236:237], v251 offset:18560
ds_read_b64_tr_b16 v[238:239], v251 offset:23168
s_waitcnt lgkmcnt(6)
v_mfma_f32_16x16x32_bf16 v[4:7], v[224:227], v[160:163], v[4:7]
v_mfma_f32_16x16x32_bf16 v[40:43], v[224:227], v[164:167], v[40:43]
buffer_load_dwordx4 v[144:147], v244, s[12:15], s40 offen offset:3072
s_add_u32 s40, s40, 4608
v_mfma_f32_16x16x32_bf16 v[76:79], v[224:227], v[168:171], v[76:79]
v_mfma_f32_16x16x32_bf16 v[112:115], v[224:227], v[172:175], v[112:115]
ds_read_b64_tr_b16 v[240:241], v251 offset:18592
ds_read_b64_tr_b16 v[242:243], v251 offset:23200
s_waitcnt lgkmcnt(6)
v_mfma_f32_16x16x32_bf16 v[8:11], v[228:231], v[160:163], v[8:11]
v_mfma_f32_16x16x32_bf16 v[44:47], v[228:231], v[164:167], v[44:47]
buffer_load_dwordx4 v[148:151], v244, s[12:15], s41 offen offset:3072
s_add_u32 s41, s41, 4608
v_mfma_f32_16x16x32_bf16 v[80:83], v[228:231], v[168:171], v[80:83]
v_mfma_f32_16x16x32_bf16 v[116:119], v[228:231], v[172:175], v[116:119]
ds_read_b64_tr_b16 v[224:225], v251 offset:18624
ds_read_b64_tr_b16 v[226:227], v251 offset:23232
s_waitcnt lgkmcnt(6)
v_mfma_f32_16x16x32_bf16 v[12:15], v[232:235], v[160:163], v[12:15]
v_mfma_f32_16x16x32_bf16 v[48:51], v[232:235], v[164:167], v[48:51]
buffer_load_dwordx4 v[152:155], v244, s[12:15], s42 offen offset:3072
s_add_u32 s42, s42, 4608
v_mfma_f32_16x16x32_bf16 v[84:87], v[232:235], v[168:171], v[84:87]
v_mfma_f32_16x16x32_bf16 v[120:123], v[232:235], v[172:175], v[120:123]
ds_read_b64_tr_b16 v[228:229], v251 offset:18656
ds_read_b64_tr_b16 v[230:231], v251 offset:23264
s_waitcnt lgkmcnt(6)
v_mfma_f32_16x16x32_bf16 v[16:19], v[236:239], v[160:163], v[16:19]
v_mfma_f32_16x16x32_bf16 v[52:55], v[236:239], v[164:167], v[52:55]
buffer_load_dwordx4 v[156:159], v244, s[12:15], s43 offen offset:3072
s_add_u32 s43, s43, 4608
v_mfma_f32_16x16x32_bf16 v[88:91], v[236:239], v[168:171], v[88:91]
v_mfma_f32_16x16x32_bf16 v[124:127], v[236:239], v[172:175], v[124:127]
ds_read_b64_tr_b16 v[232:233], v251 offset:18688
ds_read_b64_tr_b16 v[234:235], v251 offset:23296
s_waitcnt lgkmcnt(6)
v_mfma_f32_16x16x32_bf16 v[20:23], v[240:243], v[160:163], v[20:23]
v_mfma_f32_16x16x32_bf16 v[56:59], v[240:243], v[164:167], v[56:59]
v_mfma_f32_16x16x32_bf16 v[92:95], v[240:243], v[168:171], v[92:95]
v_mfma_f32_16x16x32_bf16 v[128:131], v[240:243], v[172:175], v[128:131]
s_waitcnt lgkmcnt(4)
v_mfma_f32_16x16x32_bf16 v[24:27], v[224:227], v[160:163], v[24:27]
v_mfma_f32_16x16x32_bf16 v[60:63], v[224:227], v[164:167], v[60:63]
v_mfma_f32_16x16x32_bf16 v[96:99], v[224:227], v[168:171], v[96:99]
v_mfma_f32_16x16x32_bf16 v[132:135], v[224:227], v[172:175], v[132:135]
s_waitcnt lgkmcnt(0) vmcnt(20)
s_barrier
ds_read_b64_tr_b16 v[236:237], v250 offset:0
ds_read_b64_tr_b16 v[238:239], v250 offset:4608
ds_read_b64_tr_b16 v[240:241], v250 offset:32
ds_read_b64_tr_b16 v[242:243], v250 offset:4640
v_mfma_f32_16x16x32_bf16 v[28:31], v[228:231], v[160:163], v[28:31]
v_mfma_f32_16x16x32_bf16 v[64:67], v[228:231], v[164:167], v[64:67]
s_add_u32 s33, s32, 608256
s_cmp_ge_u32 s24, 2
s_cbranch_scc1 dsk_37
s_add_u32 m0, s34, 71680
s_nop 0
buffer_load_dwordx4 v249, s[8:11], s33 offen lds
dsk_37:
v_mfma_f32_16x16x32_bf16 v[100:103], v[228:231], v[168:171], v[100:103]
v_mfma_f32_16x16x32_bf16 v[136:139], v[228:231], v[172:175], v[136:139]
s_add_u32 m0, s34, 55296
s_nop 0
buffer_load_dwordx4 v245, s[8:11], s33 offen lds
ds_read_b64_tr_b16 v[224:225], v250 offset:64
ds_read_b64_tr_b16 v[226:227], v250 offset:4672
v_mfma_f32_16x16x32_bf16 v[32:35], v[232:235], v[160:163], v[32:35]
v_mfma_f32_16x16x32_bf16 v[68:71], v[232:235], v[164:167], v[68:71]
s_add_u32 m0, s34, 59392
s_nop 0
buffer_load_dwordx4 v246, s[8:11], s33 offen lds
v_mfma_f32_16x16x32_bf16 v[104:107], v[232:235], v[168:171], v[104:107]
v_mfma_f32_16x16x32_bf16 v[140:143], v[232:235], v[172:175], v[140:143]
ds_read_b64_tr_b16 v[228:229], v250 offset:96
ds_read_b64_tr_b16 v[230:231], v250 offset:4704
s_waitcnt lgkmcnt(6)
v_mfma_f32_16x16x32_bf16 v[0:3], v[236:239], v[176:179], v[0:3]
v_mfma_f32_16x16x32_bf16 v[36:39], v[236:239], v[180:183], v[36:39]
s_add_u32 m0, s34, 63488
s_nop 0
buffer_load_dwordx4 v247, s[8:11], s33 offen lds
v_mfma_f32_16x16x32_bf16 v[72:75], v[236:239], v[184:187], v[72:75]
v_mfma_f32_16x16x32_bf16 v[108:111], v[236:239], v[188:191], v[108:111]
s_add_u32 m0, s34, 67584
s_nop 0
buffer_load_dwordx4 v248, s[8:11], s33 offen lds
ds_read_b64_tr_b16 v[232:233], v250 offset:128
ds_read_b64_tr_b16 v[234:235], v250 offset:4736
s_waitcnt lgkmcnt(6)
v_mfma_f32_16x16x32_bf16 v[4:7], v[240:243], v[176:179], v[4:7]
v_mfma_f32_16x16x32_bf16 v[40:43], v[240:243], v[180:183], v[40:43]
s_sub_u32 s44, s40, 14336
buffer_load_dwordx2 v[160:161], v253, s[12:15], s44 offen
s_sub_u32 s44, s40, 9728
buffer_load_dwordx2 v[162:163], v253, s[12:15], s44 offen
v_mfma_f32_16x16x32_bf16 v[76:79], v[240:243], v[184:187], v[76:79]
v_mfma_f32_16x16x32_bf16 v[112:115], v[240:243], v[188:191], v[112:115]
ds_read_b64_tr_b16 v[236:237], v250 offset:160
ds_read_b64_tr_b16 v[238:239], v250 offset:4768
s_waitcnt lgkmcnt(6)
v_mfma_f32_16x16x32_bf16 v[8:11], v[224:227], v[176:179], v[8:11]
v_mfma_f32_16x16x32_bf16 v[44:47], v[224:227], v[180:183], v[44:47]
s_sub_u32 s44, s41, 14336
buffer_load_dwordx2 v[164:165], v253, s[12:15], s44 offen
s_sub_u32 s44, s41, 9728
buffer_load_dwordx2 v[166:167], v253, s[12:15], s44 offen
v_mfma_f32_16x16x32_bf16 v[80:83], v[224:227], v[184:187], v[80:83]
v_mfma_f32_16x16x32_bf16 v[116:119], v[224:227], v[188:191], v[116:119]
ds_read_b64_tr_b16 v[240:241], v250 offset:192
ds_read_b64_tr_b16 v[242:243], v250 offset:4800
s_waitcnt lgkmcnt(6)
v_mfma_f32_16x16x32_bf16 v[12:15], v[228:231], v[176:179], v[12:15]
v_mfma_f32_16x16x32_bf16 v[48:51], v[228:231], v[180:183], v[48:51]
s_sub_u32 s44, s42, 14336
buffer_load_dwordx2 v[168:169], v253, s[12:15], s44 offen
s_sub_u32 s44, s42, 9728
buffer_load_dwordx2 v[170:171], v253, s[12:15], s44 offen
v_mfma_f32_16x16x32_bf16 v[84:87], v[228:231], v[184:187], v[84:87]
v_mfma_f32_16x16x32_bf16 v[120:123], v[228:231], v[188:191], v[120:123]
ds_read_b64_tr_b16 v[224:225], v250 offset:224
ds_read_b64_tr_b16 v[226:227], v250 offset:4832
s_waitcnt lgkmcnt(6)
v_mfma_f32_16x16x32_bf16 v[16:19], v[232:235], v[176:179], v[16:19]
v_mfma_f32_16x16x32_bf16 v[52:55], v[232:235], v[180:183], v[52:55]
s_sub_u32 s44, s43, 14336
buffer_load_dwordx2 v[172:173], v253, s[12:15], s44 offen
s_sub_u32 s44, s43, 9728
buffer_load_dwordx2 v[174:175], v253, s[12:15], s44 offen
v_mfma_f32_16x16x32_bf16 v[88:91], v[232:235], v[184:187], v[88:91]
v_mfma_f32_16x16x32_bf16 v[124:127], v[232:235], v[188:191], v[124:127]
ds_read_b64_tr_b16 v[228:229], v250 offset:256
ds_read_b64_tr_b16 v[230:231], v250 offset:4864
s_waitcnt lgkmcnt(6)
v_mfma_f32_16x16x32_bf16 v[20:23], v[236:239], v[176:179], v[20:23]
v_mfma_f32_16x16x32_bf16 v[56:59], v[236:239], v[180:183], v[56:59]
v_mfma_f32_16x16x32_bf16 v[92:95], v[236:239], v[184:187], v[92:95]
v_mfma_f32_16x16x32_bf16 v[128:131], v[236:239], v[188:191], v[128:131]
s_waitcnt lgkmcnt(4)
v_mfma_f32_16x16x32_bf16 v[24:27], v[240:243], v[176:179], v[24:27]
v_mfma_f32_16x16x32_bf16 v[60:63], v[240:243], v[180:183], v[60:63]
v_mfma_f32_16x16x32_bf16 v[96:99], v[240:243], v[184:187], v[96:99]
v_mfma_f32_16x16x32_bf16 v[132:135], v[240:243], v[188:191], v[132:135]
s_waitcnt lgkmcnt(0) vmcnt(24)
s_barrier
ds_read_b64_tr_b16 v[232:233], v250 offset:18432
ds_read_b64_tr_b16 v[234:235], v250 offset:23040
ds_read_b64_tr_b16 v[236:237], v250 offset:18464
ds_read_b64_tr_b16 v[238:239], v250 offset:23072
v_mfma_f32_16x16x32_bf16 v[28:31], v[224:227], v[176:179], v[28:31]
v_mfma_f32_16x16x32_bf16 v[64:67], v[224:227], v[180:183], v[64:67]
v_mul_hi_u32 v252, v245, s45
v_and_b32 v252, 1, v252
v_mul_u32_u24 v252, 147456, v252
v_add_u32 v245, v245, v252
v_mul_hi_u32 v252, v246, s45
v_and_b32 v252, 1, v252
v_mul_u32_u24 v252, 147456, v252
v_add_u32 v246, v246, v252
v_mul_hi_u32 v252, v247, s45
v_and_b32 v252, 1, v252
v_mul_u32_u24 v252, 147456, v252
v_add_u32 v247, v247, v252
v_mul_hi_u32 v252, v248, s45
v_and_b32 v252, 1, v252
v_mul_u32_u24 v252, 147456, v252
v_add_u32 v248, v248, v252
v_mul_hi_u32 v252, v249, s45
v_and_b32 v252, 1, v252
v_mul_u32_u24 v252, 147456, v252
v_add_u32 v249, v249, v252
s_add_u32 s33, s32, 147456
s_cmp_ge_u32 s24, 2
s_cbranch_scc1 dsk_38
s_add_u32 m0, s34, 16384
s_nop 0
buffer_load_dwordx4 v249, s[8:11], s33 offen lds
dsk_38:
v_mfma_f32_16x16x32_bf16 v[100:103], v[224:227], v[184:187], v[100:103]
v_mfma_f32_16x16x32_bf16 v[136:139], v[224:227], v[188:191], v[136:139]
s_add_u32 m0, s34, 0
s_nop 0
buffer_load_dwordx4 v245, s[8:11], s33 offen lds
ds_read_b64_tr_b16 v[240:241], v250 offset:18496
ds_read_b64_tr_b16 v[242:243], v250 offset:23104
v_mfma_f32_16x16x32_bf16 v[32:35], v[228:231], v[176:179], v[32:35]
v_mfma_f32_16x16x32_bf16 v[68:71], v[228:231], v[180:183], v[68:71]
s_add_u32 m0, s34, 4096
s_nop 0
buffer_load_dwordx4 v246, s[8:11], s33 offen lds
v_mfma_f32_16x16x32_bf16 v[104:107], v[228:231], v[184:187], v[104:107]
v_mfma_f32_16x16x32_bf16 v[140:143], v[228:231], v[188:191], v[140:143]
ds_read_b64_tr_b16 v[224:225], v250 offset:18528
ds_read_b64_tr_b16 v[226:227], v250 offset:23136
s_waitcnt lgkmcnt(6)
v_mfma_f32_16x16x32_bf16 v[0:3], v[232:235], v[192:195], v[0:3]
v_mfma_f32_16x16x32_bf16 v[36:39], v[232:235], v[196:199], v[36:39]
s_add_u32 m0, s34, 8192
s_nop 0
buffer_load_dwordx4 v247, s[8:11], s33 offen lds
v_mfma_f32_16x16x32_bf16 v[72:75], v[232:235], v[200:203], v[72:75]
v_mfma_f32_16x16x32_bf16 v[108:111], v[232:235], v[204:207], v[108:111]
s_add_u32 m0, s34, 12288
s_nop 0
buffer_load_dwordx4 v248, s[8:11], s33 offen lds
ds_read_b64_tr_b16 v[228:229], v250 offset:18560
ds_read_b64_tr_b16 v[230:231], v250 offset:23168
s_waitcnt lgkmcnt(6)
v_mfma_f32_16x16x32_bf16 v[4:7], v[236:239], v[192:195], v[4:7]
v_mfma_f32_16x16x32_bf16 v[40:43], v[236:239], v[196:199], v[40:43]
s_sub_u32 s44, s40, 5120
buffer_load_dwordx2 v[176:177], v253, s[12:15], s44 offen
s_sub_u32 s44, s40, 512
buffer_load_dwordx2 v[178:179], v253, s[12:15], s44 offen
v_mfma_f32_16x16x32_bf16 v[76:79], v[236:239], v[200:203], v[76:79]
v_mfma_f32_16x16x32_bf16 v[112:115], v[236:239], v[204:207], v[112:115]
ds_read_b64_tr_b16 v[232:233], v250 offset:18592
ds_read_b64_tr_b16 v[234:235], v250 offset:23200
s_waitcnt lgkmcnt(6)
v_mfma_f32_16x16x32_bf16 v[8:11], v[240:243], v[192:195], v[8:11]
v_mfma_f32_16x16x32_bf16 v[44:47], v[240:243], v[196:199], v[44:47]
s_sub_u32 s44, s41, 5120
buffer_load_dwordx2 v[180:181], v253, s[12:15], s44 offen
s_sub_u32 s44, s41, 512
buffer_load_dwordx2 v[182:183], v253, s[12:15], s44 offen
v_mfma_f32_16x16x32_bf16 v[80:83], v[240:243], v[200:203], v[80:83]
v_mfma_f32_16x16x32_bf16 v[116:119], v[240:243], v[204:207], v[116:119]
ds_read_b64_tr_b16 v[236:237], v250 offset:18624
ds_read_b64_tr_b16 v[238:239], v250 offset:23232
s_waitcnt lgkmcnt(6)
v_mfma_f32_16x16x32_bf16 v[12:15], v[224:227], v[192:195], v[12:15]
v_mfma_f32_16x16x32_bf16 v[48:51], v[224:227], v[196:199], v[48:51]
s_sub_u32 s44, s42, 5120
buffer_load_dwordx2 v[184:185], v253, s[12:15], s44 offen
s_sub_u32 s44, s42, 512
buffer_load_dwordx2 v[186:187], v253, s[12:15], s44 offen
v_mfma_f32_16x16x32_bf16 v[84:87], v[224:227], v[200:203], v[84:87]
v_mfma_f32_16x16x32_bf16 v[120:123], v[224:227], v[204:207], v[120:123]
ds_read_b64_tr_b16 v[240:241], v250 offset:18656
ds_read_b64_tr_b16 v[242:243], v250 offset:23264
s_waitcnt lgkmcnt(6)
v_mfma_f32_16x16x32_bf16 v[16:19], v[228:231], v[192:195], v[16:19]
v_mfma_f32_16x16x32_bf16 v[52:55], v[228:231], v[196:199], v[52:55]
s_sub_u32 s44, s43, 5120
buffer_load_dwordx2 v[188:189], v253, s[12:15], s44 offen
s_sub_u32 s44, s43, 512
buffer_load_dwordx2 v[190:191], v253, s[12:15], s44 offen
v_mfma_f32_16x16x32_bf16 v[88:91], v[228:231], v[200:203], v[88:91]
v_mfma_f32_16x16x32_bf16 v[124:127], v[228:231], v[204:207], v[124:127]
ds_read_b64_tr_b16 v[224:225], v250 offset:18688
ds_read_b64_tr_b16 v[226:227], v250 offset:23296
s_waitcnt lgkmcnt(6)
v_mfma_f32_16x16x32_bf16 v[20:23], v[232:235], v[192:195], v[20:23]
v_mfma_f32_16x16x32_bf16 v[56:59], v[232:235], v[196:199], v[56:59]
v_mfma_f32_16x16x32_bf16 v[92:95], v[232:235], v[200:203], v[92:95]
v_mfma_f32_16x16x32_bf16 v[128:131], v[232:235], v[204:207], v[128:131]
s_waitcnt lgkmcnt(4)
v_mfma_f32_16x16x32_bf16 v[24:27], v[236:239], v[192:195], v[24:27]
v_mfma_f32_16x16x32_bf16 v[60:63], v[236:239], v[196:199], v[60:63]
v_mfma_f32_16x16x32_bf16 v[96:99], v[236:239], v[200:203], v[96:99]
v_mfma_f32_16x16x32_bf16 v[132:135], v[236:239], v[204:207], v[132:135]
s_waitcnt lgkmcnt(0) vmcnt(28)
s_barrier
ds_read_b64_tr_b16 v[228:229], v251 offset:0
ds_read_b64_tr_b16 v[230:231], v251 offset:4608
ds_read_b64_tr_b16 v[232:233], v251 offset:32
ds_read_b64_tr_b16 v[234:235], v251 offset:4640
v_mfma_f32_16x16x32_bf16 v[28:31], v[240:243], v[192:195], v[28:31]
v_mfma_f32_16x16x32_bf16 v[64:67], v[240:243], v[196:199], v[64:67]
s_add_u32 s33, s32, 479232
s_cmp_ge_u32 s24, 2
s_cbranch_scc1 dsk_39
s_add_u32 m0, s34, 34816
s_nop 0
buffer_load_dwordx4 v249, s[8:11], s33 offen lds
dsk_39:
v_mfma_f32_16x16x32_bf16 v[100:103], v[240:243], v[200:203], v[100:103]
v_mfma_f32_16x16x32_bf16 v[136:139], v[240:243], v[204:207], v[136:139]
s_add_u32 m0, s34, 18432
s_nop 0
buffer_load_dwordx4 v245, s[8:11], s33 offen lds
ds_read_b64_tr_b16 v[236:237], v251 offset:64
ds_read_b64_tr_b16 v[238:239], v251 offset:4672
v_mfma_f32_16x16x32_bf16 v[32:35], v[224:227], v[192:195], v[32:35]
v_mfma_f32_16x16x32_bf16 v[68:71], v[224:227], v[196:199], v[68:71]
s_add_u32 m0, s34, 22528
s_nop 0
buffer_load_dwordx4 v246, s[8:11], s33 offen lds
v_mfma_f32_16x16x32_bf16 v[104:107], v[224:227], v[200:203], v[104:107]
v_mfma_f32_16x16x32_bf16 v[140:143], v[224:227], v[204:207], v[140:143]
ds_read_b64_tr_b16 v[240:241], v251 offset:96
ds_read_b64_tr_b16 v[242:243], v251 offset:4704
s_waitcnt lgkmcnt(6)
v_mfma_f32_16x16x32_bf16 v[0:3], v[228:231], v[208:211], v[0:3]
v_mfma_f32_16x16x32_bf16 v[36:39], v[228:231], v[212:215], v[36:39]
s_add_u32 m0, s34, 26624
s_nop 0
buffer_load_dwordx4 v247, s[8:11], s33 offen lds
v_mfma_f32_16x16x32_bf16 v[72:75], v[228:231], v[216:219], v[72:75]
v_mfma_f32_16x16x32_bf16 v[108:111], v[228:231], v[220:223], v[108:111]
ds_read_b64_tr_b16 v[224:225], v251 offset:128
ds_read_b64_tr_b16 v[226:227], v251 offset:4736
s_waitcnt lgkmcnt(6)
v_mfma_f32_16x16x32_bf16 v[4:7], v[232:235], v[208:211], v[4:7]
v_mfma_f32_16x16x32_bf16 v[40:43], v[232:235], v[212:215], v[40:43]
s_add_u32 m0, s34, 30720
s_nop 0
buffer_load_dwordx4 v248, s[8:11], s33 offen lds
v_mfma_f32_16x16x32_bf16 v[76:79], v[232:235], v[216:219], v[76:79]
v_mfma_f32_16x16x32_bf16 v[112:115], v[232:235], v[220:223], v[112:115]
ds_read_b64_tr_b16 v[228:229], v251 offset:160
ds_read_b64_tr_b16 v[230:231], v251 offset:4768
s_waitcnt lgkmcnt(6)
v_mfma_f32_16x16x32_bf16 v[8:11], v[236:239], v[208:211], v[8:11]
v_mfma_f32_16x16x32_bf16 v[44:47], v[236:239], v[212:215], v[44:47]
v_mfma_f32_16x16x32_bf16 v[80:83], v[236:239], v[216:219], v[80:83]
v_mfma_f32_16x16x32_bf16 v[116:119], v[236:239], v[220:223], v[116:119]
ds_read_b64_tr_b16 v[232:233], v251 offset:192
ds_read_b64_tr_b16 v[234:235], v251 offset:4800
s_waitcnt lgkmcnt(6)
v_mfma_f32_16x16x32_bf16 v[12:15], v[240:243], v[208:211], v[12:15]
v_mfma_f32_16x16x32_bf16 v[48:51], v[240:243], v[212:215], v[48:51]
v_mfma_f32_16x16x32_bf16 v[84:87], v[240:243], v[216:219], v[84:87]
v_mfma_f32_16x16x32_bf16 v[120:123], v[240:243], v[220:223], v[120:123]
ds_read_b64_tr_b16 v[236:237], v251 offset:224
ds_read_b64_tr_b16 v[238:239], v251 offset:4832
s_waitcnt lgkmcnt(6)
v_mfma_f32_16x16x32_bf16 v[16:19], v[224:227], v[208:211], v[16:19]
v_mfma_f32_16x16x32_bf16 v[52:55], v[224:227], v[212:215], v[52:55]
v_mfma_f32_16x16x32_bf16 v[88:91], v[224:227], v[216:219], v[88:91]
v_mfma_f32_16x16x32_bf16 v[124:127], v[224:227], v[220:223], v[124:127]
ds_read_b64_tr_b16 v[240:241], v251 offset:256
ds_read_b64_tr_b16 v[242:243], v251 offset:4864
s_waitcnt lgkmcnt(6)
v_mfma_f32_16x16x32_bf16 v[20:23], v[228:231], v[208:211], v[20:23]
v_mfma_f32_16x16x32_bf16 v[56:59], v[228:231], v[212:215], v[56:59]
v_mfma_f32_16x16x32_bf16 v[92:95], v[228:231], v[216:219], v[92:95]
v_mfma_f32_16x16x32_bf16 v[128:131], v[228:231], v[220:223], v[128:131]
s_waitcnt lgkmcnt(4)
v_mfma_f32_16x16x32_bf16 v[24:27], v[232:235], v[208:211], v[24:27]
v_mfma_f32_16x16x32_bf16 v[60:63], v[232:235], v[212:215], v[60:63]
v_mfma_f32_16x16x32_bf16 v[96:99], v[232:235], v[216:219], v[96:99]
v_mfma_f32_16x16x32_bf16 v[132:135], v[232:235], v[220:223], v[132:135]
s_waitcnt lgkmcnt(0) vmcnt(24)
s_barrier
ds_read_b64_tr_b16 v[224:225], v251 offset:18432
ds_read_b64_tr_b16 v[226:227], v251 offset:23040
ds_read_b64_tr_b16 v[228:229], v251 offset:18464
ds_read_b64_tr_b16 v[230:231], v251 offset:23072
v_mfma_f32_16x16x32_bf16 v[28:31], v[236:239], v[208:211], v[28:31]
v_mfma_f32_16x16x32_bf16 v[64:67], v[236:239], v[212:215], v[64:67]
v_mfma_f32_16x16x32_bf16 v[100:103], v[236:239], v[216:219], v[100:103]
v_mfma_f32_16x16x32_bf16 v[136:139], v[236:239], v[220:223], v[136:139]
ds_read_b64_tr_b16 v[232:233], v251 offset:18496
ds_read_b64_tr_b16 v[234:235], v251 offset:23104
v_mfma_f32_16x16x32_bf16 v[32:35], v[240:243], v[208:211], v[32:35]
v_mfma_f32_16x16x32_bf16 v[68:71], v[240:243], v[212:215], v[68:71]
v_mfma_f32_16x16x32_bf16 v[104:107], v[240:243], v[216:219], v[104:107]
v_mfma_f32_16x16x32_bf16 v[140:143], v[240:243], v[220:223], v[140:143]
ds_read_b64_tr_b16 v[236:237], v251 offset:18528
ds_read_b64_tr_b16 v[238:239], v251 offset:23136
s_waitcnt lgkmcnt(6)
v_mfma_f32_16x16x32_bf16 v[0:3], v[224:227], v[144:147], v[0:3]
v_mfma_f32_16x16x32_bf16 v[36:39], v[224:227], v[148:151], v[36:39]
v_mfma_f32_16x16x32_bf16 v[72:75], v[224:227], v[152:155], v[72:75]
v_mfma_f32_16x16x32_bf16 v[108:111], v[224:227], v[156:159], v[108:111]
ds_read_b64_tr_b16 v[240:241], v251 offset:18560
ds_read_b64_tr_b16 v[242:243], v251 offset:23168
s_waitcnt lgkmcnt(6)
v_mfma_f32_16x16x32_bf16 v[4:7], v[228:231], v[144:147], v[4:7]
v_mfma_f32_16x16x32_bf16 v[40:43], v[228:231], v[148:151], v[40:43]
v_mfma_f32_16x16x32_bf16 v[76:79], v[228:231], v[152:155], v[76:79]
v_mfma_f32_16x16x32_bf16 v[112:115], v[228:231], v[156:159], v[112:115]
ds_read_b64_tr_b16 v[224:225], v251 offset:18592
ds_read_b64_tr_b16 v[226:227], v251 offset:23200
s_waitcnt lgkmcnt(6)
v_mfma_f32_16x16x32_bf16 v[8:11], v[232:235], v[144:147], v[8:11]
v_mfma_f32_16x16x32_bf16 v[44:47], v[232:235], v[148:151], v[44:47]
v_mfma_f32_16x16x32_bf16 v[80:83], v[232:235], v[152:155], v[80:83]
v_mfma_f32_16x16x32_bf16 v[116:119], v[232:235], v[156:159], v[116:119]
ds_read_b64_tr_b16 v[228:229], v251 offset:18624
ds_read_b64_tr_b16 v[230:231], v251 offset:23232
s_waitcnt lgkmcnt(6)
v_mfma_f32_16x16x32_bf16 v[12:15], v[236:239], v[144:147], v[12:15]
v_mfma_f32_16x16x32_bf16 v[48:51], v[236:239], v[148:151], v[48:51]
v_mfma_f32_16x16x32_bf16 v[84:87], v[236:239], v[152:155], v[84:87]
v_mfma_f32_16x16x32_bf16 v[120:123], v[236:239], v[156:159], v[120:123]
ds_read_b64_tr_b16 v[232:233], v251 offset:18656
ds_read_b64_tr_b16 v[234:235], v251 offset:23264
s_waitcnt lgkmcnt(6)
v_mfma_f32_16x16x32_bf16 v[16:19], v[240:243], v[144:147], v[16:19]
v_mfma_f32_16x16x32_bf16 v[52:55], v[240:243], v[148:151], v[52:55]
v_mfma_f32_16x16x32_bf16 v[88:91], v[240:243], v[152:155], v[88:91]
v_mfma_f32_16x16x32_bf16 v[124:127], v[240:243], v[156:159], v[124:127]
ds_read_b64_tr_b16 v[236:237], v251 offset:18688
ds_read_b64_tr_b16 v[238:239], v251 offset:23296
s_waitcnt lgkmcnt(6)
v_mfma_f32_16x16x32_bf16 v[20:23], v[224:227], v[144:147], v[20:23]
v_mfma_f32_16x16x32_bf16 v[56:59], v[224:227], v[148:151], v[56:59]
v_mfma_f32_16x16x32_bf16 v[92:95], v[224:227], v[152:155], v[92:95]
v_mfma_f32_16x16x32_bf16 v[128:131], v[224:227], v[156:159], v[128:131]
s_waitcnt lgkmcnt(4)
v_mfma_f32_16x16x32_bf16 v[24:27], v[228:231], v[144:147], v[24:27]
v_mfma_f32_16x16x32_bf16 v[60:63], v[228:231], v[148:151], v[60:63]
v_mfma_f32_16x16x32_bf16 v[96:99], v[228:231], v[152:155], v[96:99]
v_mfma_f32_16x16x32_bf16 v[132:135], v[228:231], v[156:159], v[132:135]
s_waitcnt lgkmcnt(0) vmcnt(12)
s_barrier
ds_read_b64_tr_b16 v[240:241], v250 offset:0
ds_read_b64_tr_b16 v[242:243], v250 offset:4608
ds_read_b64_tr_b16 v[224:225], v250 offset:32
ds_read_b64_tr_b16 v[226:227], v250 offset:4640
v_mfma_f32_16x16x32_bf16 v[28:31], v[232:235], v[144:147], v[28:31]
v_mfma_f32_16x16x32_bf16 v[64:67], v[232:235], v[148:151], v[64:67]
v_mfma_f32_16x16x32_bf16 v[100:103], v[232:235], v[152:155], v[100:103]
v_mfma_f32_16x16x32_bf16 v[136:139], v[232:235], v[156:159], v[136:139]
ds_read_b64_tr_b16 v[228:229], v250 offset:64
ds_read_b64_tr_b16 v[230:231], v250 offset:4672
v_mfma_f32_16x16x32_bf16 v[32:35], v[236:239], v[144:147], v[32:35]
v_mfma_f32_16x16x32_bf16 v[68:71], v[236:239], v[148:151], v[68:71]
v_mfma_f32_16x16x32_bf16 v[104:107], v[236:239], v[152:155], v[104:107]
v_mfma_f32_16x16x32_bf16 v[140:143], v[236:239], v[156:159], v[140:143]
ds_read_b64_tr_b16 v[232:233], v250 offset:96
ds_read_b64_tr_b16 v[234:235], v250 offset:4704
s_waitcnt lgkmcnt(6)
v_mfma_f32_16x16x32_bf16 v[0:3], v[240:243], v[160:163], v[0:3]
v_mfma_f32_16x16x32_bf16 v[36:39], v[240:243], v[164:167], v[36:39]
v_mfma_f32_16x16x32_bf16 v[72:75], v[240:243], v[168:171], v[72:75]
v_mfma_f32_16x16x32_bf16 v[108:111], v[240:243], v[172:175], v[108:111]
ds_read_b64_tr_b16 v[236:237], v250 offset:128
ds_read_b64_tr_b16 v[238:239], v250 offset:4736
s_waitcnt lgkmcnt(6)
v_mfma_f32_16x16x32_bf16 v[4:7], v[224:227], v[160:163], v[4:7]
v_mfma_f32_16x16x32_bf16 v[40:43], v[224:227], v[164:167], v[40:43]
v_mfma_f32_16x16x32_bf16 v[76:79], v[224:227], v[168:171], v[76:79]
v_mfma_f32_16x16x32_bf16 v[112:115], v[224:227], v[172:175], v[112:115]
ds_read_b64_tr_b16 v[240:241], v250 offset:160
ds_read_b64_tr_b16 v[242:243], v250 offset:4768
s_waitcnt lgkmcnt(6)
v_mfma_f32_16x16x32_bf16 v[8:11], v[228:231], v[160:163], v[8:11]
v_mfma_f32_16x16x32_bf16 v[44:47], v[228:231], v[164:167], v[44:47]
v_mfma_f32_16x16x32_bf16 v[80:83], v[228:231], v[168:171], v[80:83]
v_mfma_f32_16x16x32_bf16 v[116:119], v[228:231], v[172:175], v[116:119]
ds_read_b64_tr_b16 v[224:225], v250 offset:192
ds_read_b64_tr_b16 v[226:227], v250 offset:4800
s_waitcnt lgkmcnt(6)
v_mfma_f32_16x16x32_bf16 v[12:15], v[232:235], v[160:163], v[12:15]
v_mfma_f32_16x16x32_bf16 v[48:51], v[232:235], v[164:167], v[48:51]
v_mfma_f32_16x16x32_bf16 v[84:87], v[232:235], v[168:171], v[84:87]
v_mfma_f32_16x16x32_bf16 v[120:123], v[232:235], v[172:175], v[120:123]
ds_read_b64_tr_b16 v[228:229], v250 offset:224
ds_read_b64_tr_b16 v[230:231], v250 offset:4832
s_waitcnt lgkmcnt(6)
v_mfma_f32_16x16x32_bf16 v[16:19], v[236:239], v[160:163], v[16:19]
v_mfma_f32_16x16x32_bf16 v[52:55], v[236:239], v[164:167], v[52:55]
v_mfma_f32_16x16x32_bf16 v[88:91], v[236:239], v[168:171], v[88:91]
v_mfma_f32_16x16x32_bf16 v[124:127], v[236:239], v[172:175], v[124:127]
ds_read_b64_tr_b16 v[232:233], v250 offset:256
ds_read_b64_tr_b16 v[234:235], v250 offset:4864
s_waitcnt lgkmcnt(6)
v_mfma_f32_16x16x32_bf16 v[20:23], v[240:243], v[160:163], v[20:23]
v_mfma_f32_16x16x32_bf16 v[56:59], v[240:243], v[164:167], v[56:59]
v_mfma_f32_16x16x32_bf16 v[92:95], v[240:243], v[168:171], v[92:95]
v_mfma_f32_16x16x32_bf16 v[128:131], v[240:243], v[172:175], v[128:131]
s_waitcnt lgkmcnt(4)
v_mfma_f32_16x16x32_bf16 v[24:27], v[224:227], v[160:163], v[24:27]
v_mfma_f32_16x16x32_bf16 v[60:63], v[224:227], v[164:167], v[60:63]
v_mfma_f32_16x16x32_bf16 v[96:99], v[224:227], v[168:171], v[96:99]
v_mfma_f32_16x16x32_bf16 v[132:135], v[224:227], v[172:175], v[132:135]
s_waitcnt lgkmcnt(0) vmcnt(0)
s_barrier
ds_read_b64_tr_b16 v[236:237], v250 offset:18432
ds_read_b64_tr_b16 v[238:239], v250 offset:23040
ds_read_b64_tr_b16 v[240:241], v250 offset:18464
ds_read_b64_tr_b16 v[242:243], v250 offset:23072
v_mfma_f32_16x16x32_bf16 v[28:31], v[228:231], v[160:163], v[28:31]
v_mfma_f32_16x16x32_bf16 v[64:67], v[228:231], v[164:167], v[64:67]
v_mfma_f32_16x16x32_bf16 v[100:103], v[228:231], v[168:171], v[100:103]
v_mfma_f32_16x16x32_bf16 v[136:139], v[228:231], v[172:175], v[136:139]
ds_read_b64_tr_b16 v[224:225], v250 offset:18496
ds_read_b64_tr_b16 v[226:227], v250 offset:23104
v_mfma_f32_16x16x32_bf16 v[32:35], v[232:235], v[160:163], v[32:35]
v_mfma_f32_16x16x32_bf16 v[68:71], v[232:235], v[164:167], v[68:71]
v_mfma_f32_16x16x32_bf16 v[104:107], v[232:235], v[168:171], v[104:107]
v_mfma_f32_16x16x32_bf16 v[140:143], v[232:235], v[172:175], v[140:143]
ds_read_b64_tr_b16 v[228:229], v250 offset:18528
ds_read_b64_tr_b16 v[230:231], v250 offset:23136
s_waitcnt lgkmcnt(6)
v_mfma_f32_16x16x32_bf16 v[0:3], v[236:239], v[176:179], v[0:3]
v_mfma_f32_16x16x32_bf16 v[36:39], v[236:239], v[180:183], v[36:39]
v_mfma_f32_16x16x32_bf16 v[72:75], v[236:239], v[184:187], v[72:75]
v_mfma_f32_16x16x32_bf16 v[108:111], v[236:239], v[188:191], v[108:111]
ds_read_b64_tr_b16 v[232:233], v250 offset:18560
ds_read_b64_tr_b16 v[234:235], v250 offset:23168
s_waitcnt lgkmcnt(6)
v_mfma_f32_16x16x32_bf16 v[4:7], v[240:243], v[176:179], v[4:7]
v_mfma_f32_16x16x32_bf16 v[40:43], v[240:243], v[180:183], v[40:43]
v_mfma_f32_16x16x32_bf16 v[76:79], v[240:243], v[184:187], v[76:79]
v_mfma_f32_16x16x32_bf16 v[112:115], v[240:243], v[188:191], v[112:115]
ds_read_b64_tr_b16 v[236:237], v250 offset:18592
ds_read_b64_tr_b16 v[238:239], v250 offset:23200
s_waitcnt lgkmcnt(6)
v_mfma_f32_16x16x32_bf16 v[8:11], v[224:227], v[176:179], v[8:11]
v_mfma_f32_16x16x32_bf16 v[44:47], v[224:227], v[180:183], v[44:47]
v_mfma_f32_16x16x32_bf16 v[80:83], v[224:227], v[184:187], v[80:83]
v_mfma_f32_16x16x32_bf16 v[116:119], v[224:227], v[188:191], v[116:119]
ds_read_b64_tr_b16 v[240:241], v250 offset:18624
ds_read_b64_tr_b16 v[242:243], v250 offset:23232
s_waitcnt lgkmcnt(6)
v_mfma_f32_16x16x32_bf16 v[12:15], v[228:231], v[176:179], v[12:15]
v_mfma_f32_16x16x32_bf16 v[48:51], v[228:231], v[180:183], v[48:51]
v_mfma_f32_16x16x32_bf16 v[84:87], v[228:231], v[184:187], v[84:87]
v_mfma_f32_16x16x32_bf16 v[120:123], v[228:231], v[188:191], v[120:123]
ds_read_b64_tr_b16 v[224:225], v250 offset:18656
ds_read_b64_tr_b16 v[226:227], v250 offset:23264
s_waitcnt lgkmcnt(6)
v_mfma_f32_16x16x32_bf16 v[16:19], v[232:235], v[176:179], v[16:19]
v_mfma_f32_16x16x32_bf16 v[52:55], v[232:235], v[180:183], v[52:55]
v_mfma_f32_16x16x32_bf16 v[88:91], v[232:235], v[184:187], v[88:91]
v_mfma_f32_16x16x32_bf16 v[124:127], v[232:235], v[188:191], v[124:127]
ds_read_b64_tr_b16 v[228:229], v250 offset:18688
ds_read_b64_tr_b16 v[230:231], v250 offset:23296
s_waitcnt lgkmcnt(6)
v_mfma_f32_16x16x32_bf16 v[20:23], v[236:239], v[176:179], v[20:23]
v_mfma_f32_16x16x32_bf16 v[56:59], v[236:239], v[180:183], v[56:59]
v_mfma_f32_16x16x32_bf16 v[92:95], v[236:239], v[184:187], v[92:95]
v_mfma_f32_16x16x32_bf16 v[128:131], v[236:239], v[188:191], v[128:131]
s_waitcnt lgkmcnt(4)
v_mfma_f32_16x16x32_bf16 v[24:27], v[240:243], v[176:179], v[24:27]
v_mfma_f32_16x16x32_bf16 v[60:63], v[240:243], v[180:183], v[60:63]
v_mfma_f32_16x16x32_bf16 v[96:99], v[240:243], v[184:187], v[96:99]
v_mfma_f32_16x16x32_bf16 v[132:135], v[240:243], v[188:191], v[132:135]
s_waitcnt lgkmcnt(2)
v_mfma_f32_16x16x32_bf16 v[28:31], v[224:227], v[176:179], v[28:31]
v_mfma_f32_16x16x32_bf16 v[64:67], v[224:227], v[180:183], v[64:67]
v_mfma_f32_16x16x32_bf16 v[100:103], v[224:227], v[184:187], v[100:103]
v_mfma_f32_16x16x32_bf16 v[136:139], v[224:227], v[188:191], v[136:139]
s_waitcnt lgkmcnt(0)
v_mfma_f32_16x16x32_bf16 v[32:35], v[228:231], v[176:179], v[32:35]
v_mfma_f32_16x16x32_bf16 v[68:71], v[228:231], v[180:183], v[68:71]
v_mfma_f32_16x16x32_bf16 v[104:107], v[228:231], v[184:187], v[104:107]
v_mfma_f32_16x16x32_bf16 v[140:143], v[228:231], v[188:191], v[140:143]
s_nop 7
s_nop 3
s_setprio 0
s_barrier
s_mul_i32 s29, s24, 18432
v_add_u32 v224, s29, v244
s_xor_b32 s29, s24, 2
s_mul_i32 s29, s29, 18432
v_add_u32 v225, s29, v244
s_add_u32 s37, s30, s48
s_mul_i32 s37, s37, 36
s_mul_i32 s38, s28, 9
s_add_u32 s37, s37, s38
s_lshl_b32 s37, s37, 2
s_add_u32 s37, s37, s46
s_lshl_b32 s37, s37, 10
s_add_u32 s37, s37, 67108864
s_cmp_eq_u32 s48, 1
s_cbranch_scc1 G2K_hi
ds_write_b128 v224, v[72:75] offset:0
ds_write_b128 v224, v[76:79] offset:1024
ds_write_b128 v224, v[80:83] offset:2048
ds_write_b128 v224, v[84:87] offset:3072
ds_write_b128 v224, v[88:91] offset:4096
ds_write_b128 v224, v[92:95] offset:5120
ds_write_b128 v224, v[96:99] offset:6144
ds_write_b128 v224, v[100:103] offset:7168
ds_write_b128 v224, v[104:107] offset:8192
ds_write_b128 v224, v[108:111] offset:9216
ds_write_b128 v224, v[112:115] offset:10240
ds_write_b128 v224, v[116:119] offset:11264
ds_write_b128 v224, v[120:123] offset:12288
ds_write_b128 v224, v[124:127] offset:13312
ds_write_b128 v224, v[128:131] offset:14336
ds_write_b128 v224, v[132:135] offset:15360
ds_write_b128 v224, v[136:139] offset:16384
ds_write_b128 v224, v[140:143] offset:17408
s_waitcnt lgkmcnt(0)
s_barrier
ds_read_b128 v[72:75], v225 offset:0
ds_read_b128 v[76:79], v225 offset:1024
ds_read_b128 v[80:83], v225 offset:2048
ds_read_b128 v[84:87], v225 offset:3072
ds_read_b128 v[88:91], v225 offset:4096
ds_read_b128 v[92:95], v225 offset:5120
ds_read_b128 v[96:99], v225 offset:6144
ds_read_b128 v[100:103], v225 offset:7168
ds_read_b128 v[104:107], v225 offset:8192
ds_read_b128 v[108:111], v225 offset:9216
ds_read_b128 v[112:115], v225 offset:10240
ds_read_b128 v[116:119], v225 offset:11264
ds_read_b128 v[120:123], v225 offset:12288
ds_read_b128 v[124:127], v225 offset:13312
ds_read_b128 v[128:131], v225 offset:14336
ds_read_b128 v[132:135], v225 offset:15360
ds_read_b128 v[136:139], v225 offset:16384
ds_read_b128 v[140:143], v225 offset:17408
s_waitcnt lgkmcnt(0)
v_add_f32 v0, v0, v72
v_add_f32 v1, v1, v73
v_add_f32 v2, v2, v74
v_add_f32 v3, v3, v75
v_cvt_pk_bf16_f32 v144, v0, v1
v_cvt_pk_bf16_f32 v145, v2, v3
v_add_f32 v36, v36, v108
v_add_f32 v37, v37, v109
v_add_f32 v38, v38, v110
v_add_f32 v39, v39, v111
v_cvt_pk_bf16_f32 v146, v36, v37
v_cvt_pk_bf16_f32 v147, v38, v39
s_add_u32 s38, s37, 0
buffer_store_dwordx4 v[144:147], v244, s[12:15], s38 offen sc1
v_add_f32 v4, v4, v76
v_add_f32 v5, v5, v77
v_add_f32 v6, v6, v78
v_add_f32 v7, v7, v79
v_cvt_pk_bf16_f32 v148, v4, v5
v_cvt_pk_bf16_f32 v149, v6, v7
v_add_f32 v40, v40, v112
v_add_f32 v41, v41, v113
v_add_f32 v42, v42, v114
v_add_f32 v43, v43, v115
v_cvt_pk_bf16_f32 v150, v40, v41
v_cvt_pk_bf16_f32 v151, v42, v43
s_add_u32 s38, s37, 4096
buffer_store_dwordx4 v[148:151], v244, s[12:15], s38 offen sc1
v_add_f32 v8, v8, v80
v_add_f32 v9, v9, v81
v_add_f32 v10, v10, v82
v_add_f32 v11, v11, v83
v_cvt_pk_bf16_f32 v152, v8, v9
v_cvt_pk_bf16_f32 v153, v10, v11
v_add_f32 v44, v44, v116
v_add_f32 v45, v45, v117
v_add_f32 v46, v46, v118
v_add_f32 v47, v47, v119
v_cvt_pk_bf16_f32 v154, v44, v45
v_cvt_pk_bf16_f32 v155, v46, v47
s_add_u32 s38, s37, 8192
buffer_store_dwordx4 v[152:155], v244, s[12:15], s38 offen sc1
v_add_f32 v12, v12, v84
v_add_f32 v13, v13, v85
v_add_f32 v14, v14, v86
v_add_f32 v15, v15, v87
v_cvt_pk_bf16_f32 v156, v12, v13
v_cvt_pk_bf16_f32 v157, v14, v15
v_add_f32 v48, v48, v120
v_add_f32 v49, v49, v121
v_add_f32 v50, v50, v122
v_add_f32 v51, v51, v123
v_cvt_pk_bf16_f32 v158, v48, v49
v_cvt_pk_bf16_f32 v159, v50, v51
s_add_u32 s38, s37, 12288
buffer_store_dwordx4 v[156:159], v244, s[12:15], s38 offen sc1
v_add_f32 v16, v16, v88
v_add_f32 v17, v17, v89
v_add_f32 v18, v18, v90
v_add_f32 v19, v19, v91
v_cvt_pk_bf16_f32 v160, v16, v17
v_cvt_pk_bf16_f32 v161, v18, v19
v_add_f32 v52, v52, v124
v_add_f32 v53, v53, v125
v_add_f32 v54, v54, v126
v_add_f32 v55, v55, v127
v_cvt_pk_bf16_f32 v162, v52, v53
v_cvt_pk_bf16_f32 v163, v54, v55
s_add_u32 s38, s37, 16384
buffer_store_dwordx4 v[160:163], v244, s[12:15], s38 offen sc1
v_add_f32 v20, v20, v92
v_add_f32 v21, v21, v93
v_add_f32 v22, v22, v94
v_add_f32 v23, v23, v95
v_cvt_pk_bf16_f32 v164, v20, v21
v_cvt_pk_bf16_f32 v165, v22, v23
v_add_f32 v56, v56, v128
v_add_f32 v57, v57, v129
v_add_f32 v58, v58, v130
v_add_f32 v59, v59, v131
v_cvt_pk_bf16_f32 v166, v56, v57
v_cvt_pk_bf16_f32 v167, v58, v59
s_add_u32 s38, s37, 20480
buffer_store_dwordx4 v[164:167], v244, s[12:15], s38 offen sc1
v_add_f32 v24, v24, v96
v_add_f32 v25, v25, v97
v_add_f32 v26, v26, v98
v_add_f32 v27, v27, v99
v_cvt_pk_bf16_f32 v168, v24, v25
v_cvt_pk_bf16_f32 v169, v26, v27
v_add_f32 v60, v60, v132
v_add_f32 v61, v61, v133
v_add_f32 v62, v62, v134
v_add_f32 v63, v63, v135
v_cvt_pk_bf16_f32 v170, v60, v61
v_cvt_pk_bf16_f32 v171, v62, v63
s_add_u32 s38, s37, 24576
buffer_store_dwordx4 v[168:171], v244, s[12:15], s38 offen sc1
v_add_f32 v28, v28, v100
v_add_f32 v29, v29, v101
v_add_f32 v30, v30, v102
v_add_f32 v31, v31, v103
v_cvt_pk_bf16_f32 v172, v28, v29
v_cvt_pk_bf16_f32 v173, v30, v31
v_add_f32 v64, v64, v136
v_add_f32 v65, v65, v137
v_add_f32 v66, v66, v138
v_add_f32 v67, v67, v139
v_cvt_pk_bf16_f32 v174, v64, v65
v_cvt_pk_bf16_f32 v175, v66, v67
s_add_u32 s38, s37, 28672
buffer_store_dwordx4 v[172:175], v244, s[12:15], s38 offen sc1
v_add_f32 v32, v32, v104
v_add_f32 v33, v33, v105
v_add_f32 v34, v34, v106
v_add_f32 v35, v35, v107
v_cvt_pk_bf16_f32 v144, v32, v33
v_cvt_pk_bf16_f32 v145, v34, v35
v_add_f32 v68, v68, v140
v_add_f32 v69, v69, v141
v_add_f32 v70, v70, v142
v_add_f32 v71, v71, v143
v_cvt_pk_bf16_f32 v146, v68, v69
v_cvt_pk_bf16_f32 v147, v70, v71
s_add_u32 s38, s37, 32768
buffer_store_dwordx4 v[144:147], v244, s[12:15], s38 offen sc1
s_branch G2K_done
G2K_hi:
ds_write_b128 v224, v[0:3] offset:0
ds_write_b128 v224, v[4:7] offset:1024
ds_write_b128 v224, v[8:11] offset:2048
ds_write_b128 v224, v[12:15] offset:3072
ds_write_b128 v224, v[16:19] offset:4096
ds_write_b128 v224, v[20:23] offset:5120
ds_write_b128 v224, v[24:27] offset:6144
ds_write_b128 v224, v[28:31] offset:7168
ds_write_b128 v224, v[32:35] offset:8192
ds_write_b128 v224, v[36:39] offset:9216
ds_write_b128 v224, v[40:43] offset:10240
ds_write_b128 v224, v[44:47] offset:11264
ds_write_b128 v224, v[48:51] offset:12288
ds_write_b128 v224, v[52:55] offset:13312
ds_write_b128 v224, v[56:59] offset:14336
ds_write_b128 v224, v[60:63] offset:15360
ds_write_b128 v224, v[64:67] offset:16384
ds_write_b128 v224, v[68:71] offset:17408
s_waitcnt lgkmcnt(0)
s_barrier
ds_read_b128 v[0:3], v225 offset:0
ds_read_b128 v[4:7], v225 offset:1024
ds_read_b128 v[8:11], v225 offset:2048
ds_read_b128 v[12:15], v225 offset:3072
ds_read_b128 v[16:19], v225 offset:4096
ds_read_b128 v[20:23], v225 offset:5120
ds_read_b128 v[24:27], v225 offset:6144
ds_read_b128 v[28:31], v225 offset:7168
ds_read_b128 v[32:35], v225 offset:8192
ds_read_b128 v[36:39], v225 offset:9216
ds_read_b128 v[40:43], v225 offset:10240
ds_read_b128 v[44:47], v225 offset:11264
ds_read_b128 v[48:51], v225 offset:12288
ds_read_b128 v[52:55], v225 offset:13312
ds_read_b128 v[56:59], v225 offset:14336
ds_read_b128 v[60:63], v225 offset:15360
ds_read_b128 v[64:67], v225 offset:16384
ds_read_b128 v[68:71], v225 offset:17408
s_waitcnt lgkmcnt(0)
v_add_f32 v72, v72, v0
v_add_f32 v73, v73, v1
v_add_f32 v74, v74, v2
v_add_f32 v75, v75, v3
v_cvt_pk_bf16_f32 v144, v72, v73
v_cvt_pk_bf16_f32 v145, v74, v75
v_add_f32 v108, v108, v36
v_add_f32 v109, v109, v37
v_add_f32 v110, v110, v38
v_add_f32 v111, v111, v39
v_cvt_pk_bf16_f32 v146, v108, v109
v_cvt_pk_bf16_f32 v147, v110, v111
s_add_u32 s38, s37, 0
buffer_store_dwordx4 v[144:147], v244, s[12:15], s38 offen sc1
v_add_f32 v76, v76, v4
v_add_f32 v77, v77, v5
v_add_f32 v78, v78, v6
v_add_f32 v79, v79, v7
v_cvt_pk_bf16_f32 v148, v76, v77
v_cvt_pk_bf16_f32 v149, v78, v79
v_add_f32 v112, v112, v40
v_add_f32 v113, v113, v41
v_add_f32 v114, v114, v42
v_add_f32 v115, v115, v43
v_cvt_pk_bf16_f32 v150, v112, v113
v_cvt_pk_bf16_f32 v151, v114, v115
s_add_u32 s38, s37, 4096
buffer_store_dwordx4 v[148:151], v244, s[12:15], s38 offen sc1
v_add_f32 v80, v80, v8
v_add_f32 v81, v81, v9
v_add_f32 v82, v82, v10
v_add_f32 v83, v83, v11
v_cvt_pk_bf16_f32 v152, v80, v81
v_cvt_pk_bf16_f32 v153, v82, v83
v_add_f32 v116, v116, v44
v_add_f32 v117, v117, v45
v_add_f32 v118, v118, v46
v_add_f32 v119, v119, v47
v_cvt_pk_bf16_f32 v154, v116, v117
v_cvt_pk_bf16_f32 v155, v118, v119
s_add_u32 s38, s37, 8192
buffer_store_dwordx4 v[152:155], v244, s[12:15], s38 offen sc1
v_add_f32 v84, v84, v12
v_add_f32 v85, v85, v13
v_add_f32 v86, v86, v14
v_add_f32 v87, v87, v15
v_cvt_pk_bf16_f32 v156, v84, v85
v_cvt_pk_bf16_f32 v157, v86, v87
v_add_f32 v120, v120, v48
v_add_f32 v121, v121, v49
v_add_f32 v122, v122, v50
v_add_f32 v123, v123, v51
v_cvt_pk_bf16_f32 v158, v120, v121
v_cvt_pk_bf16_f32 v159, v122, v123
s_add_u32 s38, s37, 12288
buffer_store_dwordx4 v[156:159], v244, s[12:15], s38 offen sc1
v_add_f32 v88, v88, v16
v_add_f32 v89, v89, v17
v_add_f32 v90, v90, v18
v_add_f32 v91, v91, v19
v_cvt_pk_bf16_f32 v160, v88, v89
v_cvt_pk_bf16_f32 v161, v90, v91
v_add_f32 v124, v124, v52
v_add_f32 v125, v125, v53
v_add_f32 v126, v126, v54
v_add_f32 v127, v127, v55
v_cvt_pk_bf16_f32 v162, v124, v125
v_cvt_pk_bf16_f32 v163, v126, v127
s_add_u32 s38, s37, 16384
buffer_store_dwordx4 v[160:163], v244, s[12:15], s38 offen sc1
v_add_f32 v92, v92, v20
v_add_f32 v93, v93, v21
v_add_f32 v94, v94, v22
v_add_f32 v95, v95, v23
v_cvt_pk_bf16_f32 v164, v92, v93
v_cvt_pk_bf16_f32 v165, v94, v95
v_add_f32 v128, v128, v56
v_add_f32 v129, v129, v57
v_add_f32 v130, v130, v58
v_add_f32 v131, v131, v59
v_cvt_pk_bf16_f32 v166, v128, v129
v_cvt_pk_bf16_f32 v167, v130, v131
s_add_u32 s38, s37, 20480
buffer_store_dwordx4 v[164:167], v244, s[12:15], s38 offen sc1
v_add_f32 v96, v96, v24
v_add_f32 v97, v97, v25
v_add_f32 v98, v98, v26
v_add_f32 v99, v99, v27
v_cvt_pk_bf16_f32 v168, v96, v97
v_cvt_pk_bf16_f32 v169, v98, v99
v_add_f32 v132, v132, v60
v_add_f32 v133, v133, v61
v_add_f32 v134, v134, v62
v_add_f32 v135, v135, v63
v_cvt_pk_bf16_f32 v170, v132, v133
v_cvt_pk_bf16_f32 v171, v134, v135
s_add_u32 s38, s37, 24576
buffer_store_dwordx4 v[168:171], v244, s[12:15], s38 offen sc1
v_add_f32 v100, v100, v28
v_add_f32 v101, v101, v29
v_add_f32 v102, v102, v30
v_add_f32 v103, v103, v31
v_cvt_pk_bf16_f32 v172, v100, v101
v_cvt_pk_bf16_f32 v173, v102, v103
v_add_f32 v136, v136, v64
v_add_f32 v137, v137, v65
v_add_f32 v138, v138, v66
v_add_f32 v139, v139, v67
v_cvt_pk_bf16_f32 v174, v136, v137
v_cvt_pk_bf16_f32 v175, v138, v139
s_add_u32 s38, s37, 28672
buffer_store_dwordx4 v[172:175], v244, s[12:15], s38 offen sc1
v_add_f32 v104, v104, v32
v_add_f32 v105, v105, v33
v_add_f32 v106, v106, v34
v_add_f32 v107, v107, v35
v_cvt_pk_bf16_f32 v144, v104, v105
v_cvt_pk_bf16_f32 v145, v106, v107
v_add_f32 v140, v140, v68
v_add_f32 v141, v141, v69
v_add_f32 v142, v142, v70
v_add_f32 v143, v143, v71
v_cvt_pk_bf16_f32 v146, v140, v141
v_cvt_pk_bf16_f32 v147, v142, v143
s_add_u32 s38, s37, 32768
buffer_store_dwordx4 v[144:147], v244, s[12:15], s38 offen sc1
G2K_done:
s_endpgm
K2_b:
s_cmp_ge_u32 s2, 264
s_cbranch_scc1 K2_cf
s_getpc_b64 s[4:5]
s_add_u32 s4, s4, k2_kernel@rel32@lo+4
s_addc_u32 s5, s5, k2_kernel@rel32@hi+12
v_lshlrev_b32 v2, 6, v0
global_load_dword v1, v2, s[4:5]
v_add_u32 v2, 16384, v2
global_load_dword v1, v2, s[4:5]
s_endpgm
K2_cf:
s_sub_u32 s3, s2, 264
s_cmp_ge_u32 s3, 146
s_cbranch_scc1 K2_end
s_load_dwordx2 s[6:7], s[0:1], 80
v_lshrrev_b32 v1, 6, v0
v_and_b32 v2, 63, v0
v_readfirstlane_b32 s24, v1
s_and_b32 s25, s3, 1
s_lshr_b32 s26, s3, 1
s_and_b32 s26, s26, 1
s_lshr_b32 s27, s3, 2
s_getpc_b64 s[4:5]
s_add_u32 s4, s4, tab_cf@rel32@lo+4
s_addc_u32 s5, s5, tab_cf@rel32@hi+12
s_mov_b32 s8, s4
s_and_b32 s9, s5, 0xffff
s_mov_b32 s10, 73728
s_mov_b32 s11, 0x00020000
v_lshlrev_b32 v3, 4, v2
v_lshlrev_b32 v4, 2, v2
s_lshl_b32 s28, s27, 2
s_add_u32 s28, s28, s24
s_lshl_b32 s29, s28, 1
s_add_u32 s29, s29, s26
s_mul_i32 s30, s26, 288
s_lshl_b32 s31, s28, 1
s_add_u32 s30, s30, s31
s_cmp_eq_u32 s27, 36
s_cselect_b32 s30, 1, s30
s_and_b32 s43, s30, 7
s_and_b32 s31, s30, 8
s_lshl_b32 s31, s31, 4
s_lshr_b32 s30, s30, 4
s_lshl_b32 s30, s30, 11
s_add_u32 s30, s30, s31
s_lshl_b32 s31, s25, 10
s_add_u32 s30, s30, s31
s_add_u32 s30, s30, 12582912
v_lshrrev_b32 v11, 3, v2
v_and_b32 v12, 7, v2
v_xor_b32 v12, v12, v11
v_mul_u32_u24 v11, 73728, v11
v_lshl_add_u32 v11, v12, 4, v11
v_and_b32 v12, 7, v2
v_xor_b32 v13, s43, v12
v_lshlrev_b32 v13, 4, v13
v_lshl_add_u32 v13, v2, 7, v13
v_xor_b32 v14, 16, v13
s_cmp_eq_u32 s29, 0
s_cselect_b32 s33, 1, 0
s_cmp_eq_u32 s29, 288
s_cselect_b32 s33, 1, s33
s_mul_i32 s34, s25, 36864
s_mul_i32 s40, s24, 9216
s_add_u32 s34, s34, s40
s_waitcnt lgkmcnt(0)
s_mov_b32 s12, s6
s_and_b32 s13, s7, 0xffff
s_mov_b32 s14, 268435456
s_mov_b32 s15, 0x00020000
s_lshl_b32 s44, s24, 8
s_add_u32 s44, s44, s30
s_lshl_b32 s45, s24, 12
s_add_u32 m0, s45, 36864
s_add_u32 s42, s44, 0
buffer_load_dwordx4 v11, s[12:15], s42 offen lds
s_add_u32 m0, s45, 37888
s_add_u32 s42, s44, 589824
buffer_load_dwordx4 v11, s[12:15], s42 offen lds
s_add_u32 m0, s45, 38912
s_add_u32 s42, s44, 1179648
buffer_load_dwordx4 v11, s[12:15], s42 offen lds
s_add_u32 m0, s45, 39936
s_add_u32 s42, s44, 1769472
buffer_load_dwordx4 v11, s[12:15], s42 offen lds
s_add_u32 m0, s40, 0
s_add_u32 s42, s34, 0
buffer_load_dwordx4 v3, s[8:11], s42 offen offset:0 lds
buffer_load_dwordx4 v3, s[8:11], s42 offen offset:1024 lds
buffer_load_dwordx4 v3, s[8:11], s42 offen offset:2048 lds
buffer_load_dwordx4 v3, s[8:11], s42 offen offset:3072 lds
s_add_u32 m0, s40, 4096
s_add_u32 s42, s34, 4096
buffer_load_dwordx4 v3, s[8:11], s42 offen offset:0 lds
buffer_load_dwordx4 v3, s[8:11], s42 offen offset:1024 lds
buffer_load_dwordx4 v3, s[8:11], s42 offen offset:2048 lds
buffer_load_dwordx4 v3, s[8:11], s42 offen offset:3072 lds
s_add_u32 m0, s40, 8192
s_add_u32 s42, s34, 8192
buffer_load_dwordx4 v3, s[8:11], s42 offen offset:0 lds
s_mov_b32 s46, 25231360
buffer_load_dwordx4 v[176:179], v3, s[12:15], s46 offen
s_min_u32 s38, s29, 288
s_lshl_b32 s38, s38, 13
s_lshl_b32 s39, s25, 12
s_add_u32 s38, s38, s39
s_add_u32 s38, s38, 8388608
buffer_load_dword v160, v4, s[12:15], s38 offen offset:0
buffer_load_dword v161, v4, s[12:15], s38 offen offset:256
buffer_load_dword v162, v4, s[12:15], s38 offen offset:512
buffer_load_dword v163, v4, s[12:15], s38 offen offset:768
buffer_load_dword v164, v4, s[12:15], s38 offen offset:1024
buffer_load_dword v165, v4, s[12:15], s38 offen offset:1280
buffer_load_dword v166, v4, s[12:15], s38 offen offset:1536
buffer_load_dword v167, v4, s[12:15], s38 offen offset:1792
buffer_load_dword v168, v4, s[12:15], s38 offen offset:2048
buffer_load_dword v169, v4, s[12:15], s38 offen offset:2304
buffer_load_dword v170, v4, s[12:15], s38 offen offset:2560
buffer_load_dword v171, v4, s[12:15], s38 offen offset:2816
buffer_load_dword v172, v4, s[12:15], s38 offen offset:3072
buffer_load_dword v173, v4, s[12:15], s38 offen offset:3328
buffer_load_dword v174, v4, s[12:15], s38 offen offset:3584
buffer_load_dword v175, v4, s[12:15], s38 offen offset:3840
s_waitcnt vmcnt(16)
s_barrier
s_cmp_lg_u32 s27, 36
s_cbranch_scc1 CF_go
s_cmp_eq_u32 s24, 0
s_cbranch_scc1 CF_go
s_endpgm
CF_go:
ds_read_b128 v[16:19], v13 offset:36864
ds_read_b128 v[20:23], v13 offset:45056
ds_read_b128 v[24:27], v14 offset:36864
ds_read_b128 v[28:31], v14 offset:45056
ds_read_b128 v[104:107], v3 offset:6144
ds_read_b128 v[108:111], v3 offset:7168
ds_read_b128 v[112:115], v3 offset:8192
ds_read_b128 v[116:119], v3 offset:9216
ds_read_b128 v[120:123], v3 offset:10240
ds_read_b128 v[124:127], v3 offset:11264
v_max_u32 v176, v176, v177
v_max_u32 v178, v178, v179
v_max_u32 v176, v176, v178
s_nop 1
v_max_u32_dpp v176, v176, v176 row_ror:8 row_mask:0xf bank_mask:0xf
s_nop 1
v_max_u32_dpp v176, v176, v176 row_ror:4 row_mask:0xf bank_mask:0xf
s_nop 1
v_max_u32_dpp v176, v176, v176 row_ror:2 row_mask:0xf bank_mask:0xf
s_nop 1
v_max_u32_dpp v176, v176, v176 row_ror:1 row_mask:0xf bank_mask:0xf
v_mov_b32 v177, v176
s_nop 1
v_permlane16_swap_b32 v176, v177
s_nop 1
v_max_u32 v176, v176, v177
v_mov_b32 v177, v176
s_nop 1
v_permlane32_swap_b32 v176, v177
s_nop 1
v_max_u32 v176, v176, v177
s_nop 0
v_readfirstlane_b32 s46, v176
s_nop 3
s_lshr_b32 s46, s46, 7
s_max_u32 s46, s46, 20
s_min_u32 s46, s46, 240
s_sub_u32 s32, 247, s46
s_sub_u32 s32, s32, s33
s_lshl_b32 s32, s32, 23
s_waitcnt lgkmcnt(0)
s_cmp_eq_u32 s33, 0
s_cbranch_scc1 CF_hasim
v_mov_b32 v24, 0
v_mov_b32 v25, 0
v_mov_b32 v26, 0
v_mov_b32 v27, 0
v_mov_b32 v28, 0
v_mov_b32 v29, 0
v_mov_b32 v30, 0
v_mov_b32 v31, 0
s_nop 1
CF_hasim:
ds_read_b128 v[128:131], v3 offset:18432
ds_read_b128 v[132:135], v3 offset:19456
ds_read_b128 v[136:139], v3 offset:20480
ds_read_b128 v[140:143], v3 offset:21504
ds_read_b128 v[144:147], v3 offset:22528
ds_read_b128 v[148:151], v3 offset:23552
ds_read_b128 v[152:155], v3 offset:24576
ds_read_b128 v[156:159], v3 offset:25600
ds_read_b128 v[80:83], v3 offset:0
ds_read_b128 v[84:87], v3 offset:1024
ds_read_b128 v[88:91], v3 offset:2048
ds_read_b128 v[92:95], v3 offset:3072
ds_read_b128 v[96:99], v3 offset:4096
ds_read_b128 v[100:103], v3 offset:5120
v_mfma_f32_32x32x16_f16 v[48:63], v[16:19], v[104:107], 0
v_mfma_f32_32x32x16_f16 v[64:79], v[24:27], v[104:107], 0
v_mfma_f32_32x32x16_f16 v[48:63], v[20:23], v[108:111], v[48:63]
v_mfma_f32_32x32x16_f16 v[64:79], v[28:31], v[108:111], v[64:79]
v_mfma_f32_32x32x16_f16 v[48:63], v[24:27], v[112:115], v[48:63]
v_mfma_f32_32x32x16_f16 v[64:79], v[16:19], v[120:123], v[64:79]
v_mfma_f32_32x32x16_f16 v[48:63], v[28:31], v[116:119], v[48:63]
v_mfma_f32_32x32x16_f16 v[64:79], v[20:23], v[124:127], v[64:79]
s_nop 15
s_nop 3
s_waitcnt lgkmcnt(0)
ds_read_b128 v[104:107], v3 offset:12288
ds_read_b128 v[108:111], v3 offset:13312
ds_read_b128 v[112:115], v3 offset:14336
ds_read_b128 v[116:119], v3 offset:15360
ds_read_b128 v[120:123], v3 offset:16384
ds_read_b128 v[124:127], v3 offset:17408
v_mul_f32 v176, v48, v128
v_mul_f32 v177, v64, v128
v_fma_f32 v176, v64, v144, v176
v_fma_f32 v177, -v48, v144, v177
v_mul_f32 v178, v49, v129
v_mul_f32 v179, v65, v129
v_fma_f32 v178, v65, v145, v178
v_fma_f32 v179, -v49, v145, v179
v_cvt_pk_f16_f32 v16, v176, v178
v_cvt_pk_f16_f32 v24, v177, v179
v_mul_f32 v180, v50, v130
v_mul_f32 v181, v66, v130
v_fma_f32 v180, v66, v146, v180
v_fma_f32 v181, -v50, v146, v181
v_mul_f32 v182, v51, v131
v_mul_f32 v183, v67, v131
v_fma_f32 v182, v67, v147, v182
v_fma_f32 v183, -v51, v147, v183
v_cvt_pk_f16_f32 v17, v180, v182
v_cvt_pk_f16_f32 v25, v181, v183
v_mul_f32 v176, v52, v132
v_mul_f32 v177, v68, v132
v_fma_f32 v176, v68, v148, v176
v_fma_f32 v177, -v52, v148, v177
v_mul_f32 v178, v53, v133
v_mul_f32 v179, v69, v133
v_fma_f32 v178, v69, v149, v178
v_fma_f32 v179, -v53, v149, v179
v_cvt_pk_f16_f32 v18, v176, v178
v_cvt_pk_f16_f32 v26, v177, v179
v_mul_f32 v180, v54, v134
v_mul_f32 v181, v70, v134
v_fma_f32 v180, v70, v150, v180
v_fma_f32 v181, -v54, v150, v181
v_mul_f32 v182, v55, v135
v_mul_f32 v183, v71, v135
v_fma_f32 v182, v71, v151, v182
v_fma_f32 v183, -v55, v151, v183
v_cvt_pk_f16_f32 v19, v180, v182
v_cvt_pk_f16_f32 v27, v181, v183
v_mul_f32 v176, v56, v136
v_mul_f32 v177, v72, v136
v_fma_f32 v176, v72, v152, v176
v_fma_f32 v177, -v56, v152, v177
v_mul_f32 v178, v57, v137
v_mul_f32 v179, v73, v137
v_fma_f32 v178, v73, v153, v178
v_fma_f32 v179, -v57, v153, v179
v_cvt_pk_f16_f32 v20, v176, v178
v_cvt_pk_f16_f32 v28, v177, v179
v_mul_f32 v180, v58, v138
v_mul_f32 v181, v74, v138
v_fma_f32 v180, v74, v154, v180
v_fma_f32 v181, -v58, v154, v181
v_mul_f32 v182, v59, v139
v_mul_f32 v183, v75, v139
v_fma_f32 v182, v75, v155, v182
v_fma_f32 v183, -v59, v155, v183
v_cvt_pk_f16_f32 v21, v180, v182
v_cvt_pk_f16_f32 v29, v181, v183
v_mul_f32 v176, v60, v140
v_mul_f32 v177, v76, v140
v_fma_f32 v176, v76, v156, v176
v_fma_f32 v177, -v60, v156, v177
v_mul_f32 v178, v61, v141
v_mul_f32 v179, v77, v141
v_fma_f32 v178, v77, v157, v178
v_fma_f32 v179, -v61, v157, v179
v_cvt_pk_f16_f32 v22, v176, v178
v_cvt_pk_f16_f32 v30, v177, v179
v_mul_f32 v180, v62, v142
v_mul_f32 v181, v78, v142
v_fma_f32 v180, v78, v158, v180
v_fma_f32 v181, -v62, v158, v181
v_mul_f32 v182, v63, v143
v_mul_f32 v183, v79, v143
v_fma_f32 v182, v79, v159, v182
v_fma_f32 v183, -v63, v159, v183
v_cvt_pk_f16_f32 v23, v180, v182
v_cvt_pk_f16_f32 v31, v181, v183
s_nop 1
ds_read_b128 v[128:131], v3 offset:26624
ds_read_b128 v[132:135], v3 offset:27648
ds_read_b128 v[136:139], v3 offset:28672
ds_read_b128 v[140:143], v3 offset:29696
ds_read_b128 v[144:147], v3 offset:30720
ds_read_b128 v[148:151], v3 offset:31744
ds_read_b128 v[152:155], v3 offset:32768
ds_read_b128 v[156:159], v3 offset:33792
v_mfma_f32_32x32x16_f16 v[48:63], v[80:83], v[16:19], 0
v_mfma_f32_32x32x16_f16 v[64:79], v[80:83], v[24:27], 0
v_mfma_f32_32x32x16_f16 v[48:63], v[84:87], v[20:23], v[48:63]
v_mfma_f32_32x32x16_f16 v[64:79], v[84:87], v[28:31], v[64:79]
v_mfma_f32_32x32x16_f16 v[48:63], v[88:91], v[24:27], v[48:63]
v_mfma_f32_32x32x16_f16 v[64:79], v[96:99], v[16:19], v[64:79]
v_mfma_f32_32x32x16_f16 v[48:63], v[92:95], v[28:31], v[48:63]
v_mfma_f32_32x32x16_f16 v[64:79], v[100:103], v[20:23], v[64:79]
s_nop 15
s_nop 3
s_waitcnt vmcnt(0)
v_lshlrev_b32 v176, 16, v160
v_and_b32 v177, 0xffff0000, v160
v_mul_f32 v176, s32, v176
v_mul_f32 v177, s32, v177
v_mul_f32 v178, v48, v176
v_mul_f32 v179, v48, v177
v_fma_f32 v178, -v64, v177, v178
v_fma_f32 v179, v64, v176, v179
v_lshlrev_b32 v180, 16, v161
v_and_b32 v181, 0xffff0000, v161
v_mul_f32 v180, s32, v180
v_mul_f32 v181, s32, v181
v_mul_f32 v182, v49, v180
v_mul_f32 v183, v49, v181
v_fma_f32 v182, -v65, v181, v182
v_fma_f32 v183, v65, v180, v183
v_cvt_pk_f16_f32 v16, v178, v182
v_cvt_pk_f16_f32 v24, v179, v183
v_lshlrev_b32 v176, 16, v162
v_and_b32 v177, 0xffff0000, v162
v_mul_f32 v176, s32, v176
v_mul_f32 v177, s32, v177
v_mul_f32 v178, v50, v176
v_mul_f32 v179, v50, v177
v_fma_f32 v178, -v66, v177, v178
v_fma_f32 v179, v66, v176, v179
v_lshlrev_b32 v180, 16, v163
v_and_b32 v181, 0xffff0000, v163
v_mul_f32 v180, s32, v180
v_mul_f32 v181, s32, v181
v_mul_f32 v182, v51, v180
v_mul_f32 v183, v51, v181
v_fma_f32 v182, -v67, v181, v182
v_fma_f32 v183, v67, v180, v183
v_cvt_pk_f16_f32 v17, v178, v182
v_cvt_pk_f16_f32 v25, v179, v183
v_lshlrev_b32 v176, 16, v164
v_and_b32 v177, 0xffff0000, v164
v_mul_f32 v176, s32, v176
v_mul_f32 v177, s32, v177
v_mul_f32 v178, v52, v176
v_mul_f32 v179, v52, v177
v_fma_f32 v178, -v68, v177, v178
v_fma_f32 v179, v68, v176, v179
v_lshlrev_b32 v180, 16, v165
v_and_b32 v181, 0xffff0000, v165
v_mul_f32 v180, s32, v180
v_mul_f32 v181, s32, v181
v_mul_f32 v182, v53, v180
v_mul_f32 v183, v53, v181
v_fma_f32 v182, -v69, v181, v182
v_fma_f32 v183, v69, v180, v183
v_cvt_pk_f16_f32 v18, v178, v182
v_cvt_pk_f16_f32 v26, v179, v183
v_lshlrev_b32 v176, 16, v166
v_and_b32 v177, 0xffff0000, v166
v_mul_f32 v176, s32, v176
v_mul_f32 v177, s32, v177
v_mul_f32 v178, v54, v176
v_mul_f32 v179, v54, v177
v_fma_f32 v178, -v70, v177, v178
v_fma_f32 v179, v70, v176, v179
v_lshlrev_b32 v180, 16, v167
v_and_b32 v181, 0xffff0000, v167
v_mul_f32 v180, s32, v180
v_mul_f32 v181, s32, v181
v_mul_f32 v182, v55, v180
v_mul_f32 v183, v55, v181
v_fma_f32 v182, -v71, v181, v182
v_fma_f32 v183, v71, v180, v183
v_cvt_pk_f16_f32 v19, v178, v182
v_cvt_pk_f16_f32 v27, v179, v183
v_lshlrev_b32 v176, 16, v168
v_and_b32 v177, 0xffff0000, v168
v_mul_f32 v176, s32, v176
v_mul_f32 v177, s32, v177
v_mul_f32 v178, v56, v176
v_mul_f32 v179, v56, v177
v_fma_f32 v178, -v72, v177, v178
v_fma_f32 v179, v72, v176, v179
v_lshlrev_b32 v180, 16, v169
v_and_b32 v181, 0xffff0000, v169
v_mul_f32 v180, s32, v180
v_mul_f32 v181, s32, v181
v_mul_f32 v182, v57, v180
v_mul_f32 v183, v57, v181
v_fma_f32 v182, -v73, v181, v182
v_fma_f32 v183, v73, v180, v183
v_cvt_pk_f16_f32 v20, v178, v182
v_cvt_pk_f16_f32 v28, v179, v183
v_lshlrev_b32 v176, 16, v170
v_and_b32 v177, 0xffff0000, v170
v_mul_f32 v176, s32, v176
v_mul_f32 v177, s32, v177
v_mul_f32 v178, v58, v176
v_mul_f32 v179, v58, v177
v_fma_f32 v178, -v74, v177, v178
v_fma_f32 v179, v74, v176, v179
v_lshlrev_b32 v180, 16, v171
v_and_b32 v181, 0xffff0000, v171
v_mul_f32 v180, s32, v180
v_mul_f32 v181, s32, v181
v_mul_f32 v182, v59, v180
v_mul_f32 v183, v59, v181
v_fma_f32 v182, -v75, v181, v182
v_fma_f32 v183, v75, v180, v183
v_cvt_pk_f16_f32 v21, v178, v182
v_cvt_pk_f16_f32 v29, v179, v183
v_lshlrev_b32 v176, 16, v172
v_and_b32 v177, 0xffff0000, v172
v_mul_f32 v176, s32, v176
v_mul_f32 v177, s32, v177
v_mul_f32 v178, v60, v176
v_mul_f32 v179, v60, v177
v_fma_f32 v178, -v76, v177, v178
v_fma_f32 v179, v76, v176, v179
v_lshlrev_b32 v180, 16, v173
v_and_b32 v181, 0xffff0000, v173
v_mul_f32 v180, s32, v180
v_mul_f32 v181, s32, v181
v_mul_f32 v182, v61, v180
v_mul_f32 v183, v61, v181
v_fma_f32 v182, -v77, v181, v182
v_fma_f32 v183, v77, v180, v183
v_cvt_pk_f16_f32 v22, v178, v182
v_cvt_pk_f16_f32 v30, v179, v183
v_lshlrev_b32 v176, 16, v174
v_and_b32 v177, 0xffff0000, v174
v_mul_f32 v176, s32, v176
v_mul_f32 v177, s32, v177
v_mul_f32 v178, v62, v176
v_mul_f32 v179, v62, v177
v_fma_f32 v178, -v78, v177, v178
v_fma_f32 v179, v78, v176, v179
v_lshlrev_b32 v180, 16, v175
v_and_b32 v181, 0xffff0000, v175
v_mul_f32 v180, s32, v180
v_mul_f32 v181, s32, v181
v_mul_f32 v182, v63, v180
v_mul_f32 v183, v63, v181
v_fma_f32 v182, -v79, v181, v182
v_fma_f32 v183, v79, v180, v183
v_cvt_pk_f16_f32 v23, v178, v182
v_cvt_pk_f16_f32 v31, v179, v183
s_nop 1
v_mfma_f32_32x32x16_f16 v[48:63], v[16:19], v[80:83], 0
v_mfma_f32_32x32x16_f16 v[64:79], v[24:27], v[80:83], 0
v_mfma_f32_32x32x16_f16 v[48:63], v[20:23], v[84:87], v[48:63]
v_mfma_f32_32x32x16_f16 v[64:79], v[28:31], v[84:87], v[64:79]
v_mfma_f32_32x32x16_f16 v[48:63], v[24:27], v[96:99], v[48:63]
v_mfma_f32_32x32x16_f16 v[64:79], v[16:19], v[88:91], v[64:79]
v_mfma_f32_32x32x16_f16 v[48:63], v[28:31], v[100:103], v[48:63]
v_mfma_f32_32x32x16_f16 v[64:79], v[20:23], v[92:95], v[64:79]
s_nop 15
s_nop 3
s_waitcnt lgkmcnt(0)
v_mul_f32 v176, v48, v128
v_mul_f32 v177, v64, v128
v_fma_f32 v176, -v64, v144, v176
v_fma_f32 v177, v48, v144, v177
v_mul_f32 v178, v49, v129
v_mul_f32 v179, v65, v129
v_fma_f32 v178, -v65, v145, v178
v_fma_f32 v179, v49, v145, v179
v_cvt_pk_f16_f32 v16, v176, v178
v_cvt_pk_f16_f32 v24, v177, v179
v_mul_f32 v180, v50, v130
v_mul_f32 v181, v66, v130
v_fma_f32 v180, -v66, v146, v180
v_fma_f32 v181, v50, v146, v181
v_mul_f32 v182, v51, v131
v_mul_f32 v183, v67, v131
v_fma_f32 v182, -v67, v147, v182
v_fma_f32 v183, v51, v147, v183
v_cvt_pk_f16_f32 v17, v180, v182
v_cvt_pk_f16_f32 v25, v181, v183
v_mul_f32 v176, v52, v132
v_mul_f32 v177, v68, v132
v_fma_f32 v176, -v68, v148, v176
v_fma_f32 v177, v52, v148, v177
v_mul_f32 v178, v53, v133
v_mul_f32 v179, v69, v133
v_fma_f32 v178, -v69, v149, v178
v_fma_f32 v179, v53, v149, v179
v_cvt_pk_f16_f32 v18, v176, v178
v_cvt_pk_f16_f32 v26, v177, v179
v_mul_f32 v180, v54, v134
v_mul_f32 v181, v70, v134
v_fma_f32 v180, -v70, v150, v180
v_fma_f32 v181, v54, v150, v181
v_mul_f32 v182, v55, v135
v_mul_f32 v183, v71, v135
v_fma_f32 v182, -v71, v151, v182
v_fma_f32 v183, v55, v151, v183
v_cvt_pk_f16_f32 v19, v180, v182
v_cvt_pk_f16_f32 v27, v181, v183
v_mul_f32 v176, v56, v136
v_mul_f32 v177, v72, v136
v_fma_f32 v176, -v72, v152, v176
v_fma_f32 v177, v56, v152, v177
v_mul_f32 v178, v57, v137
v_mul_f32 v179, v73, v137
v_fma_f32 v178, -v73, v153, v178
v_fma_f32 v179, v57, v153, v179
v_cvt_pk_f16_f32 v20, v176, v178
v_cvt_pk_f16_f32 v28, v177, v179
v_mul_f32 v180, v58, v138
v_mul_f32 v181, v74, v138
v_fma_f32 v180, -v74, v154, v180
v_fma_f32 v181, v58, v154, v181
v_mul_f32 v182, v59, v139
v_mul_f32 v183, v75, v139
v_fma_f32 v182, -v75, v155, v182
v_fma_f32 v183, v59, v155, v183
v_cvt_pk_f16_f32 v21, v180, v182
v_cvt_pk_f16_f32 v29, v181, v183
v_mul_f32 v176, v60, v140
v_mul_f32 v177, v76, v140
v_fma_f32 v176, -v76, v156, v176
v_fma_f32 v177, v60, v156, v177
v_mul_f32 v178, v61, v141
v_mul_f32 v179, v77, v141
v_fma_f32 v178, -v77, v157, v178
v_fma_f32 v179, v61, v157, v179
v_cvt_pk_f16_f32 v22, v176, v178
v_cvt_pk_f16_f32 v30, v177, v179
v_mul_f32 v180, v62, v142
v_mul_f32 v181, v78, v142
v_fma_f32 v180, -v78, v158, v180
v_fma_f32 v181, v62, v158, v181
v_mul_f32 v182, v63, v143
v_mul_f32 v183, v79, v143
v_fma_f32 v182, -v79, v159, v182
v_fma_f32 v183, v63, v159, v183
v_cvt_pk_f16_f32 v23, v180, v182
v_cvt_pk_f16_f32 v31, v181, v183
s_nop 1
v_mfma_f32_32x32x16_f16 v[48:63], v[104:107], v[16:19], 0
v_mfma_f32_32x32x16_f16 v[64:79], v[104:107], v[24:27], 0
v_mfma_f32_32x32x16_f16 v[48:63], v[108:111], v[20:23], v[48:63]
v_mfma_f32_32x32x16_f16 v[64:79], v[108:111], v[28:31], v[64:79]
v_mfma_f32_32x32x16_f16 v[48:63], v[120:123], v[24:27], v[48:63]
v_mfma_f32_32x32x16_f16 v[64:79], v[112:115], v[16:19], v[64:79]
v_mfma_f32_32x32x16_f16 v[48:63], v[124:127], v[28:31], v[48:63]
v_mfma_f32_32x32x16_f16 v[64:79], v[116:119], v[20:23], v[64:79]
s_nop 15
s_nop 3
s_cmp_lg_u32 s27, 36
s_cbranch_scc1 CF_out
v_and_b32 v5, 31, v2
v_lshrrev_b32 v6, 5, v2
v_lshlrev_b32 v6, 9, v6
v_lshl_add_u32 v5, v5, 2, v6
s_lshl_b32 s38, s25, 12
s_add_u32 s38, s38, 25165824
v_mul_f32 v48, 0x3e000000, v48
buffer_store_dword v48, v5, s[12:15], s38 offen offset:0
v_mul_f32 v49, 0x3e000000, v49
buffer_store_dword v49, v5, s[12:15], s38 offen offset:128
v_mul_f32 v50, 0x3e000000, v50
buffer_store_dword v50, v5, s[12:15], s38 offen offset:256
v_mul_f32 v51, 0x3e000000, v51
buffer_store_dword v51, v5, s[12:15], s38 offen offset:384
v_mul_f32 v52, 0x3e000000, v52
buffer_store_dword v52, v5, s[12:15], s38 offen offset:1024
v_mul_f32 v53, 0x3e000000, v53
buffer_store_dword v53, v5, s[12:15], s38 offen offset:1152
v_mul_f32 v54, 0x3e000000, v54
buffer_store_dword v54, v5, s[12:15], s38 offen offset:1280
v_mul_f32 v55, 0x3e000000, v55
buffer_store_dword v55, v5, s[12:15], s38 offen offset:1408
v_mul_f32 v56, 0x3e000000, v56
buffer_store_dword v56, v5, s[12:15], s38 offen offset:2048
v_mul_f32 v57, 0x3e000000, v57
buffer_store_dword v57, v5, s[12:15], s38 offen offset:2176
v_mul_f32 v58, 0x3e000000, v58
buffer_store_dword v58, v5, s[12:15], s38 offen offset:2304
v_mul_f32 v59, 0x3e000000, v59
buffer_store_dword v59, v5, s[12:15], s38 offen offset:2432
v_mul_f32 v60, 0x3e000000, v60
buffer_store_dword v60, v5, s[12:15], s38 offen offset:3072
v_mul_f32 v61, 0x3e000000, v61
buffer_store_dword v61, v5, s[12:15], s38 offen offset:3200
v_mul_f32 v62, 0x3e000000, v62
buffer_store_dword v62, v5, s[12:15], s38 offen offset:3328
v_mul_f32 v63, 0x3e000000, v63
buffer_store_dword v63, v5, s[12:15], s38 offen offset:3456
s_endpgm
CF_out:
v_and_b32 v5, 31, v2
v_mul_u32_u24 v5, 528, v5
v_lshrrev_b32 v6, 5, v2
v_lshl_add_u32 v5, v6, 6, v5
s_lshl_b32 s38, s24, 2
s_add_u32 s38, s38, 53248
v_add_u32 v5, s38, v5
v_mul_f32 v48, 0x3e000000, v48
v_mul_f32 v64, 0x3e000000, v64
v_cvt_pk_f16_f32 v176, v48, v64
ds_write_b32 v5, v176 offset:0
v_mul_f32 v49, 0x3e000000, v49
v_mul_f32 v65, 0x3e000000, v65
v_cvt_pk_f16_f32 v177, v49, v65
ds_write_b32 v5, v177 offset:16
v_mul_f32 v50, 0x3e000000, v50
v_mul_f32 v66, 0x3e000000, v66
v_cvt_pk_f16_f32 v178, v50, v66
ds_write_b32 v5, v178 offset:32
v_mul_f32 v51, 0x3e000000, v51
v_mul_f32 v67, 0x3e000000, v67
v_cvt_pk_f16_f32 v179, v51, v67
ds_write_b32 v5, v179 offset:48
v_mul_f32 v52, 0x3e000000, v52
v_mul_f32 v68, 0x3e000000, v68
v_cvt_pk_f16_f32 v176, v52, v68
ds_write_b32 v5, v176 offset:256
v_mul_f32 v53, 0x3e000000, v53
v_mul_f32 v69, 0x3e000000, v69
v_cvt_pk_f16_f32 v177, v53, v69
ds_write_b32 v5, v177 offset:272
v_mul_f32 v54, 0x3e000000, v54
v_mul_f32 v70, 0x3e000000, v70
v_cvt_pk_f16_f32 v178, v54, v70
ds_write_b32 v5, v178 offset:288
v_mul_f32 v55, 0x3e000000, v55
v_mul_f32 v71, 0x3e000000, v71
v_cvt_pk_f16_f32 v179, v55, v71
ds_write_b32 v5, v179 offset:304
v_mul_f32 v56, 0x3e000000, v56
v_mul_f32 v72, 0x3e000000, v72
v_cvt_pk_f16_f32 v176, v56, v72
ds_write_b32 v5, v176 offset:128
v_mul_f32 v57, 0x3e000000, v57
v_mul_f32 v73, 0x3e000000, v73
v_cvt_pk_f16_f32 v177, v57, v73
ds_write_b32 v5, v177 offset:144
v_mul_f32 v58, 0x3e000000, v58
v_mul_f32 v74, 0x3e000000, v74
v_cvt_pk_f16_f32 v178, v58, v74
ds_write_b32 v5, v178 offset:160
v_mul_f32 v59, 0x3e000000, v59
v_mul_f32 v75, 0x3e000000, v75
v_cvt_pk_f16_f32 v179, v59, v75
ds_write_b32 v5, v179 offset:176
v_mul_f32 v60, 0x3e000000, v60
v_mul_f32 v76, 0x3e000000, v76
v_cvt_pk_f16_f32 v176, v60, v76
ds_write_b32 v5, v176 offset:384
v_mul_f32 v61, 0x3e000000, v61
v_mul_f32 v77, 0x3e000000, v77
v_cvt_pk_f16_f32 v177, v61, v77
ds_write_b32 v5, v177 offset:400
v_mul_f32 v62, 0x3e000000, v62
v_mul_f32 v78, 0x3e000000, v78
v_cvt_pk_f16_f32 v178, v62, v78
ds_write_b32 v5, v178 offset:416
v_mul_f32 v63, 0x3e000000, v63
v_mul_f32 v79, 0x3e000000, v79
v_cvt_pk_f16_f32 v179, v63, v79
ds_write_b32 v5, v179 offset:432
v_lshrrev_b32 v6, 5, v2
v_and_b32 v7, 31, v2
v_mul_u32_u24 v8, 528, v6
v_lshl_add_u32 v8, v7, 4, v8
s_mul_i32 s38, s24, 4224
s_add_u32 s38, s38, 53248
v_add_u32 v8, s38, v8
v_lshrrev_b32 v9, 4, v2
v_mul_u32_u24 v9, 9216, v9
v_and_b32 v10, 15, v2
v_lshl_add_u32 v9, v10, 4, v9
s_lshl_b32 s38, s25, 1
s_add_u32 s38, s38, s26
s_lshl_b32 s38, s38, 6
s_lshl_b32 s39, s24, 4
s_add_u32 s38, s38, s39
s_mul_i32 s38, s38, 9216
s_lshr_b32 s39, s27, 2
s_lshl_b32 s39, s39, 10
s_add_u32 s38, s38, s39
s_and_b32 s39, s27, 3
s_lshl_b32 s39, s39, 8
s_add_u32 s38, s38, s39
s_add_u32 s38, s38, 18874368
s_waitcnt lgkmcnt(0)
s_barrier
ds_read_b128 v[16:19], v8 offset:0
ds_read_b128 v[20:23], v8 offset:1056
ds_read_b128 v[24:27], v8 offset:2112
ds_read_b128 v[28:31], v8 offset:3168
s_waitcnt lgkmcnt(3)
buffer_store_dwordx4 v[16:19], v9, s[12:15], s38 offen sc1
s_add_u32 s38, s38, 36864
s_waitcnt lgkmcnt(2)
buffer_store_dwordx4 v[20:23], v9, s[12:15], s38 offen sc1
s_add_u32 s38, s38, 36864
s_waitcnt lgkmcnt(1)
buffer_store_dwordx4 v[24:27], v9, s[12:15], s38 offen sc1
s_add_u32 s38, s38, 36864
s_waitcnt lgkmcnt(0)
buffer_store_dwordx4 v[28:31], v9, s[12:15], s38 offen sc1
s_endpgm
K2_end:
s_endpgm
.globl k3_kernel
.p2align 8
.type k3_kernel,@function
k3_kernel:
s_cmp_ge_u32 s2, 256
s_cbranch_scc1 K3_end
s_cmp_ge_u32 s2, 8
s_cbranch_scc1 K3_a
v_cmp_gt_u32 vcc, 320, v0
s_nop 4
s_cbranch_vccnz K3_a
v_and_b32 v8, 63, v0
v_lshlrev_b32 v8, 1, v8
s_getpc_b64 s[4:5]
s_add_u32 s4, s4, k3_kernel@rel32@lo+4
s_addc_u32 s5, s5, k3_kernel@rel32@hi+12
v_lshlrev_b32 v10, 6, v8
global_load_dword v9, v10, s[4:5]
v_add_u32 v10, 64, v10
global_load_dword v9, v10, s[4:5]
K3_a:
s_load_dwordx2 s[6:7], s[0:1], 80
s_load_dwordx2 s[16:17], s[0:1], 0
s_load_dwordx2 s[18:19], s[0:1], 64
s_load_dwordx2 s[44:45], s[0:1], 56
v_lshrrev_b32 v1, 6, v0
v_and_b32 v2, 63, v0
v_readfirstlane_b32 s24, v1
s_and_b32 s25, s2, 63
s_lshr_b32 s26, s2, 6
s_mul_i32 s27, s26, 5
s_cmp_eq_u32 s26, 3
s_cselect_b32 s47, 1, 0
s_sub_u32 s27, s27, s47
s_add_u32 s27, s27, s24
s_cmp_lt_u32 s26, 2
s_cselect_b32 s47, 5, 4
v_lshlrev_b32 v3, 4, v2
s_mul_i32 s28, s25, 9216
s_add_u32 s28, s28, 18874368
s_mul_i32 s30, s27, 18432
s_mul_i32 s29, s24, 6
s_mul_i32 s31, s25, 36
s_add_u32 s31, s31, s27
s_lshl_b32 s31, s31, 12
s_add_u32 s31, s31, 67108864
s_add_u32 s43, s31, 73728
v_lshrrev_b32 v7, 4, v2
v_lshlrev_b32 v7, 3, v7
s_lshl_b32 s46, s27, 5
s_getpc_b64 s[4:5]
s_add_u32 s4, s4, tab_ti@rel32@lo+4
s_addc_u32 s5, s5, tab_ti@rel32@hi+12
s_mov_b32 s8, s4
s_and_b32 s9, s5, 0xffff
s_mov_b32 s10, 331776
s_mov_b32 s11, 0x00020000
s_waitcnt lgkmcnt(0)
s_mov_b32 s12, s6
s_and_b32 s13, s7, 0xffff
s_mov_b32 s14, 268435456
s_mov_b32 s15, 0x00020000
s_cmp_lt_u32 s24, s47
s_cbranch_scc1 RI_active
s_add_u32 s38, s29, 0
s_mul_i32 s32, s38, 57
s_lshr_b32 s32, s32, 9
s_mul_i32 s33, s32, 580608
s_lshl_b32 s34, s38, 10
s_mov_b32 m0, s34
s_add_u32 s33, s33, s34
s_add_u32 s33, s33, s28
buffer_load_dwordx4 v3, s[12:15], s33 offen lds
s_add_u32 s38, s29, 1
s_mul_i32 s32, s38, 57
s_lshr_b32 s32, s32, 9
s_mul_i32 s33, s32, 580608
s_lshl_b32 s34, s38, 10
s_mov_b32 m0, s34
s_add_u32 s33, s33, s34
s_add_u32 s33, s33, s28
buffer_load_dwordx4 v3, s[12:15], s33 offen lds
s_add_u32 s38, s29, 2
s_mul_i32 s32, s38, 57
s_lshr_b32 s32, s32, 9
s_mul_i32 s33, s32, 580608
s_lshl_b32 s34, s38, 10
s_mov_b32 m0, s34
s_add_u32 s33, s33, s34
s_add_u32 s33, s33, s28
buffer_load_dwordx4 v3, s[12:15], s33 offen lds
s_add_u32 s38, s29, 3
s_mul_i32 s32, s38, 57
s_lshr_b32 s32, s32, 9
s_mul_i32 s33, s32, 580608
s_lshl_b32 s34, s38, 10
s_mov_b32 m0, s34
s_add_u32 s33, s33, s34
s_add_u32 s33, s33, s28
buffer_load_dwordx4 v3, s[12:15], s33 offen lds
s_add_u32 s38, s29, 4
s_mul_i32 s32, s38, 57
s_lshr_b32 s32, s32, 9
s_mul_i32 s33, s32, 580608
s_lshl_b32 s34, s38, 10
s_mov_b32 m0, s34
s_add_u32 s33, s33, s34
s_add_u32 s33, s33, s28
buffer_load_dwordx4 v3, s[12:15], s33 offen lds
s_add_u32 s38, s29, 5
s_mul_i32 s32, s38, 57
s_lshr_b32 s32, s32, 9
s_mul_i32 s33, s32, 580608
s_lshl_b32 s34, s38, 10
s_mov_b32 m0, s34
s_add_u32 s33, s33, s34
s_add_u32 s33, s33, s28
buffer_load_dwordx4 v3, s[12:15], s33 offen lds
s_waitcnt vmcnt(0)
s_barrier
s_endpgm
RI_active:
buffer_load_dwordx4 v[136:139], v3, s[12:15], s31 offen offset:0
buffer_load_dwordx4 v[140:143], v3, s[12:15], s31 offen offset:1024
buffer_load_dwordx4 v[144:147], v3, s[12:15], s31 offen offset:2048
buffer_load_dwordx4 v[148:151], v3, s[12:15], s31 offen offset:3072
buffer_load_dwordx4 v[152:155], v3, s[12:15], s43 offen offset:0
buffer_load_dwordx4 v[156:159], v3, s[12:15], s43 offen offset:1024
buffer_load_dwordx4 v[160:163], v3, s[12:15], s43 offen offset:2048
buffer_load_dwordx4 v[164:167], v3, s[12:15], s43 offen offset:3072
s_mov_b32 s52, s44
s_and_b32 s53, s45, 0xffff
s_mov_b32 s54, 1152
s_mov_b32 s55, 0x00020000
buffer_load_dwordx2 v[176:177], v7, s[52:55], s46 offen offset:0
buffer_load_dwordx2 v[178:179], v7, s[52:55], s46 offen offset:576
s_add_u32 s38, s29, 0
s_mul_i32 s32, s38, 57
s_lshr_b32 s32, s32, 9
s_mul_i32 s33, s32, 580608
s_lshl_b32 s34, s38, 10
s_mov_b32 m0, s34
s_add_u32 s33, s33, s34
s_add_u32 s33, s33, s28
buffer_load_dwordx4 v3, s[12:15], s33 offen lds
s_add_u32 s38, s29, 1
s_mul_i32 s32, s38, 57
s_lshr_b32 s32, s32, 9
s_mul_i32 s33, s32, 580608
s_lshl_b32 s34, s38, 10
s_mov_b32 m0, s34
s_add_u32 s33, s33, s34
s_add_u32 s33, s33, s28
buffer_load_dwordx4 v3, s[12:15], s33 offen lds
s_add_u32 s38, s29, 2
s_mul_i32 s32, s38, 57
s_lshr_b32 s32, s32, 9
s_mul_i32 s33, s32, 580608
s_lshl_b32 s34, s38, 10
s_mov_b32 m0, s34
s_add_u32 s33, s33, s34
s_add_u32 s33, s33, s28
buffer_load_dwordx4 v3, s[12:15], s33 offen lds
s_add_u32 s38, s29, 3
s_mul_i32 s32, s38, 57
s_lshr_b32 s32, s32, 9
s_mul_i32 s33, s32, 580608
s_lshl_b32 s34, s38, 10
s_mov_b32 m0, s34
s_add_u32 s33, s33, s34
s_add_u32 s33, s33, s28
buffer_load_dwordx4 v3, s[12:15], s33 offen lds
s_add_u32 s38, s29, 4
s_mul_i32 s32, s38, 57
s_lshr_b32 s32, s32, 9
s_mul_i32 s33, s32, 580608
s_lshl_b32 s34, s38, 10
s_mov_b32 m0, s34
s_add_u32 s33, s33, s34
s_add_u32 s33, s33, s28
buffer_load_dwordx4 v3, s[12:15], s33 offen lds
s_add_u32 s38, s29, 5
s_mul_i32 s32, s38, 57
s_lshr_b32 s32, s32, 9
s_mul_i32 s33, s32, 580608
s_lshl_b32 s34, s38, 10
s_mov_b32 m0, s34
s_add_u32 s33, s33, s34
s_add_u32 s33, s33, s28
buffer_load_dwordx4 v3, s[12:15], s33 offen lds
s_add_u32 s32, s30, 0
buffer_load_dwordx4 v[64:67], v3, s[8:11], s32 offen offset:0
buffer_load_dwordx4 v[68:71], v3, s[8:11], s32 offen offset:1024
buffer_load_dwordx4 v[72:75], v3, s[8:11], s32 offen offset:2048
buffer_load_dwordx4 v[76:79], v3, s[8:11], s32 offen offset:3072
s_add_u32 s32, s30, 4096
buffer_load_dwordx4 v[80:83], v3, s[8:11], s32 offen offset:0
buffer_load_dwordx4 v[84:87], v3, s[8:11], s32 offen offset:1024
buffer_load_dwordx4 v[88:91], v3, s[8:11], s32 offen offset:2048
buffer_load_dwordx4 v[92:95], v3, s[8:11], s32 offen offset:3072
s_add_u32 s32, s30, 8192
buffer_load_dwordx4 v[96:99], v3, s[8:11], s32 offen offset:0
buffer_load_dwordx4 v[100:103], v3, s[8:11], s32 offen offset:1024
buffer_load_dwordx4 v[104:107], v3, s[8:11], s32 offen offset:2048
buffer_load_dwordx4 v[108:111], v3, s[8:11], s32 offen offset:3072
s_add_u32 s32, s30, 12288
buffer_load_dwordx4 v[112:115], v3, s[8:11], s32 offen offset:0
buffer_load_dwordx4 v[116:119], v3, s[8:11], s32 offen offset:1024
buffer_load_dwordx4 v[120:123], v3, s[8:11], s32 offen offset:2048
buffer_load_dwordx4 v[124:127], v3, s[8:11], s32 offen offset:3072
s_add_u32 s32, s30, 16384
buffer_load_dwordx4 v[128:131], v3, s[8:11], s32 offen offset:0
buffer_load_dwordx4 v[132:135], v3, s[8:11], s32 offen offset:1024
s_mov_b32 s20, s16
s_and_b32 s21, s17, 0xffff
s_mov_b32 s22, 2359296
s_mov_b32 s23, 0x00020000
s_mov_b32 s48, s18
s_and_b32 s49, s19, 0xffff
s_mov_b32 s50, 2359296
s_mov_b32 s51, 0x00020000
v_and_b32 v6, 15, v2
v_lshrrev_b32 v5, 3, v6
v_lshlrev_b32 v5, 4, v5
v_and_b32 v6, 7, v6
v_add_u32 v6, v6, v5
s_and_b32 s32, s25, 1
s_lshl_b32 s32, s32, 3
v_add_u32 v6, s32, v6
v_lshlrev_b32 v13, 7, v6
v_mul_u32_u24 v6, 36864, v6
v_add_u32 v6, v6, v7
s_lshr_b32 s40, s25, 1
s_mul_i32 s40, s40, 1152
s_add_u32 s40, s40, s46
s_add_u32 s41, s40, 1179648
buffer_load_dwordx2 v[168:169], v6, s[20:23], s40 offen offset:0
buffer_load_dwordx2 v[170:171], v6, s[20:23], s40 offen offset:576
buffer_load_dwordx2 v[172:173], v6, s[20:23], s41 offen offset:0
buffer_load_dwordx2 v[174:175], v6, s[20:23], s41 offen offset:576
s_lshr_b32 s43, s25, 1
s_lshl_b32 s43, s43, 2
s_add_u32 s43, s43, 25165824
s_add_u32 s34, s43, 4096
buffer_load_dword v14, v13, s[12:15], s43 offen
buffer_load_dword v15, v13, s[12:15], s34 offen
s_mov_b32 s36, 25231360
buffer_load_dwordx4 v[180:183], v3, s[12:15], s36 offen
s_mov_b32 s35, 0xbfb8aa3b
s_waitcnt vmcnt(31)
v_lshlrev_b32 v32, 16, v136
v_and_b32 v33, 0xffff0000, v136
v_lshlrev_b32 v34, 16, v137
v_and_b32 v35, 0xffff0000, v137
v_lshlrev_b32 v40, 16, v138
v_and_b32 v41, 0xffff0000, v138
v_lshlrev_b32 v42, 16, v139
v_and_b32 v43, 0xffff0000, v139
v_lshlrev_b32 v48, 16, v140
v_and_b32 v49, 0xffff0000, v140
v_lshlrev_b32 v50, 16, v141
v_and_b32 v51, 0xffff0000, v141
v_add_f32 v32, v32, v48
v_add_f32 v33, v33, v49
v_add_f32 v34, v34, v50
v_add_f32 v35, v35, v51
v_lshlrev_b32 v52, 16, v142
v_and_b32 v53, 0xffff0000, v142
v_lshlrev_b32 v54, 16, v143
v_and_b32 v55, 0xffff0000, v143
v_add_f32 v40, v40, v52
v_add_f32 v41, v41, v53
v_add_f32 v42, v42, v54
v_add_f32 v43, v43, v55
v_lshlrev_b32 v48, 16, v144
v_and_b32 v49, 0xffff0000, v144
v_lshlrev_b32 v50, 16, v145
v_and_b32 v51, 0xffff0000, v145
v_add_f32 v32, v32, v48
v_add_f32 v33, v33, v49
v_add_f32 v34, v34, v50
v_add_f32 v35, v35, v51
v_lshlrev_b32 v52, 16, v146
v_and_b32 v53, 0xffff0000, v146
v_lshlrev_b32 v54, 16, v147
v_and_b32 v55, 0xffff0000, v147
v_add_f32 v40, v40, v52
v_add_f32 v41, v41, v53
v_add_f32 v42, v42, v54
v_add_f32 v43, v43, v55
v_lshlrev_b32 v48, 16, v148
v_and_b32 v49, 0xffff0000, v148
v_lshlrev_b32 v50, 16, v149
v_and_b32 v51, 0xffff0000, v149
v_add_f32 v32, v32, v48
v_add_f32 v33, v33, v49
v_add_f32 v34, v34, v50
v_add_f32 v35, v35, v51
v_lshlrev_b32 v52, 16, v150
v_and_b32 v53, 0xffff0000, v150
v_lshlrev_b32 v54, 16, v151
v_and_b32 v55, 0xffff0000, v151
v_add_f32 v40, v40, v52
v_add_f32 v41, v41, v53
v_add_f32 v42, v42, v54
v_add_f32 v43, v43, v55
v_lshlrev_b32 v36, 16, v152
v_and_b32 v37, 0xffff0000, v152
v_lshlrev_b32 v38, 16, v153
v_and_b32 v39, 0xffff0000, v153
v_lshlrev_b32 v44, 16, v154
v_and_b32 v45, 0xffff0000, v154
v_lshlrev_b32 v46, 16, v155
v_and_b32 v47, 0xffff0000, v155
v_lshlrev_b32 v48, 16, v156
v_and_b32 v49, 0xffff0000, v156
v_lshlrev_b32 v50, 16, v157
v_and_b32 v51, 0xffff0000, v157
v_add_f32 v36, v36, v48
v_add_f32 v37, v37, v49
v_add_f32 v38, v38, v50
v_add_f32 v39, v39, v51
v_lshlrev_b32 v52, 16, v158
v_and_b32 v53, 0xffff0000, v158
v_lshlrev_b32 v54, 16, v159
v_and_b32 v55, 0xffff0000, v159
v_add_f32 v44, v44, v52
v_add_f32 v45, v45, v53
v_add_f32 v46, v46, v54
v_add_f32 v47, v47, v55
v_lshlrev_b32 v48, 16, v160
v_and_b32 v49, 0xffff0000, v160
v_lshlrev_b32 v50, 16, v161
v_and_b32 v51, 0xffff0000, v161
v_add_f32 v36, v36, v48
v_add_f32 v37, v37, v49
v_add_f32 v38, v38, v50
v_add_f32 v39, v39, v51
v_lshlrev_b32 v52, 16, v162
v_and_b32 v53, 0xffff0000, v162
v_lshlrev_b32 v54, 16, v163
v_and_b32 v55, 0xffff0000, v163
v_add_f32 v44, v44, v52
v_add_f32 v45, v45, v53
v_add_f32 v46, v46, v54
v_add_f32 v47, v47, v55
v_lshlrev_b32 v48, 16, v164
v_and_b32 v49, 0xffff0000, v164
v_lshlrev_b32 v50, 16, v165
v_and_b32 v51, 0xffff0000, v165
v_add_f32 v36, v36, v48
v_add_f32 v37, v37, v49
v_add_f32 v38, v38, v50
v_add_f32 v39, v39, v51
v_lshlrev_b32 v52, 16, v166
v_and_b32 v53, 0xffff0000, v166
v_lshlrev_b32 v54, 16, v167
v_and_b32 v55, 0xffff0000, v167
v_add_f32 v44, v44, v52
v_add_f32 v45, v45, v53
v_add_f32 v46, v46, v54
v_add_f32 v47, v47, v55
v_cvt_pk_bf16_f32 v8, v32, v33
v_cvt_pk_bf16_f32 v9, v34, v35
v_lshlrev_b32 v32, 16, v8
v_and_b32 v33, 0xffff0000, v8
v_lshlrev_b32 v34, 16, v9
v_and_b32 v35, 0xffff0000, v9
v_lshlrev_b32 v52, 16, v176
v_and_b32 v53, 0xffff0000, v176
v_lshlrev_b32 v54, 16, v177
v_and_b32 v55, 0xffff0000, v177
v_add_f32 v32, v32, v52
v_add_f32 v33, v33, v53
v_add_f32 v34, v34, v54
v_add_f32 v35, v35, v55
v_cvt_pk_bf16_f32 v8, v32, v33
v_cvt_pk_bf16_f32 v9, v34, v35
v_lshlrev_b32 v32, 16, v8
v_and_b32 v33, 0xffff0000, v8
v_lshlrev_b32 v34, 16, v9
v_and_b32 v35, 0xffff0000, v9
v_mul_f32 v52, s35, v32
v_mul_f32 v53, s35, v33
v_mul_f32 v54, s35, v34
v_mul_f32 v55, s35, v35
v_exp_f32 v52, v52
v_exp_f32 v53, v53
v_exp_f32 v54, v54
v_exp_f32 v55, v55
v_add_f32 v52, 1.0, v52
v_add_f32 v53, 1.0, v53
v_add_f32 v54, 1.0, v54
v_add_f32 v55, 1.0, v55
v_rcp_f32 v52, v52
v_rcp_f32 v53, v53
v_rcp_f32 v54, v54
v_rcp_f32 v55, v55
v_mul_f32 v32, v32, v52
v_mul_f32 v33, v33, v53
v_mul_f32 v34, v34, v54
v_mul_f32 v35, v35, v55
v_cvt_pk_bf16_f32 v8, v32, v33
v_cvt_pk_bf16_f32 v9, v34, v35
v_lshlrev_b32 v32, 16, v8
v_and_b32 v33, 0xffff0000, v8
v_lshlrev_b32 v34, 16, v9
v_and_b32 v35, 0xffff0000, v9
v_cvt_pk_bf16_f32 v8, v36, v37
v_cvt_pk_bf16_f32 v9, v38, v39
v_lshlrev_b32 v36, 16, v8
v_and_b32 v37, 0xffff0000, v8
v_lshlrev_b32 v38, 16, v9
v_and_b32 v39, 0xffff0000, v9
v_lshlrev_b32 v52, 16, v178
v_and_b32 v53, 0xffff0000, v178
v_lshlrev_b32 v54, 16, v179
v_and_b32 v55, 0xffff0000, v179
v_add_f32 v36, v36, v52
v_add_f32 v37, v37, v53
v_add_f32 v38, v38, v54
v_add_f32 v39, v39, v55
v_cvt_pk_bf16_f32 v8, v36, v37
v_cvt_pk_bf16_f32 v9, v38, v39
v_lshlrev_b32 v36, 16, v8
v_and_b32 v37, 0xffff0000, v8
v_lshlrev_b32 v38, 16, v9
v_and_b32 v39, 0xffff0000, v9
v_mul_f32 v52, s35, v36
v_mul_f32 v53, s35, v37
v_mul_f32 v54, s35, v38
v_mul_f32 v55, s35, v39
v_exp_f32 v52, v52
v_exp_f32 v53, v53
v_exp_f32 v54, v54
v_exp_f32 v55, v55
v_add_f32 v52, 1.0, v52
v_add_f32 v53, 1.0, v53
v_add_f32 v54, 1.0, v54
v_add_f32 v55, 1.0, v55
v_rcp_f32 v52, v52
v_rcp_f32 v53, v53
v_rcp_f32 v54, v54
v_rcp_f32 v55, v55
v_mul_f32 v36, v36, v52
v_mul_f32 v37, v37, v53
v_mul_f32 v38, v38, v54
v_mul_f32 v39, v39, v55
v_cvt_pk_bf16_f32 v8, v36, v37
v_cvt_pk_bf16_f32 v9, v38, v39
v_lshlrev_b32 v36, 16, v8
v_and_b32 v37, 0xffff0000, v8
v_lshlrev_b32 v38, 16, v9
v_and_b32 v39, 0xffff0000, v9
v_cvt_pk_bf16_f32 v8, v40, v41
v_cvt_pk_bf16_f32 v9, v42, v43
v_lshlrev_b32 v40, 16, v8
v_and_b32 v41, 0xffff0000, v8
v_lshlrev_b32 v42, 16, v9
v_and_b32 v43, 0xffff0000, v9
v_lshlrev_b32 v52, 16, v176
v_and_b32 v53, 0xffff0000, v176
v_lshlrev_b32 v54, 16, v177
v_and_b32 v55, 0xffff0000, v177
v_add_f32 v40, v40, v52
v_add_f32 v41, v41, v53
v_add_f32 v42, v42, v54
v_add_f32 v43, v43, v55
v_cvt_pk_bf16_f32 v8, v40, v41
v_cvt_pk_bf16_f32 v9, v42, v43
v_lshlrev_b32 v40, 16, v8
v_and_b32 v41, 0xffff0000, v8
v_lshlrev_b32 v42, 16, v9
v_and_b32 v43, 0xffff0000, v9
v_mul_f32 v52, s35, v40
v_mul_f32 v53, s35, v41
v_mul_f32 v54, s35, v42
v_mul_f32 v55, s35, v43
v_exp_f32 v52, v52
v_exp_f32 v53, v53
v_exp_f32 v54, v54
v_exp_f32 v55, v55
v_add_f32 v52, 1.0, v52
v_add_f32 v53, 1.0, v53
v_add_f32 v54, 1.0, v54
v_add_f32 v55, 1.0, v55
v_rcp_f32 v52, v52
v_rcp_f32 v53, v53
v_rcp_f32 v54, v54
v_rcp_f32 v55, v55
v_mul_f32 v40, v40, v52
v_mul_f32 v41, v41, v53
v_mul_f32 v42, v42, v54
v_mul_f32 v43, v43, v55
v_cvt_pk_bf16_f32 v8, v40, v41
v_cvt_pk_bf16_f32 v9, v42, v43
v_lshlrev_b32 v40, 16, v8
v_and_b32 v41, 0xffff0000, v8
v_lshlrev_b32 v42, 16, v9
v_and_b32 v43, 0xffff0000, v9
v_cvt_pk_bf16_f32 v8, v44, v45
v_cvt_pk_bf16_f32 v9, v46, v47
v_lshlrev_b32 v44, 16, v8
v_and_b32 v45, 0xffff0000, v8
v_lshlrev_b32 v46, 16, v9
v_and_b32 v47, 0xffff0000, v9
v_lshlrev_b32 v52, 16, v178
v_and_b32 v53, 0xffff0000, v178
v_lshlrev_b32 v54, 16, v179
v_and_b32 v55, 0xffff0000, v179
v_add_f32 v44, v44, v52
v_add_f32 v45, v45, v53
v_add_f32 v46, v46, v54
v_add_f32 v47, v47, v55
v_cvt_pk_bf16_f32 v8, v44, v45
v_cvt_pk_bf16_f32 v9, v46, v47
v_lshlrev_b32 v44, 16, v8
v_and_b32 v45, 0xffff0000, v8
v_lshlrev_b32 v46, 16, v9
v_and_b32 v47, 0xffff0000, v9
v_mul_f32 v52, s35, v44
v_mul_f32 v53, s35, v45
v_mul_f32 v54, s35, v46
v_mul_f32 v55, s35, v47
v_exp_f32 v52, v52
v_exp_f32 v53, v53
v_exp_f32 v54, v54
v_exp_f32 v55, v55
v_add_f32 v52, 1.0, v52
v_add_f32 v53, 1.0, v53
v_add_f32 v54, 1.0, v54
v_add_f32 v55, 1.0, v55
v_rcp_f32 v52, v52
v_rcp_f32 v53, v53
v_rcp_f32 v54, v54
v_rcp_f32 v55, v55
v_mul_f32 v44, v44, v52
v_mul_f32 v45, v45, v53
v_mul_f32 v46, v46, v54
v_mul_f32 v47, v47, v55
v_cvt_pk_bf16_f32 v8, v44, v45
v_cvt_pk_bf16_f32 v9, v46, v47
v_lshlrev_b32 v44, 16, v8
v_and_b32 v45, 0xffff0000, v8
v_lshlrev_b32 v46, 16, v9
v_and_b32 v47, 0xffff0000, v9
s_waitcnt vmcnt(25)
s_barrier
ds_read_b128 v[208:211], v3 offset:0
ds_read_b128 v[212:215], v3 offset:18432
ds_read_b128 v[216:219], v3 offset:1024
ds_read_b128 v[220:223], v3 offset:19456
ds_read_b128 v[224:227], v3 offset:2048
ds_read_b128 v[228:231], v3 offset:20480
ds_read_b128 v[232:235], v3 offset:3072
ds_read_b128 v[236:239], v3 offset:21504
s_waitcnt lgkmcnt(6) vmcnt(24)
v_mfma_f32_16x16x32_f16 v[16:19], v[64:67], v[208:211], 0
v_mfma_f32_16x16x32_f16 v[24:27], v[64:67], v[212:215], 0
ds_read_b128 v[208:211], v3 offset:4096
ds_read_b128 v[212:215], v3 offset:22528
s_waitcnt lgkmcnt(6) vmcnt(23)
v_mfma_f32_16x16x32_f16 v[16:19], v[68:71], v[216:219], v[16:19]
v_mfma_f32_16x16x32_f16 v[24:27], v[68:71], v[220:223], v[24:27]
ds_read_b128 v[216:219], v3 offset:5120
ds_read_b128 v[220:223], v3 offset:23552
s_waitcnt lgkmcnt(6) vmcnt(22)
v_mfma_f32_16x16x32_f16 v[16:19], v[72:75], v[224:227], v[16:19]
v_mfma_f32_16x16x32_f16 v[24:27], v[72:75], v[228:231], v[24:27]
ds_read_b128 v[224:227], v3 offset:6144
ds_read_b128 v[228:231], v3 offset:24576
s_waitcnt lgkmcnt(6) vmcnt(21)
v_mfma_f32_16x16x32_f16 v[16:19], v[76:79], v[232:235], v[16:19]
v_mfma_f32_16x16x32_f16 v[24:27], v[76:79], v[236:239], v[24:27]
ds_read_b128 v[232:235], v3 offset:7168
ds_read_b128 v[236:239], v3 offset:25600
s_waitcnt lgkmcnt(6) vmcnt(20)
v_mfma_f32_16x16x32_f16 v[16:19], v[80:83], v[208:211], v[16:19]
v_mfma_f32_16x16x32_f16 v[24:27], v[80:83], v[212:215], v[24:27]
ds_read_b128 v[208:211], v3 offset:8192
ds_read_b128 v[212:215], v3 offset:26624
s_waitcnt lgkmcnt(6) vmcnt(19)
v_mfma_f32_16x16x32_f16 v[16:19], v[84:87], v[216:219], v[16:19]
v_mfma_f32_16x16x32_f16 v[24:27], v[84:87], v[220:223], v[24:27]
ds_read_b128 v[216:219], v3 offset:9216
ds_read_b128 v[220:223], v3 offset:27648
s_waitcnt lgkmcnt(6) vmcnt(18)
v_mfma_f32_16x16x32_f16 v[16:19], v[88:91], v[224:227], v[16:19]
v_mfma_f32_16x16x32_f16 v[24:27], v[88:91], v[228:231], v[24:27]
ds_read_b128 v[224:227], v3 offset:10240
ds_read_b128 v[228:231], v3 offset:28672
s_waitcnt lgkmcnt(6) vmcnt(17)
v_mfma_f32_16x16x32_f16 v[16:19], v[92:95], v[232:235], v[16:19]
v_mfma_f32_16x16x32_f16 v[24:27], v[92:95], v[236:239], v[24:27]
ds_read_b128 v[232:235], v3 offset:11264
ds_read_b128 v[236:239], v3 offset:29696
s_waitcnt lgkmcnt(6) vmcnt(16)
v_mfma_f32_16x16x32_f16 v[16:19], v[96:99], v[208:211], v[16:19]
v_mfma_f32_16x16x32_f16 v[24:27], v[96:99], v[212:215], v[24:27]
ds_read_b128 v[208:211], v3 offset:12288
ds_read_b128 v[212:215], v3 offset:30720
s_waitcnt lgkmcnt(6) vmcnt(15)
v_mfma_f32_16x16x32_f16 v[20:23], v[100:103], v[216:219], 0
v_mfma_f32_16x16x32_f16 v[28:31], v[100:103], v[220:223], 0
ds_read_b128 v[216:219], v3 offset:13312
ds_read_b128 v[220:223], v3 offset:31744
s_waitcnt lgkmcnt(6) vmcnt(14)
v_mfma_f32_16x16x32_f16 v[20:23], v[104:107], v[224:227], v[20:23]
v_mfma_f32_16x16x32_f16 v[28:31], v[104:107], v[228:231], v[28:31]
ds_read_b128 v[224:227], v3 offset:14336
ds_read_b128 v[228:231], v3 offset:32768
s_waitcnt lgkmcnt(6) vmcnt(13)
v_mfma_f32_16x16x32_f16 v[20:23], v[108:111], v[232:235], v[20:23]
v_mfma_f32_16x16x32_f16 v[28:31], v[108:111], v[236:239], v[28:31]
ds_read_b128 v[232:235], v3 offset:15360
ds_read_b128 v[236:239], v3 offset:33792
s_waitcnt lgkmcnt(6) vmcnt(12)
v_mfma_f32_16x16x32_f16 v[20:23], v[112:115], v[208:211], v[20:23]
v_mfma_f32_16x16x32_f16 v[28:31], v[112:115], v[212:215], v[28:31]
ds_read_b128 v[208:211], v3 offset:16384
ds_read_b128 v[212:215], v3 offset:34816
s_waitcnt lgkmcnt(6) vmcnt(11)
v_mfma_f32_16x16x32_f16 v[20:23], v[116:119], v[216:219], v[20:23]
v_mfma_f32_16x16x32_f16 v[28:31], v[116:119], v[220:223], v[28:31]
ds_read_b128 v[216:219], v3 offset:17408
ds_read_b128 v[220:223], v3 offset:35840
s_waitcnt lgkmcnt(6) vmcnt(10)
v_mfma_f32_16x16x32_f16 v[20:23], v[120:123], v[224:227], v[20:23]
v_mfma_f32_16x16x32_f16 v[28:31], v[120:123], v[228:231], v[28:31]
s_waitcnt lgkmcnt(4) vmcnt(9)
v_mfma_f32_16x16x32_f16 v[20:23], v[124:127], v[232:235], v[20:23]
v_mfma_f32_16x16x32_f16 v[28:31], v[124:127], v[236:239], v[28:31]
s_waitcnt lgkmcnt(2) vmcnt(8)
v_mfma_f32_16x16x32_f16 v[20:23], v[128:131], v[208:211], v[20:23]
v_mfma_f32_16x16x32_f16 v[28:31], v[128:131], v[212:215], v[28:31]
s_waitcnt lgkmcnt(0) vmcnt(7)
v_mfma_f32_16x16x32_f16 v[20:23], v[132:135], v[216:219], v[20:23]
v_mfma_f32_16x16x32_f16 v[28:31], v[132:135], v[220:223], v[28:31]
s_waitcnt vmcnt(0)
v_max_u32 v180, v180, v181
v_max_u32 v182, v182, v183
v_max_u32 v180, v180, v182
s_nop 1
v_max_u32_dpp v180, v180, v180 row_ror:8 row_mask:0xf bank_mask:0xf
s_nop 1
v_max_u32_dpp v180, v180, v180 row_ror:4 row_mask:0xf bank_mask:0xf
s_nop 1
v_max_u32_dpp v180, v180, v180 row_ror:2 row_mask:0xf bank_mask:0xf
s_nop 1
v_max_u32_dpp v180, v180, v180 row_ror:1 row_mask:0xf bank_mask:0xf
v_mov_b32 v181, v180
s_nop 1
v_permlane16_swap_b32 v180, v181
s_nop 1
v_max_u32 v180, v180, v181
v_mov_b32 v181, v180
s_nop 1
v_permlane32_swap_b32 v180, v181
s_nop 1
v_max_u32 v180, v180, v181
s_nop 0
v_readfirstlane_b32 s36, v180
s_nop 3
s_lshr_b32 s36, s36, 7
s_max_u32 s36, s36, 20
s_min_u32 s36, s36, 240
s_add_u32 s36, s36, 1
s_lshl_b32 s36, s36, 23
s_mov_b32 s37, 0x3be38e39
v_add_f32 v16, v16, v14
v_add_f32 v24, v24, v15
v_add_f32 v48, v16, v20
v_sub_f32 v49, v16, v20
v_add_f32 v50, v24, v28
v_sub_f32 v51, v24, v28
v_add_f32 v64, v48, v50
v_add_f32 v68, v49, v51
v_sub_f32 v72, v48, v50
v_sub_f32 v76, v49, v51
v_sub_f32 v17, v17, v14
v_sub_f32 v25, v25, v15
v_add_f32 v48, v17, v21
v_sub_f32 v49, v17, v21
v_add_f32 v50, v25, v29
v_sub_f32 v51, v25, v29
v_add_f32 v65, v48, v50
v_add_f32 v69, v49, v51
v_sub_f32 v73, v48, v50
v_sub_f32 v77, v49, v51
v_add_f32 v18, v18, v14
v_add_f32 v26, v26, v15
v_add_f32 v48, v18, v22
v_sub_f32 v49, v18, v22
v_add_f32 v50, v26, v30
v_sub_f32 v51, v26, v30
v_add_f32 v66, v48, v50
v_add_f32 v70, v49, v51
v_sub_f32 v74, v48, v50
v_sub_f32 v78, v49, v51
v_sub_f32 v19, v19, v14
v_sub_f32 v27, v27, v15
v_add_f32 v48, v19, v23
v_sub_f32 v49, v19, v23
v_add_f32 v50, v27, v31
v_sub_f32 v51, v27, v31
v_add_f32 v67, v48, v50
v_add_f32 v71, v49, v51
v_sub_f32 v75, v48, v50
v_sub_f32 v79, v49, v51
v_mul_f32 v64, s37, v64
v_mul_f32 v64, s36, v64
v_mul_f32 v65, s37, v65
v_mul_f32 v65, s36, v65
v_mul_f32 v66, s37, v66
v_mul_f32 v66, s36, v66
v_mul_f32 v67, s37, v67
v_mul_f32 v67, s36, v67
v_mul_f32 v68, s37, v68
v_mul_f32 v68, s36, v68
v_mul_f32 v69, s37, v69
v_mul_f32 v69, s36, v69
v_mul_f32 v70, s37, v70
v_mul_f32 v70, s36, v70
v_mul_f32 v71, s37, v71
v_mul_f32 v71, s36, v71
v_mul_f32 v72, s37, v72
v_mul_f32 v72, s36, v72
v_mul_f32 v73, s37, v73
v_mul_f32 v73, s36, v73
v_mul_f32 v74, s37, v74
v_mul_f32 v74, s36, v74
v_mul_f32 v75, s37, v75
v_mul_f32 v75, s36, v75
v_mul_f32 v76, s37, v76
v_mul_f32 v76, s36, v76
v_mul_f32 v77, s37, v77
v_mul_f32 v77, s36, v77
v_mul_f32 v78, s37, v78
v_mul_f32 v78, s36, v78
v_mul_f32 v79, s37, v79
v_mul_f32 v79, s36, v79
v_cvt_pk_bf16_f32 v8, v64, v65
v_cvt_pk_bf16_f32 v9, v66, v67
v_lshlrev_b32 v64, 16, v8
v_and_b32 v65, 0xffff0000, v8
v_lshlrev_b32 v66, 16, v9
v_and_b32 v67, 0xffff0000, v9
v_mul_f32 v64, v64, v32
v_mul_f32 v65, v65, v33
v_mul_f32 v66, v66, v34
v_mul_f32 v67, v67, v35
v_cvt_pk_bf16_f32 v8, v64, v65
v_cvt_pk_bf16_f32 v9, v66, v67
v_lshlrev_b32 v64, 16, v8
v_and_b32 v65, 0xffff0000, v8
v_lshlrev_b32 v66, 16, v9
v_and_b32 v67, 0xffff0000, v9
v_lshlrev_b32 v52, 16, v168
v_and_b32 v53, 0xffff0000, v168
v_lshlrev_b32 v54, 16, v169
v_and_b32 v55, 0xffff0000, v169
v_add_f32 v64, v64, v52
v_add_f32 v65, v65, v53
v_add_f32 v66, v66, v54
v_add_f32 v67, v67, v55
v_cvt_pk_bf16_f32 v56, v64, v65
v_cvt_pk_bf16_f32 v57, v66, v67
buffer_store_dwordx2 v[56:57], v6, s[48:51], s40 offen offset:0
v_cvt_pk_bf16_f32 v8, v68, v69
v_cvt_pk_bf16_f32 v9, v70, v71
v_lshlrev_b32 v68, 16, v8
v_and_b32 v69, 0xffff0000, v8
v_lshlrev_b32 v70, 16, v9
v_and_b32 v71, 0xffff0000, v9
v_mul_f32 v68, v68, v36
v_mul_f32 v69, v69, v37
v_mul_f32 v70, v70, v38
v_mul_f32 v71, v71, v39
v_cvt_pk_bf16_f32 v8, v68, v69
v_cvt_pk_bf16_f32 v9, v70, v71
v_lshlrev_b32 v68, 16, v8
v_and_b32 v69, 0xffff0000, v8
v_lshlrev_b32 v70, 16, v9
v_and_b32 v71, 0xffff0000, v9
v_lshlrev_b32 v52, 16, v170
v_and_b32 v53, 0xffff0000, v170
v_lshlrev_b32 v54, 16, v171
v_and_b32 v55, 0xffff0000, v171
v_add_f32 v68, v68, v52
v_add_f32 v69, v69, v53
v_add_f32 v70, v70, v54
v_add_f32 v71, v71, v55
v_cvt_pk_bf16_f32 v58, v68, v69
v_cvt_pk_bf16_f32 v59, v70, v71
buffer_store_dwordx2 v[58:59], v6, s[48:51], s40 offen offset:576
v_cvt_pk_bf16_f32 v8, v72, v73
v_cvt_pk_bf16_f32 v9, v74, v75
v_lshlrev_b32 v72, 16, v8
v_and_b32 v73, 0xffff0000, v8
v_lshlrev_b32 v74, 16, v9
v_and_b32 v75, 0xffff0000, v9
v_mul_f32 v72, v72, v40
v_mul_f32 v73, v73, v41
v_mul_f32 v74, v74, v42
v_mul_f32 v75, v75, v43
v_cvt_pk_bf16_f32 v8, v72, v73
v_cvt_pk_bf16_f32 v9, v74, v75
v_lshlrev_b32 v72, 16, v8
v_and_b32 v73, 0xffff0000, v8
v_lshlrev_b32 v74, 16, v9
v_and_b32 v75, 0xffff0000, v9
v_lshlrev_b32 v52, 16, v172
v_and_b32 v53, 0xffff0000, v172
v_lshlrev_b32 v54, 16, v173
v_and_b32 v55, 0xffff0000, v173
v_add_f32 v72, v72, v52
v_add_f32 v73, v73, v53
v_add_f32 v74, v74, v54
v_add_f32 v75, v75, v55
v_cvt_pk_bf16_f32 v60, v72, v73
v_cvt_pk_bf16_f32 v61, v74, v75
buffer_store_dwordx2 v[60:61], v6, s[48:51], s41 offen offset:0
v_cvt_pk_bf16_f32 v8, v76, v77
v_cvt_pk_bf16_f32 v9, v78, v79
v_lshlrev_b32 v76, 16, v8
v_and_b32 v77, 0xffff0000, v8
v_lshlrev_b32 v78, 16, v9
v_and_b32 v79, 0xffff0000, v9
v_mul_f32 v76, v76, v44
v_mul_f32 v77, v77, v45
v_mul_f32 v78, v78, v46
v_mul_f32 v79, v79, v47
v_cvt_pk_bf16_f32 v8, v76, v77
v_cvt_pk_bf16_f32 v9, v78, v79
v_lshlrev_b32 v76, 16, v8
v_and_b32 v77, 0xffff0000, v8
v_lshlrev_b32 v78, 16, v9
v_and_b32 v79, 0xffff0000, v9
v_lshlrev_b32 v52, 16, v174
v_and_b32 v53, 0xffff0000, v174
v_lshlrev_b32 v54, 16, v175
v_and_b32 v55, 0xffff0000, v175
v_add_f32 v76, v76, v52
v_add_f32 v77, v77, v53
v_add_f32 v78, v78, v54
v_add_f32 v79, v79, v55
v_cvt_pk_bf16_f32 v62, v76, v77
v_cvt_pk_bf16_f32 v63, v78, v79
buffer_store_dwordx2 v[62:63], v6, s[48:51], s41 offen offset:576
s_endpgm
K3_end:
s_endpgm
.fill 16384, 4, 0xbf800000
.section .rodata,"a"
.p2align 6
.amdhsa_kernel k0_kernel
  .amdhsa_next_free_vgpr 64
  .amdhsa_next_free_sgpr 40
  .amdhsa_accum_offset 64
  .amdhsa_group_segment_fixed_size 0
  .amdhsa_kernarg_size 88
  .amdhsa_user_sgpr_count 2
  .amdhsa_user_sgpr_kernarg_segment_ptr 1
  .amdhsa_system_sgpr_workgroup_id_x 1
.end_amdhsa_kernel
.amdhsa_kernel k1_kernel
  .amdhsa_next_free_vgpr 256
  .amdhsa_next_free_sgpr 100
  .amdhsa_accum_offset 256
  .amdhsa_group_segment_fixed_size 0
  .amdhsa_kernarg_size 88
  .amdhsa_user_sgpr_count 2
  .amdhsa_user_sgpr_kernarg_segment_ptr 1
  .amdhsa_system_sgpr_workgroup_id_x 1
.end_amdhsa_kernel
.amdhsa_kernel k2_kernel
  .amdhsa_next_free_vgpr 256
  .amdhsa_next_free_sgpr 100
  .amdhsa_accum_offset 256
  .amdhsa_group_segment_fixed_size 0
  .amdhsa_kernarg_size 88
  .amdhsa_user_sgpr_count 2
  .amdhsa_user_sgpr_kernarg_segment_ptr 1
  .amdhsa_system_sgpr_workgroup_id_x 1
.end_amdhsa_kernel
.amdhsa_kernel k3_kernel
  .amdhsa_next_free_vgpr 256
  .amdhsa_next_free_sgpr 100
  .amdhsa_accum_offset 256
  .amdhsa_group_segment_fixed_size 0
  .amdhsa_kernarg_size 88
  .amdhsa_user_sgpr_count 2
  .amdhsa_user_sgpr_kernarg_segment_ptr 1
  .amdhsa_system_sgpr_workgroup_id_x 1
.end_amdhsa_kernel
.p2align 8
tab_cf:
.long 0x3c003c00,0x3c003c00,0x3c003c00,0x3c003c00,0x3bd93c00,0x3aa73b64,0xb23e0000,0xb872b61f
.long 0x3b643c00,0x361f39a8,0xbb64bc00,0xb61fb9a8,0x3aa73c00,0xb23e361f,0x38720000,0x3bd93b64
.long 0x39a83c00,0xb9a80000,0x39a83c00,0xb9a80000,0x38723c00,0xbbd9b61f,0xbaa70000,0xb23ebb64
.long 0x361f3c00,0xbb64b9a8,0xb61fbc00,0x3b6439a8,0x323e3c00,0xb872bb64,0x3bd90000,0xbaa7361f
.long 0x3c00,0xbc00,0x3c00,0x8000bc00,0xb23e3c00,0x3872bb64,0xbbd90000,0x3aa7361f
.long 0xb61f3c00,0x3b64b9a8,0x361fbc00,0xbb6439a8,0xb8723c00,0x3bd9b61f,0x3aa78000,0x323ebb64
.long 0xb9a83c00,0x39a80000,0xb9a83c00,0x39a88000,0xbaa73c00,0x323e361f,0xb8720000,0xbbd93b64
.long 0xbb643c00,0xb61f39a8,0x3b64bc00,0x361fb9a8,0xbbd93c00,0xbaa73b64,0x323e8000,0x3872b61f
.long 0xbc003c00,0xbc003c00,0xbc003c00,0xbc003c00,0xbbd93c00,0xbaa73b64,0x323e0000,0x3872b61f
.long 0xbb643c00,0xb61f39a8,0x3b64bc00,0x361fb9a8,0xbaa73c00,0x323e361f,0xb8728000,0xbbd93b64
.long 0xb9a83c00,0x39a80000,0xb9a83c00,0x39a80000,0xb8723c00,0x3bd9b61f,0x3aa70000,0x323ebb64
.long 0xb61f3c00,0x3b64b9a8,0x361fbc00,0xbb6439a8,0xb23e3c00,0x3872bb64,0xbbd98000,0x3aa7361f
.long 0x3c00,0xbc00,0x80003c00,0xbc00,0x323e3c00,0xb872bb64,0x3bd90000,0xbaa7361f
.long 0x361f3c00,0xbb64b9a8,0xb61fbc00,0x3b6439a8,0x38723c00,0xbbd9b61f,0xbaa78000,0xb23ebb64
.long 0x39a83c00,0xb9a80000,0x39a83c00,0xb9a88000,0x3aa73c00,0xb23e361f,0x38720000,0x3bd93b64
.long 0x3b643c00,0x361f39a8,0xbb64bc00,0xb61fb9a8,0x3bd93c00,0x3aa73b64,0xb23e8000,0xb872b61f
.long 0x3c003c00,0x3c003c00,0x3c003c00,0x3c003c00,0x387239a8,0x323e361f,0xbaa7b9a8,0xbbd9bb64
.long 0xb61f0000,0xbb64b9a8,0x361f0000,0x3b6439a8,0xbbd9b9a8,0xb872bb64,0x323e39a8,0xbaa7b61f
.long 0xb9a8bc00,0x39a80000,0xb9a8bc00,0x39a80000,0x323eb9a8,0x3aa73b64,0x3bd939a8,0xb872361f
.long 0x3b640000,0xb61f39a8,0xbb640000,0x361fb9a8,0x3aa739a8,0xbbd9b61f,0x3872b9a8,0xb23e3b64
.long 0x3c00,0xbc00,0x3c00,0x8000bc00,0xbaa739a8,0x3bd9b61f,0xb872b9a8,0x323e3b64
.long 0xbb640000,0x361f39a8,0x3b648000,0xb61fb9a8,0xb23eb9a8,0xbaa73b64,0xbbd939a8,0x3872361f
.long 0x39a8bc00,0xb9a80000,0x39a8bc00,0xb9a80000,0x3bd9b9a8,0x3872bb64,0xb23e39a8,0x3aa7b61f
.long 0x361f0000,0x3b64b9a8,0xb61f0000,0xbb6439a8,0xb87239a8,0xb23e361f,0x3aa7b9a8,0x3bd9bb64
.long 0xbc003c00,0xbc003c00,0xbc003c00,0xbc003c00,0xb87239a8,0xb23e361f,0x3aa7b9a8,0x3bd9bb64
.long 0x361f0000,0x3b64b9a8,0xb61f8000,0xbb6439a8,0x3bd9b9a8,0x3872bb64,0xb23e39a8,0x3aa7b61f
.long 0x39a8bc00,0xb9a88000,0x39a8bc00,0xb9a88000,0xb23eb9a8,0xbaa73b64,0xbbd939a8,0x3872361f
.long 0xbb648000,0x361f39a8,0x3b640000,0xb61fb9a8,0xbaa739a8,0x3bd9b61f,0xb872b9a8,0x323e3b64
.long 0x80003c00,0xbc00,0x3c00,0xbc00,0x3aa739a8,0xbbd9b61f,0x3872b9a8,0xb23e3b64
.long 0x3b640000,0xb61f39a8,0xbb648000,0x361fb9a8,0x323eb9a8,0x3aa73b64,0x3bd939a8,0xb872361f
.long 0xb9a8bc00,0x39a80000,0xb9a8bc00,0x39a80000,0xbbd9b9a8,0xb872bb64,0x323e39a8,0xbaa7b61f
.long 0xb61f8000,0xbb64b9a8,0x361f0000,0x3b6439a8,0x387239a8,0x323e361f,0xbaa7b9a8,0xbbd9bb64
.long 0x3c003c00,0x3c003c00,0x3c003c00,0x3c003c00,0xbbd9bc00,0xbaa7bb64,0x323e0000,0x3872361f
.long 0x3b643c00,0x361f39a8,0xbb64bc00,0xb61fb9a8,0xbaa7bc00,0x323eb61f,0xb8720000,0xbbd9bb64
.long 0x39a83c00,0xb9a80000,0x39a83c00,0xb9a80000,0xb872bc00,0x3bd9361f,0x3aa78000,0x323e3b64
.long 0x361f3c00,0xbb64b9a8,0xb61fbc00,0x3b6439a8,0xb23ebc00,0x38723b64,0xbbd90000,0x3aa7b61f
.long 0x3c00,0x8000bc00,0x3c00,0x8000bc00,0x323ebc00,0xb8723b64,0x3bd98000,0xbaa7b61f
.long 0xb61f3c00,0x3b64b9a8,0x361fbc00,0xbb6439a8,0x3872bc00,0xbbd9361f,0xbaa70000,0xb23e3b64
.long 0xb9a83c00,0x39a88000,0xb9a83c00,0x39a80000,0x3aa7bc00,0xb23eb61f,0x38728000,0x3bd9bb64
.long 0xbb643c00,0xb61f39a8,0x3b64bc00,0x361fb9a8,0x3bd9bc00,0x3aa7bb64,0xb23e0000,0xb872361f
.long 0xbc003c00,0xbc003c00,0xbc003c00,0xbc003c00,0x3bd9bc00,0x3aa7bb64,0xb23e8000,0xb872361f
.long 0xbb643c00,0xb61f39a8,0x3b64bc00,0x361fb9a8,0x3aa7bc00,0xb23eb61f,0x38720000,0x3bd9bb64
.long 0xb9a83c00,0x39a80000,0xb9a83c00,0x39a88000,0x3872bc00,0xbbd9361f,0xbaa70000,0xb23e3b64
.long 0xb61f3c00,0x3b64b9a8,0x361fbc00,0xbb6439a8,0x323ebc00,0xb8723b64,0x3bd90000,0xbaa7b61f
.long 0x3c00,0xbc00,0x80003c00,0xbc00,0xb23ebc00,0x38723b64,0xbbd98000,0x3aa7b61f
.long 0x361f3c00,0xbb64b9a8,0xb61fbc00,0x3b6439a8,0xb872bc00,0x3bd9361f,0x3aa70000,0x323e3b64
.long 0x39a83c00,0xb9a80000,0x39a83c00,0xb9a80000,0xbaa7bc00,0x323eb61f,0xb8728000,0xbbd9bb64
.long 0x3b643c00,0x361f39a8,0xbb64bc00,0xb61fb9a8,0xbbd9bc00,0xbaa7bb64,0x323e0000,0x3872361f
.long 0x3c003c00,0x3c003c00,0x3c003c00,0x3c003c00,0xb872b9a8,0xb23eb61f,0x3aa739a8,0x3bd93b64
.long 0xb61f0000,0xbb64b9a8,0x361f0000,0x3b6439a8,0x3bd939a8,0x38723b64,0xb23eb9a8,0x3aa7361f
.long 0xb9a8bc00,0x39a88000,0xb9a8bc00,0x39a88000,0xb23e39a8,0xbaa7bb64,0xbbd9b9a8,0x3872b61f
.long 0x3b648000,0xb61f39a8,0xbb640000,0x361fb9a8,0xbaa7b9a8,0x3bd9361f,0xb87239a8,0x323ebb64
.long 0x3c00,0x8000bc00,0x3c00,0x8000bc00,0x3aa7b9a8,0xbbd9361f,0x387239a8,0xb23ebb64
.long 0xbb640000,0x361f39a8,0x3b648000,0xb61fb9a8,0x323e39a8,0x3aa7bb64,0x3bd9b9a8,0xb872b61f
.long 0x39a8bc00,0xb9a80000,0x39a8bc00,0xb9a80000,0xbbd939a8,0xb8723b64,0x323eb9a8,0xbaa7361f
.long 0x361f8000,0x3b64b9a8,0xb61f0000,0xbb6439a8,0x3872b9a8,0x323eb61f,0xbaa739a8,0xbbd93b64
.long 0xbc003c00,0xbc003c00,0xbc003c00,0xbc003c00,0x3872b9a8,0x323eb61f,0xbaa739a8,0xbbd93b64
.long 0x361f0000,0x3b64b9a8,0xb61f0000,0xbb6439a8,0xbbd939a8,0xb8723b64,0x323eb9a8,0xbaa7361f
.long 0x39a8bc00,0xb9a88000,0x39a8bc00,0xb9a88000,0x323e39a8,0x3aa7bb64,0x3bd9b9a8,0xb872b61f
.long 0xbb640000,0x361f39a8,0x3b640000,0xb61fb9a8,0x3aa7b9a8,0xbbd9361f,0x387239a8,0xb23ebb64
.long 0x3c00,0xbc00,0x80003c00,0xbc00,0xbaa7b9a8,0x3bd9361f,0xb87239a8,0x323ebb64
.long 0x3b640000,0xb61f39a8,0xbb648000,0x361fb9a8,0xb23e39a8,0xbaa7bb64,0xbbd9b9a8,0x3872b61f
.long 0xb9a8bc00,0x39a80000,0xb9a8bc00,0x39a80000,0x3bd939a8,0x38723b64,0xb23eb9a8,0x3aa7361f
.long 0xb61f8000,0xbb64b9a8,0x361f8000,0x3b6439a8,0xb872b9a8,0xb23eb61f,0x3aa739a8,0x3bd93b64
.long 0x0,0x0,0x0,0x0,0x323e0000,0x3872361f,0x3bd93c00,0x3aa73b64
.long 0x361f0000,0x3b6439a8,0xb61f0000,0xbb64b9a8,0x38720000,0x3bd93b64,0xbaa7bc00,0x323eb61f
.long 0x39a80000,0x39a83c00,0x39a80000,0x39a83c00,0x3aa70000,0x323e3b64,0x38723c00,0xbbd9b61f
.long 0x3b640000,0xb61f39a8,0xbb640000,0x361fb9a8,0x3bd90000,0xbaa7361f,0xb23ebc00,0x38723b64
.long 0x3c000000,0xbc000000,0x3c000000,0xbc000000,0x3bd90000,0xbaa7b61f,0xb23e3c00,0x3872bb64
.long 0x3b640000,0xb61fb9a8,0xbb640000,0x361f39a8,0x3aa70000,0x323ebb64,0x3872bc00,0xbbd9361f
.long 0x39a80000,0x39a8bc00,0x39a80000,0x39a8bc00,0x38720000,0x3bd9bb64,0xbaa73c00,0x323e361f
.long 0x361f0000,0x3b64b9a8,0xb61f0000,0xbb6439a8,0x323e0000,0x3872b61f,0x3bd9bc00,0x3aa7bb64
.long 0x0,0x0,0x0,0x8000,0xb23e0000,0xb872361f,0xbbd93c00,0xbaa73b64
.long 0xb61f0000,0xbb6439a8,0x361f0000,0x3b64b9a8,0xb8720000,0xbbd93b64,0x3aa7bc00,0xb23eb61f
.long 0xb9a80000,0xb9a83c00,0xb9a88000,0xb9a83c00,0xbaa70000,0xb23e3b64,0xb8723c00,0x3bd9b61f
.long 0xbb640000,0x361f39a8,0x3b640000,0xb61fb9a8,0xbbd90000,0x3aa7361f,0x323ebc00,0xb8723b64
.long 0xbc000000,0x3c000000,0xbc008000,0x3c000000,0xbbd90000,0x3aa7b61f,0x323e3c00,0xb872bb64
.long 0xbb640000,0x361fb9a8,0x3b648000,0xb61f39a8,0xbaa70000,0xb23ebb64,0xb872bc00,0x3bd9361f
.long 0xb9a80000,0xb9a8bc00,0xb9a88000,0xb9a8bc00,0xb8720000,0xbbd9bb64,0x3aa73c00,0xb23e361f
.long 0xb61f0000,0xbb64b9a8,0x361f0000,0x3b6439a8,0xb23e0000,0xb872b61f,0xbbd9bc00,0xbaa7bb64
.long 0x0,0x0,0x0,0x0,0x3aa739a8,0x3bd93b64,0x387239a8,0x323e361f
.long 0x3b643c00,0x361f39a8,0xbb64bc00,0xb61fb9a8,0x323e39a8,0xbaa7b61f,0x3bd939a8,0x38723b64
.long 0xb9a80000,0xb9a8bc00,0xb9a80000,0xb9a8bc00,0xbbd9b9a8,0x3872b61f,0x323eb9a8,0x3aa73b64
.long 0xb61fbc00,0x3b6439a8,0x361f3c00,0xbb64b9a8,0x3872b9a8,0xb23e3b64,0xbaa7b9a8,0x3bd9361f
.long 0x3c000000,0xbc000000,0x3c000000,0xbc000000,0x387239a8,0xb23ebb64,0xbaa739a8,0x3bd9b61f
.long 0xb61f3c00,0x3b64b9a8,0x361fbc00,0xbb6439a8,0xbbd939a8,0x3872361f,0x323e39a8,0x3aa7bb64
.long 0xb9a80000,0xb9a83c00,0xb9a80000,0xb9a83c00,0x323eb9a8,0xbaa7361f,0x3bd9b9a8,0x3872bb64
.long 0x3b64bc00,0x361fb9a8,0xbb643c00,0xb61f39a8,0x3aa7b9a8,0x3bd9bb64,0x3872b9a8,0x323eb61f
.long 0x0,0x0,0x80008000,0x8000,0xbaa739a8,0xbbd93b64,0xb87239a8,0xb23e361f
.long 0xbb643c00,0xb61f39a8,0x3b64bc00,0x361fb9a8,0xb23e39a8,0x3aa7b61f,0xbbd939a8,0xb8723b64
.long 0x39a80000,0x39a8bc00,0x39a80000,0x39a8bc00,0x3bd9b9a8,0xb872b61f,0xb23eb9a8,0xbaa73b64
.long 0x361fbc00,0xbb6439a8,0xb61f3c00,0x3b64b9a8,0xb872b9a8,0x323e3b64,0x3aa7b9a8,0xbbd9361f
.long 0xbc000000,0x3c000000,0xbc008000,0x3c000000,0xb87239a8,0x323ebb64,0x3aa739a8,0xbbd9b61f
.long 0x361f3c00,0xbb64b9a8,0xb61fbc00,0x3b6439a8,0x3bd939a8,0xb872361f,0xb23e39a8,0xbaa7bb64
.long 0x39a80000,0x39a83c00,0x39a80000,0x39a83c00,0xb23eb9a8,0x3aa7361f,0xbbd9b9a8,0xb872bb64
.long 0xbb64bc00,0xb61fb9a8,0x3b643c00,0x361f39a8,0xbaa7b9a8,0xbbd9bb64,0xb872b9a8,0xb23eb61f
.long 0x0,0x0,0x0,0x0,0xb23e0000,0xb872b61f,0xbbd9bc00,0xbaa7bb64
.long 0x361f0000,0x3b6439a8,0xb61f0000,0xbb64b9a8,0xb8720000,0xbbd9bb64,0x3aa73c00,0xb23e361f
.long 0x39a80000,0x39a83c00,0x39a80000,0x39a83c00,0xbaa70000,0xb23ebb64,0xb872bc00,0x3bd9361f
.long 0x3b640000,0xb61f39a8,0xbb640000,0x361fb9a8,0xbbd90000,0x3aa7b61f,0x323e3c00,0xb872bb64
.long 0x3c000000,0xbc000000,0x3c008000,0xbc008000,0xbbd90000,0x3aa7361f,0x323ebc00,0xb8723b64
.long 0x3b648000,0xb61fb9a8,0xbb640000,0x361f39a8,0xbaa70000,0xb23e3b64,0xb8723c00,0x3bd9b61f
.long 0x39a88000,0x39a8bc00,0x39a88000,0x39a8bc00,0xb8728000,0xbbd93b64,0x3aa7bc00,0xb23eb61f
.long 0x361f8000,0x3b64b9a8,0xb61f0000,0xbb6439a8,0xb23e0000,0xb872361f,0xbbd93c00,0xbaa73b64
.long 0x80008000,0x8000,0x8000,0x0,0x323e8000,0x3872b61f,0x3bd9bc00,0x3aa7bb64
.long 0xb61f8000,0xbb6439a8,0x361f0000,0x3b64b9a8,0x38720000,0x3bd9bb64,0xbaa73c00,0x323e361f
.long 0xb9a88000,0xb9a83c00,0xb9a88000,0xb9a83c00,0x3aa70000,0x323ebb64,0x3872bc00,0xbbd9361f
.long 0xbb648000,0x361f39a8,0x3b640000,0xb61fb9a8,0x3bd90000,0xbaa7b61f,0xb23e3c00,0x3872bb64
.long 0xbc008000,0x3c000000,0xbc008000,0x3c008000,0x3bd90000,0xbaa7361f,0xb23ebc00,0x38723b64
.long 0xbb640000,0x361fb9a8,0x3b640000,0xb61f39a8,0x3aa70000,0x323e3b64,0x38723c00,0xbbd9b61f
.long 0xb9a88000,0xb9a8bc00,0xb9a80000,0xb9a8bc00,0x38720000,0x3bd93b64,0xbaa7bc00,0x323eb61f
.long 0xb61f8000,0xbb64b9a8,0x361f0000,0x3b6439a8,0x323e0000,0x3872361f,0x3bd93c00,0x3aa73b64
.long 0x0,0x0,0x0,0x0,0xbaa7b9a8,0xbbd9bb64,0xb872b9a8,0xb23eb61f
.long 0x3b643c00,0x361f39a8,0xbb64bc00,0xb61fb9a8,0xb23eb9a8,0x3aa7361f,0xbbd9b9a8,0xb872bb64
.long 0xb9a80000,0xb9a8bc00,0xb9a80000,0xb9a8bc00,0x3bd939a8,0xb872361f,0xb23e39a8,0xbaa7bb64
.long 0xb61fbc00,0x3b6439a8,0x361f3c00,0xbb64b9a8,0xb87239a8,0x323ebb64,0x3aa739a8,0xbbd9b61f
.long 0x3c008000,0xbc000000,0x3c008000,0xbc000000,0xb872b9a8,0x323e3b64,0x3aa7b9a8,0xbbd9361f
.long 0xb61f3c00,0x3b64b9a8,0x361fbc00,0xbb6439a8,0x3bd9b9a8,0xb872b61f,0xb23eb9a8,0xbaa73b64
.long 0xb9a80000,0xb9a83c00,0xb9a80000,0xb9a83c00,0xb23e39a8,0x3aa7b61f,0xbbd939a8,0xb8723b64
.long 0x3b64bc00,0x361fb9a8,0xbb643c00,0xb61f39a8,0xbaa739a8,0xbbd93b64,0xb87239a8,0xb23e361f
.long 0x8000,0x8000,0x8000,0x8000,0x3aa7b9a8,0x3bd9bb64,0x3872b9a8,0x323eb61f
.long 0xbb643c00,0xb61f39a8,0x3b64bc00,0x361fb9a8,0x323eb9a8,0xbaa7361f,0x3bd9b9a8,0x3872bb64
.long 0x39a80000,0x39a8bc00,0x39a80000,0x39a8bc00,0xbbd939a8,0x3872361f,0x323e39a8,0x3aa7bb64
.long 0x361fbc00,0xbb6439a8,0xb61f3c00,0x3b64b9a8,0x387239a8,0xb23ebb64,0xbaa739a8,0x3bd9b61f
.long 0xbc008000,0x3c000000,0xbc000000,0x3c000000,0x3872b9a8,0xb23e3b64,0xbaa7b9a8,0x3bd9361f
.long 0x361f3c00,0xbb64b9a8,0xb61fbc00,0x3b6439a8,0xbbd9b9a8,0x3872b61f,0x323eb9a8,0x3aa73b64
.long 0x39a80000,0x39a83c00,0x39a80000,0x39a83c00,0x323e39a8,0xbaa7b61f,0x3bd939a8,0x38723b64
.long 0xbb64bc00,0xb61fb9a8,0x3b643c00,0x361f39a8,0x3aa739a8,0x3bd93b64,0x387239a8,0x323e361f
.long 0x80008000,0x80008000,0x80008000,0x80008000,0xb23e8000,0xb872b61f,0xbbd9bc00,0xbaa7bb64
.long 0xb61f8000,0xbb64b9a8,0x361f8000,0x3b6439a8,0xb8728000,0xbbd9bb64,0x3aa73c00,0xb23e361f
.long 0xb9a88000,0xb9a8bc00,0xb9a88000,0xb9a8bc00,0xbaa78000,0xb23ebb64,0xb872bc00,0x3bd9361f
.long 0xbb648000,0x361fb9a8,0x3b648000,0xb61f39a8,0xbbd98000,0x3aa7b61f,0x323e3c00,0xb872bb64
.long 0xbc008000,0x3c008000,0xbc008000,0x3c008000,0xbbd98000,0x3aa7361f,0x323ebc00,0xb8723b64
.long 0xbb648000,0x361f39a8,0x3b648000,0xb61fb9a8,0xbaa78000,0xb23e3b64,0xb8723c00,0x3bd9b61f
.long 0xb9a88000,0xb9a83c00,0xb9a88000,0xb9a83c00,0xb8728000,0xbbd93b64,0x3aa7bc00,0xb23eb61f
.long 0xb61f8000,0xbb6439a8,0x361f8000,0x3b64b9a8,0xb23e8000,0xb872361f,0xbbd93c00,0xbaa73b64
.long 0x80008000,0x80008000,0x80008000,0x80000000,0x323e8000,0x3872b61f,0x3bd9bc00,0x3aa7bb64
.long 0x361f8000,0x3b64b9a8,0xb61f8000,0xbb6439a8,0x38728000,0x3bd9bb64,0xbaa73c00,0x323e361f
.long 0x39a88000,0x39a8bc00,0x39a80000,0x39a8bc00,0x3aa78000,0x323ebb64,0x3872bc00,0xbbd9361f
.long 0x3b648000,0xb61fb9a8,0xbb648000,0x361f39a8,0x3bd98000,0xbaa7b61f,0xb23e3c00,0x3872bb64
.long 0x3c008000,0xbc008000,0x3c000000,0xbc008000,0x3bd98000,0xbaa7361f,0xb23ebc00,0x38723b64
.long 0x3b648000,0xb61f39a8,0xbb640000,0x361fb9a8,0x3aa78000,0x323e3b64,0x38723c00,0xbbd9b61f
.long 0x39a88000,0x39a83c00,0x39a80000,0x39a83c00,0x38728000,0x3bd93b64,0xbaa7bc00,0x323eb61f
.long 0x361f8000,0x3b6439a8,0xb61f8000,0xbb64b9a8,0x323e8000,0x3872361f,0x3bd93c00,0x3aa73b64
.long 0x80008000,0x80008000,0x80008000,0x80008000,0xbaa7b9a8,0xbbd9bb64,0xb872b9a8,0xb23eb61f
.long 0xbb64bc00,0xb61fb9a8,0x3b643c00,0x361f39a8,0xb23eb9a8,0x3aa7361f,0xbbd9b9a8,0xb872bb64
.long 0x39a88000,0x39a83c00,0x39a88000,0x39a83c00,0x3bd939a8,0xb872361f,0xb23e39a8,0xbaa7bb64
.long 0x361f3c00,0xbb64b9a8,0xb61fbc00,0x3b6439a8,0xb87239a8,0x323ebb64,0x3aa739a8,0xbbd9b61f
.long 0xbc008000,0x3c008000,0xbc008000,0x3c008000,0xb872b9a8,0x323e3b64,0x3aa7b9a8,0xbbd9361f
.long 0x361fbc00,0xbb6439a8,0xb61f3c00,0x3b64b9a8,0x3bd9b9a8,0xb872b61f,0xb23eb9a8,0xbaa73b64
.long 0x39a88000,0x39a8bc00,0x39a88000,0x39a8bc00,0xb23e39a8,0x3aa7b61f,0xbbd939a8,0xb8723b64
.long 0xbb643c00,0xb61f39a8,0x3b64bc00,0x361fb9a8,0xbaa739a8,0xbbd93b64,0xb87239a8,0xb23e361f
.long 0x80008000,0x80008000,0x0,0x80000000,0x3aa7b9a8,0x3bd9bb64,0x3872b9a8,0x323eb61f
.long 0x3b64bc00,0x361fb9a8,0xbb643c00,0xb61f39a8,0x323eb9a8,0xbaa7361f,0x3bd9b9a8,0x3872bb64
.long 0xb9a88000,0xb9a83c00,0xb9a88000,0xb9a83c00,0xbbd939a8,0x3872361f,0x323e39a8,0x3aa7bb64
.long 0xb61f3c00,0x3b64b9a8,0x361fbc00,0xbb6439a8,0x387239a8,0xb23ebb64,0xbaa739a8,0x3bd9b61f
.long 0x3c008000,0xbc008000,0x3c000000,0xbc008000,0x3872b9a8,0xb23e3b64,0xbaa7b9a8,0x3bd9361f
.long 0xb61fbc00,0x3b6439a8,0x361f3c00,0xbb64b9a8,0xbbd9b9a8,0x3872b61f,0x323eb9a8,0x3aa73b64
.long 0xb9a88000,0xb9a8bc00,0xb9a88000,0xb9a8bc00,0x323e39a8,0xbaa7b61f,0x3bd939a8,0x38723b64
.long 0x3b643c00,0x361f39a8,0xbb64bc00,0xb61fb9a8,0x3aa739a8,0x3bd93b64,0x387239a8,0x323e361f
.long 0x80008000,0x80008000,0x80008000,0x80008000,0x323e8000,0x3872361f,0x3bd93c00,0x3aa73b64
.long 0xb61f8000,0xbb64b9a8,0x361f8000,0x3b6439a8,0x38728000,0x3bd93b64,0xbaa7bc00,0x323eb61f
.long 0xb9a88000,0xb9a8bc00,0xb9a88000,0xb9a8bc00,0x3aa78000,0x323e3b64,0x38723c00,0xbbd9b61f
.long 0xbb648000,0x361fb9a8,0x3b648000,0xb61f39a8,0x3bd98000,0xbaa7361f,0xb23ebc00,0x38723b64
.long 0xbc008000,0x3c008000,0xbc000000,0x3c000000,0x3bd98000,0xbaa7b61f,0xb23e3c00,0x3872bb64
.long 0xbb640000,0x361f39a8,0x3b648000,0xb61fb9a8,0x3aa78000,0x323ebb64,0x3872bc00,0xbbd9361f
.long 0xb9a80000,0xb9a83c00,0xb9a80000,0xb9a83c00,0x38720000,0x3bd9bb64,0xbaa73c00,0x323e361f
.long 0xb61f0000,0xbb6439a8,0x361f8000,0x3b64b9a8,0x323e8000,0x3872b61f,0x3bd9bc00,0x3aa7bb64
.long 0x0,0x80000000,0x80000000,0x80008000,0xb23e0000,0xb872361f,0xbbd93c00,0xbaa73b64
.long 0x361f0000,0x3b64b9a8,0xb61f8000,0xbb6439a8,0xb8728000,0xbbd93b64,0x3aa7bc00,0xb23eb61f
.long 0x39a80000,0x39a8bc00,0x39a80000,0x39a8bc00,0xbaa78000,0xb23e3b64,0xb8723c00,0x3bd9b61f
.long 0x3b640000,0xb61fb9a8,0xbb648000,0x361f39a8,0xbbd98000,0x3aa7361f,0x323ebc00,0xb8723b64
.long 0x3c000000,0xbc008000,0x3c000000,0xbc000000,0xbbd98000,0x3aa7b61f,0x323e3c00,0xb872bb64
.long 0x3b648000,0xb61f39a8,0xbb648000,0x361fb9a8,0xbaa78000,0xb23ebb64,0xb872bc00,0x3bd9361f
.long 0x39a80000,0x39a83c00,0x39a88000,0x39a83c00,0xb8728000,0xbbd9bb64,0x3aa73c00,0xb23e361f
.long 0x361f0000,0x3b6439a8,0xb61f8000,0xbb64b9a8,0xb23e8000,0xb872b61f,0xbbd9bc00,0xbaa7bb64
.long 0x80008000,0x80008000,0x80008000,0x80008000,0x3aa739a8,0x3bd93b64,0x387239a8,0x323e361f
.long 0xbb64bc00,0xb61fb9a8,0x3b643c00,0x361f39a8,0x323e39a8,0xbaa7b61f,0x3bd939a8,0x38723b64
.long 0x39a88000,0x39a83c00,0x39a88000,0x39a83c00,0xbbd9b9a8,0x3872b61f,0x323eb9a8,0x3aa73b64
.long 0x361f3c00,0xbb64b9a8,0xb61fbc00,0x3b6439a8,0x3872b9a8,0xb23e3b64,0xbaa7b9a8,0x3bd9361f
.long 0xbc000000,0x3c008000,0xbc000000,0x3c008000,0x387239a8,0xb23ebb64,0xbaa739a8,0x3bd9b61f
.long 0x361fbc00,0xbb6439a8,0xb61f3c00,0x3b64b9a8,0xbbd939a8,0x3872361f,0x323e39a8,0x3aa7bb64
.long 0x39a88000,0x39a8bc00,0x39a88000,0x39a8bc00,0x323eb9a8,0xbaa7361f,0x3bd9b9a8,0x3872bb64
.long 0xbb643c00,0xb61f39a8,0x3b64bc00,0x361fb9a8,0x3aa7b9a8,0x3bd9bb64,0x3872b9a8,0x323eb61f
.long 0x80000000,0x80000000,0x80000000,0x80000000,0xbaa739a8,0xbbd93b64,0xb87239a8,0xb23e361f
.long 0x3b64bc00,0x361fb9a8,0xbb643c00,0xb61f39a8,0xb23e39a8,0x3aa7b61f,0xbbd939a8,0xb8723b64
.long 0xb9a88000,0xb9a83c00,0xb9a88000,0xb9a83c00,0x3bd9b9a8,0xb872b61f,0xb23eb9a8,0xbaa73b64
.long 0xb61f3c00,0x3b64b9a8,0x361fbc00,0xbb6439a8,0xb872b9a8,0x323e3b64,0x3aa7b9a8,0xbbd9361f
.long 0x3c000000,0xbc008000,0x3c008000,0xbc008000,0xb87239a8,0x323ebb64,0x3aa739a8,0xbbd9b61f
.long 0xb61fbc00,0x3b6439a8,0x361f3c00,0xbb64b9a8,0x3bd939a8,0xb872361f,0xb23e39a8,0xbaa7bb64
.long 0xb9a88000,0xb9a8bc00,0xb9a88000,0xb9a8bc00,0xb23eb9a8,0x3aa7361f,0xbbd9b9a8,0xb872bb64
.long 0x3b643c00,0x361f39a8,0xbb64bc00,0xb61fb9a8,0xbaa7b9a8,0xbbd9bb64,0xb872b9a8,0xb23eb61f
.long 0x3c003c00,0x3c003c00,0x3c003c00,0x3c003c00,0x3bd93c00,0x3aa73b64,0xb23e0000,0xb872b61f
.long 0x3b643c00,0x361f39a8,0xbb64bc00,0xb61fb9a8,0x3aa73c00,0xb23e361f,0x38720000,0x3bd93b64
.long 0x39a83c00,0xb9a80000,0x39a83c00,0xb9a80000,0x38723c00,0xbbd9b61f,0xbaa70000,0xb23ebb64
.long 0x361f3c00,0xbb64b9a8,0xb61fbc00,0x3b6439a8,0x323e3c00,0xb872bb64,0x3bd90000,0xbaa7361f
.long 0x3c00,0xbc00,0x3c00,0x8000bc00,0xb23e3c00,0x3872bb64,0xbbd90000,0x3aa7361f
.long 0xb61f3c00,0x3b64b9a8,0x361fbc00,0xbb6439a8,0xb8723c00,0x3bd9b61f,0x3aa78000,0x323ebb64
.long 0xb9a83c00,0x39a80000,0xb9a83c00,0x39a88000,0xbaa73c00,0x323e361f,0xb8720000,0xbbd93b64
.long 0xbb643c00,0xb61f39a8,0x3b64bc00,0x361fb9a8,0xbbd93c00,0xbaa73b64,0x323e8000,0x3872b61f
.long 0xbc003c00,0xbc003c00,0xbc003c00,0xbc003c00,0xbbd93c00,0xbaa73b64,0x323e0000,0x3872b61f
.long 0xbb643c00,0xb61f39a8,0x3b64bc00,0x361fb9a8,0xbaa73c00,0x323e361f,0xb8728000,0xbbd93b64
.long 0xb9a83c00,0x39a80000,0xb9a83c00,0x39a80000,0xb8723c00,0x3bd9b61f,0x3aa70000,0x323ebb64
.long 0xb61f3c00,0x3b64b9a8,0x361fbc00,0xbb6439a8,0xb23e3c00,0x3872bb64,0xbbd98000,0x3aa7361f
.long 0x3c00,0xbc00,0x80003c00,0xbc00,0x323e3c00,0xb872bb64,0x3bd90000,0xbaa7361f
.long 0x361f3c00,0xbb64b9a8,0xb61fbc00,0x3b6439a8,0x38723c00,0xbbd9b61f,0xbaa78000,0xb23ebb64
.long 0x39a83c00,0xb9a80000,0x39a83c00,0xb9a88000,0x3aa73c00,0xb23e361f,0x38720000,0x3bd93b64
.long 0x3b643c00,0x361f39a8,0xbb64bc00,0xb61fb9a8,0x3bd93c00,0x3aa73b64,0xb23e8000,0xb872b61f
.long 0x3c003c00,0x3c003c00,0x3c003c00,0x3c003c00,0x387239a8,0x323e361f,0xbaa7b9a8,0xbbd9bb64
.long 0xb61f0000,0xbb64b9a8,0x361f0000,0x3b6439a8,0xbbd9b9a8,0xb872bb64,0x323e39a8,0xbaa7b61f
.long 0xb9a8bc00,0x39a80000,0xb9a8bc00,0x39a80000,0x323eb9a8,0x3aa73b64,0x3bd939a8,0xb872361f
.long 0x3b640000,0xb61f39a8,0xbb640000,0x361fb9a8,0x3aa739a8,0xbbd9b61f,0x3872b9a8,0xb23e3b64
.long 0x3c00,0xbc00,0x3c00,0x8000bc00,0xbaa739a8,0x3bd9b61f,0xb872b9a8,0x323e3b64
.long 0xbb640000,0x361f39a8,0x3b648000,0xb61fb9a8,0xb23eb9a8,0xbaa73b64,0xbbd939a8,0x3872361f
.long 0x39a8bc00,0xb9a80000,0x39a8bc00,0xb9a80000,0x3bd9b9a8,0x3872bb64,0xb23e39a8,0x3aa7b61f
.long 0x361f0000,0x3b64b9a8,0xb61f0000,0xbb6439a8,0xb87239a8,0xb23e361f,0x3aa7b9a8,0x3bd9bb64
.long 0xbc003c00,0xbc003c00,0xbc003c00,0xbc003c00,0xb87239a8,0xb23e361f,0x3aa7b9a8,0x3bd9bb64
.long 0x361f0000,0x3b64b9a8,0xb61f8000,0xbb6439a8,0x3bd9b9a8,0x3872bb64,0xb23e39a8,0x3aa7b61f
.long 0x39a8bc00,0xb9a88000,0x39a8bc00,0xb9a88000,0xb23eb9a8,0xbaa73b64,0xbbd939a8,0x3872361f
.long 0xbb648000,0x361f39a8,0x3b640000,0xb61fb9a8,0xbaa739a8,0x3bd9b61f,0xb872b9a8,0x323e3b64
.long 0x80003c00,0xbc00,0x3c00,0xbc00,0x3aa739a8,0xbbd9b61f,0x3872b9a8,0xb23e3b64
.long 0x3b640000,0xb61f39a8,0xbb648000,0x361fb9a8,0x323eb9a8,0x3aa73b64,0x3bd939a8,0xb872361f
.long 0xb9a8bc00,0x39a80000,0xb9a8bc00,0x39a80000,0xbbd9b9a8,0xb872bb64,0x323e39a8,0xbaa7b61f
.long 0xb61f8000,0xbb64b9a8,0x361f0000,0x3b6439a8,0x387239a8,0x323e361f,0xbaa7b9a8,0xbbd9bb64
.long 0x3c003c00,0x3c003c00,0x3c003c00,0x3c003c00,0xbbd9bc00,0xbaa7bb64,0x323e0000,0x3872361f
.long 0x3b643c00,0x361f39a8,0xbb64bc00,0xb61fb9a8,0xbaa7bc00,0x323eb61f,0xb8720000,0xbbd9bb64
.long 0x39a83c00,0xb9a80000,0x39a83c00,0xb9a80000,0xb872bc00,0x3bd9361f,0x3aa78000,0x323e3b64
.long 0x361f3c00,0xbb64b9a8,0xb61fbc00,0x3b6439a8,0xb23ebc00,0x38723b64,0xbbd90000,0x3aa7b61f
.long 0x3c00,0x8000bc00,0x3c00,0x8000bc00,0x323ebc00,0xb8723b64,0x3bd98000,0xbaa7b61f
.long 0xb61f3c00,0x3b64b9a8,0x361fbc00,0xbb6439a8,0x3872bc00,0xbbd9361f,0xbaa70000,0xb23e3b64
.long 0xb9a83c00,0x39a88000,0xb9a83c00,0x39a80000,0x3aa7bc00,0xb23eb61f,0x38728000,0x3bd9bb64
.long 0xbb643c00,0xb61f39a8,0x3b64bc00,0x361fb9a8,0x3bd9bc00,0x3aa7bb64,0xb23e0000,0xb872361f
.long 0xbc003c00,0xbc003c00,0xbc003c00,0xbc003c00,0x3bd9bc00,0x3aa7bb64,0xb23e8000,0xb872361f
.long 0xbb643c00,0xb61f39a8,0x3b64bc00,0x361fb9a8,0x3aa7bc00,0xb23eb61f,0x38720000,0x3bd9bb64
.long 0xb9a83c00,0x39a80000,0xb9a83c00,0x39a88000,0x3872bc00,0xbbd9361f,0xbaa70000,0xb23e3b64
.long 0xb61f3c00,0x3b64b9a8,0x361fbc00,0xbb6439a8,0x323ebc00,0xb8723b64,0x3bd90000,0xbaa7b61f
.long 0x3c00,0xbc00,0x80003c00,0xbc00,0xb23ebc00,0x38723b64,0xbbd98000,0x3aa7b61f
.long 0x361f3c00,0xbb64b9a8,0xb61fbc00,0x3b6439a8,0xb872bc00,0x3bd9361f,0x3aa70000,0x323e3b64
.long 0x39a83c00,0xb9a80000,0x39a83c00,0xb9a80000,0xbaa7bc00,0x323eb61f,0xb8728000,0xbbd9bb64
.long 0x3b643c00,0x361f39a8,0xbb64bc00,0xb61fb9a8,0xbbd9bc00,0xbaa7bb64,0x323e0000,0x3872361f
.long 0x3c003c00,0x3c003c00,0x3c003c00,0x3c003c00,0xb872b9a8,0xb23eb61f,0x3aa739a8,0x3bd93b64
.long 0xb61f0000,0xbb64b9a8,0x361f0000,0x3b6439a8,0x3bd939a8,0x38723b64,0xb23eb9a8,0x3aa7361f
.long 0xb9a8bc00,0x39a88000,0xb9a8bc00,0x39a88000,0xb23e39a8,0xbaa7bb64,0xbbd9b9a8,0x3872b61f
.long 0x3b648000,0xb61f39a8,0xbb640000,0x361fb9a8,0xbaa7b9a8,0x3bd9361f,0xb87239a8,0x323ebb64
.long 0x3c00,0x8000bc00,0x3c00,0x8000bc00,0x3aa7b9a8,0xbbd9361f,0x387239a8,0xb23ebb64
.long 0xbb640000,0x361f39a8,0x3b648000,0xb61fb9a8,0x323e39a8,0x3aa7bb64,0x3bd9b9a8,0xb872b61f
.long 0x39a8bc00,0xb9a80000,0x39a8bc00,0xb9a80000,0xbbd939a8,0xb8723b64,0x323eb9a8,0xbaa7361f
.long 0x361f8000,0x3b64b9a8,0xb61f0000,0xbb6439a8,0x3872b9a8,0x323eb61f,0xbaa739a8,0xbbd93b64
.long 0xbc003c00,0xbc003c00,0xbc003c00,0xbc003c00,0x3872b9a8,0x323eb61f,0xbaa739a8,0xbbd93b64
.long 0x361f0000,0x3b64b9a8,0xb61f0000,0xbb6439a8,0xbbd939a8,0xb8723b64,0x323eb9a8,0xbaa7361f
.long 0x39a8bc00,0xb9a88000,0x39a8bc00,0xb9a88000,0x323e39a8,0x3aa7bb64,0x3bd9b9a8,0xb872b61f
.long 0xbb640000,0x361f39a8,0x3b640000,0xb61fb9a8,0x3aa7b9a8,0xbbd9361f,0x387239a8,0xb23ebb64
.long 0x3c00,0xbc00,0x80003c00,0xbc00,0xbaa7b9a8,0x3bd9361f,0xb87239a8,0x323ebb64
.long 0x3b640000,0xb61f39a8,0xbb648000,0x361fb9a8,0xb23e39a8,0xbaa7bb64,0xbbd9b9a8,0x3872b61f
.long 0xb9a8bc00,0x39a80000,0xb9a8bc00,0x39a80000,0x3bd939a8,0x38723b64,0xb23eb9a8,0x3aa7361f
.long 0xb61f8000,0xbb64b9a8,0x361f8000,0x3b6439a8,0xb872b9a8,0xb23eb61f,0x3aa739a8,0x3bd93b64
.long 0x0,0x0,0x0,0x0,0x323e0000,0x3872361f,0x3bd93c00,0x3aa73b64
.long 0x361f0000,0x3b6439a8,0xb61f0000,0xbb64b9a8,0x38720000,0x3bd93b64,0xbaa7bc00,0x323eb61f
.long 0x39a80000,0x39a83c00,0x39a80000,0x39a83c00,0x3aa70000,0x323e3b64,0x38723c00,0xbbd9b61f
.long 0x3b640000,0xb61f39a8,0xbb640000,0x361fb9a8,0x3bd90000,0xbaa7361f,0xb23ebc00,0x38723b64
.long 0x3c000000,0xbc000000,0x3c000000,0xbc000000,0x3bd90000,0xbaa7b61f,0xb23e3c00,0x3872bb64
.long 0x3b640000,0xb61fb9a8,0xbb640000,0x361f39a8,0x3aa70000,0x323ebb64,0x3872bc00,0xbbd9361f
.long 0x39a80000,0x39a8bc00,0x39a80000,0x39a8bc00,0x38720000,0x3bd9bb64,0xbaa73c00,0x323e361f
.long 0x361f0000,0x3b64b9a8,0xb61f0000,0xbb6439a8,0x323e0000,0x3872b61f,0x3bd9bc00,0x3aa7bb64
.long 0x0,0x0,0x0,0x8000,0xb23e0000,0xb872361f,0xbbd93c00,0xbaa73b64
.long 0xb61f0000,0xbb6439a8,0x361f0000,0x3b64b9a8,0xb8720000,0xbbd93b64,0x3aa7bc00,0xb23eb61f
.long 0xb9a80000,0xb9a83c00,0xb9a88000,0xb9a83c00,0xbaa70000,0xb23e3b64,0xb8723c00,0x3bd9b61f
.long 0xbb640000,0x361f39a8,0x3b640000,0xb61fb9a8,0xbbd90000,0x3aa7361f,0x323ebc00,0xb8723b64
.long 0xbc000000,0x3c000000,0xbc008000,0x3c000000,0xbbd90000,0x3aa7b61f,0x323e3c00,0xb872bb64
.long 0xbb640000,0x361fb9a8,0x3b648000,0xb61f39a8,0xbaa70000,0xb23ebb64,0xb872bc00,0x3bd9361f
.long 0xb9a80000,0xb9a8bc00,0xb9a88000,0xb9a8bc00,0xb8720000,0xbbd9bb64,0x3aa73c00,0xb23e361f
.long 0xb61f0000,0xbb64b9a8,0x361f0000,0x3b6439a8,0xb23e0000,0xb872b61f,0xbbd9bc00,0xbaa7bb64
.long 0x0,0x0,0x0,0x0,0x3aa739a8,0x3bd93b64,0x387239a8,0x323e361f
.long 0x3b643c00,0x361f39a8,0xbb64bc00,0xb61fb9a8,0x323e39a8,0xbaa7b61f,0x3bd939a8,0x38723b64
.long 0xb9a80000,0xb9a8bc00,0xb9a80000,0xb9a8bc00,0xbbd9b9a8,0x3872b61f,0x323eb9a8,0x3aa73b64
.long 0xb61fbc00,0x3b6439a8,0x361f3c00,0xbb64b9a8,0x3872b9a8,0xb23e3b64,0xbaa7b9a8,0x3bd9361f
.long 0x3c000000,0xbc000000,0x3c000000,0xbc000000,0x387239a8,0xb23ebb64,0xbaa739a8,0x3bd9b61f
.long 0xb61f3c00,0x3b64b9a8,0x361fbc00,0xbb6439a8,0xbbd939a8,0x3872361f,0x323e39a8,0x3aa7bb64
.long 0xb9a80000,0xb9a83c00,0xb9a80000,0xb9a83c00,0x323eb9a8,0xbaa7361f,0x3bd9b9a8,0x3872bb64
.long 0x3b64bc00,0x361fb9a8,0xbb643c00,0xb61f39a8,0x3aa7b9a8,0x3bd9bb64,0x3872b9a8,0x323eb61f
.long 0x0,0x0,0x80008000,0x8000,0xbaa739a8,0xbbd93b64,0xb87239a8,0xb23e361f
.long 0xbb643c00,0xb61f39a8,0x3b64bc00,0x361fb9a8,0xb23e39a8,0x3aa7b61f,0xbbd939a8,0xb8723b64
.long 0x39a80000,0x39a8bc00,0x39a80000,0x39a8bc00,0x3bd9b9a8,0xb872b61f,0xb23eb9a8,0xbaa73b64
.long 0x361fbc00,0xbb6439a8,0xb61f3c00,0x3b64b9a8,0xb872b9a8,0x323e3b64,0x3aa7b9a8,0xbbd9361f
.long 0xbc000000,0x3c000000,0xbc008000,0x3c000000,0xb87239a8,0x323ebb64,0x3aa739a8,0xbbd9b61f
.long 0x361f3c00,0xbb64b9a8,0xb61fbc00,0x3b6439a8,0x3bd939a8,0xb872361f,0xb23e39a8,0xbaa7bb64
.long 0x39a80000,0x39a83c00,0x39a80000,0x39a83c00,0xb23eb9a8,0x3aa7361f,0xbbd9b9a8,0xb872bb64
.long 0xbb64bc00,0xb61fb9a8,0x3b643c00,0x361f39a8,0xbaa7b9a8,0xbbd9bb64,0xb872b9a8,0xb23eb61f
.long 0x0,0x0,0x0,0x0,0xb23e0000,0xb872b61f,0xbbd9bc00,0xbaa7bb64
.long 0x361f0000,0x3b6439a8,0xb61f0000,0xbb64b9a8,0xb8720000,0xbbd9bb64,0x3aa73c00,0xb23e361f
.long 0x39a80000,0x39a83c00,0x39a80000,0x39a83c00,0xbaa70000,0xb23ebb64,0xb872bc00,0x3bd9361f
.long 0x3b640000,0xb61f39a8,0xbb640000,0x361fb9a8,0xbbd90000,0x3aa7b61f,0x323e3c00,0xb872bb64
.long 0x3c000000,0xbc000000,0x3c008000,0xbc008000,0xbbd90000,0x3aa7361f,0x323ebc00,0xb8723b64
.long 0x3b648000,0xb61fb9a8,0xbb640000,0x361f39a8,0xbaa70000,0xb23e3b64,0xb8723c00,0x3bd9b61f
.long 0x39a88000,0x39a8bc00,0x39a88000,0x39a8bc00,0xb8728000,0xbbd93b64,0x3aa7bc00,0xb23eb61f
.long 0x361f8000,0x3b64b9a8,0xb61f0000,0xbb6439a8,0xb23e0000,0xb872361f,0xbbd93c00,0xbaa73b64
.long 0x80008000,0x8000,0x8000,0x0,0x323e8000,0x3872b61f,0x3bd9bc00,0x3aa7bb64
.long 0xb61f8000,0xbb6439a8,0x361f0000,0x3b64b9a8,0x38720000,0x3bd9bb64,0xbaa73c00,0x323e361f
.long 0xb9a88000,0xb9a83c00,0xb9a88000,0xb9a83c00,0x3aa70000,0x323ebb64,0x3872bc00,0xbbd9361f
.long 0xbb648000,0x361f39a8,0x3b640000,0xb61fb9a8,0x3bd90000,0xbaa7b61f,0xb23e3c00,0x3872bb64
.long 0xbc008000,0x3c000000,0xbc008000,0x3c008000,0x3bd90000,0xbaa7361f,0xb23ebc00,0x38723b64
.long 0xbb640000,0x361fb9a8,0x3b640000,0xb61f39a8,0x3aa70000,0x323e3b64,0x38723c00,0xbbd9b61f
.long 0xb9a88000,0xb9a8bc00,0xb9a80000,0xb9a8bc00,0x38720000,0x3bd93b64,0xbaa7bc00,0x323eb61f
.long 0xb61f8000,0xbb64b9a8,0x361f0000,0x3b6439a8,0x323e0000,0x3872361f,0x3bd93c00,0x3aa73b64
.long 0x0,0x0,0x0,0x0,0xbaa7b9a8,0xbbd9bb64,0xb872b9a8,0xb23eb61f
.long 0x3b643c00,0x361f39a8,0xbb64bc00,0xb61fb9a8,0xb23eb9a8,0x3aa7361f,0xbbd9b9a8,0xb872bb64
.long 0xb9a80000,0xb9a8bc00,0xb9a80000,0xb9a8bc00,0x3bd939a8,0xb872361f,0xb23e39a8,0xbaa7bb64
.long 0xb61fbc00,0x3b6439a8,0x361f3c00,0xbb64b9a8,0xb87239a8,0x323ebb64,0x3aa739a8,0xbbd9b61f
.long 0x3c008000,0xbc000000,0x3c008000,0xbc000000,0xb872b9a8,0x323e3b64,0x3aa7b9a8,0xbbd9361f
.long 0xb61f3c00,0x3b64b9a8,0x361fbc00,0xbb6439a8,0x3bd9b9a8,0xb872b61f,0xb23eb9a8,0xbaa73b64
.long 0xb9a80000,0xb9a83c00,0xb9a80000,0xb9a83c00,0xb23e39a8,0x3aa7b61f,0xbbd939a8,0xb8723b64
.long 0x3b64bc00,0x361fb9a8,0xbb643c00,0xb61f39a8,0xbaa739a8,0xbbd93b64,0xb87239a8,0xb23e361f
.long 0x8000,0x8000,0x8000,0x8000,0x3aa7b9a8,0x3bd9bb64,0x3872b9a8,0x323eb61f
.long 0xbb643c00,0xb61f39a8,0x3b64bc00,0x361fb9a8,0x323eb9a8,0xbaa7361f,0x3bd9b9a8,0x3872bb64
.long 0x39a80000,0x39a8bc00,0x39a80000,0x39a8bc00,0xbbd939a8,0x3872361f,0x323e39a8,0x3aa7bb64
.long 0x361fbc00,0xbb6439a8,0xb61f3c00,0x3b64b9a8,0x387239a8,0xb23ebb64,0xbaa739a8,0x3bd9b61f
.long 0xbc008000,0x3c000000,0xbc000000,0x3c000000,0x3872b9a8,0xb23e3b64,0xbaa7b9a8,0x3bd9361f
.long 0x361f3c00,0xbb64b9a8,0xb61fbc00,0x3b6439a8,0xbbd9b9a8,0x3872b61f,0x323eb9a8,0x3aa73b64
.long 0x39a80000,0x39a83c00,0x39a80000,0x39a83c00,0x323e39a8,0xbaa7b61f,0x3bd939a8,0x38723b64
.long 0xbb64bc00,0xb61fb9a8,0x3b643c00,0x361f39a8,0x3aa739a8,0x3bd93b64,0x387239a8,0x323e361f
.long 0x80008000,0x80008000,0x80008000,0x80008000,0xb23e8000,0xb872b61f,0xbbd9bc00,0xbaa7bb64
.long 0xb61f8000,0xbb64b9a8,0x361f8000,0x3b6439a8,0xb8728000,0xbbd9bb64,0x3aa73c00,0xb23e361f
.long 0xb9a88000,0xb9a8bc00,0xb9a88000,0xb9a8bc00,0xbaa78000,0xb23ebb64,0xb872bc00,0x3bd9361f
.long 0xbb648000,0x361fb9a8,0x3b648000,0xb61f39a8,0xbbd98000,0x3aa7b61f,0x323e3c00,0xb872bb64
.long 0xbc008000,0x3c008000,0xbc008000,0x3c008000,0xbbd98000,0x3aa7361f,0x323ebc00,0xb8723b64
.long 0xbb648000,0x361f39a8,0x3b648000,0xb61fb9a8,0xbaa78000,0xb23e3b64,0xb8723c00,0x3bd9b61f
.long 0xb9a88000,0xb9a83c00,0xb9a88000,0xb9a83c00,0xb8728000,0xbbd93b64,0x3aa7bc00,0xb23eb61f
.long 0xb61f8000,0xbb6439a8,0x361f8000,0x3b64b9a8,0xb23e8000,0xb872361f,0xbbd93c00,0xbaa73b64
.long 0x80008000,0x80008000,0x80008000,0x80000000,0x323e8000,0x3872b61f,0x3bd9bc00,0x3aa7bb64
.long 0x361f8000,0x3b64b9a8,0xb61f8000,0xbb6439a8,0x38728000,0x3bd9bb64,0xbaa73c00,0x323e361f
.long 0x39a88000,0x39a8bc00,0x39a80000,0x39a8bc00,0x3aa78000,0x323ebb64,0x3872bc00,0xbbd9361f
.long 0x3b648000,0xb61fb9a8,0xbb648000,0x361f39a8,0x3bd98000,0xbaa7b61f,0xb23e3c00,0x3872bb64
.long 0x3c008000,0xbc008000,0x3c000000,0xbc008000,0x3bd98000,0xbaa7361f,0xb23ebc00,0x38723b64
.long 0x3b648000,0xb61f39a8,0xbb640000,0x361fb9a8,0x3aa78000,0x323e3b64,0x38723c00,0xbbd9b61f
.long 0x39a88000,0x39a83c00,0x39a80000,0x39a83c00,0x38728000,0x3bd93b64,0xbaa7bc00,0x323eb61f
.long 0x361f8000,0x3b6439a8,0xb61f8000,0xbb64b9a8,0x323e8000,0x3872361f,0x3bd93c00,0x3aa73b64
.long 0x80008000,0x80008000,0x80008000,0x80008000,0xbaa7b9a8,0xbbd9bb64,0xb872b9a8,0xb23eb61f
.long 0xbb64bc00,0xb61fb9a8,0x3b643c00,0x361f39a8,0xb23eb9a8,0x3aa7361f,0xbbd9b9a8,0xb872bb64
.long 0x39a88000,0x39a83c00,0x39a88000,0x39a83c00,0x3bd939a8,0xb872361f,0xb23e39a8,0xbaa7bb64
.long 0x361f3c00,0xbb64b9a8,0xb61fbc00,0x3b6439a8,0xb87239a8,0x323ebb64,0x3aa739a8,0xbbd9b61f
.long 0xbc008000,0x3c008000,0xbc008000,0x3c008000,0xb872b9a8,0x323e3b64,0x3aa7b9a8,0xbbd9361f
.long 0x361fbc00,0xbb6439a8,0xb61f3c00,0x3b64b9a8,0x3bd9b9a8,0xb872b61f,0xb23eb9a8,0xbaa73b64
.long 0x39a88000,0x39a8bc00,0x39a88000,0x39a8bc00,0xb23e39a8,0x3aa7b61f,0xbbd939a8,0xb8723b64
.long 0xbb643c00,0xb61f39a8,0x3b64bc00,0x361fb9a8,0xbaa739a8,0xbbd93b64,0xb87239a8,0xb23e361f
.long 0x80008000,0x80008000,0x0,0x80000000,0x3aa7b9a8,0x3bd9bb64,0x3872b9a8,0x323eb61f
.long 0x3b64bc00,0x361fb9a8,0xbb643c00,0xb61f39a8,0x323eb9a8,0xbaa7361f,0x3bd9b9a8,0x3872bb64
.long 0xb9a88000,0xb9a83c00,0xb9a88000,0xb9a83c00,0xbbd939a8,0x3872361f,0x323e39a8,0x3aa7bb64
.long 0xb61f3c00,0x3b64b9a8,0x361fbc00,0xbb6439a8,0x387239a8,0xb23ebb64,0xbaa739a8,0x3bd9b61f
.long 0x3c008000,0xbc008000,0x3c000000,0xbc008000,0x3872b9a8,0xb23e3b64,0xbaa7b9a8,0x3bd9361f
.long 0xb61fbc00,0x3b6439a8,0x361f3c00,0xbb64b9a8,0xbbd9b9a8,0x3872b61f,0x323eb9a8,0x3aa73b64
.long 0xb9a88000,0xb9a8bc00,0xb9a88000,0xb9a8bc00,0x323e39a8,0xbaa7b61f,0x3bd939a8,0x38723b64
.long 0x3b643c00,0x361f39a8,0xbb64bc00,0xb61fb9a8,0x3aa739a8,0x3bd93b64,0x387239a8,0x323e361f
.long 0x80008000,0x80008000,0x80008000,0x80008000,0x323e8000,0x3872361f,0x3bd93c00,0x3aa73b64
.long 0xb61f8000,0xbb64b9a8,0x361f8000,0x3b6439a8,0x38728000,0x3bd93b64,0xbaa7bc00,0x323eb61f
.long 0xb9a88000,0xb9a8bc00,0xb9a88000,0xb9a8bc00,0x3aa78000,0x323e3b64,0x38723c00,0xbbd9b61f
.long 0xbb648000,0x361fb9a8,0x3b648000,0xb61f39a8,0x3bd98000,0xbaa7361f,0xb23ebc00,0x38723b64
.long 0xbc008000,0x3c008000,0xbc000000,0x3c000000,0x3bd98000,0xbaa7b61f,0xb23e3c00,0x3872bb64
.long 0xbb640000,0x361f39a8,0x3b648000,0xb61fb9a8,0x3aa78000,0x323ebb64,0x3872bc00,0xbbd9361f
.long 0xb9a80000,0xb9a83c00,0xb9a80000,0xb9a83c00,0x38720000,0x3bd9bb64,0xbaa73c00,0x323e361f
.long 0xb61f0000,0xbb6439a8,0x361f8000,0x3b64b9a8,0x323e8000,0x3872b61f,0x3bd9bc00,0x3aa7bb64
.long 0x0,0x80000000,0x80000000,0x80008000,0xb23e0000,0xb872361f,0xbbd93c00,0xbaa73b64
.long 0x361f0000,0x3b64b9a8,0xb61f8000,0xbb6439a8,0xb8728000,0xbbd93b64,0x3aa7bc00,0xb23eb61f
.long 0x39a80000,0x39a8bc00,0x39a80000,0x39a8bc00,0xbaa78000,0xb23e3b64,0xb8723c00,0x3bd9b61f
.long 0x3b640000,0xb61fb9a8,0xbb648000,0x361f39a8,0xbbd98000,0x3aa7361f,0x323ebc00,0xb8723b64
.long 0x3c000000,0xbc008000,0x3c000000,0xbc000000,0xbbd98000,0x3aa7b61f,0x323e3c00,0xb872bb64
.long 0x3b648000,0xb61f39a8,0xbb648000,0x361fb9a8,0xbaa78000,0xb23ebb64,0xb872bc00,0x3bd9361f
.long 0x39a80000,0x39a83c00,0x39a88000,0x39a83c00,0xb8728000,0xbbd9bb64,0x3aa73c00,0xb23e361f
.long 0x361f0000,0x3b6439a8,0xb61f8000,0xbb64b9a8,0xb23e8000,0xb872b61f,0xbbd9bc00,0xbaa7bb64
.long 0x80008000,0x80008000,0x80008000,0x80008000,0x3aa739a8,0x3bd93b64,0x387239a8,0x323e361f
.long 0xbb64bc00,0xb61fb9a8,0x3b643c00,0x361f39a8,0x323e39a8,0xbaa7b61f,0x3bd939a8,0x38723b64
.long 0x39a88000,0x39a83c00,0x39a88000,0x39a83c00,0xbbd9b9a8,0x3872b61f,0x323eb9a8,0x3aa73b64
.long 0x361f3c00,0xbb64b9a8,0xb61fbc00,0x3b6439a8,0x3872b9a8,0xb23e3b64,0xbaa7b9a8,0x3bd9361f
.long 0xbc000000,0x3c008000,0xbc000000,0x3c008000,0x387239a8,0xb23ebb64,0xbaa739a8,0x3bd9b61f
.long 0x361fbc00,0xbb6439a8,0xb61f3c00,0x3b64b9a8,0xbbd939a8,0x3872361f,0x323e39a8,0x3aa7bb64
.long 0x39a88000,0x39a8bc00,0x39a88000,0x39a8bc00,0x323eb9a8,0xbaa7361f,0x3bd9b9a8,0x3872bb64
.long 0xbb643c00,0xb61f39a8,0x3b64bc00,0x361fb9a8,0x3aa7b9a8,0x3bd9bb64,0x3872b9a8,0x323eb61f
.long 0x80000000,0x80000000,0x80000000,0x80000000,0xbaa739a8,0xbbd93b64,0xb87239a8,0xb23e361f
.long 0x3b64bc00,0x361fb9a8,0xbb643c00,0xb61f39a8,0xb23e39a8,0x3aa7b61f,0xbbd939a8,0xb8723b64
.long 0xb9a88000,0xb9a83c00,0xb9a88000,0xb9a83c00,0x3bd9b9a8,0xb872b61f,0xb23eb9a8,0xbaa73b64
.long 0xb61f3c00,0x3b64b9a8,0x361fbc00,0xbb6439a8,0xb872b9a8,0x323e3b64,0x3aa7b9a8,0xbbd9361f
.long 0x3c000000,0xbc008000,0x3c008000,0xbc008000,0xb87239a8,0x323ebb64,0x3aa739a8,0xbbd9b61f
.long 0xb61fbc00,0x3b6439a8,0x361f3c00,0xbb64b9a8,0x3bd939a8,0xb872361f,0xb23e39a8,0xbaa7bb64
.long 0xb9a88000,0xb9a8bc00,0xb9a88000,0xb9a8bc00,0xb23eb9a8,0x3aa7361f,0xbbd9b9a8,0xb872bb64
.long 0x3b643c00,0x361f39a8,0xbb64bc00,0xb61fb9a8,0xbaa7b9a8,0xbbd9bb64,0xb872b9a8,0xb23eb61f
.long 0x3c003c00,0x3c003c00,0x3c003c00,0x3c003c00,0x3bd93c00,0x3aa73b64,0xb23e0000,0xb872b61f
.long 0x3b643c00,0x361f39a8,0xbb64bc00,0xb61fb9a8,0x3aa73c00,0xb23e361f,0x38720000,0x3bd93b64
.long 0x39a83c00,0xb9a80000,0x39a83c00,0xb9a80000,0x38723c00,0xbbd9b61f,0xbaa70000,0xb23ebb64
.long 0x361f3c00,0xbb64b9a8,0xb61fbc00,0x3b6439a8,0x323e3c00,0xb872bb64,0x3bd90000,0xbaa7361f
.long 0x3c00,0xbc00,0x3c00,0x8000bc00,0xb23e3c00,0x3872bb64,0xbbd90000,0x3aa7361f
.long 0xb61f3c00,0x3b64b9a8,0x361fbc00,0xbb6439a8,0xb8723c00,0x3bd9b61f,0x3aa78000,0x323ebb64
.long 0xb9a83c00,0x39a80000,0xb9a83c00,0x39a88000,0xbaa73c00,0x323e361f,0xb8720000,0xbbd93b64
.long 0xbb643c00,0xb61f39a8,0x3b64bc00,0x361fb9a8,0xbbd93c00,0xbaa73b64,0x323e8000,0x3872b61f
.long 0xbc003c00,0xbc003c00,0xbc003c00,0xbc003c00,0xbbd93c00,0xbaa73b64,0x323e0000,0x3872b61f
.long 0xbb643c00,0xb61f39a8,0x3b64bc00,0x361fb9a8,0xbaa73c00,0x323e361f,0xb8728000,0xbbd93b64
.long 0xb9a83c00,0x39a80000,0xb9a83c00,0x39a80000,0xb8723c00,0x3bd9b61f,0x3aa70000,0x323ebb64
.long 0xb61f3c00,0x3b64b9a8,0x361fbc00,0xbb6439a8,0xb23e3c00,0x3872bb64,0xbbd98000,0x3aa7361f
.long 0x3c00,0xbc00,0x80003c00,0xbc00,0x323e3c00,0xb872bb64,0x3bd90000,0xbaa7361f
.long 0x361f3c00,0xbb64b9a8,0xb61fbc00,0x3b6439a8,0x38723c00,0xbbd9b61f,0xbaa78000,0xb23ebb64
.long 0x39a83c00,0xb9a80000,0x39a83c00,0xb9a88000,0x3aa73c00,0xb23e361f,0x38720000,0x3bd93b64
.long 0x3b643c00,0x361f39a8,0xbb64bc00,0xb61fb9a8,0x3bd93c00,0x3aa73b64,0xb23e8000,0xb872b61f
.long 0x3c003c00,0x3c003c00,0x3c003c00,0x3c003c00,0x387239a8,0x323e361f,0xbaa7b9a8,0xbbd9bb64
.long 0xb61f0000,0xbb64b9a8,0x361f0000,0x3b6439a8,0xbbd9b9a8,0xb872bb64,0x323e39a8,0xbaa7b61f
.long 0xb9a8bc00,0x39a80000,0xb9a8bc00,0x39a80000,0x323eb9a8,0x3aa73b64,0x3bd939a8,0xb872361f
.long 0x3b640000,0xb61f39a8,0xbb640000,0x361fb9a8,0x3aa739a8,0xbbd9b61f,0x3872b9a8,0xb23e3b64
.long 0x3c00,0xbc00,0x3c00,0x8000bc00,0xbaa739a8,0x3bd9b61f,0xb872b9a8,0x323e3b64
.long 0xbb640000,0x361f39a8,0x3b648000,0xb61fb9a8,0xb23eb9a8,0xbaa73b64,0xbbd939a8,0x3872361f
.long 0x39a8bc00,0xb9a80000,0x39a8bc00,0xb9a80000,0x3bd9b9a8,0x3872bb64,0xb23e39a8,0x3aa7b61f
.long 0x361f0000,0x3b64b9a8,0xb61f0000,0xbb6439a8,0xb87239a8,0xb23e361f,0x3aa7b9a8,0x3bd9bb64
.long 0xbc003c00,0xbc003c00,0xbc003c00,0xbc003c00,0xb87239a8,0xb23e361f,0x3aa7b9a8,0x3bd9bb64
.long 0x361f0000,0x3b64b9a8,0xb61f8000,0xbb6439a8,0x3bd9b9a8,0x3872bb64,0xb23e39a8,0x3aa7b61f
.long 0x39a8bc00,0xb9a88000,0x39a8bc00,0xb9a88000,0xb23eb9a8,0xbaa73b64,0xbbd939a8,0x3872361f
.long 0xbb648000,0x361f39a8,0x3b640000,0xb61fb9a8,0xbaa739a8,0x3bd9b61f,0xb872b9a8,0x323e3b64
.long 0x80003c00,0xbc00,0x80003c00,0xbc00,0x3aa739a8,0xbbd9b61f,0x3872b9a8,0xb23e3b64
.long 0x3b640000,0xb61f39a8,0xbb640000,0x361fb9a8,0x323eb9a8,0x3aa73b64,0x3bd939a8,0xb872361f
.long 0xb9a8bc00,0x39a80000,0xb9a8bc00,0x39a80000,0xbbd9b9a8,0xb872bb64,0x323e39a8,0xbaa7b61f
.long 0xb61f8000,0xbb64b9a8,0x361f0000,0x3b6439a8,0x387239a8,0x323e361f,0xbaa7b9a8,0xbbd9bb64
.long 0x3c003c00,0x3c003c00,0x3c003c00,0x3c003c00,0xbbd9bc00,0xbaa7bb64,0x323e0000,0x3872361f
.long 0x3b643c00,0x361f39a8,0xbb64bc00,0xb61fb9a8,0xbaa7bc00,0x323eb61f,0xb8720000,0xbbd9bb64
.long 0x39a83c00,0xb9a80000,0x39a83c00,0xb9a80000,0xb872bc00,0x3bd9361f,0x3aa78000,0x323e3b64
.long 0x361f3c00,0xbb64b9a8,0xb61fbc00,0x3b6439a8,0xb23ebc00,0x38723b64,0xbbd90000,0x3aa7b61f
.long 0x3c00,0x8000bc00,0x3c00,0x8000bc00,0x323ebc00,0xb8723b64,0x3bd98000,0xbaa7b61f
.long 0xb61f3c00,0x3b64b9a8,0x361fbc00,0xbb6439a8,0x3872bc00,0xbbd9361f,0xbaa70000,0xb23e3b64
.long 0xb9a83c00,0x39a88000,0xb9a83c00,0x39a88000,0x3aa7bc00,0xb23eb61f,0x38720000,0x3bd9bb64
.long 0xbb643c00,0xb61f39a8,0x3b64bc00,0x361fb9a8,0x3bd9bc00,0x3aa7bb64,0xb23e0000,0xb872361f
.long 0xbc003c00,0xbc003c00,0xbc003c00,0xbc003c00,0x3bd9bc00,0x3aa7bb64,0xb23e0000,0xb872361f
.long 0xbb643c00,0xb61f39a8,0x3b64bc00,0x361fb9a8,0x3aa7bc00,0xb23eb61f,0x38720000,0x3bd9bb64
.long 0xb9a83c00,0x39a80000,0xb9a83c00,0x39a80000,0x3872bc00,0xbbd9361f,0xbaa70000,0xb23e3b64
.long 0xb61f3c00,0x3b64b9a8,0x361fbc00,0xbb6439a8,0x323ebc00,0xb8723b64,0x3bd90000,0xbaa7b61f
.long 0x80003c00,0xbc00,0x80003c00,0xbc00,0xb23ebc00,0x38723b64,0xbbd98000,0x3aa7b61f
.long 0x361f3c00,0xbb64b9a8,0xb61fbc00,0x3b6439a8,0xb872bc00,0x3bd9361f,0x3aa70000,0x323e3b64
.long 0x39a83c00,0xb9a80000,0x39a83c00,0xb9a88000,0xbaa7bc00,0x323eb61f,0xb8728000,0xbbd9bb64
.long 0x3b643c00,0x361f39a8,0xbb64bc00,0xb61fb9a8,0xbbd9bc00,0xbaa7bb64,0x323e0000,0x3872361f
.long 0x3c003c00,0x3c003c00,0x3c003c00,0x3c003c00,0xb872b9a8,0xb23eb61f,0x3aa739a8,0x3bd93b64
.long 0xb61f0000,0xbb64b9a8,0x361f0000,0x3b6439a8,0x3bd939a8,0x38723b64,0xb23eb9a8,0x3aa7361f
.long 0xb9a8bc00,0x39a88000,0xb9a8bc00,0x39a88000,0xb23e39a8,0xbaa7bb64,0xbbd9b9a8,0x3872b61f
.long 0x3b648000,0xb61f39a8,0xbb640000,0x361fb9a8,0xbaa7b9a8,0x3bd9361f,0xb87239a8,0x323ebb64
.long 0x3c00,0x8000bc00,0x3c00,0x8000bc00,0x3aa7b9a8,0xbbd9361f,0x387239a8,0xb23ebb64
.long 0xbb640000,0x361f39a8,0x3b648000,0xb61fb9a8,0x323e39a8,0x3aa7bb64,0x3bd9b9a8,0xb872b61f
.long 0x39a8bc00,0xb9a80000,0x39a8bc00,0xb9a80000,0xbbd939a8,0xb8723b64,0x323eb9a8,0xbaa7361f
.long 0x361f8000,0x3b64b9a8,0xb61f0000,0xbb6439a8,0x3872b9a8,0x323eb61f,0xbaa739a8,0xbbd93b64
.long 0xbc003c00,0xbc003c00,0xbc003c00,0xbc003c00,0x3872b9a8,0x323eb61f,0xbaa739a8,0xbbd93b64
.long 0x361f0000,0x3b64b9a8,0xb61f0000,0xbb6439a8,0xbbd939a8,0xb8723b64,0x323eb9a8,0xbaa7361f
.long 0x39a8bc00,0xb9a80000,0x39a8bc00,0xb9a88000,0x323e39a8,0x3aa7bb64,0x3bd9b9a8,0xb872b61f
.long 0xbb648000,0x361f39a8,0x3b640000,0xb61fb9a8,0x3aa7b9a8,0xbbd9361f,0x387239a8,0xb23ebb64
.long 0x3c00,0xbc00,0x80003c00,0xbc00,0xbaa7b9a8,0x3bd9361f,0xb87239a8,0x323ebb64
.long 0x3b648000,0xb61f39a8,0xbb640000,0x361fb9a8,0xb23e39a8,0xbaa7bb64,0xbbd9b9a8,0x3872b61f
.long 0xb9a8bc00,0x39a80000,0xb9a8bc00,0x39a88000,0x3bd939a8,0x38723b64,0xb23eb9a8,0x3aa7361f
.long 0xb61f8000,0xbb64b9a8,0x361f0000,0x3b6439a8,0xb872b9a8,0xb23eb61f,0x3aa739a8,0x3bd93b64
.long 0x0,0x0,0x0,0x0,0x323e0000,0x3872361f,0x3bd93c00,0x3aa73b64
.long 0x361f0000,0x3b6439a8,0xb61f0000,0xbb64b9a8,0x38720000,0x3bd93b64,0xbaa7bc00,0x323eb61f
.long 0x39a80000,0x39a83c00,0x39a80000,0x39a83c00,0x3aa70000,0x323e3b64,0x38723c00,0xbbd9b61f
.long 0x3b640000,0xb61f39a8,0xbb640000,0x361fb9a8,0x3bd90000,0xbaa7361f,0xb23ebc00,0x38723b64
.long 0x3c000000,0xbc000000,0x3c000000,0xbc000000,0x3bd90000,0xbaa7b61f,0xb23e3c00,0x3872bb64
.long 0x3b640000,0xb61fb9a8,0xbb640000,0x361f39a8,0x3aa70000,0x323ebb64,0x3872bc00,0xbbd9361f
.long 0x39a80000,0x39a8bc00,0x39a80000,0x39a8bc00,0x38720000,0x3bd9bb64,0xbaa73c00,0x323e361f
.long 0x361f0000,0x3b64b9a8,0xb61f0000,0xbb6439a8,0x323e0000,0x3872b61f,0x3bd9bc00,0x3aa7bb64
.long 0x0,0x0,0x0,0x8000,0xb23e0000,0xb872361f,0xbbd93c00,0xbaa73b64
.long 0xb61f0000,0xbb6439a8,0x361f0000,0x3b64b9a8,0xb8720000,0xbbd93b64,0x3aa7bc00,0xb23eb61f
.long 0xb9a80000,0xb9a83c00,0xb9a88000,0xb9a83c00,0xbaa70000,0xb23e3b64,0xb8723c00,0x3bd9b61f
.long 0xbb640000,0x361f39a8,0x3b640000,0xb61fb9a8,0xbbd90000,0x3aa7361f,0x323ebc00,0xb8723b64
.long 0xbc000000,0x3c000000,0xbc008000,0x3c000000,0xbbd90000,0x3aa7b61f,0x323e3c00,0xb872bb64
.long 0xbb640000,0x361fb9a8,0x3b648000,0xb61f39a8,0xbaa70000,0xb23ebb64,0xb872bc00,0x3bd9361f
.long 0xb9a80000,0xb9a8bc00,0xb9a88000,0xb9a8bc00,0xb8720000,0xbbd9bb64,0x3aa73c00,0xb23e361f
.long 0xb61f0000,0xbb64b9a8,0x361f0000,0x3b6439a8,0xb23e0000,0xb872b61f,0xbbd9bc00,0xbaa7bb64
.long 0x0,0x0,0x0,0x0,0x3aa739a8,0x3bd93b64,0x387239a8,0x323e361f
.long 0x3b643c00,0x361f39a8,0xbb64bc00,0xb61fb9a8,0x323e39a8,0xbaa7b61f,0x3bd939a8,0x38723b64
.long 0xb9a80000,0xb9a8bc00,0xb9a80000,0xb9a8bc00,0xbbd9b9a8,0x3872b61f,0x323eb9a8,0x3aa73b64
.long 0xb61fbc00,0x3b6439a8,0x361f3c00,0xbb64b9a8,0x3872b9a8,0xb23e3b64,0xbaa7b9a8,0x3bd9361f
.long 0x3c000000,0xbc000000,0x3c000000,0xbc000000,0x387239a8,0xb23ebb64,0xbaa739a8,0x3bd9b61f
.long 0xb61f3c00,0x3b64b9a8,0x361fbc00,0xbb6439a8,0xbbd939a8,0x3872361f,0x323e39a8,0x3aa7bb64
.long 0xb9a80000,0xb9a83c00,0xb9a80000,0xb9a83c00,0x323eb9a8,0xbaa7361f,0x3bd9b9a8,0x3872bb64
.long 0x3b64bc00,0x361fb9a8,0xbb643c00,0xb61f39a8,0x3aa7b9a8,0x3bd9bb64,0x3872b9a8,0x323eb61f
.long 0x0,0x0,0x80008000,0x8000,0xbaa739a8,0xbbd93b64,0xb87239a8,0xb23e361f
.long 0xbb643c00,0xb61f39a8,0x3b64bc00,0x361fb9a8,0xb23e39a8,0x3aa7b61f,0xbbd939a8,0xb8723b64
.long 0x39a80000,0x39a8bc00,0x39a80000,0x39a8bc00,0x3bd9b9a8,0xb872b61f,0xb23eb9a8,0xbaa73b64
.long 0x361fbc00,0xbb6439a8,0xb61f3c00,0x3b64b9a8,0xb872b9a8,0x323e3b64,0x3aa7b9a8,0xbbd9361f
.long 0xbc000000,0x3c000000,0xbc008000,0x3c000000,0xb87239a8,0x323ebb64,0x3aa739a8,0xbbd9b61f
.long 0x361f3c00,0xbb64b9a8,0xb61fbc00,0x3b6439a8,0x3bd939a8,0xb872361f,0xb23e39a8,0xbaa7bb64
.long 0x39a80000,0x39a83c00,0x39a80000,0x39a83c00,0xb23eb9a8,0x3aa7361f,0xbbd9b9a8,0xb872bb64
.long 0xbb64bc00,0xb61fb9a8,0x3b643c00,0x361f39a8,0xbaa7b9a8,0xbbd9bb64,0xb872b9a8,0xb23eb61f
.long 0x0,0x0,0x0,0x0,0xb23e0000,0xb872b61f,0xbbd9bc00,0xbaa7bb64
.long 0x361f0000,0x3b6439a8,0xb61f0000,0xbb64b9a8,0xb8720000,0xbbd9bb64,0x3aa73c00,0xb23e361f
.long 0x39a80000,0x39a83c00,0x39a80000,0x39a83c00,0xbaa70000,0xb23ebb64,0xb872bc00,0x3bd9361f
.long 0x3b640000,0xb61f39a8,0xbb640000,0x361fb9a8,0xbbd90000,0x3aa7b61f,0x323e3c00,0xb872bb64
.long 0x3c000000,0xbc000000,0x3c008000,0xbc008000,0xbbd90000,0x3aa7361f,0x323ebc00,0xb8723b64
.long 0x3b648000,0xb61fb9a8,0xbb640000,0x361f39a8,0xbaa70000,0xb23e3b64,0xb8723c00,0x3bd9b61f
.long 0x39a88000,0x39a8bc00,0x39a88000,0x39a8bc00,0xb8728000,0xbbd93b64,0x3aa7bc00,0xb23eb61f
.long 0x361f8000,0x3b64b9a8,0xb61f0000,0xbb6439a8,0xb23e0000,0xb872361f,0xbbd93c00,0xbaa73b64
.long 0x80008000,0x8000,0x8000,0x0,0x323e8000,0x3872b61f,0x3bd9bc00,0x3aa7bb64
.long 0xb61f8000,0xbb6439a8,0x361f0000,0x3b64b9a8,0x38720000,0x3bd9bb64,0xbaa73c00,0x323e361f
.long 0xb9a88000,0xb9a83c00,0xb9a88000,0xb9a83c00,0x3aa70000,0x323ebb64,0x3872bc00,0xbbd9361f
.long 0xbb648000,0x361f39a8,0x3b640000,0xb61fb9a8,0x3bd90000,0xbaa7b61f,0xb23e3c00,0x3872bb64
.long 0xbc008000,0x3c000000,0xbc008000,0x3c000000,0x3bd90000,0xbaa7361f,0xb23ebc00,0x38723b64
.long 0xbb640000,0x361fb9a8,0x3b648000,0xb61f39a8,0x3aa70000,0x323e3b64,0x38723c00,0xbbd9b61f
.long 0xb9a88000,0xb9a8bc00,0xb9a80000,0xb9a8bc00,0x38720000,0x3bd93b64,0xbaa7bc00,0x323eb61f
.long 0xb61f8000,0xbb64b9a8,0x361f0000,0x3b6439a8,0x323e0000,0x3872361f,0x3bd93c00,0x3aa73b64
.long 0x0,0x0,0x0,0x0,0xbaa7b9a8,0xbbd9bb64,0xb872b9a8,0xb23eb61f
.long 0x3b643c00,0x361f39a8,0xbb64bc00,0xb61fb9a8,0xb23eb9a8,0x3aa7361f,0xbbd9b9a8,0xb872bb64
.long 0xb9a80000,0xb9a8bc00,0xb9a80000,0xb9a8bc00,0x3bd939a8,0xb872361f,0xb23e39a8,0xbaa7bb64
.long 0xb61fbc00,0x3b6439a8,0x361f3c00,0xbb64b9a8,0xb87239a8,0x323ebb64,0x3aa739a8,0xbbd9b61f
.long 0x3c008000,0xbc000000,0x3c008000,0xbc000000,0xb872b9a8,0x323e3b64,0x3aa7b9a8,0xbbd9361f
.long 0xb61f3c00,0x3b64b9a8,0x361fbc00,0xbb6439a8,0x3bd9b9a8,0xb872b61f,0xb23eb9a8,0xbaa73b64
.long 0xb9a80000,0xb9a83c00,0xb9a80000,0xb9a83c00,0xb23e39a8,0x3aa7b61f,0xbbd939a8,0xb8723b64
.long 0x3b64bc00,0x361fb9a8,0xbb643c00,0xb61f39a8,0xbaa739a8,0xbbd93b64,0xb87239a8,0xb23e361f
.long 0x8000,0x8000,0x8000,0x8000,0x3aa7b9a8,0x3bd9bb64,0x3872b9a8,0x323eb61f
.long 0xbb643c00,0xb61f39a8,0x3b64bc00,0x361fb9a8,0x323eb9a8,0xbaa7361f,0x3bd9b9a8,0x3872bb64
.long 0x39a80000,0x39a8bc00,0x39a80000,0x39a8bc00,0xbbd939a8,0x3872361f,0x323e39a8,0x3aa7bb64
.long 0x361fbc00,0xbb6439a8,0xb61f3c00,0x3b64b9a8,0x387239a8,0xb23ebb64,0xbaa739a8,0x3bd9b61f
.long 0xbc008000,0x3c000000,0xbc000000,0x3c000000,0x3872b9a8,0xb23e3b64,0xbaa7b9a8,0x3bd9361f
.long 0x361f3c00,0xbb64b9a8,0xb61fbc00,0x3b6439a8,0xbbd9b9a8,0x3872b61f,0x323eb9a8,0x3aa73b64
.long 0x39a80000,0x39a83c00,0x39a80000,0x39a83c00,0x323e39a8,0xbaa7b61f,0x3bd939a8,0x38723b64
.long 0xbb64bc00,0xb61fb9a8,0x3b643c00,0x361f39a8,0x3aa739a8,0x3bd93b64,0x387239a8,0x323e361f
.long 0x80008000,0x80008000,0x80008000,0x80008000,0xb23e8000,0xb872b61f,0xbbd9bc00,0xbaa7bb64
.long 0xb61f8000,0xbb64b9a8,0x361f8000,0x3b6439a8,0xb8728000,0xbbd9bb64,0x3aa73c00,0xb23e361f
.long 0xb9a88000,0xb9a8bc00,0xb9a88000,0xb9a8bc00,0xbaa78000,0xb23ebb64,0xb872bc00,0x3bd9361f
.long 0xbb648000,0x361fb9a8,0x3b648000,0xb61f39a8,0xbbd98000,0x3aa7b61f,0x323e3c00,0xb872bb64
.long 0xbc008000,0x3c008000,0xbc008000,0x3c008000,0xbbd98000,0x3aa7361f,0x323ebc00,0xb8723b64
.long 0xbb648000,0x361f39a8,0x3b648000,0xb61fb9a8,0xbaa78000,0xb23e3b64,0xb8723c00,0x3bd9b61f
.long 0xb9a88000,0xb9a83c00,0xb9a88000,0xb9a83c00,0xb8728000,0xbbd93b64,0x3aa7bc00,0xb23eb61f
.long 0xb61f8000,0xbb6439a8,0x361f8000,0x3b64b9a8,0xb23e8000,0xb872361f,0xbbd93c00,0xbaa73b64
.long 0x80008000,0x80008000,0x80008000,0x80000000,0x323e8000,0x3872b61f,0x3bd9bc00,0x3aa7bb64
.long 0x361f8000,0x3b64b9a8,0xb61f8000,0xbb6439a8,0x38728000,0x3bd9bb64,0xbaa73c00,0x323e361f
.long 0x39a88000,0x39a8bc00,0x39a80000,0x39a8bc00,0x3aa78000,0x323ebb64,0x3872bc00,0xbbd9361f
.long 0x3b648000,0xb61fb9a8,0xbb648000,0x361f39a8,0x3bd98000,0xbaa7b61f,0xb23e3c00,0x3872bb64
.long 0x3c008000,0xbc008000,0x3c000000,0xbc008000,0x3bd98000,0xbaa7361f,0xb23ebc00,0x38723b64
.long 0x3b648000,0xb61f39a8,0xbb640000,0x361fb9a8,0x3aa78000,0x323e3b64,0x38723c00,0xbbd9b61f
.long 0x39a88000,0x39a83c00,0x39a80000,0x39a83c00,0x38728000,0x3bd93b64,0xbaa7bc00,0x323eb61f
.long 0x361f8000,0x3b6439a8,0xb61f8000,0xbb64b9a8,0x323e8000,0x3872361f,0x3bd93c00,0x3aa73b64
.long 0x80008000,0x80008000,0x80008000,0x80008000,0xbaa7b9a8,0xbbd9bb64,0xb872b9a8,0xb23eb61f
.long 0xbb64bc00,0xb61fb9a8,0x3b643c00,0x361f39a8,0xb23eb9a8,0x3aa7361f,0xbbd9b9a8,0xb872bb64
.long 0x39a88000,0x39a83c00,0x39a88000,0x39a83c00,0x3bd939a8,0xb872361f,0xb23e39a8,0xbaa7bb64
.long 0x361f3c00,0xbb64b9a8,0xb61fbc00,0x3b6439a8,0xb87239a8,0x323ebb64,0x3aa739a8,0xbbd9b61f
.long 0xbc008000,0x3c008000,0xbc008000,0x3c008000,0xb872b9a8,0x323e3b64,0x3aa7b9a8,0xbbd9361f
.long 0x361fbc00,0xbb6439a8,0xb61f3c00,0x3b64b9a8,0x3bd9b9a8,0xb872b61f,0xb23eb9a8,0xbaa73b64
.long 0x39a88000,0x39a8bc00,0x39a88000,0x39a8bc00,0xb23e39a8,0x3aa7b61f,0xbbd939a8,0xb8723b64
.long 0xbb643c00,0xb61f39a8,0x3b64bc00,0x361fb9a8,0xbaa739a8,0xbbd93b64,0xb87239a8,0xb23e361f
.long 0x80008000,0x80008000,0x0,0x80000000,0x3aa7b9a8,0x3bd9bb64,0x3872b9a8,0x323eb61f
.long 0x3b64bc00,0x361fb9a8,0xbb643c00,0xb61f39a8,0x323eb9a8,0xbaa7361f,0x3bd9b9a8,0x3872bb64
.long 0xb9a88000,0xb9a83c00,0xb9a88000,0xb9a83c00,0xbbd939a8,0x3872361f,0x323e39a8,0x3aa7bb64
.long 0xb61f3c00,0x3b64b9a8,0x361fbc00,0xbb6439a8,0x387239a8,0xb23ebb64,0xbaa739a8,0x3bd9b61f
.long 0x3c008000,0xbc008000,0x3c000000,0xbc008000,0x3872b9a8,0xb23e3b64,0xbaa7b9a8,0x3bd9361f
.long 0xb61fbc00,0x3b6439a8,0x361f3c00,0xbb64b9a8,0xbbd9b9a8,0x3872b61f,0x323eb9a8,0x3aa73b64
.long 0xb9a88000,0xb9a8bc00,0xb9a88000,0xb9a8bc00,0x323e39a8,0xbaa7b61f,0x3bd939a8,0x38723b64
.long 0x3b643c00,0x361f39a8,0xbb64bc00,0xb61fb9a8,0x3aa739a8,0x3bd93b64,0x387239a8,0x323e361f
.long 0x80008000,0x80008000,0x80008000,0x80008000,0x323e8000,0x3872361f,0x3bd93c00,0x3aa73b64
.long 0xb61f8000,0xbb64b9a8,0x361f8000,0x3b6439a8,0x38728000,0x3bd93b64,0xbaa7bc00,0x323eb61f
.long 0xb9a88000,0xb9a8bc00,0xb9a88000,0xb9a8bc00,0x3aa78000,0x323e3b64,0x38723c00,0xbbd9b61f
.long 0xbb648000,0x361fb9a8,0x3b648000,0xb61f39a8,0x3bd98000,0xbaa7361f,0xb23ebc00,0x38723b64
.long 0xbc008000,0x3c008000,0xbc000000,0x3c000000,0x3bd98000,0xbaa7b61f,0xb23e3c00,0x3872bb64
.long 0xbb640000,0x361f39a8,0x3b648000,0xb61fb9a8,0x3aa78000,0x323ebb64,0x3872bc00,0xbbd9361f
.long 0xb9a80000,0xb9a83c00,0xb9a80000,0xb9a83c00,0x38720000,0x3bd9bb64,0xbaa73c00,0x323e361f
.long 0xb61f0000,0xbb6439a8,0x361f8000,0x3b64b9a8,0x323e8000,0x3872b61f,0x3bd9bc00,0x3aa7bb64
.long 0x0,0x80000000,0x80000000,0x80008000,0xb23e0000,0xb872361f,0xbbd93c00,0xbaa73b64
.long 0x361f0000,0x3b64b9a8,0xb61f8000,0xbb6439a8,0xb8728000,0xbbd93b64,0x3aa7bc00,0xb23eb61f
.long 0x39a80000,0x39a8bc00,0x39a80000,0x39a8bc00,0xbaa78000,0xb23e3b64,0xb8723c00,0x3bd9b61f
.long 0x3b640000,0xb61fb9a8,0xbb648000,0x361f39a8,0xbbd98000,0x3aa7361f,0x323ebc00,0xb8723b64
.long 0x3c000000,0xbc008000,0x3c000000,0xbc008000,0xbbd98000,0x3aa7b61f,0x323e3c00,0xb872bb64
.long 0x3b648000,0xb61f39a8,0xbb640000,0x361fb9a8,0xbaa78000,0xb23ebb64,0xb872bc00,0x3bd9361f
.long 0x39a80000,0x39a83c00,0x39a88000,0x39a83c00,0xb8728000,0xbbd9bb64,0x3aa73c00,0xb23e361f
.long 0x361f0000,0x3b6439a8,0xb61f8000,0xbb64b9a8,0xb23e8000,0xb872b61f,0xbbd9bc00,0xbaa7bb64
.long 0x80008000,0x80008000,0x80008000,0x80008000,0x3aa739a8,0x3bd93b64,0x387239a8,0x323e361f
.long 0xbb64bc00,0xb61fb9a8,0x3b643c00,0x361f39a8,0x323e39a8,0xbaa7b61f,0x3bd939a8,0x38723b64
.long 0x39a88000,0x39a83c00,0x39a88000,0x39a83c00,0xbbd9b9a8,0x3872b61f,0x323eb9a8,0x3aa73b64
.long 0x361f3c00,0xbb64b9a8,0xb61fbc00,0x3b6439a8,0x3872b9a8,0xb23e3b64,0xbaa7b9a8,0x3bd9361f
.long 0xbc000000,0x3c008000,0xbc000000,0x3c008000,0x387239a8,0xb23ebb64,0xbaa739a8,0x3bd9b61f
.long 0x361fbc00,0xbb6439a8,0xb61f3c00,0x3b64b9a8,0xbbd939a8,0x3872361f,0x323e39a8,0x3aa7bb64
.long 0x39a88000,0x39a8bc00,0x39a88000,0x39a8bc00,0x323eb9a8,0xbaa7361f,0x3bd9b9a8,0x3872bb64
.long 0xbb643c00,0xb61f39a8,0x3b64bc00,0x361fb9a8,0x3aa7b9a8,0x3bd9bb64,0x3872b9a8,0x323eb61f
.long 0x80000000,0x80000000,0x80000000,0x80000000,0xbaa739a8,0xbbd93b64,0xb87239a8,0xb23e361f
.long 0x3b64bc00,0x361fb9a8,0xbb643c00,0xb61f39a8,0xb23e39a8,0x3aa7b61f,0xbbd939a8,0xb8723b64
.long 0xb9a88000,0xb9a83c00,0xb9a88000,0xb9a83c00,0x3bd9b9a8,0xb872b61f,0xb23eb9a8,0xbaa73b64
.long 0xb61f3c00,0x3b64b9a8,0x361fbc00,0xbb6439a8,0xb872b9a8,0x323e3b64,0x3aa7b9a8,0xbbd9361f
.long 0x3c000000,0xbc008000,0x3c008000,0xbc008000,0xb87239a8,0x323ebb64,0x3aa739a8,0xbbd9b61f
.long 0xb61fbc00,0x3b6439a8,0x361f3c00,0xbb64b9a8,0x3bd939a8,0xb872361f,0xb23e39a8,0xbaa7bb64
.long 0xb9a88000,0xb9a8bc00,0xb9a88000,0xb9a8bc00,0xb23eb9a8,0x3aa7361f,0xbbd9b9a8,0xb872bb64
.long 0x3b643c00,0x361f39a8,0xbb64bc00,0xb61fb9a8,0xbaa7b9a8,0xbbd9bb64,0xb872b9a8,0xb23eb61f
.long 0x3f800000,0x3f800000,0x3f800000,0x3f800000,0x3f800000,0x3f7ffec4,0x3f7ffb11,0x3f7ff4e6
.long 0x3f800000,0x3f7ffb11,0x3f7fec43,0x3f7fd397,0x3f800000,0x3f7ff4e6,0x3f7fd397,0x3f7f9c18
.long 0x3f800000,0x3f7fec43,0x3f7fb10f,0x3f7f4e6d,0x3f800000,0x3f7fe129,0x3f7f84ab,0x3f7eea9d
.long 0x3f800000,0x3f7fd397,0x3f7f4e6d,0x3f7e70b0,0x3f800000,0x3f7fc38f,0x3f7f0e58,0x3f7de0b1
.long 0x3f800000,0x3f7fb10f,0x3f7ec46d,0x3f7d3aac,0x3f800000,0x3f7f9c18,0x3f7e70b0,0x3f7c7eb0
.long 0x3f800000,0x3f7f84ab,0x3f7e1324,0x3f7baccd,0x3f800000,0x3f7f6ac7,0x3f7dabcc,0x3f7ac516
.long 0x3f800000,0x3f7f4e6d,0x3f7d3aac,0x3f79c79d,0x3f800000,0x3f7f2f9d,0x3f7cbfc9,0x3f78b47b
.long 0x3f800000,0x3f7f0e58,0x3f7c3b28,0x3f778bc5,0x3f800000,0x3f7eea9d,0x3f7baccd,0x3f764d97
.long 0x3f800000,0x3f7ec46d,0x3f7b14be,0x3f74fa0b,0x3f800000,0x3f7e9bc9,0x3f7a7302,0x3f73913f
.long 0x3f800000,0x3f7e70b0,0x3f79c79d,0x3f721352,0x3f800000,0x3f7e4323,0x3f791298,0x3f708066
.long 0x3f800000,0x3f7e1324,0x3f7853f8,0x3f6ed89e,0x3f800000,0x3f7de0b1,0x3f778bc5,0x3f6d1c1d
.long 0x3f800000,0x3f7dabcc,0x3f76ba07,0x3f6b4b0c,0x3f800000,0x3f7d7474,0x3f75dec6,0x3f696591
.long 0x3f800000,0x3f7d3aac,0x3f74fa0b,0x3f676bd8,0x3f800000,0x3f7cfe73,0x3f740bdd,0x3f655e0b
.long 0x3f800000,0x3f7cbfc9,0x3f731447,0x3f633c5a,0x3f800000,0x3f7c7eb0,0x3f721352,0x3f6106f2
.long 0x3f800000,0x3f7c3b28,0x3f710908,0x3f5ebe05,0x3f800000,0x3f7bf531,0x3f6ff573,0x3f5c61c7
.long 0x3f800000,0x3f7baccd,0x3f6ed89e,0x3f59f26a,0x3f800000,0x3f7b61fc,0x3f6db293,0x3f577026
.long 0x3f800000,0x3f800000,0x3f800000,0x3f800000,0x3f7fec43,0x3f7fe129,0x3f7fd397,0x3f7fc38f
.long 0x3f7fb10f,0x3f7f84ab,0x3f7f4e6d,0x3f7f0e58,0x3f7f4e6d,0x3f7eea9d,0x3f7e70b0,0x3f7de0b1
.long 0x3f7ec46d,0x3f7e1324,0x3f7d3aac,0x3f7c3b28,0x3f7e1324,0x3f7cfe73,0x3f7baccd,0x3f7a1e84
.long 0x3f7d3aac,0x3f7baccd,0x3f79c79d,0x3f778bc5,0x3f7c3b28,0x3f7a1e84,0x3f778bc5,0x3f748422
.long 0x3f7b14be,0x3f7853f8,0x3f74fa0b,0x3f710908,0x3f79c79d,0x3f764d97,0x3f721352,0x3f6d1c1d
.long 0x3f7853f8,0x3f740bdd,0x3f6ed89e,0x3f68bf3c,0x3f76ba07,0x3f718f57,0x3f6b4b0c,0x3f63f473
.long 0x3f74fa0b,0x3f6ed89e,0x3f676bd8,0x3f5ebe05,0x3f731447,0x3f6be858,0x3f633c5a,0x3f591e6a
.long 0x3f710908,0x3f68bf3c,0x3f5ebe05,0x3f531849,0x3f6ed89e,0x3f655e0b,0x3f59f26a,0x3f4cae79
.long 0x3f6c835e,0x3f61c598,0x3f54db31,0x3f45e403,0x3f6a09a7,0x3f5df6be,0x3f4f7a1f,0x3f3ebc1b
.long 0x3f676bd8,0x3f59f26a,0x3f49d112,0x3f373a23,0x3f64aa59,0x3f55b993,0x3f43e200,0x3f2f61a5
.long 0x3f61c598,0x3f514d3d,0x3f3daef9,0x3f273656,0x3f5ebe05,0x3f4cae79,0x3f373a23,0x3f1ebc12
.long 0x3f5b941a,0x3f47de65,0x3f3085bb,0x3f15f6d9,0x3f584853,0x3f42de29,0x3f299415,0x3f0cead0
.long 0x3f54db31,0x3f3daef9,0x3f226799,0x3f039c3d,0x3f514d3d,0x3f385216,0x3f1b02c6,0x3ef41f07
.long 0x3f4d9f02,0x3f32c8c9,0x3f13682a,0x3ee0924f,0x3f49d112,0x3f2d1469,0x3f0b9a6b,0x3ecc9b8b
.long 0x3f45e403,0x3f273656,0x3f039c3d,0x3eb8442a,0x3f41d870,0x3f212ff9,0x3ef6e0cb,0x3ea395c5
.long 0x3f3daef9,0x3f1b02c6,0x3ee63375,0x3e8e9a22,0x3f396842,0x3f14b039,0x3ed53641,0x3e72b651
.long 0x3f800000,0x3f800000,0x3f800000,0x3f800000,0x3f7fb10f,0x3f7f9c18,0x3f7f84ab,0x3f7f6ac7
.long 0x3f7ec46d,0x3f7e70b0,0x3f7e1324,0x3f7dabcc,0x3f7d3aac,0x3f7c7eb0,0x3f7baccd,0x3f7ac516
.long 0x3f7b14be,0x3f79c79d,0x3f7853f8,0x3f76ba07,0x3f7853f8,0x3f764d97,0x3f740bdd,0x3f718f57
.long 0x3f74fa0b,0x3f721352,0x3f6ed89e,0x3f6b4b0c,0x3f710908,0x3f6d1c1d,0x3f68bf3c,0x3f63f473
.long 0x3f6c835e,0x3f676bd8,0x3f61c598,0x3f5b941a,0x3f676bd8,0x3f6106f2,0x3f59f26a,0x3f5233c6
.long 0x3f61c598,0x3f59f26a,0x3f514d3d,0x3f47de65,0x3f5b941a,0x3f5233c6,0x3f47de65,0x3f3ca003
.long 0x3f54db31,0x3f49d112,0x3f3daef9,0x3f3085bb,0x3f4d9f02,0x3f40d0da,0x3f32c8c9,0x3f239da9
.long 0x3f45e403,0x3f373a23,0x3f273656,0x3f15f6d9,0x3f3daef9,0x3f2d1469,0x3f1b02c6,0x3f07a136
.long 0x3f3504f3,0x3f226799,0x3f0e39da,0x3ef15aea,0x3f2beb4a,0x3f173c07,0x3f00e7e4,0x3ed25a09
.long 0x3f226799,0x3f0b9a6b,0x3ee63375,0x3eb263ef,0x3f187fc0,0x3eff17b2,0x3ec9b953,0x3e919ddd
.long 0x3f0e39da,0x3ee63375,0x3eac7cd4,0x3e605c13,0x3f039c3d,0x3ecc9b8b,0x3e8e9a22,0x3e1c76de
.long 0x3ef15aea,0x3eb263ef,0x3e605c13,0x3dafb680,0x3edae880,0x3e97a117,0x3e22abb6,0x3c96c9b6
.long 0x3ec3ef15,0x3e78cfcc,0x3dc8bd36,0xbd48fb30,0x3eac7cd4,0x3e419b37,0x3d16c32c,0xbdee3876
.long 0x3e94a031,0x3e09cf86,0xbcc90ab0,0xbe3b6ecf,0x3e78cfcc,0x3da3308c,0xbdafb680,0xbe7ee6e1
.long 0x3e47c5c2,0x3cc90ab0,0xbe164083,0xbea09ae5,0x3e164083,0xbcfb49ba,0xbe541501,0xbec1071e
.long 0x3dc8bd36,0xbdafb680,0xbe888e93,0xbee0924f,0x3d48fb30,0xbe1008b7,0xbea68f12,0xbeff17b2
.long 0x3f800000,0x3f800000,0x3f800000,0x3f800000,0x3f7f4e6d,0x3f7f2f9d,0x3f7f0e58,0x3f7eea9d
.long 0x3f7d3aac,0x3f7cbfc9,0x3f7c3b28,0x3f7baccd,0x3f79c79d,0x3f78b47b,0x3f778bc5,0x3f764d97
.long 0x3f74fa0b,0x3f731447,0x3f710908,0x3f6ed89e,0x3f6ed89e,0x3f6be858,0x3f68bf3c,0x3f655e0b
.long 0x3f676bd8,0x3f633c5a,0x3f5ebe05,0x3f59f26a,0x3f5ebe05,0x3f591e6a,0x3f531849,0x3f4cae79
.long 0x3f54db31,0x3f4d9f02,0x3f45e403,0x3f3daef9,0x3f49d112,0x3f40d0da,0x3f373a23,0x3f2d1469
.long 0x3f3daef9,0x3f32c8c9,0x3f273656,0x3f1b02c6,0x3f3085bb,0x3f239da9,0x3f15f6d9,0x3f07a136
.long 0x3f226799,0x3f13682a,0x3f039c3d,0x3ee63375,0x3f13682a,0x3f0242b1,0x3ee0924f,0x3ebb31a0
.long 0x3f039c3d,0x3ee0924f,0x3eb8442a,0x3e8e9a22,0x3ee63375,0x3ebb31a0,0x3e8e9a22,0x3e419b37
.long 0x3ec3ef15,0x3e94a031,0x3e47c5c2,0x3dc8bd36,0x3ea09ae5,0x3e5a3997,0x3de1bc2e,0x3bc90f88
.long 0x3e78cfcc,0x3e09cf86,0x3cc90ab0,0xbdafb680,0x3e2f10a2,0x3d621469,0xbd7b2b74,0xbe354098
.long 0x3dc8bd36,0xbcc90ab0,0xbe164083,0xbe888e93,0x3cc90ab0,0xbdd53db9,0xbe6c9a7f,0xbeb554ec
.long 0xbd48fb30,0xbe3b6ecf,0xbea09ae5,0xbee0924f,0xbdfab273,0xbe8586ce,0xbec9b953,0xbf04f484
.long 0xbe47c5c2,0xbeac7cd4,0xbef15aea,0xbf187fc0,0xbe888e93,0xbed25a09,0xbf0b9a6b,0xbf2ac082
.long 0xbeac7cd4,0xbef6e0cb,0xbf1d7fd1,0xbf3b8f3b,0xbecf7bca,0xbf0cead0,0xbf2e3bde,0xbf4ac77f
.long 0xbef15aea,0xbf1d7fd1,0xbf3daef9,0xbf584853,0xbf08f59b,0xbf2d1469,0xbf4bbbf8,0xbf63f473
.long 0xbf187fc0,0xbf3b8f3b,0xbf584853,0xbf6db293,0xbf273656,0xbf48d8b3,0xbf633c5a,0xbf756d97
.long 0x3f800000,0x3f800000,0x3f800000,0x3f800000,0x3f7ec46d,0x3f7e9bc9,0x3f7e70b0,0x3f7e4323
.long 0x3f7b14be,0x3f7a7302,0x3f79c79d,0x3f791298,0x3f74fa0b,0x3f73913f,0x3f721352,0x3f708066
.long 0x3f6c835e,0x3f6a09a7,0x3f676bd8,0x3f64aa59,0x3f61c598,0x3f5df6be,0x3f59f26a,0x3f55b993
.long 0x3f54db31,0x3f4f7a1f,0x3f49d112,0x3f43e200,0x3f45e403,0x3f3ebc1b,0x3f373a23,0x3f2f61a5
.long 0x3f3504f3,0x3f2beb4a,0x3f226799,0x3f187fc0,0x3f226799,0x3f173c07,0x3f0b9a6b,0x3eff17b2
.long 0x3f0e39da,0x3f00e7e4,0x3ee63375,0x3ec9b953,0x3ef15aea,0x3ed25a09,0x3eb263ef,0x3e919ddd
.long 0x3ec3ef15,0x3ea09ae5,0x3e78cfcc,0x3e2f10a2,0x3e94a031,0x3e5a3997,0x3e09cf86,0x3d621469
.long 0x3e47c5c2,0x3de1bc2e,0x3cc90ab0,0xbd7b2b74,0x3dc8bd36,0x3bc90f88,0xbdafb680,0xbe354098
.long 0x248d3132,0xbdc8bd36,0xbe47c5c2,0xbe94a031,0xbdc8bd36,0xbe4dee60,0xbe9aa086,0xbecc9b8b
.long 0xbe47c5c2,0xbe9aa086,0xbecf7bca,0xbf00e7e4,0xbe94a031,0xbecc9b8b,0xbf00e7e4,0xbf19c200
.long 0xbec3ef15,0xbefc5d27,0xbf187fc0,0xbf3085bb,0xbef15aea,0xbf14b039,0xbf2e3bde,0xbf44e3f5
.long 0xbf0e39da,0xbf299415,0xbf41d870,0xbf5695e5,0xbf226799,0xbf3ca003,0xbf531849,0xbf655e0b
.long 0xbf3504f3,0xbf4d9f02,0xbf61c598,0xbf710908,0xbf45e403,0xbf5c61c7,0xbf6db293,0xbf796e4e
.long 0xbf54db31,0xbf68bf3c,0xbf76ba07,0xbf7e70b0,0xbf61c598,0xbf7294f8,0xbf7cbfc9,0xbf7ffec4
.long 0xbf6c835e,0xbf79c79d,0xbf7fb10f,0xbf7e1324,0xbf74fa0b,0xbf7e4323,0xbf7f84ab,0xbf78b47b
.long 0xbf7b14be,0xbf7ffb11,0xbf7c3b28,0xbf6ff573,0xbf7ec46d,0xbf7eea9d,0xbf75dec6,0xbf63f473
.long 0x3f800000,0x3f800000,0x3f800000,0x3f800000,0x3f7e1324,0x3f7de0b1,0x3f7dabcc,0x3f7d7474
.long 0x3f7853f8,0x3f778bc5,0x3f76ba07,0x3f75dec6,0x3f6ed89e,0x3f6d1c1d,0x3f6b4b0c,0x3f696591
.long 0x3f61c598,0x3f5ebe05,0x3f5b941a,0x3f584853,0x3f514d3d,0x3f4cae79,0x3f47de65,0x3f42de29
.long 0x3f3daef9,0x3f373a23,0x3f3085bb,0x3f299415,0x3f273656,0x3f1ebc12,0x3f15f6d9,0x3f0cead0
.long 0x3f0e39da,0x3f039c3d,0x3ef15aea,0x3edae880,0x3ee63375,0x3ecc9b8b,0x3eb263ef,0x3e97a117
.long 0x3eac7cd4,0x3e8e9a22,0x3e605c13,0x3e22abb6,0x3e605c13,0x3e1c76de,0x3dafb680,0x3c96c9b6
.long 0x3dc8bd36,0x3cc90ab0,0xbd48fb30,0xbdfab273,0xbcc90ab0,0xbdd53db9,0xbe3b6ecf,0xbe8586ce
.long 0xbe164083,0xbe6c9a7f,0xbea09ae5,0xbec9b953,0xbe888e93,0xbeb554ec,0xbee0924f,0xbf04f484
.long 0xbec3ef15,0xbef15aea,0xbf0e39da,0xbf226799,0xbefc5d27,0xbf14b039,0xbf299415,0xbf3ca003
.long 0xbf187fc0,0xbf2e3bde,0xbf41d870,0xbf531849,0xbf3085bb,0xbf44e3f5,0xbf5695e5,0xbf655e0b
.long 0xbf45e403,0xbf584853,0xbf676bd8,0xbf731447,0xbf584853,0xbf6816a8,0xbf740bdd,0xbf7bf531
.long 0xbf676bd8,0xbf740bdd,0xbf7c3b28,0xbf7fd397,0xbf731447,0xbf7bf531,0xbf7fd397,0xbf7e9bc9
.long 0xbf7b14be,0xbf7fb10f,0xbf7ec46d,0xbf7853f8,0xbf7f4e6d,0xbf7f2f9d,0xbf791298,0xbf6d1c1d
.long 0xbf7fb10f,0xbf7a7302,0xbf6ed89e,0xbf5d2d53,0xbf7c3b28,0xbf718f57,0xbf604621,0xbf48d8b3
.long 0xbf74fa0b,0xbf64aa59,0xbf4d9f02,0xbf3085bb,0xbf6a09a7,0xbf53fac3,0xbf373a23,0xbf14b039
.long 0xbf5b941a,0xbf3fc767,0xbf1d7fd1,0xbeebcbbb,0xbf49d112,0xbf286605,0xbf00e7e4,0xbea986c4
.long 0x3f800000,0x3f800000,0x3f800000,0x3f800000,0x3f7d3aac,0x3f7cfe73,0x3f7cbfc9,0x3f7c7eb0
.long 0x3f74fa0b,0x3f740bdd,0x3f731447,0x3f721352,0x3f676bd8,0x3f655e0b,0x3f633c5a,0x3f6106f2
.long 0x3f54db31,0x3f514d3d,0x3f4d9f02,0x3f49d112,0x3f3daef9,0x3f385216,0x3f32c8c9,0x3f2d1469
.long 0x3f226799,0x3f1b02c6,0x3f13682a,0x3f0b9a6b,0x3f039c3d,0x3ef41f07,0x3ee0924f,0x3ecc9b8b
.long 0x3ec3ef15,0x3eac7cd4,0x3e94a031,0x3e78cfcc,0x3e78cfcc,0x3e419b37,0x3e09cf86,0x3da3308c
.long 0x3dc8bd36,0x3d16c32c,0xbcc90ab0,0xbdafb680,0xbd48fb30,0xbdee3876,0xbe3b6ecf,0xbe7ee6e1
.long 0xbe47c5c2,0xbe888e93,0xbeac7cd4,0xbecf7bca,0xbeac7cd4,0xbed25a09,0xbef6e0cb,0xbf0cead0
.long 0xbef15aea,0xbf0b9a6b,0xbf1d7fd1,0xbf2e3bde,0xbf187fc0,0xbf2ac082,0xbf3b8f3b,0xbf4ac77f
.long 0xbf3504f3,0xbf45e403,0xbf54db31,0xbf61c598,0xbf4d9f02,0xbf5c61c7,0xbf68bf3c,0xbf7294f8
.long 0xbf61c598,0xbf6db293,0xbf76ba07,0xbf7cbfc9,0xbf710908,0xbf796e4e,0xbf7e70b0,0xbf7ffec4
.long 0xbf7b14be,0xbf7f4e6d,0xbf7fb10f,0xbf7c3b28,0xbf7fb10f,0xbf7f2f9d,0xbf7a7302,0xbf718f57
.long 0xbf7ec46d,0xbf791298,0xbf6ed89e,0xbf604621,0xbf7853f8,0xbf6d1c1d,0xbf5d2d53,0xbf48d8b3
.long 0xbf6c835e,0xbf5b941a,0xbf45e403,0xbf2beb4a,0xbf5b941a,0xbf44e3f5,0xbf299415,0xbf0a48ad
.long 0xbf45e403,0xbf299415,0xbf08f59b,0xbec9b953,0xbf2beb4a,0xbf0a48ad,0xbec9b953,0xbe72b651
.long 0xbf0e39da,0xbecf7bca,0xbe78cfcc,0xbd96a905,0xbedae880,0xbe8586ce,0xbdafb680,0x3dbc3ac3
.long 0xbe94a031,0xbde1bc2e,0x3d96a905,0x3e827dc0,0xbe164083,0x3d2fe007,0x3e6c9a7f,0x3ed25a09
.long 0x3f800000,0x3f800000,0x3f800000,0x3f800000,0x3f7c3b28,0x3f7bf531,0x3f7baccd,0x3f7b61fc
.long 0x3f710908,0x3f6ff573,0x3f6ed89e,0x3f6db293,0x3f5ebe05,0x3f5c61c7,0x3f59f26a,0x3f577026
.long 0x3f45e403,0x3f41d870,0x3f3daef9,0x3f396842,0x3f273656,0x3f212ff9,0x3f1b02c6,0x3f14b039
.long 0x3f039c3d,0x3ef6e0cb,0x3ee63375,0x3ed53641,0x3eb8442a,0x3ea395c5,0x3e8e9a22,0x3e72b651
.long 0x3e47c5c2,0x3e164083,0x3dc8bd36,0x3d48fb30,0x3cc90ab0,0xbcfb49ba,0xbdafb680,0xbe1008b7
.long 0xbe164083,0xbe541501,0xbe888e93,0xbea68f12,0xbea09ae5,0xbec1071e,0xbee0924f,0xbeff17b2
.long 0xbef15aea,0xbf08f59b,0xbf187fc0,0xbf273656,0xbf1d7fd1,0xbf2d1469,0xbf3b8f3b,0xbf48d8b3
.long 0xbf3daef9,0xbf4bbbf8,0xbf584853,0xbf633c5a,0xbf584853,0xbf63f473,0xbf6db293,0xbf756d97
.long 0xbf6c835e,0xbf74fa0b,0xbf7b14be,0xbf7ec46d,0xbf79c79d,0xbf7e4323,0xbf7ffb11,0xbf7eea9d
.long 0xbf7fb10f,0xbf7f84ab,0xbf7c3b28,0xbf75dec6,0xbf7e1324,0xbf78b47b,0xbf6ff573,0xbf63f473
.long 0xbf74fa0b,0xbf6a09a7,0xbf5b941a,0xbf49d112,0xbf64aa59,0xbf53fac3,0xbf3fc767,0xbf286605
.long 0xbf4d9f02,0xbf373a23,0xbf1d7fd1,0xbf00e7e4,0xbf3085bb,0xbf14b039,0xbeebcbbb,0xbea986c4
.long 0xbf0e39da,0xbedae880,0xbe94a031,0xbe164083,0xbecf7bca,0xbe8586ce,0xbde1bc2e,0x3d2fe007
.long 0xbe78cfcc,0xbdafb680,0x3d96a905,0x3e6c9a7f,0xbd96a905,0x3dbc3ac3,0x3e827dc0,0x3ed25a09
.long 0x3dc8bd36,0x3e888e93,0x3edae880,0x3f13682a,0x3e888e93,0x3eddbe79,0x3f15f6d9,0x3f385216
.long 0x3edae880,0x3f15f6d9,0x3f396842,0x3f5695e5,0x3f13682a,0x3f385216,0x3f5695e5,0x3f6d1c1d
.long 0x0,0x0,0x0,0x0,0x0,0x3bc90f88,0x3c490e90,0x3c96c9b6
.long 0x0,0x3c490e90,0x3cc90ab0,0x3d16c32c,0x0,0x3c96c9b6,0x3d16c32c,0x3d621469
.long 0x0,0x3cc90ab0,0x3d48fb30,0x3d96a905,0x0,0x3cfb49ba,0x3d7b2b74,0x3dbc3ac3
.long 0x0,0x3d16c32c,0x3d96a905,0x3de1bc2e,0x0,0x3d2fe007,0x3dafb680,0x3e039502
.long 0x0,0x3d48fb30,0x3dc8bd36,0x3e164083,0x0,0x3d621469,0x3de1bc2e,0x3e28defc
.long 0x0,0x3d7b2b74,0x3dfab273,0x3e3b6ecf,0x0,0x3d8a200a,0x3e09cf86,0x3e4dee60
.long 0x0,0x3d96a905,0x3e164083,0x3e605c13,0x0,0x3da3308c,0x3e22abb6,0x3e72b651
.long 0x0,0x3dafb680,0x3e2f10a2,0x3e827dc0,0x0,0x3dbc3ac3,0x3e3b6ecf,0x3e8b9507
.long 0x0,0x3dc8bd36,0x3e47c5c2,0x3e94a031,0x0,0x3dd53db9,0x3e541501,0x3e9d9e78
.long 0x0,0x3de1bc2e,0x3e605c13,0x3ea68f12,0x0,0x3dee3876,0x3e6c9a7f,0x3eaf713a
.long 0x0,0x3dfab273,0x3e78cfcc,0x3eb8442a,0x0,0x3e039502,0x3e827dc0,0x3ec1071e
.long 0x0,0x3e09cf86,0x3e888e93,0x3ec9b953,0x0,0x3e1008b7,0x3e8e9a22,0x3ed25a09
.long 0x0,0x3e164083,0x3e94a031,0x3edae880,0x0,0x3e1c76de,0x3e9aa086,0x3ee363fa
.long 0x0,0x3e22abb6,0x3ea09ae5,0x3eebcbbb,0x0,0x3e28defc,0x3ea68f12,0x3ef41f07
.long 0x0,0x3e2f10a2,0x3eac7cd4,0x3efc5d27,0x0,0x3e354098,0x3eb263ef,0x3f0242b1
.long 0x0,0x3e3b6ecf,0x3eb8442a,0x3f064b82,0x0,0x3e419b37,0x3ebe1d4a,0x3f0a48ad
.long 0x0,0x0,0x0,0x0,0x3cc90ab0,0x3cfb49ba,0x3d16c32c,0x3d2fe007
.long 0x3d48fb30,0x3d7b2b74,0x3d96a905,0x3dafb680,0x3d96a905,0x3dbc3ac3,0x3de1bc2e,0x3e039502
.long 0x3dc8bd36,0x3dfab273,0x3e164083,0x3e2f10a2,0x3dfab273,0x3e1c76de,0x3e3b6ecf,0x3e5a3997
.long 0x3e164083,0x3e3b6ecf,0x3e605c13,0x3e827dc0,0x3e2f10a2,0x3e5a3997,0x3e827dc0,0x3e97a117
.long 0x3e47c5c2,0x3e78cfcc,0x3e94a031,0x3eac7cd4,0x3e605c13,0x3e8b9507,0x3ea68f12,0x3ec1071e
.long 0x3e78cfcc,0x3e9aa086,0x3eb8442a,0x3ed53641,0x3e888e93,0x3ea986c4,0x3ec9b953,0x3ee900b7
.long 0x3e94a031,0x3eb8442a,0x3edae880,0x3efc5d27,0x3ea09ae5,0x3ec6d529,0x3eebcbbb,0x3f07a136
.long 0x3eac7cd4,0x3ed53641,0x3efc5d27,0x3f10d3cd,0x3eb8442a,0x3ee363fa,0x3f064b82,0x3f19c200
.long 0x3ec3ef15,0x3ef15aea,0x3f0e39da,0x3f226799,0x3ecf7bca,0x3eff17b2,0x3f15f6d9,0x3f2ac082
.long 0x3edae880,0x3f064b82,0x3f1d7fd1,0x3f32c8c9,0x3ee63375,0x3f0cead0,0x3f24d225,0x3f3a7ca4
.long 0x3ef15aea,0x3f13682a,0x3f2beb4a,0x3f41d870,0x3efc5d27,0x3f19c200,0x3f32c8c9,0x3f48d8b3
.long 0x3f039c3d,0x3f1ff6cb,0x3f396842,0x3f4f7a1f,0x3f08f59b,0x3f26050a,0x3f3fc767,0x3f55b993
.long 0x3f0e39da,0x3f2beb4a,0x3f45e403,0x3f5b941a,0x3f13682a,0x3f31a81d,0x3f4bbbf8,0x3f6106f2
.long 0x3f187fc0,0x3f373a23,0x3f514d3d,0x3f660f88,0x3f1d7fd1,0x3f3ca003,0x3f5695e5,0x3f6aab7b
.long 0x3f226799,0x3f41d870,0x3f5b941a,0x3f6ed89e,0x3f273656,0x3f46e22a,0x3f604621,0x3f7294f8
.long 0x3f2beb4a,0x3f4bbbf8,0x3f64aa59,0x3f75dec6,0x3f3085bb,0x3f5064af,0x3f68bf3c,0x3f78b47b
.long 0x0,0x0,0x0,0x0,0x3d48fb30,0x3d621469,0x3d7b2b74,0x3d8a200a
.long 0x3dc8bd36,0x3de1bc2e,0x3dfab273,0x3e09cf86,0x3e164083,0x3e28defc,0x3e3b6ecf,0x3e4dee60
.long 0x3e47c5c2,0x3e605c13,0x3e78cfcc,0x3e888e93,0x3e78cfcc,0x3e8b9507,0x3e9aa086,0x3ea986c4
.long 0x3e94a031,0x3ea68f12,0x3eb8442a,0x3ec9b953,0x3eac7cd4,0x3ec1071e,0x3ed53641,0x3ee900b7
.long 0x3ec3ef15,0x3edae880,0x3ef15aea,0x3f039c3d,0x3edae880,0x3ef41f07,0x3f064b82,0x3f121eb0
.long 0x3ef15aea,0x3f064b82,0x3f13682a,0x3f1ff6cb,0x3f039c3d,0x3f121eb0,0x3f1ff6cb,0x3f2d1469
.long 0x3f0e39da,0x3f1d7fd1,0x3f2beb4a,0x3f396842,0x3f187fc0,0x3f286605,0x3f373a23,0x3f44e3f5
.long 0x3f226799,0x3f32c8c9,0x3f41d870,0x3f4f7a1f,0x3f2beb4a,0x3f3ca003,0x3f4bbbf8,0x3f591e6a
.long 0x3f3504f3,0x3f45e403,0x3f54db31,0x3f61c598,0x3f3daef9,0x3f4e8d90,0x3f5d2d53,0x3f696591
.long 0x3f45e403,0x3f5695e5,0x3f64aa59,0x3f6ff573,0x3f4d9f02,0x3f5df6be,0x3f6b4b0c,0x3f756d97
.long 0x3f54db31,0x3f64aa59,0x3f710908,0x3f79c79d,0x3f5b941a,0x3f6aab7b,0x3f75dec6,0x3f7cfe73
.long 0x3f61c598,0x3f6ff573,0x3f79c79d,0x3f7f0e58,0x3f676bd8,0x3f748422,0x3f7cbfc9,0x3f7ff4e6
.long 0x3f6c835e,0x3f7853f8,0x3f7ec46d,0x3f7fb10f,0x3f710908,0x3f7b61fc,0x3f7fd397,0x3f7e4323
.long 0x3f74fa0b,0x3f7dabcc,0x3f7fec43,0x3f7baccd,0x3f7853f8,0x3f7f2f9d,0x3f7f0e58,0x3f77f110
.long 0x3f7b14be,0x3f7fec43,0x3f7d3aac,0x3f731447,0x3f7d3aac,0x3f7fe129,0x3f7a7302,0x3f6d1c1d
.long 0x3f7ec46d,0x3f7f0e58,0x3f76ba07,0x3f660f88,0x3f7fb10f,0x3f7d7474,0x3f721352,0x3f5df6be
.long 0x0,0x0,0x0,0x0,0x3d96a905,0x3da3308c,0x3dafb680,0x3dbc3ac3
.long 0x3e164083,0x3e22abb6,0x3e2f10a2,0x3e3b6ecf,0x3e605c13,0x3e72b651,0x3e827dc0,0x3e8b9507
.long 0x3e94a031,0x3ea09ae5,0x3eac7cd4,0x3eb8442a,0x3eb8442a,0x3ec6d529,0x3ed53641,0x3ee363fa
.long 0x3edae880,0x3eebcbbb,0x3efc5d27,0x3f064b82,0x3efc5d27,0x3f07a136,0x3f10d3cd,0x3f19c200
.long 0x3f0e39da,0x3f187fc0,0x3f226799,0x3f2beb4a,0x3f1d7fd1,0x3f286605,0x3f32c8c9,0x3f3ca003
.long 0x3f2beb4a,0x3f373a23,0x3f41d870,0x3f4bbbf8,0x3f396842,0x3f44e3f5,0x3f4f7a1f,0x3f591e6a
.long 0x3f45e403,0x3f514d3d,0x3f5b941a,0x3f64aa59,0x3f514d3d,0x3f5c61c7,0x3f660f88,0x3f6e46be
.long 0x3f5b941a,0x3f660f88,0x3f6ed89e,0x3f75dec6,0x3f64aa59,0x3f6e46be,0x3f75dec6,0x3f7b61fc
.long 0x3f6c835e,0x3f74fa0b,0x3f7b14be,0x3f7ec46d,0x3f731447,0x3f7a1e84,0x3f7e70b0,0x3f7ffec4
.long 0x3f7853f8,0x3f7dabcc,0x3f7fec43,0x3f7f0e58,0x3f7c3b28,0x3f7f9c18,0x3f7f84ab,0x3f7bf531
.long 0x3f7ec46d,0x3f7fec43,0x3f7d3aac,0x3f76ba07,0x3f7fec43,0x3f7e9bc9,0x3f791298,0x3f6f6830
.long 0x3f7fb10f,0x3f7baccd,0x3f731447,0x3f660f88,0x3f7e1324,0x3f772417,0x3f6b4b0c,0x3f5ac450
.long 0x3f7b14be,0x3f710908,0x3f61c598,0x3f4d9f02,0x3f76ba07,0x3f696591,0x3f5695e5,0x3f3ebc1b
.long 0x3f710908,0x3f604621,0x3f49d112,0x3f2e3bde,0x3f6a09a7,0x3f55b993,0x3f3b8f3b,0x3f1c420c
.long 0x3f61c598,0x3f49d112,0x3f2beb4a,0x3f08f59b,0x3f584853,0x3f3ca003,0x3f1b02c6,0x3ee900b7
.long 0x3f4d9f02,0x3f2e3bde,0x3f08f59b,0x3ebe1d4a,0x3f41d870,0x3f1ebc12,0x3eebcbbb,0x3e919ddd
.long 0x0,0x0,0x0,0x0,0x3dc8bd36,0x3dd53db9,0x3de1bc2e,0x3dee3876
.long 0x3e47c5c2,0x3e541501,0x3e605c13,0x3e6c9a7f,0x3e94a031,0x3e9d9e78,0x3ea68f12,0x3eaf713a
.long 0x3ec3ef15,0x3ecf7bca,0x3edae880,0x3ee63375,0x3ef15aea,0x3eff17b2,0x3f064b82,0x3f0cead0
.long 0x3f0e39da,0x3f15f6d9,0x3f1d7fd1,0x3f24d225,0x3f226799,0x3f2ac082,0x3f32c8c9,0x3f3a7ca4
.long 0x3f3504f3,0x3f3daef9,0x3f45e403,0x3f4d9f02,0x3f45e403,0x3f4e8d90,0x3f5695e5,0x3f5df6be
.long 0x3f54db31,0x3f5d2d53,0x3f64aa59,0x3f6b4b0c,0x3f61c598,0x3f696591,0x3f6ff573,0x3f756d97
.long 0x3f6c835e,0x3f731447,0x3f7853f8,0x3f7c3b28,0x3f74fa0b,0x3f7a1e84,0x3f7dabcc,0x3f7f9c18
.long 0x3f7b14be,0x3f7e70b0,0x3f7fec43,0x3f7f84ab,0x3f7ec46d,0x3f7ffec4,0x3f7f0e58,0x3f7bf531
.long 0x3f800000,0x3f7ec46d,0x3f7b14be,0x3f74fa0b,0x3f7ec46d,0x3f7ac516,0x3f740bdd,0x3f6aab7b
.long 0x3f7b14be,0x3f740bdd,0x3f6a09a7,0x3f5d2d53,0x3f74fa0b,0x3f6aab7b,0x3f5d2d53,0x3f4cae79
.long 0x3f6c835e,0x3f5ebe05,0x3f4d9f02,0x3f396842,0x3f61c598,0x3f5064af,0x3f3b8f3b,0x3f239da9
.long 0x3f54db31,0x3f3fc767,0x3f273656,0x3f0b9a6b,0x3f45e403,0x3f2d1469,0x3f10d3cd,0x3ee363fa
.long 0x3f3504f3,0x3f187fc0,0x3ef15aea,0x3eac7cd4,0x3f226799,0x3f0242b1,0x3ebe1d4a,0x3e667c66
.long 0x3f0e39da,0x3ed53641,0x3e888e93,0x3de1bc2e,0x3ef15aea,0x3ea395c5,0x3e22abb6,0xbbc90f88
.long 0x3ec3ef15,0x3e605c13,0x3d48fb30,0xbdfab273,0x3e94a031,0x3dee3876,0xbd7b2b74,0xbe72b651
.long 0x3e47c5c2,0x3c490e90,0xbe2f10a2,0xbeb263ef,0x3dc8bd36,0xbdbc3ac3,0xbe8e9a22,0xbee900b7
.long 0x0,0x0,0x0,0x0,0x3dfab273,0x3e039502,0x3e09cf86,0x3e1008b7
.long 0x3e78cfcc,0x3e827dc0,0x3e888e93,0x3e8e9a22,0x3eb8442a,0x3ec1071e,0x3ec9b953,0x3ed25a09
.long 0x3ef15aea,0x3efc5d27,0x3f039c3d,0x3f08f59b,0x3f13682a,0x3f19c200,0x3f1ff6cb,0x3f26050a
.long 0x3f2beb4a,0x3f32c8c9,0x3f396842,0x3f3fc767,0x3f41d870,0x3f48d8b3,0x3f4f7a1f,0x3f55b993
.long 0x3f54db31,0x3f5b941a,0x3f61c598,0x3f676bd8,0x3f64aa59,0x3f6aab7b,0x3f6ff573,0x3f748422
.long 0x3f710908,0x3f75dec6,0x3f79c79d,0x3f7cbfc9,0x3f79c79d,0x3f7cfe73,0x3f7f0e58,0x3f7ff4e6
.long 0x3f7ec46d,0x3f7fec43,0x3f7fb10f,0x3f7e1324,0x3f7fec43,0x3f7e9bc9,0x3f7baccd,0x3f772417
.long 0x3f7d3aac,0x3f791298,0x3f731447,0x3f6b4b0c,0x3f76ba07,0x3f6f6830,0x3f660f88,0x3f5ac450
.long 0x3f6c835e,0x3f61c598,0x3f54db31,0x3f45e403,0x3f5ebe05,0x3f5064af,0x3f3fc767,0x3f2d1469
.long 0x3f4d9f02,0x3f3b8f3b,0x3f273656,0x3f10d3cd,0x3f396842,0x3f239da9,0x3f0b9a6b,0x3ee363fa
.long 0x3f226799,0x3f08f59b,0x3edae880,0x3ea09ae5,0x3f08f59b,0x3ed8106b,0x3e9aa086,0x3e354098
.long 0x3edae880,0x3e9aa086,0x3e2f10a2,0x3d16c32c,0x3ea09ae5,0x3e354098,0x3d16c32c,0xbdd53db9
.long 0x3e47c5c2,0x3d48fb30,0xbdc8bd36,0xbe78cfcc,0x3d96a905,0xbda3308c,0xbe6c9a7f,0xbec1071e
.long 0xbd48fb30,0xbe541501,0xbeb8442a,0xbf00e7e4,0xbe2f10a2,0xbea986c4,0xbef6e0cb,0xbf1ebc12
.long 0xbe94a031,0xbee63375,0xbf187fc0,0xbf396842,0xbecf7bca,0xbf0f8784,0xbf32c8c9,0xbf5064af
.long 0xbf039c3d,0xbf299415,0xbf49d112,0xbf633c5a,0xbf1d7fd1,0xbf40d0da,0xbf5d2d53,0xbf718f57
.long 0x0,0x0,0x0,0x0,0x3e164083,0x3e1c76de,0x3e22abb6,0x3e28defc
.long 0x3e94a031,0x3e9aa086,0x3ea09ae5,0x3ea68f12,0x3edae880,0x3ee363fa,0x3eebcbbb,0x3ef41f07
.long 0x3f0e39da,0x3f13682a,0x3f187fc0,0x3f1d7fd1,0x3f2beb4a,0x3f31a81d,0x3f373a23,0x3f3ca003
.long 0x3f45e403,0x3f4bbbf8,0x3f514d3d,0x3f5695e5,0x3f5b941a,0x3f6106f2,0x3f660f88,0x3f6aab7b
.long 0x3f6c835e,0x3f710908,0x3f74fa0b,0x3f7853f8,0x3f7853f8,0x3f7b61fc,0x3f7dabcc,0x3f7f2f9d
.long 0x3f7ec46d,0x3f7fd397,0x3f7fec43,0x3f7f0e58,0x3f7fb10f,0x3f7e4323,0x3f7baccd,0x3f77f110
.long 0x3f7b14be,0x3f76ba07,0x3f710908,0x3f6a09a7,0x3f710908,0x3f696591,0x3f604621,0x3f55b993
.long 0x3f61c598,0x3f5695e5,0x3f49d112,0x3f3b8f3b,0x3f4d9f02,0x3f3ebc1b,0x3f2e3bde,0x3f1c420c
.long 0x3f3504f3,0x3f226799,0x3f0e39da,0x3ef15aea,0x3f187fc0,0x3f0242b1,0x3ed53641,0x3ea395c5
.long 0x3ef15aea,0x3ebe1d4a,0x3e888e93,0x3e22abb6,0x3eac7cd4,0x3e667c66,0x3de1bc2e,0xbbc90f88
.long 0x3e47c5c2,0x3d96a905,0xbd48fb30,0xbe2f10a2,0x3d48fb30,0xbda3308c,0xbe541501,0xbea986c4
.long 0xbdc8bd36,0xbe6c9a7f,0xbeb8442a,0xbef6e0cb,0xbe78cfcc,0xbec1071e,0xbf00e7e4,0xbf1ebc12
.long 0xbec3ef15,0xbf039c3d,0xbf226799,0xbf3daef9,0xbf039c3d,0xbf239da9,0xbf3fc767,0xbf577026
.long 0xbf226799,0xbf3fc767,0xbf584853,0xbf6b4b0c,0xbf3daef9,0xbf577026,0xbf6b4b0c,0xbf78b47b
.long 0xbf54db31,0xbf6a09a7,0xbf7853f8,0xbf7f4e6d,0xbf676bd8,0xbf772417,0xbf7f0e58,0xbf7eea9d
.long 0xbf74fa0b,0xbf7e70b0,0xbf7f4e6d,0xbf778bc5,0xbf7d3aac,0xbf7fc38f,0xbf791298,0xbf696591
.long 0x0,0x0,0x0,0x0,0x3e2f10a2,0x3e354098,0x3e3b6ecf,0x3e419b37
.long 0x3eac7cd4,0x3eb263ef,0x3eb8442a,0x3ebe1d4a,0x3efc5d27,0x3f0242b1,0x3f064b82,0x3f0a48ad
.long 0x3f226799,0x3f273656,0x3f2beb4a,0x3f3085bb,0x3f41d870,0x3f46e22a,0x3f4bbbf8,0x3f5064af
.long 0x3f5b941a,0x3f604621,0x3f64aa59,0x3f68bf3c,0x3f6ed89e,0x3f7294f8,0x3f75dec6,0x3f78b47b
.long 0x3f7b14be,0x3f7d3aac,0x3f7ec46d,0x3f7fb10f,0x3f7fec43,0x3f7fe129,0x3f7f0e58,0x3f7d7474
.long 0x3f7d3aac,0x3f7a7302,0x3f76ba07,0x3f721352,0x3f731447,0x3f6d1c1d,0x3f660f88,0x3f5df6be
.long 0x3f61c598,0x3f584853,0x3f4d9f02,0x3f41d870,0x3f49d112,0x3f3ca003,0x3f2e3bde,0x3f1ebc12
.long 0x3f2beb4a,0x3f1b02c6,0x3f08f59b,0x3eebcbbb,0x3f08f59b,0x3ee900b7,0x3ebe1d4a,0x3e919ddd
.long 0x3ec3ef15,0x3e94a031,0x3e47c5c2,0x3dc8bd36,0x3e605c13,0x3dee3876,0x3c490e90,0xbdbc3ac3
.long 0x3d48fb30,0xbd7b2b74,0xbe2f10a2,0xbe8e9a22,0xbdfab273,0xbe72b651,0xbeb263ef,0xbee900b7
.long 0xbe94a031,0xbecf7bca,0xbf039c3d,0xbf1d7fd1,0xbee63375,0xbf0f8784,0xbf299415,0xbf40d0da
.long 0xbf187fc0,0xbf32c8c9,0xbf49d112,0xbf5d2d53,0xbf396842,0xbf5064af,0xbf633c5a,0xbf718f57
.long 0xbf54db31,0xbf676bd8,0xbf74fa0b,0xbf7d3aac,0xbf6a09a7,0xbf772417,0xbf7e70b0,0xbf7fc38f
.long 0xbf7853f8,0xbf7f0e58,0xbf7f4e6d,0xbf791298,0xbf7f4e6d,0xbf7eea9d,0xbf778bc5,0xbf696591
.long 0xbf7ec46d,0xbf76ba07,0xbf676bd8,0xbf514d3d,0xbf76ba07,0xbf66becc,0xbf4f7a1f,0xbf31a81d
.long 0xbf676bd8,0xbf4f7a1f,0xbf3085bb,0xbf0b9a6b,0xbf514d3d,0xbf31a81d,0xbf0b9a6b,0xbec1071e
.long 0x3e000000,0x3e000000,0x3e000000,0x3e000000,0x3e000000,0x3dfffec4,0x3dfffb11,0x3dfff4e6
.long 0x3e000000,0x3dfffb11,0x3dffec43,0x3dffd397,0x3e000000,0x3dfff4e6,0x3dffd397,0x3dff9c18
.long 0x3e000000,0x3dffec43,0x3dffb10f,0x3dff4e6d,0x3e000000,0x3dffe129,0x3dff84ab,0x3dfeea9d
.long 0x3e000000,0x3dffd397,0x3dff4e6d,0x3dfe70b0,0x3e000000,0x3dffc38f,0x3dff0e58,0x3dfde0b1
.long 0x3e000000,0x3dffb10f,0x3dfec46d,0x3dfd3aac,0x3e000000,0x3dff9c18,0x3dfe70b0,0x3dfc7eb0
.long 0x3e000000,0x3dff84ab,0x3dfe1324,0x3dfbaccd,0x3e000000,0x3dff6ac7,0x3dfdabcc,0x3dfac516
.long 0x3e000000,0x3dff4e6d,0x3dfd3aac,0x3df9c79d,0x3e000000,0x3dff2f9d,0x3dfcbfc9,0x3df8b47b
.long 0x3e000000,0x3dff0e58,0x3dfc3b28,0x3df78bc5,0x3e000000,0x3dfeea9d,0x3dfbaccd,0x3df64d97
.long 0x3e000000,0x3dfec46d,0x3dfb14be,0x3df4fa0b,0x3e000000,0x3dfe9bc9,0x3dfa7302,0x3df3913f
.long 0x3e000000,0x3dfe70b0,0x3df9c79d,0x3df21352,0x3e000000,0x3dfe4323,0x3df91298,0x3df08066
.long 0x3e000000,0x3dfe1324,0x3df853f8,0x3deed89e,0x3e000000,0x3dfde0b1,0x3df78bc5,0x3ded1c1d
.long 0x3e000000,0x3dfdabcc,0x3df6ba07,0x3deb4b0c,0x3e000000,0x3dfd7474,0x3df5dec6,0x3de96591
.long 0x3e000000,0x3dfd3aac,0x3df4fa0b,0x3de76bd8,0x3e000000,0x3dfcfe73,0x3df40bdd,0x3de55e0b
.long 0x3e000000,0x3dfcbfc9,0x3df31447,0x3de33c5a,0x3e000000,0x3dfc7eb0,0x3df21352,0x3de106f2
.long 0x3e000000,0x3dfc3b28,0x3df10908,0x3ddebe05,0x3e000000,0x3dfbf531,0x3deff573,0x3ddc61c7
.long 0x3e000000,0x3dfbaccd,0x3deed89e,0x3dd9f26a,0x3e000000,0x3dfb61fc,0x3dedb293,0x3dd77026
.long 0x3e000000,0x3e000000,0x3e000000,0x3e000000,0x3dffec43,0x3dffe129,0x3dffd397,0x3dffc38f
.long 0x3dffb10f,0x3dff84ab,0x3dff4e6d,0x3dff0e58,0x3dff4e6d,0x3dfeea9d,0x3dfe70b0,0x3dfde0b1
.long 0x3dfec46d,0x3dfe1324,0x3dfd3aac,0x3dfc3b28,0x3dfe1324,0x3dfcfe73,0x3dfbaccd,0x3dfa1e84
.long 0x3dfd3aac,0x3dfbaccd,0x3df9c79d,0x3df78bc5,0x3dfc3b28,0x3dfa1e84,0x3df78bc5,0x3df48422
.long 0x3dfb14be,0x3df853f8,0x3df4fa0b,0x3df10908,0x3df9c79d,0x3df64d97,0x3df21352,0x3ded1c1d
.long 0x3df853f8,0x3df40bdd,0x3deed89e,0x3de8bf3c,0x3df6ba07,0x3df18f57,0x3deb4b0c,0x3de3f473
.long 0x3df4fa0b,0x3deed89e,0x3de76bd8,0x3ddebe05,0x3df31447,0x3debe858,0x3de33c5a,0x3dd91e6a
.long 0x3df10908,0x3de8bf3c,0x3ddebe05,0x3dd31849,0x3deed89e,0x3de55e0b,0x3dd9f26a,0x3dccae79
.long 0x3dec835e,0x3de1c598,0x3dd4db31,0x3dc5e403,0x3dea09a7,0x3dddf6be,0x3dcf7a1f,0x3dbebc1b
.long 0x3de76bd8,0x3dd9f26a,0x3dc9d112,0x3db73a23,0x3de4aa59,0x3dd5b993,0x3dc3e200,0x3daf61a5
.long 0x3de1c598,0x3dd14d3d,0x3dbdaef9,0x3da73656,0x3ddebe05,0x3dccae79,0x3db73a23,0x3d9ebc12
.long 0x3ddb941a,0x3dc7de65,0x3db085bb,0x3d95f6d9,0x3dd84853,0x3dc2de29,0x3da99415,0x3d8cead0
.long 0x3dd4db31,0x3dbdaef9,0x3da26799,0x3d839c3d,0x3dd14d3d,0x3db85216,0x3d9b02c6,0x3d741f07
.long 0x3dcd9f02,0x3db2c8c9,0x3d93682a,0x3d60924f,0x3dc9d112,0x3dad1469,0x3d8b9a6b,0x3d4c9b8b
.long 0x3dc5e403,0x3da73656,0x3d839c3d,0x3d38442a,0x3dc1d870,0x3da12ff9,0x3d76e0cb,0x3d2395c5
.long 0x3dbdaef9,0x3d9b02c6,0x3d663375,0x3d0e9a22,0x3db96842,0x3d94b039,0x3d553641,0x3cf2b651
.long 0x3e000000,0x3e000000,0x3e000000,0x3e000000,0x3dffb10f,0x3dff9c18,0x3dff84ab,0x3dff6ac7
.long 0x3dfec46d,0x3dfe70b0,0x3dfe1324,0x3dfdabcc,0x3dfd3aac,0x3dfc7eb0,0x3dfbaccd,0x3dfac516
.long 0x3dfb14be,0x3df9c79d,0x3df853f8,0x3df6ba07,0x3df853f8,0x3df64d97,0x3df40bdd,0x3df18f57
.long 0x3df4fa0b,0x3df21352,0x3deed89e,0x3deb4b0c,0x3df10908,0x3ded1c1d,0x3de8bf3c,0x3de3f473
.long 0x3dec835e,0x3de76bd8,0x3de1c598,0x3ddb941a,0x3de76bd8,0x3de106f2,0x3dd9f26a,0x3dd233c6
.long 0x3de1c598,0x3dd9f26a,0x3dd14d3d,0x3dc7de65,0x3ddb941a,0x3dd233c6,0x3dc7de65,0x3dbca003
.long 0x3dd4db31,0x3dc9d112,0x3dbdaef9,0x3db085bb,0x3dcd9f02,0x3dc0d0da,0x3db2c8c9,0x3da39da9
.long 0x3dc5e403,0x3db73a23,0x3da73656,0x3d95f6d9,0x3dbdaef9,0x3dad1469,0x3d9b02c6,0x3d87a136
.long 0x3db504f3,0x3da26799,0x3d8e39da,0x3d715aea,0x3dabeb4a,0x3d973c07,0x3d80e7e4,0x3d525a09
.long 0x3da26799,0x3d8b9a6b,0x3d663375,0x3d3263ef,0x3d987fc0,0x3d7f17b2,0x3d49b953,0x3d119ddd
.long 0x3d8e39da,0x3d663375,0x3d2c7cd4,0x3ce05c13,0x3d839c3d,0x3d4c9b8b,0x3d0e9a22,0x3c9c76de
.long 0x3d715aea,0x3d3263ef,0x3ce05c13,0x3c2fb680,0x3d5ae880,0x3d17a117,0x3ca2abb6,0x3b16c9b6
.long 0x3d43ef15,0x3cf8cfcc,0x3c48bd36,0xbbc8fb30,0x3d2c7cd4,0x3cc19b37,0x3b96c32c,0xbc6e3876
.long 0x3d14a031,0x3c89cf86,0xbb490ab0,0xbcbb6ecf,0x3cf8cfcc,0x3c23308c,0xbc2fb680,0xbcfee6e1
.long 0x3cc7c5c2,0x3b490ab0,0xbc964083,0xbd209ae5,0x3c964083,0xbb7b49ba,0xbcd41501,0xbd41071e
.long 0x3c48bd36,0xbc2fb680,0xbd088e93,0xbd60924f,0x3bc8fb30,0xbc9008b7,0xbd268f12,0xbd7f17b2
.long 0x3e000000,0x3e000000,0x3e000000,0x3e000000,0x3dff4e6d,0x3dff2f9d,0x3dff0e58,0x3dfeea9d
.long 0x3dfd3aac,0x3dfcbfc9,0x3dfc3b28,0x3dfbaccd,0x3df9c79d,0x3df8b47b,0x3df78bc5,0x3df64d97
.long 0x3df4fa0b,0x3df31447,0x3df10908,0x3deed89e,0x3deed89e,0x3debe858,0x3de8bf3c,0x3de55e0b
.long 0x3de76bd8,0x3de33c5a,0x3ddebe05,0x3dd9f26a,0x3ddebe05,0x3dd91e6a,0x3dd31849,0x3dccae79
.long 0x3dd4db31,0x3dcd9f02,0x3dc5e403,0x3dbdaef9,0x3dc9d112,0x3dc0d0da,0x3db73a23,0x3dad1469
.long 0x3dbdaef9,0x3db2c8c9,0x3da73656,0x3d9b02c6,0x3db085bb,0x3da39da9,0x3d95f6d9,0x3d87a136
.long 0x3da26799,0x3d93682a,0x3d839c3d,0x3d663375,0x3d93682a,0x3d8242b1,0x3d60924f,0x3d3b31a0
.long 0x3d839c3d,0x3d60924f,0x3d38442a,0x3d0e9a22,0x3d663375,0x3d3b31a0,0x3d0e9a22,0x3cc19b37
.long 0x3d43ef15,0x3d14a031,0x3cc7c5c2,0x3c48bd36,0x3d209ae5,0x3cda3997,0x3c61bc2e,0x3a490f88
.long 0x3cf8cfcc,0x3c89cf86,0x3b490ab0,0xbc2fb680,0x3caf10a2,0x3be21469,0xbbfb2b74,0xbcb54098
.long 0x3c48bd36,0xbb490ab0,0xbc964083,0xbd088e93,0x3b490ab0,0xbc553db9,0xbcec9a7f,0xbd3554ec
.long 0xbbc8fb30,0xbcbb6ecf,0xbd209ae5,0xbd60924f,0xbc7ab273,0xbd0586ce,0xbd49b953,0xbd84f484
.long 0xbcc7c5c2,0xbd2c7cd4,0xbd715aea,0xbd987fc0,0xbd088e93,0xbd525a09,0xbd8b9a6b,0xbdaac082
.long 0xbd2c7cd4,0xbd76e0cb,0xbd9d7fd1,0xbdbb8f3b,0xbd4f7bca,0xbd8cead0,0xbdae3bde,0xbdcac77f
.long 0xbd715aea,0xbd9d7fd1,0xbdbdaef9,0xbdd84853,0xbd88f59b,0xbdad1469,0xbdcbbbf8,0xbde3f473
.long 0xbd987fc0,0xbdbb8f3b,0xbdd84853,0xbdedb293,0xbda73656,0xbdc8d8b3,0xbde33c5a,0xbdf56d97
.long 0x3e000000,0x3e000000,0x3e000000,0x3e000000,0x3dfec46d,0x3dfe9bc9,0x3dfe70b0,0x3dfe4323
.long 0x3dfb14be,0x3dfa7302,0x3df9c79d,0x3df91298,0x3df4fa0b,0x3df3913f,0x3df21352,0x3df08066
.long 0x3dec835e,0x3dea09a7,0x3de76bd8,0x3de4aa59,0x3de1c598,0x3dddf6be,0x3dd9f26a,0x3dd5b993
.long 0x3dd4db31,0x3dcf7a1f,0x3dc9d112,0x3dc3e200,0x3dc5e403,0x3dbebc1b,0x3db73a23,0x3daf61a5
.long 0x3db504f3,0x3dabeb4a,0x3da26799,0x3d987fc0,0x3da26799,0x3d973c07,0x3d8b9a6b,0x3d7f17b2
.long 0x3d8e39da,0x3d80e7e4,0x3d663375,0x3d49b953,0x3d715aea,0x3d525a09,0x3d3263ef,0x3d119ddd
.long 0x3d43ef15,0x3d209ae5,0x3cf8cfcc,0x3caf10a2,0x3d14a031,0x3cda3997,0x3c89cf86,0x3be21469
.long 0x3cc7c5c2,0x3c61bc2e,0x3b490ab0,0xbbfb2b74,0x3c48bd36,0x3a490f88,0xbc2fb680,0xbcb54098
.long 0x230d3132,0xbc48bd36,0xbcc7c5c2,0xbd14a031,0xbc48bd36,0xbccdee60,0xbd1aa086,0xbd4c9b8b
.long 0xbcc7c5c2,0xbd1aa086,0xbd4f7bca,0xbd80e7e4,0xbd14a031,0xbd4c9b8b,0xbd80e7e4,0xbd99c200
.long 0xbd43ef15,0xbd7c5d27,0xbd987fc0,0xbdb085bb,0xbd715aea,0xbd94b039,0xbdae3bde,0xbdc4e3f5
.long 0xbd8e39da,0xbda99415,0xbdc1d870,0xbdd695e5,0xbda26799,0xbdbca003,0xbdd31849,0xbde55e0b
.long 0xbdb504f3,0xbdcd9f02,0xbde1c598,0xbdf10908,0xbdc5e403,0xbddc61c7,0xbdedb293,0xbdf96e4e
.long 0xbdd4db31,0xbde8bf3c,0xbdf6ba07,0xbdfe70b0,0xbde1c598,0xbdf294f8,0xbdfcbfc9,0xbdfffec4
.long 0xbdec835e,0xbdf9c79d,0xbdffb10f,0xbdfe1324,0xbdf4fa0b,0xbdfe4323,0xbdff84ab,0xbdf8b47b
.long 0xbdfb14be,0xbdfffb11,0xbdfc3b28,0xbdeff573,0xbdfec46d,0xbdfeea9d,0xbdf5dec6,0xbde3f473
.long 0x3e000000,0x3e000000,0x3e000000,0x3e000000,0x3dfe1324,0x3dfde0b1,0x3dfdabcc,0x3dfd7474
.long 0x3df853f8,0x3df78bc5,0x3df6ba07,0x3df5dec6,0x3deed89e,0x3ded1c1d,0x3deb4b0c,0x3de96591
.long 0x3de1c598,0x3ddebe05,0x3ddb941a,0x3dd84853,0x3dd14d3d,0x3dccae79,0x3dc7de65,0x3dc2de29
.long 0x3dbdaef9,0x3db73a23,0x3db085bb,0x3da99415,0x3da73656,0x3d9ebc12,0x3d95f6d9,0x3d8cead0
.long 0x3d8e39da,0x3d839c3d,0x3d715aea,0x3d5ae880,0x3d663375,0x3d4c9b8b,0x3d3263ef,0x3d17a117
.long 0x3d2c7cd4,0x3d0e9a22,0x3ce05c13,0x3ca2abb6,0x3ce05c13,0x3c9c76de,0x3c2fb680,0x3b16c9b6
.long 0x3c48bd36,0x3b490ab0,0xbbc8fb30,0xbc7ab273,0xbb490ab0,0xbc553db9,0xbcbb6ecf,0xbd0586ce
.long 0xbc964083,0xbcec9a7f,0xbd209ae5,0xbd49b953,0xbd088e93,0xbd3554ec,0xbd60924f,0xbd84f484
.long 0xbd43ef15,0xbd715aea,0xbd8e39da,0xbda26799,0xbd7c5d27,0xbd94b039,0xbda99415,0xbdbca003
.long 0xbd987fc0,0xbdae3bde,0xbdc1d870,0xbdd31849,0xbdb085bb,0xbdc4e3f5,0xbdd695e5,0xbde55e0b
.long 0xbdc5e403,0xbdd84853,0xbde76bd8,0xbdf31447,0xbdd84853,0xbde816a8,0xbdf40bdd,0xbdfbf531
.long 0xbde76bd8,0xbdf40bdd,0xbdfc3b28,0xbdffd397,0xbdf31447,0xbdfbf531,0xbdffd397,0xbdfe9bc9
.long 0xbdfb14be,0xbdffb10f,0xbdfec46d,0xbdf853f8,0xbdff4e6d,0xbdff2f9d,0xbdf91298,0xbded1c1d
.long 0xbdffb10f,0xbdfa7302,0xbdeed89e,0xbddd2d53,0xbdfc3b28,0xbdf18f57,0xbde04621,0xbdc8d8b3
.long 0xbdf4fa0b,0xbde4aa59,0xbdcd9f02,0xbdb085bb,0xbdea09a7,0xbdd3fac3,0xbdb73a23,0xbd94b039
.long 0xbddb941a,0xbdbfc767,0xbd9d7fd1,0xbd6bcbbb,0xbdc9d112,0xbda86605,0xbd80e7e4,0xbd2986c4
.long 0x3e000000,0x3e000000,0x3e000000,0x3e000000,0x3dfd3aac,0x3dfcfe73,0x3dfcbfc9,0x3dfc7eb0
.long 0x3df4fa0b,0x3df40bdd,0x3df31447,0x3df21352,0x3de76bd8,0x3de55e0b,0x3de33c5a,0x3de106f2
.long 0x3dd4db31,0x3dd14d3d,0x3dcd9f02,0x3dc9d112,0x3dbdaef9,0x3db85216,0x3db2c8c9,0x3dad1469
.long 0x3da26799,0x3d9b02c6,0x3d93682a,0x3d8b9a6b,0x3d839c3d,0x3d741f07,0x3d60924f,0x3d4c9b8b
.long 0x3d43ef15,0x3d2c7cd4,0x3d14a031,0x3cf8cfcc,0x3cf8cfcc,0x3cc19b37,0x3c89cf86,0x3c23308c
.long 0x3c48bd36,0x3b96c32c,0xbb490ab0,0xbc2fb680,0xbbc8fb30,0xbc6e3876,0xbcbb6ecf,0xbcfee6e1
.long 0xbcc7c5c2,0xbd088e93,0xbd2c7cd4,0xbd4f7bca,0xbd2c7cd4,0xbd525a09,0xbd76e0cb,0xbd8cead0
.long 0xbd715aea,0xbd8b9a6b,0xbd9d7fd1,0xbdae3bde,0xbd987fc0,0xbdaac082,0xbdbb8f3b,0xbdcac77f
.long 0xbdb504f3,0xbdc5e403,0xbdd4db31,0xbde1c598,0xbdcd9f02,0xbddc61c7,0xbde8bf3c,0xbdf294f8
.long 0xbde1c598,0xbdedb293,0xbdf6ba07,0xbdfcbfc9,0xbdf10908,0xbdf96e4e,0xbdfe70b0,0xbdfffec4
.long 0xbdfb14be,0xbdff4e6d,0xbdffb10f,0xbdfc3b28,0xbdffb10f,0xbdff2f9d,0xbdfa7302,0xbdf18f57
.long 0xbdfec46d,0xbdf91298,0xbdeed89e,0xbde04621,0xbdf853f8,0xbded1c1d,0xbddd2d53,0xbdc8d8b3
.long 0xbdec835e,0xbddb941a,0xbdc5e403,0xbdabeb4a,0xbddb941a,0xbdc4e3f5,0xbda99415,0xbd8a48ad
.long 0xbdc5e403,0xbda99415,0xbd88f59b,0xbd49b953,0xbdabeb4a,0xbd8a48ad,0xbd49b953,0xbcf2b651
.long 0xbd8e39da,0xbd4f7bca,0xbcf8cfcc,0xbc16a905,0xbd5ae880,0xbd0586ce,0xbc2fb680,0x3c3c3ac3
.long 0xbd14a031,0xbc61bc2e,0x3c16a905,0x3d027dc0,0xbc964083,0x3bafe007,0x3cec9a7f,0x3d525a09
.long 0x3e000000,0x3e000000,0x3e000000,0x3e000000,0x3dfc3b28,0x3dfbf531,0x3dfbaccd,0x3dfb61fc
.long 0x3df10908,0x3deff573,0x3deed89e,0x3dedb293,0x3ddebe05,0x3ddc61c7,0x3dd9f26a,0x3dd77026
.long 0x3dc5e403,0x3dc1d870,0x3dbdaef9,0x3db96842,0x3da73656,0x3da12ff9,0x3d9b02c6,0x3d94b039
.long 0x3d839c3d,0x3d76e0cb,0x3d663375,0x3d553641,0x3d38442a,0x3d2395c5,0x3d0e9a22,0x3cf2b651
.long 0x3cc7c5c2,0x3c964083,0x3c48bd36,0x3bc8fb30,0x3b490ab0,0xbb7b49ba,0xbc2fb680,0xbc9008b7
.long 0xbc964083,0xbcd41501,0xbd088e93,0xbd268f12,0xbd209ae5,0xbd41071e,0xbd60924f,0xbd7f17b2
.long 0xbd715aea,0xbd88f59b,0xbd987fc0,0xbda73656,0xbd9d7fd1,0xbdad1469,0xbdbb8f3b,0xbdc8d8b3
.long 0xbdbdaef9,0xbdcbbbf8,0xbdd84853,0xbde33c5a,0xbdd84853,0xbde3f473,0xbdedb293,0xbdf56d97
.long 0xbdec835e,0xbdf4fa0b,0xbdfb14be,0xbdfec46d,0xbdf9c79d,0xbdfe4323,0xbdfffb11,0xbdfeea9d
.long 0xbdffb10f,0xbdff84ab,0xbdfc3b28,0xbdf5dec6,0xbdfe1324,0xbdf8b47b,0xbdeff573,0xbde3f473
.long 0xbdf4fa0b,0xbdea09a7,0xbddb941a,0xbdc9d112,0xbde4aa59,0xbdd3fac3,0xbdbfc767,0xbda86605
.long 0xbdcd9f02,0xbdb73a23,0xbd9d7fd1,0xbd80e7e4,0xbdb085bb,0xbd94b039,0xbd6bcbbb,0xbd2986c4
.long 0xbd8e39da,0xbd5ae880,0xbd14a031,0xbc964083,0xbd4f7bca,0xbd0586ce,0xbc61bc2e,0x3bafe007
.long 0xbcf8cfcc,0xbc2fb680,0x3c16a905,0x3cec9a7f,0xbc16a905,0x3c3c3ac3,0x3d027dc0,0x3d525a09
.long 0x3c48bd36,0x3d088e93,0x3d5ae880,0x3d93682a,0x3d088e93,0x3d5dbe79,0x3d95f6d9,0x3db85216
.long 0x3d5ae880,0x3d95f6d9,0x3db96842,0x3dd695e5,0x3d93682a,0x3db85216,0x3dd695e5,0x3ded1c1d
.long 0x0,0x0,0x0,0x0,0x0,0x3a490f88,0x3ac90e90,0x3b16c9b6
.long 0x0,0x3ac90e90,0x3b490ab0,0x3b96c32c,0x0,0x3b16c9b6,0x3b96c32c,0x3be21469
.long 0x0,0x3b490ab0,0x3bc8fb30,0x3c16a905,0x0,0x3b7b49ba,0x3bfb2b74,0x3c3c3ac3
.long 0x0,0x3b96c32c,0x3c16a905,0x3c61bc2e,0x0,0x3bafe007,0x3c2fb680,0x3c839502
.long 0x0,0x3bc8fb30,0x3c48bd36,0x3c964083,0x0,0x3be21469,0x3c61bc2e,0x3ca8defc
.long 0x0,0x3bfb2b74,0x3c7ab273,0x3cbb6ecf,0x0,0x3c0a200a,0x3c89cf86,0x3ccdee60
.long 0x0,0x3c16a905,0x3c964083,0x3ce05c13,0x0,0x3c23308c,0x3ca2abb6,0x3cf2b651
.long 0x0,0x3c2fb680,0x3caf10a2,0x3d027dc0,0x0,0x3c3c3ac3,0x3cbb6ecf,0x3d0b9507
.long 0x0,0x3c48bd36,0x3cc7c5c2,0x3d14a031,0x0,0x3c553db9,0x3cd41501,0x3d1d9e78
.long 0x0,0x3c61bc2e,0x3ce05c13,0x3d268f12,0x0,0x3c6e3876,0x3cec9a7f,0x3d2f713a
.long 0x0,0x3c7ab273,0x3cf8cfcc,0x3d38442a,0x0,0x3c839502,0x3d027dc0,0x3d41071e
.long 0x0,0x3c89cf86,0x3d088e93,0x3d49b953,0x0,0x3c9008b7,0x3d0e9a22,0x3d525a09
.long 0x0,0x3c964083,0x3d14a031,0x3d5ae880,0x0,0x3c9c76de,0x3d1aa086,0x3d6363fa
.long 0x0,0x3ca2abb6,0x3d209ae5,0x3d6bcbbb,0x0,0x3ca8defc,0x3d268f12,0x3d741f07
.long 0x0,0x3caf10a2,0x3d2c7cd4,0x3d7c5d27,0x0,0x3cb54098,0x3d3263ef,0x3d8242b1
.long 0x0,0x3cbb6ecf,0x3d38442a,0x3d864b82,0x0,0x3cc19b37,0x3d3e1d4a,0x3d8a48ad
.long 0x0,0x0,0x0,0x0,0x3b490ab0,0x3b7b49ba,0x3b96c32c,0x3bafe007
.long 0x3bc8fb30,0x3bfb2b74,0x3c16a905,0x3c2fb680,0x3c16a905,0x3c3c3ac3,0x3c61bc2e,0x3c839502
.long 0x3c48bd36,0x3c7ab273,0x3c964083,0x3caf10a2,0x3c7ab273,0x3c9c76de,0x3cbb6ecf,0x3cda3997
.long 0x3c964083,0x3cbb6ecf,0x3ce05c13,0x3d027dc0,0x3caf10a2,0x3cda3997,0x3d027dc0,0x3d17a117
.long 0x3cc7c5c2,0x3cf8cfcc,0x3d14a031,0x3d2c7cd4,0x3ce05c13,0x3d0b9507,0x3d268f12,0x3d41071e
.long 0x3cf8cfcc,0x3d1aa086,0x3d38442a,0x3d553641,0x3d088e93,0x3d2986c4,0x3d49b953,0x3d6900b7
.long 0x3d14a031,0x3d38442a,0x3d5ae880,0x3d7c5d27,0x3d209ae5,0x3d46d529,0x3d6bcbbb,0x3d87a136
.long 0x3d2c7cd4,0x3d553641,0x3d7c5d27,0x3d90d3cd,0x3d38442a,0x3d6363fa,0x3d864b82,0x3d99c200
.long 0x3d43ef15,0x3d715aea,0x3d8e39da,0x3da26799,0x3d4f7bca,0x3d7f17b2,0x3d95f6d9,0x3daac082
.long 0x3d5ae880,0x3d864b82,0x3d9d7fd1,0x3db2c8c9,0x3d663375,0x3d8cead0,0x3da4d225,0x3dba7ca4
.long 0x3d715aea,0x3d93682a,0x3dabeb4a,0x3dc1d870,0x3d7c5d27,0x3d99c200,0x3db2c8c9,0x3dc8d8b3
.long 0x3d839c3d,0x3d9ff6cb,0x3db96842,0x3dcf7a1f,0x3d88f59b,0x3da6050a,0x3dbfc767,0x3dd5b993
.long 0x3d8e39da,0x3dabeb4a,0x3dc5e403,0x3ddb941a,0x3d93682a,0x3db1a81d,0x3dcbbbf8,0x3de106f2
.long 0x3d987fc0,0x3db73a23,0x3dd14d3d,0x3de60f88,0x3d9d7fd1,0x3dbca003,0x3dd695e5,0x3deaab7b
.long 0x3da26799,0x3dc1d870,0x3ddb941a,0x3deed89e,0x3da73656,0x3dc6e22a,0x3de04621,0x3df294f8
.long 0x3dabeb4a,0x3dcbbbf8,0x3de4aa59,0x3df5dec6,0x3db085bb,0x3dd064af,0x3de8bf3c,0x3df8b47b
.long 0x0,0x0,0x0,0x0,0x3bc8fb30,0x3be21469,0x3bfb2b74,0x3c0a200a
.long 0x3c48bd36,0x3c61bc2e,0x3c7ab273,0x3c89cf86,0x3c964083,0x3ca8defc,0x3cbb6ecf,0x3ccdee60
.long 0x3cc7c5c2,0x3ce05c13,0x3cf8cfcc,0x3d088e93,0x3cf8cfcc,0x3d0b9507,0x3d1aa086,0x3d2986c4
.long 0x3d14a031,0x3d268f12,0x3d38442a,0x3d49b953,0x3d2c7cd4,0x3d41071e,0x3d553641,0x3d6900b7
.long 0x3d43ef15,0x3d5ae880,0x3d715aea,0x3d839c3d,0x3d5ae880,0x3d741f07,0x3d864b82,0x3d921eb0
.long 0x3d715aea,0x3d864b82,0x3d93682a,0x3d9ff6cb,0x3d839c3d,0x3d921eb0,0x3d9ff6cb,0x3dad1469
.long 0x3d8e39da,0x3d9d7fd1,0x3dabeb4a,0x3db96842,0x3d987fc0,0x3da86605,0x3db73a23,0x3dc4e3f5
.long 0x3da26799,0x3db2c8c9,0x3dc1d870,0x3dcf7a1f,0x3dabeb4a,0x3dbca003,0x3dcbbbf8,0x3dd91e6a
.long 0x3db504f3,0x3dc5e403,0x3dd4db31,0x3de1c598,0x3dbdaef9,0x3dce8d90,0x3ddd2d53,0x3de96591
.long 0x3dc5e403,0x3dd695e5,0x3de4aa59,0x3deff573,0x3dcd9f02,0x3dddf6be,0x3deb4b0c,0x3df56d97
.long 0x3dd4db31,0x3de4aa59,0x3df10908,0x3df9c79d,0x3ddb941a,0x3deaab7b,0x3df5dec6,0x3dfcfe73
.long 0x3de1c598,0x3deff573,0x3df9c79d,0x3dff0e58,0x3de76bd8,0x3df48422,0x3dfcbfc9,0x3dfff4e6
.long 0x3dec835e,0x3df853f8,0x3dfec46d,0x3dffb10f,0x3df10908,0x3dfb61fc,0x3dffd397,0x3dfe4323
.long 0x3df4fa0b,0x3dfdabcc,0x3dffec43,0x3dfbaccd,0x3df853f8,0x3dff2f9d,0x3dff0e58,0x3df7f110
.long 0x3dfb14be,0x3dffec43,0x3dfd3aac,0x3df31447,0x3dfd3aac,0x3dffe129,0x3dfa7302,0x3ded1c1d
.long 0x3dfec46d,0x3dff0e58,0x3df6ba07,0x3de60f88,0x3dffb10f,0x3dfd7474,0x3df21352,0x3dddf6be
.long 0x0,0x0,0x0,0x0,0x3c16a905,0x3c23308c,0x3c2fb680,0x3c3c3ac3
.long 0x3c964083,0x3ca2abb6,0x3caf10a2,0x3cbb6ecf,0x3ce05c13,0x3cf2b651,0x3d027dc0,0x3d0b9507
.long 0x3d14a031,0x3d209ae5,0x3d2c7cd4,0x3d38442a,0x3d38442a,0x3d46d529,0x3d553641,0x3d6363fa
.long 0x3d5ae880,0x3d6bcbbb,0x3d7c5d27,0x3d864b82,0x3d7c5d27,0x3d87a136,0x3d90d3cd,0x3d99c200
.long 0x3d8e39da,0x3d987fc0,0x3da26799,0x3dabeb4a,0x3d9d7fd1,0x3da86605,0x3db2c8c9,0x3dbca003
.long 0x3dabeb4a,0x3db73a23,0x3dc1d870,0x3dcbbbf8,0x3db96842,0x3dc4e3f5,0x3dcf7a1f,0x3dd91e6a
.long 0x3dc5e403,0x3dd14d3d,0x3ddb941a,0x3de4aa59,0x3dd14d3d,0x3ddc61c7,0x3de60f88,0x3dee46be
.long 0x3ddb941a,0x3de60f88,0x3deed89e,0x3df5dec6,0x3de4aa59,0x3dee46be,0x3df5dec6,0x3dfb61fc
.long 0x3dec835e,0x3df4fa0b,0x3dfb14be,0x3dfec46d,0x3df31447,0x3dfa1e84,0x3dfe70b0,0x3dfffec4
.long 0x3df853f8,0x3dfdabcc,0x3dffec43,0x3dff0e58,0x3dfc3b28,0x3dff9c18,0x3dff84ab,0x3dfbf531
.long 0x3dfec46d,0x3dffec43,0x3dfd3aac,0x3df6ba07,0x3dffec43,0x3dfe9bc9,0x3df91298,0x3def6830
.long 0x3dffb10f,0x3dfbaccd,0x3df31447,0x3de60f88,0x3dfe1324,0x3df72417,0x3deb4b0c,0x3ddac450
.long 0x3dfb14be,0x3df10908,0x3de1c598,0x3dcd9f02,0x3df6ba07,0x3de96591,0x3dd695e5,0x3dbebc1b
.long 0x3df10908,0x3de04621,0x3dc9d112,0x3dae3bde,0x3dea09a7,0x3dd5b993,0x3dbb8f3b,0x3d9c420c
.long 0x3de1c598,0x3dc9d112,0x3dabeb4a,0x3d88f59b,0x3dd84853,0x3dbca003,0x3d9b02c6,0x3d6900b7
.long 0x3dcd9f02,0x3dae3bde,0x3d88f59b,0x3d3e1d4a,0x3dc1d870,0x3d9ebc12,0x3d6bcbbb,0x3d119ddd
.long 0x0,0x0,0x0,0x0,0x3c48bd36,0x3c553db9,0x3c61bc2e,0x3c6e3876
.long 0x3cc7c5c2,0x3cd41501,0x3ce05c13,0x3cec9a7f,0x3d14a031,0x3d1d9e78,0x3d268f12,0x3d2f713a
.long 0x3d43ef15,0x3d4f7bca,0x3d5ae880,0x3d663375,0x3d715aea,0x3d7f17b2,0x3d864b82,0x3d8cead0
.long 0x3d8e39da,0x3d95f6d9,0x3d9d7fd1,0x3da4d225,0x3da26799,0x3daac082,0x3db2c8c9,0x3dba7ca4
.long 0x3db504f3,0x3dbdaef9,0x3dc5e403,0x3dcd9f02,0x3dc5e403,0x3dce8d90,0x3dd695e5,0x3dddf6be
.long 0x3dd4db31,0x3ddd2d53,0x3de4aa59,0x3deb4b0c,0x3de1c598,0x3de96591,0x3deff573,0x3df56d97
.long 0x3dec835e,0x3df31447,0x3df853f8,0x3dfc3b28,0x3df4fa0b,0x3dfa1e84,0x3dfdabcc,0x3dff9c18
.long 0x3dfb14be,0x3dfe70b0,0x3dffec43,0x3dff84ab,0x3dfec46d,0x3dfffec4,0x3dff0e58,0x3dfbf531
.long 0x3e000000,0x3dfec46d,0x3dfb14be,0x3df4fa0b,0x3dfec46d,0x3dfac516,0x3df40bdd,0x3deaab7b
.long 0x3dfb14be,0x3df40bdd,0x3dea09a7,0x3ddd2d53,0x3df4fa0b,0x3deaab7b,0x3ddd2d53,0x3dccae79
.long 0x3dec835e,0x3ddebe05,0x3dcd9f02,0x3db96842,0x3de1c598,0x3dd064af,0x3dbb8f3b,0x3da39da9
.long 0x3dd4db31,0x3dbfc767,0x3da73656,0x3d8b9a6b,0x3dc5e403,0x3dad1469,0x3d90d3cd,0x3d6363fa
.long 0x3db504f3,0x3d987fc0,0x3d715aea,0x3d2c7cd4,0x3da26799,0x3d8242b1,0x3d3e1d4a,0x3ce67c66
.long 0x3d8e39da,0x3d553641,0x3d088e93,0x3c61bc2e,0x3d715aea,0x3d2395c5,0x3ca2abb6,0xba490f88
.long 0x3d43ef15,0x3ce05c13,0x3bc8fb30,0xbc7ab273,0x3d14a031,0x3c6e3876,0xbbfb2b74,0xbcf2b651
.long 0x3cc7c5c2,0x3ac90e90,0xbcaf10a2,0xbd3263ef,0x3c48bd36,0xbc3c3ac3,0xbd0e9a22,0xbd6900b7
.long 0x0,0x0,0x0,0x0,0x3c7ab273,0x3c839502,0x3c89cf86,0x3c9008b7
.long 0x3cf8cfcc,0x3d027dc0,0x3d088e93,0x3d0e9a22,0x3d38442a,0x3d41071e,0x3d49b953,0x3d525a09
.long 0x3d715aea,0x3d7c5d27,0x3d839c3d,0x3d88f59b,0x3d93682a,0x3d99c200,0x3d9ff6cb,0x3da6050a
.long 0x3dabeb4a,0x3db2c8c9,0x3db96842,0x3dbfc767,0x3dc1d870,0x3dc8d8b3,0x3dcf7a1f,0x3dd5b993
.long 0x3dd4db31,0x3ddb941a,0x3de1c598,0x3de76bd8,0x3de4aa59,0x3deaab7b,0x3deff573,0x3df48422
.long 0x3df10908,0x3df5dec6,0x3df9c79d,0x3dfcbfc9,0x3df9c79d,0x3dfcfe73,0x3dff0e58,0x3dfff4e6
.long 0x3dfec46d,0x3dffec43,0x3dffb10f,0x3dfe1324,0x3dffec43,0x3dfe9bc9,0x3dfbaccd,0x3df72417
.long 0x3dfd3aac,0x3df91298,0x3df31447,0x3deb4b0c,0x3df6ba07,0x3def6830,0x3de60f88,0x3ddac450
.long 0x3dec835e,0x3de1c598,0x3dd4db31,0x3dc5e403,0x3ddebe05,0x3dd064af,0x3dbfc767,0x3dad1469
.long 0x3dcd9f02,0x3dbb8f3b,0x3da73656,0x3d90d3cd,0x3db96842,0x3da39da9,0x3d8b9a6b,0x3d6363fa
.long 0x3da26799,0x3d88f59b,0x3d5ae880,0x3d209ae5,0x3d88f59b,0x3d58106b,0x3d1aa086,0x3cb54098
.long 0x3d5ae880,0x3d1aa086,0x3caf10a2,0x3b96c32c,0x3d209ae5,0x3cb54098,0x3b96c32c,0xbc553db9
.long 0x3cc7c5c2,0x3bc8fb30,0xbc48bd36,0xbcf8cfcc,0x3c16a905,0xbc23308c,0xbcec9a7f,0xbd41071e
.long 0xbbc8fb30,0xbcd41501,0xbd38442a,0xbd80e7e4,0xbcaf10a2,0xbd2986c4,0xbd76e0cb,0xbd9ebc12
.long 0xbd14a031,0xbd663375,0xbd987fc0,0xbdb96842,0xbd4f7bca,0xbd8f8784,0xbdb2c8c9,0xbdd064af
.long 0xbd839c3d,0xbda99415,0xbdc9d112,0xbde33c5a,0xbd9d7fd1,0xbdc0d0da,0xbddd2d53,0xbdf18f57
.long 0x0,0x0,0x0,0x0,0x3c964083,0x3c9c76de,0x3ca2abb6,0x3ca8defc
.long 0x3d14a031,0x3d1aa086,0x3d209ae5,0x3d268f12,0x3d5ae880,0x3d6363fa,0x3d6bcbbb,0x3d741f07
.long 0x3d8e39da,0x3d93682a,0x3d987fc0,0x3d9d7fd1,0x3dabeb4a,0x3db1a81d,0x3db73a23,0x3dbca003
.long 0x3dc5e403,0x3dcbbbf8,0x3dd14d3d,0x3dd695e5,0x3ddb941a,0x3de106f2,0x3de60f88,0x3deaab7b
.long 0x3dec835e,0x3df10908,0x3df4fa0b,0x3df853f8,0x3df853f8,0x3dfb61fc,0x3dfdabcc,0x3dff2f9d
.long 0x3dfec46d,0x3dffd397,0x3dffec43,0x3dff0e58,0x3dffb10f,0x3dfe4323,0x3dfbaccd,0x3df7f110
.long 0x3dfb14be,0x3df6ba07,0x3df10908,0x3dea09a7,0x3df10908,0x3de96591,0x3de04621,0x3dd5b993
.long 0x3de1c598,0x3dd695e5,0x3dc9d112,0x3dbb8f3b,0x3dcd9f02,0x3dbebc1b,0x3dae3bde,0x3d9c420c
.long 0x3db504f3,0x3da26799,0x3d8e39da,0x3d715aea,0x3d987fc0,0x3d8242b1,0x3d553641,0x3d2395c5
.long 0x3d715aea,0x3d3e1d4a,0x3d088e93,0x3ca2abb6,0x3d2c7cd4,0x3ce67c66,0x3c61bc2e,0xba490f88
.long 0x3cc7c5c2,0x3c16a905,0xbbc8fb30,0xbcaf10a2,0x3bc8fb30,0xbc23308c,0xbcd41501,0xbd2986c4
.long 0xbc48bd36,0xbcec9a7f,0xbd38442a,0xbd76e0cb,0xbcf8cfcc,0xbd41071e,0xbd80e7e4,0xbd9ebc12
.long 0xbd43ef15,0xbd839c3d,0xbda26799,0xbdbdaef9,0xbd839c3d,0xbda39da9,0xbdbfc767,0xbdd77026
.long 0xbda26799,0xbdbfc767,0xbdd84853,0xbdeb4b0c,0xbdbdaef9,0xbdd77026,0xbdeb4b0c,0xbdf8b47b
.long 0xbdd4db31,0xbdea09a7,0xbdf853f8,0xbdff4e6d,0xbde76bd8,0xbdf72417,0xbdff0e58,0xbdfeea9d
.long 0xbdf4fa0b,0xbdfe70b0,0xbdff4e6d,0xbdf78bc5,0xbdfd3aac,0xbdffc38f,0xbdf91298,0xbde96591
.long 0x0,0x0,0x0,0x0,0x3caf10a2,0x3cb54098,0x3cbb6ecf,0x3cc19b37
.long 0x3d2c7cd4,0x3d3263ef,0x3d38442a,0x3d3e1d4a,0x3d7c5d27,0x3d8242b1,0x3d864b82,0x3d8a48ad
.long 0x3da26799,0x3da73656,0x3dabeb4a,0x3db085bb,0x3dc1d870,0x3dc6e22a,0x3dcbbbf8,0x3dd064af
.long 0x3ddb941a,0x3de04621,0x3de4aa59,0x3de8bf3c,0x3deed89e,0x3df294f8,0x3df5dec6,0x3df8b47b
.long 0x3dfb14be,0x3dfd3aac,0x3dfec46d,0x3dffb10f,0x3dffec43,0x3dffe129,0x3dff0e58,0x3dfd7474
.long 0x3dfd3aac,0x3dfa7302,0x3df6ba07,0x3df21352,0x3df31447,0x3ded1c1d,0x3de60f88,0x3dddf6be
.long 0x3de1c598,0x3dd84853,0x3dcd9f02,0x3dc1d870,0x3dc9d112,0x3dbca003,0x3dae3bde,0x3d9ebc12
.long 0x3dabeb4a,0x3d9b02c6,0x3d88f59b,0x3d6bcbbb,0x3d88f59b,0x3d6900b7,0x3d3e1d4a,0x3d119ddd
.long 0x3d43ef15,0x3d14a031,0x3cc7c5c2,0x3c48bd36,0x3ce05c13,0x3c6e3876,0x3ac90e90,0xbc3c3ac3
.long 0x3bc8fb30,0xbbfb2b74,0xbcaf10a2,0xbd0e9a22,0xbc7ab273,0xbcf2b651,0xbd3263ef,0xbd6900b7
.long 0xbd14a031,0xbd4f7bca,0xbd839c3d,0xbd9d7fd1,0xbd663375,0xbd8f8784,0xbda99415,0xbdc0d0da
.long 0xbd987fc0,0xbdb2c8c9,0xbdc9d112,0xbddd2d53,0xbdb96842,0xbdd064af,0xbde33c5a,0xbdf18f57
.long 0xbdd4db31,0xbde76bd8,0xbdf4fa0b,0xbdfd3aac,0xbdea09a7,0xbdf72417,0xbdfe70b0,0xbdffc38f
.long 0xbdf853f8,0xbdff0e58,0xbdff4e6d,0xbdf91298,0xbdff4e6d,0xbdfeea9d,0xbdf78bc5,0xbde96591
.long 0xbdfec46d,0xbdf6ba07,0xbde76bd8,0xbdd14d3d,0xbdf6ba07,0xbde6becc,0xbdcf7a1f,0xbdb1a81d
.long 0xbde76bd8,0xbdcf7a1f,0xbdb085bb,0xbd8b9a6b,0xbdd14d3d,0xbdb1a81d,0xbd8b9a6b,0xbd41071e
.long 0x0,0x0,0x0,0x0,0x0,0x0,0x0,0x0
.long 0x0,0x0,0x0,0x0,0x0,0x0,0x0,0x0
.long 0x0,0x0,0x0,0x0,0x0,0x0,0x0,0x0
.long 0x0,0x0,0x0,0x0,0x0,0x0,0x0,0x0
.long 0x0,0x0,0x0,0x0,0x0,0x0,0x0,0x0
.long 0x0,0x0,0x0,0x0,0x0,0x0,0x0,0x0
.long 0x0,0x0,0x0,0x0,0x0,0x0,0x0,0x0
.long 0x0,0x0,0x0,0x0,0x0,0x0,0x0,0x0
.long 0x0,0x0,0x0,0x0,0x0,0x0,0x0,0x0
.long 0x0,0x0,0x0,0x0,0x0,0x0,0x0,0x0
.long 0x0,0x0,0x0,0x0,0x0,0x0,0x0,0x0
.long 0x0,0x0,0x0,0x0,0x0,0x0,0x0,0x0
.long 0x0,0x0,0x0,0x0,0x0,0x0,0x0,0x0
.long 0x0,0x0,0x0,0x0,0x0,0x0,0x0,0x0
.long 0x0,0x0,0x0,0x0,0x0,0x0,0x0,0x0
.long 0x0,0x0,0x0,0x0,0x0,0x0,0x0,0x0
.long 0x0,0x0,0x0,0x0,0x0,0x0,0x0,0x0
.long 0x0,0x0,0x0,0x0,0x0,0x0,0x0,0x0
.long 0x0,0x0,0x0,0x0,0x0,0x0,0x0,0x0
.long 0x0,0x0,0x0,0x0,0x0,0x0,0x0,0x0
.long 0x0,0x0,0x0,0x0,0x0,0x0,0x0,0x0
.long 0x0,0x0,0x0,0x0,0x0,0x0,0x0,0x0
.long 0x0,0x0,0x0,0x0,0x0,0x0,0x0,0x0
.long 0x0,0x0,0x0,0x0,0x0,0x0,0x0,0x0
.long 0x0,0x0,0x0,0x0,0x0,0x0,0x0,0x0
.long 0x0,0x0,0x0,0x0,0x0,0x0,0x0,0x0
.long 0x0,0x0,0x0,0x0,0x0,0x0,0x0,0x0
.long 0x0,0x0,0x0,0x0,0x0,0x0,0x0,0x0
.long 0x0,0x0,0x0,0x0,0x0,0x0,0x0,0x0
.long 0x0,0x0,0x0,0x0,0x0,0x0,0x0,0x0
.long 0x0,0x0,0x0,0x0,0x0,0x0,0x0,0x0
.long 0x0,0x0,0x0,0x0,0x0,0x0,0x0,0x0
.long 0x0,0x0,0x0,0x0,0x0,0x0,0x0,0x0
.long 0x0,0x0,0x0,0x0,0x0,0x0,0x0,0x0
.long 0x0,0x0,0x0,0x0,0x0,0x0,0x0,0x0
.long 0x0,0x0,0x0,0x0,0x0,0x0,0x0,0x0
.long 0x0,0x0,0x0,0x0,0x0,0x0,0x0,0x0
.long 0x0,0x0,0x0,0x0,0x0,0x0,0x0,0x0
.long 0x0,0x0,0x0,0x0,0x0,0x0,0x0,0x0
.long 0x0,0x0,0x0,0x0,0x0,0x0,0x0,0x0
.long 0x0,0x0,0x0,0x0,0x0,0x0,0x0,0x0
.long 0x0,0x0,0x0,0x0,0x0,0x0,0x0,0x0
.long 0x0,0x0,0x0,0x0,0x0,0x0,0x0,0x0
.long 0x0,0x0,0x0,0x0,0x0,0x0,0x0,0x0
.long 0x0,0x0,0x0,0x0,0x0,0x0,0x0,0x0
.long 0x0,0x0,0x0,0x0,0x0,0x0,0x0,0x0
.long 0x0,0x0,0x0,0x0,0x0,0x0,0x0,0x0
.long 0x0,0x0,0x0,0x0,0x0,0x0,0x0,0x0
.long 0x0,0x0,0x0,0x0,0x0,0x0,0x0,0x0
.long 0x0,0x0,0x0,0x0,0x0,0x0,0x0,0x0
.long 0x0,0x0,0x0,0x0,0x0,0x0,0x0,0x0
.long 0x0,0x0,0x0,0x0,0x0,0x0,0x0,0x0
.long 0x0,0x0,0x0,0x0,0x0,0x0,0x0,0x0
.long 0x0,0x0,0x0,0x0,0x0,0x0,0x0,0x0
.long 0x0,0x0,0x0,0x0,0x0,0x0,0x0,0x0
.long 0x0,0x0,0x0,0x0,0x0,0x0,0x0,0x0
.long 0x0,0x0,0x0,0x0,0x0,0x0,0x0,0x0
.long 0x0,0x0,0x0,0x0,0x0,0x0,0x0,0x0
.long 0x0,0x0,0x0,0x0,0x0,0x0,0x0,0x0
.long 0x0,0x0,0x0,0x0,0x0,0x0,0x0,0x0
.long 0x0,0x0,0x0,0x0,0x0,0x0,0x0,0x0
.long 0x0,0x0,0x0,0x0,0x0,0x0,0x0,0x0
.long 0x0,0x0,0x0,0x0,0x0,0x0,0x0,0x0
.long 0x0,0x0,0x0,0x0,0x0,0x0,0x0,0x0
.long 0x3c003c00,0x3c003c00,0x3c003c00,0x3c003c00,0x3bd93c00,0x3aa73b64,0xb23e0000,0xb872b61f
.long 0x3b643c00,0x361f39a8,0xbb64bc00,0xb61fb9a8,0x3aa73c00,0xb23e361f,0x38720000,0x3bd93b64
.long 0x39a83c00,0xb9a80000,0x39a83c00,0xb9a80000,0x38723c00,0xbbd9b61f,0xbaa70000,0xb23ebb64
.long 0x361f3c00,0xbb64b9a8,0xb61fbc00,0x3b6439a8,0x323e3c00,0xb872bb64,0x3bd90000,0xbaa7361f
.long 0x3c00,0xbc00,0x3c00,0x8000bc00,0xb23e3c00,0x3872bb64,0xbbd90000,0x3aa7361f
.long 0xb61f3c00,0x3b64b9a8,0x361fbc00,0xbb6439a8,0xb8723c00,0x3bd9b61f,0x3aa78000,0x323ebb64
.long 0xb9a83c00,0x39a80000,0xb9a83c00,0x39a88000,0xbaa73c00,0x323e361f,0xb8720000,0xbbd93b64
.long 0xbb643c00,0xb61f39a8,0x3b64bc00,0x361fb9a8,0xbbd93c00,0xbaa73b64,0x323e8000,0x3872b61f
.long 0xbc003c00,0xbc003c00,0xbc003c00,0xbc003c00,0xbbd93c00,0xbaa73b64,0x323e0000,0x3872b61f
.long 0xbb643c00,0xb61f39a8,0x3b64bc00,0x361fb9a8,0xbaa73c00,0x323e361f,0xb8728000,0xbbd93b64
.long 0xb9a83c00,0x39a80000,0xb9a83c00,0x39a80000,0xb8723c00,0x3bd9b61f,0x3aa70000,0x323ebb64
.long 0xb61f3c00,0x3b64b9a8,0x361fbc00,0xbb6439a8,0xb23e3c00,0x3872bb64,0xbbd98000,0x3aa7361f
.long 0x3c00,0xbc00,0x80003c00,0xbc00,0x323e3c00,0xb872bb64,0x3bd90000,0xbaa7361f
.long 0x361f3c00,0xbb64b9a8,0xb61fbc00,0x3b6439a8,0x38723c00,0xbbd9b61f,0xbaa78000,0xb23ebb64
.long 0x39a83c00,0xb9a80000,0x39a83c00,0xb9a88000,0x3aa73c00,0xb23e361f,0x38720000,0x3bd93b64
.long 0x3b643c00,0x361f39a8,0xbb64bc00,0xb61fb9a8,0x3bd93c00,0x3aa73b64,0xb23e8000,0xb872b61f
.long 0x3c003c00,0x3c003c00,0x3c003c00,0x3c003c00,0x387239a8,0x323e361f,0xbaa7b9a8,0xbbd9bb64
.long 0xb61f0000,0xbb64b9a8,0x361f0000,0x3b6439a8,0xbbd9b9a8,0xb872bb64,0x323e39a8,0xbaa7b61f
.long 0xb9a8bc00,0x39a80000,0xb9a8bc00,0x39a80000,0x323eb9a8,0x3aa73b64,0x3bd939a8,0xb872361f
.long 0x3b640000,0xb61f39a8,0xbb640000,0x361fb9a8,0x3aa739a8,0xbbd9b61f,0x3872b9a8,0xb23e3b64
.long 0x3c00,0xbc00,0x3c00,0x8000bc00,0xbaa739a8,0x3bd9b61f,0xb872b9a8,0x323e3b64
.long 0xbb640000,0x361f39a8,0x3b648000,0xb61fb9a8,0xb23eb9a8,0xbaa73b64,0xbbd939a8,0x3872361f
.long 0x39a8bc00,0xb9a80000,0x39a8bc00,0xb9a80000,0x3bd9b9a8,0x3872bb64,0xb23e39a8,0x3aa7b61f
.long 0x361f0000,0x3b64b9a8,0xb61f0000,0xbb6439a8,0xb87239a8,0xb23e361f,0x3aa7b9a8,0x3bd9bb64
.long 0xbc003c00,0xbc003c00,0xbc003c00,0xbc003c00,0xb87239a8,0xb23e361f,0x3aa7b9a8,0x3bd9bb64
.long 0x361f0000,0x3b64b9a8,0xb61f8000,0xbb6439a8,0x3bd9b9a8,0x3872bb64,0xb23e39a8,0x3aa7b61f
.long 0x39a8bc00,0xb9a88000,0x39a8bc00,0xb9a88000,0xb23eb9a8,0xbaa73b64,0xbbd939a8,0x3872361f
.long 0xbb648000,0x361f39a8,0x3b640000,0xb61fb9a8,0xbaa739a8,0x3bd9b61f,0xb872b9a8,0x323e3b64
.long 0x80003c00,0xbc00,0x3c00,0xbc00,0x3aa739a8,0xbbd9b61f,0x3872b9a8,0xb23e3b64
.long 0x3b640000,0xb61f39a8,0xbb648000,0x361fb9a8,0x323eb9a8,0x3aa73b64,0x3bd939a8,0xb872361f
.long 0xb9a8bc00,0x39a80000,0xb9a8bc00,0x39a80000,0xbbd9b9a8,0xb872bb64,0x323e39a8,0xbaa7b61f
.long 0xb61f8000,0xbb64b9a8,0x361f0000,0x3b6439a8,0x387239a8,0x323e361f,0xbaa7b9a8,0xbbd9bb64
.long 0x3c003c00,0x3c003c00,0x3c003c00,0x3c003c00,0xbbd9bc00,0xbaa7bb64,0x323e0000,0x3872361f
.long 0x3b643c00,0x361f39a8,0xbb64bc00,0xb61fb9a8,0xbaa7bc00,0x323eb61f,0xb8720000,0xbbd9bb64
.long 0x39a83c00,0xb9a80000,0x39a83c00,0xb9a80000,0xb872bc00,0x3bd9361f,0x3aa78000,0x323e3b64
.long 0x361f3c00,0xbb64b9a8,0xb61fbc00,0x3b6439a8,0xb23ebc00,0x38723b64,0xbbd90000,0x3aa7b61f
.long 0x3c00,0x8000bc00,0x3c00,0x8000bc00,0x323ebc00,0xb8723b64,0x3bd98000,0xbaa7b61f
.long 0xb61f3c00,0x3b64b9a8,0x361fbc00,0xbb6439a8,0x3872bc00,0xbbd9361f,0xbaa70000,0xb23e3b64
.long 0xb9a83c00,0x39a88000,0xb9a83c00,0x39a80000,0x3aa7bc00,0xb23eb61f,0x38728000,0x3bd9bb64
.long 0xbb643c00,0xb61f39a8,0x3b64bc00,0x361fb9a8,0x3bd9bc00,0x3aa7bb64,0xb23e0000,0xb872361f
.long 0xbc003c00,0xbc003c00,0xbc003c00,0xbc003c00,0x3bd9bc00,0x3aa7bb64,0xb23e8000,0xb872361f
.long 0xbb643c00,0xb61f39a8,0x3b64bc00,0x361fb9a8,0x3aa7bc00,0xb23eb61f,0x38720000,0x3bd9bb64
.long 0xb9a83c00,0x39a80000,0xb9a83c00,0x39a88000,0x3872bc00,0xbbd9361f,0xbaa70000,0xb23e3b64
.long 0xb61f3c00,0x3b64b9a8,0x361fbc00,0xbb6439a8,0x323ebc00,0xb8723b64,0x3bd90000,0xbaa7b61f
.long 0x3c00,0xbc00,0x80003c00,0xbc00,0xb23ebc00,0x38723b64,0xbbd98000,0x3aa7b61f
.long 0x361f3c00,0xbb64b9a8,0xb61fbc00,0x3b6439a8,0xb872bc00,0x3bd9361f,0x3aa70000,0x323e3b64
.long 0x39a83c00,0xb9a80000,0x39a83c00,0xb9a80000,0xbaa7bc00,0x323eb61f,0xb8728000,0xbbd9bb64
.long 0x3b643c00,0x361f39a8,0xbb64bc00,0xb61fb9a8,0xbbd9bc00,0xbaa7bb64,0x323e0000,0x3872361f
.long 0x3c003c00,0x3c003c00,0x3c003c00,0x3c003c00,0xb872b9a8,0xb23eb61f,0x3aa739a8,0x3bd93b64
.long 0xb61f0000,0xbb64b9a8,0x361f0000,0x3b6439a8,0x3bd939a8,0x38723b64,0xb23eb9a8,0x3aa7361f
.long 0xb9a8bc00,0x39a88000,0xb9a8bc00,0x39a88000,0xb23e39a8,0xbaa7bb64,0xbbd9b9a8,0x3872b61f
.long 0x3b648000,0xb61f39a8,0xbb640000,0x361fb9a8,0xbaa7b9a8,0x3bd9361f,0xb87239a8,0x323ebb64
.long 0x3c00,0x8000bc00,0x3c00,0x8000bc00,0x3aa7b9a8,0xbbd9361f,0x387239a8,0xb23ebb64
.long 0xbb640000,0x361f39a8,0x3b648000,0xb61fb9a8,0x323e39a8,0x3aa7bb64,0x3bd9b9a8,0xb872b61f
.long 0x39a8bc00,0xb9a80000,0x39a8bc00,0xb9a80000,0xbbd939a8,0xb8723b64,0x323eb9a8,0xbaa7361f
.long 0x361f8000,0x3b64b9a8,0xb61f0000,0xbb6439a8,0x3872b9a8,0x323eb61f,0xbaa739a8,0xbbd93b64
.long 0xbc003c00,0xbc003c00,0xbc003c00,0xbc003c00,0x3872b9a8,0x323eb61f,0xbaa739a8,0xbbd93b64
.long 0x361f0000,0x3b64b9a8,0xb61f0000,0xbb6439a8,0xbbd939a8,0xb8723b64,0x323eb9a8,0xbaa7361f
.long 0x39a8bc00,0xb9a88000,0x39a8bc00,0xb9a88000,0x323e39a8,0x3aa7bb64,0x3bd9b9a8,0xb872b61f
.long 0xbb640000,0x361f39a8,0x3b640000,0xb61fb9a8,0x3aa7b9a8,0xbbd9361f,0x387239a8,0xb23ebb64
.long 0x3c00,0xbc00,0x80003c00,0xbc00,0xbaa7b9a8,0x3bd9361f,0xb87239a8,0x323ebb64
.long 0x3b640000,0xb61f39a8,0xbb648000,0x361fb9a8,0xb23e39a8,0xbaa7bb64,0xbbd9b9a8,0x3872b61f
.long 0xb9a8bc00,0x39a80000,0xb9a8bc00,0x39a80000,0x3bd939a8,0x38723b64,0xb23eb9a8,0x3aa7361f
.long 0xb61f8000,0xbb64b9a8,0x361f8000,0x3b6439a8,0xb872b9a8,0xb23eb61f,0x3aa739a8,0x3bd93b64
.long 0x0,0x0,0x0,0x0,0x323e0000,0x3872361f,0x3bd93c00,0x3aa73b64
.long 0x361f0000,0x3b6439a8,0xb61f0000,0xbb64b9a8,0x38720000,0x3bd93b64,0xbaa7bc00,0x323eb61f
.long 0x39a80000,0x39a83c00,0x39a80000,0x39a83c00,0x3aa70000,0x323e3b64,0x38723c00,0xbbd9b61f
.long 0x3b640000,0xb61f39a8,0xbb640000,0x361fb9a8,0x3bd90000,0xbaa7361f,0xb23ebc00,0x38723b64
.long 0x3c000000,0xbc000000,0x3c000000,0xbc000000,0x3bd90000,0xbaa7b61f,0xb23e3c00,0x3872bb64
.long 0x3b640000,0xb61fb9a8,0xbb640000,0x361f39a8,0x3aa70000,0x323ebb64,0x3872bc00,0xbbd9361f
.long 0x39a80000,0x39a8bc00,0x39a80000,0x39a8bc00,0x38720000,0x3bd9bb64,0xbaa73c00,0x323e361f
.long 0x361f0000,0x3b64b9a8,0xb61f0000,0xbb6439a8,0x323e0000,0x3872b61f,0x3bd9bc00,0x3aa7bb64
.long 0x0,0x0,0x0,0x8000,0xb23e0000,0xb872361f,0xbbd93c00,0xbaa73b64
.long 0xb61f0000,0xbb6439a8,0x361f0000,0x3b64b9a8,0xb8720000,0xbbd93b64,0x3aa7bc00,0xb23eb61f
.long 0xb9a80000,0xb9a83c00,0xb9a88000,0xb9a83c00,0xbaa70000,0xb23e3b64,0xb8723c00,0x3bd9b61f
.long 0xbb640000,0x361f39a8,0x3b640000,0xb61fb9a8,0xbbd90000,0x3aa7361f,0x323ebc00,0xb8723b64
.long 0xbc000000,0x3c000000,0xbc008000,0x3c000000,0xbbd90000,0x3aa7b61f,0x323e3c00,0xb872bb64
.long 0xbb640000,0x361fb9a8,0x3b648000,0xb61f39a8,0xbaa70000,0xb23ebb64,0xb872bc00,0x3bd9361f
.long 0xb9a80000,0xb9a8bc00,0xb9a88000,0xb9a8bc00,0xb8720000,0xbbd9bb64,0x3aa73c00,0xb23e361f
.long 0xb61f0000,0xbb64b9a8,0x361f0000,0x3b6439a8,0xb23e0000,0xb872b61f,0xbbd9bc00,0xbaa7bb64
.long 0x0,0x0,0x0,0x0,0x3aa739a8,0x3bd93b64,0x387239a8,0x323e361f
.long 0x3b643c00,0x361f39a8,0xbb64bc00,0xb61fb9a8,0x323e39a8,0xbaa7b61f,0x3bd939a8,0x38723b64
.long 0xb9a80000,0xb9a8bc00,0xb9a80000,0xb9a8bc00,0xbbd9b9a8,0x3872b61f,0x323eb9a8,0x3aa73b64
.long 0xb61fbc00,0x3b6439a8,0x361f3c00,0xbb64b9a8,0x3872b9a8,0xb23e3b64,0xbaa7b9a8,0x3bd9361f
.long 0x3c000000,0xbc000000,0x3c000000,0xbc000000,0x387239a8,0xb23ebb64,0xbaa739a8,0x3bd9b61f
.long 0xb61f3c00,0x3b64b9a8,0x361fbc00,0xbb6439a8,0xbbd939a8,0x3872361f,0x323e39a8,0x3aa7bb64
.long 0xb9a80000,0xb9a83c00,0xb9a80000,0xb9a83c00,0x323eb9a8,0xbaa7361f,0x3bd9b9a8,0x3872bb64
.long 0x3b64bc00,0x361fb9a8,0xbb643c00,0xb61f39a8,0x3aa7b9a8,0x3bd9bb64,0x3872b9a8,0x323eb61f
.long 0x0,0x0,0x80008000,0x8000,0xbaa739a8,0xbbd93b64,0xb87239a8,0xb23e361f
.long 0xbb643c00,0xb61f39a8,0x3b64bc00,0x361fb9a8,0xb23e39a8,0x3aa7b61f,0xbbd939a8,0xb8723b64
.long 0x39a80000,0x39a8bc00,0x39a80000,0x39a8bc00,0x3bd9b9a8,0xb872b61f,0xb23eb9a8,0xbaa73b64
.long 0x361fbc00,0xbb6439a8,0xb61f3c00,0x3b64b9a8,0xb872b9a8,0x323e3b64,0x3aa7b9a8,0xbbd9361f
.long 0xbc000000,0x3c000000,0xbc008000,0x3c000000,0xb87239a8,0x323ebb64,0x3aa739a8,0xbbd9b61f
.long 0x361f3c00,0xbb64b9a8,0xb61fbc00,0x3b6439a8,0x3bd939a8,0xb872361f,0xb23e39a8,0xbaa7bb64
.long 0x39a80000,0x39a83c00,0x39a80000,0x39a83c00,0xb23eb9a8,0x3aa7361f,0xbbd9b9a8,0xb872bb64
.long 0xbb64bc00,0xb61fb9a8,0x3b643c00,0x361f39a8,0xbaa7b9a8,0xbbd9bb64,0xb872b9a8,0xb23eb61f
.long 0x0,0x0,0x0,0x0,0xb23e0000,0xb872b61f,0xbbd9bc00,0xbaa7bb64
.long 0x361f0000,0x3b6439a8,0xb61f0000,0xbb64b9a8,0xb8720000,0xbbd9bb64,0x3aa73c00,0xb23e361f
.long 0x39a80000,0x39a83c00,0x39a80000,0x39a83c00,0xbaa70000,0xb23ebb64,0xb872bc00,0x3bd9361f
.long 0x3b640000,0xb61f39a8,0xbb640000,0x361fb9a8,0xbbd90000,0x3aa7b61f,0x323e3c00,0xb872bb64
.long 0x3c000000,0xbc000000,0x3c008000,0xbc008000,0xbbd90000,0x3aa7361f,0x323ebc00,0xb8723b64
.long 0x3b648000,0xb61fb9a8,0xbb640000,0x361f39a8,0xbaa70000,0xb23e3b64,0xb8723c00,0x3bd9b61f
.long 0x39a88000,0x39a8bc00,0x39a88000,0x39a8bc00,0xb8728000,0xbbd93b64,0x3aa7bc00,0xb23eb61f
.long 0x361f8000,0x3b64b9a8,0xb61f0000,0xbb6439a8,0xb23e0000,0xb872361f,0xbbd93c00,0xbaa73b64
.long 0x80008000,0x8000,0x8000,0x0,0x323e8000,0x3872b61f,0x3bd9bc00,0x3aa7bb64
.long 0xb61f8000,0xbb6439a8,0x361f0000,0x3b64b9a8,0x38720000,0x3bd9bb64,0xbaa73c00,0x323e361f
.long 0xb9a88000,0xb9a83c00,0xb9a88000,0xb9a83c00,0x3aa70000,0x323ebb64,0x3872bc00,0xbbd9361f
.long 0xbb648000,0x361f39a8,0x3b640000,0xb61fb9a8,0x3bd90000,0xbaa7b61f,0xb23e3c00,0x3872bb64
.long 0xbc008000,0x3c000000,0xbc008000,0x3c008000,0x3bd90000,0xbaa7361f,0xb23ebc00,0x38723b64
.long 0xbb640000,0x361fb9a8,0x3b640000,0xb61f39a8,0x3aa70000,0x323e3b64,0x38723c00,0xbbd9b61f
.long 0xb9a88000,0xb9a8bc00,0xb9a80000,0xb9a8bc00,0x38720000,0x3bd93b64,0xbaa7bc00,0x323eb61f
.long 0xb61f8000,0xbb64b9a8,0x361f0000,0x3b6439a8,0x323e0000,0x3872361f,0x3bd93c00,0x3aa73b64
.long 0x0,0x0,0x0,0x0,0xbaa7b9a8,0xbbd9bb64,0xb872b9a8,0xb23eb61f
.long 0x3b643c00,0x361f39a8,0xbb64bc00,0xb61fb9a8,0xb23eb9a8,0x3aa7361f,0xbbd9b9a8,0xb872bb64
.long 0xb9a80000,0xb9a8bc00,0xb9a80000,0xb9a8bc00,0x3bd939a8,0xb872361f,0xb23e39a8,0xbaa7bb64
.long 0xb61fbc00,0x3b6439a8,0x361f3c00,0xbb64b9a8,0xb87239a8,0x323ebb64,0x3aa739a8,0xbbd9b61f
.long 0x3c008000,0xbc000000,0x3c008000,0xbc000000,0xb872b9a8,0x323e3b64,0x3aa7b9a8,0xbbd9361f
.long 0xb61f3c00,0x3b64b9a8,0x361fbc00,0xbb6439a8,0x3bd9b9a8,0xb872b61f,0xb23eb9a8,0xbaa73b64
.long 0xb9a80000,0xb9a83c00,0xb9a80000,0xb9a83c00,0xb23e39a8,0x3aa7b61f,0xbbd939a8,0xb8723b64
.long 0x3b64bc00,0x361fb9a8,0xbb643c00,0xb61f39a8,0xbaa739a8,0xbbd93b64,0xb87239a8,0xb23e361f
.long 0x8000,0x8000,0x8000,0x8000,0x3aa7b9a8,0x3bd9bb64,0x3872b9a8,0x323eb61f
.long 0xbb643c00,0xb61f39a8,0x3b64bc00,0x361fb9a8,0x323eb9a8,0xbaa7361f,0x3bd9b9a8,0x3872bb64
.long 0x39a80000,0x39a8bc00,0x39a80000,0x39a8bc00,0xbbd939a8,0x3872361f,0x323e39a8,0x3aa7bb64
.long 0x361fbc00,0xbb6439a8,0xb61f3c00,0x3b64b9a8,0x387239a8,0xb23ebb64,0xbaa739a8,0x3bd9b61f
.long 0xbc008000,0x3c000000,0xbc000000,0x3c000000,0x3872b9a8,0xb23e3b64,0xbaa7b9a8,0x3bd9361f
.long 0x361f3c00,0xbb64b9a8,0xb61fbc00,0x3b6439a8,0xbbd9b9a8,0x3872b61f,0x323eb9a8,0x3aa73b64
.long 0x39a80000,0x39a83c00,0x39a80000,0x39a83c00,0x323e39a8,0xbaa7b61f,0x3bd939a8,0x38723b64
.long 0xbb64bc00,0xb61fb9a8,0x3b643c00,0x361f39a8,0x3aa739a8,0x3bd93b64,0x387239a8,0x323e361f
.long 0x80008000,0x80008000,0x80008000,0x80008000,0xb23e8000,0xb872b61f,0xbbd9bc00,0xbaa7bb64
.long 0xb61f8000,0xbb64b9a8,0x361f8000,0x3b6439a8,0xb8728000,0xbbd9bb64,0x3aa73c00,0xb23e361f
.long 0xb9a88000,0xb9a8bc00,0xb9a88000,0xb9a8bc00,0xbaa78000,0xb23ebb64,0xb872bc00,0x3bd9361f
.long 0xbb648000,0x361fb9a8,0x3b648000,0xb61f39a8,0xbbd98000,0x3aa7b61f,0x323e3c00,0xb872bb64
.long 0xbc008000,0x3c008000,0xbc008000,0x3c008000,0xbbd98000,0x3aa7361f,0x323ebc00,0xb8723b64
.long 0xbb648000,0x361f39a8,0x3b648000,0xb61fb9a8,0xbaa78000,0xb23e3b64,0xb8723c00,0x3bd9b61f
.long 0xb9a88000,0xb9a83c00,0xb9a88000,0xb9a83c00,0xb8728000,0xbbd93b64,0x3aa7bc00,0xb23eb61f
.long 0xb61f8000,0xbb6439a8,0x361f8000,0x3b64b9a8,0xb23e8000,0xb872361f,0xbbd93c00,0xbaa73b64
.long 0x80008000,0x80008000,0x80008000,0x80000000,0x323e8000,0x3872b61f,0x3bd9bc00,0x3aa7bb64
.long 0x361f8000,0x3b64b9a8,0xb61f8000,0xbb6439a8,0x38728000,0x3bd9bb64,0xbaa73c00,0x323e361f
.long 0x39a88000,0x39a8bc00,0x39a80000,0x39a8bc00,0x3aa78000,0x323ebb64,0x3872bc00,0xbbd9361f
.long 0x3b648000,0xb61fb9a8,0xbb648000,0x361f39a8,0x3bd98000,0xbaa7b61f,0xb23e3c00,0x3872bb64
.long 0x3c008000,0xbc008000,0x3c000000,0xbc008000,0x3bd98000,0xbaa7361f,0xb23ebc00,0x38723b64
.long 0x3b648000,0xb61f39a8,0xbb640000,0x361fb9a8,0x3aa78000,0x323e3b64,0x38723c00,0xbbd9b61f
.long 0x39a88000,0x39a83c00,0x39a80000,0x39a83c00,0x38728000,0x3bd93b64,0xbaa7bc00,0x323eb61f
.long 0x361f8000,0x3b6439a8,0xb61f8000,0xbb64b9a8,0x323e8000,0x3872361f,0x3bd93c00,0x3aa73b64
.long 0x80008000,0x80008000,0x80008000,0x80008000,0xbaa7b9a8,0xbbd9bb64,0xb872b9a8,0xb23eb61f
.long 0xbb64bc00,0xb61fb9a8,0x3b643c00,0x361f39a8,0xb23eb9a8,0x3aa7361f,0xbbd9b9a8,0xb872bb64
.long 0x39a88000,0x39a83c00,0x39a88000,0x39a83c00,0x3bd939a8,0xb872361f,0xb23e39a8,0xbaa7bb64
.long 0x361f3c00,0xbb64b9a8,0xb61fbc00,0x3b6439a8,0xb87239a8,0x323ebb64,0x3aa739a8,0xbbd9b61f
.long 0xbc008000,0x3c008000,0xbc008000,0x3c008000,0xb872b9a8,0x323e3b64,0x3aa7b9a8,0xbbd9361f
.long 0x361fbc00,0xbb6439a8,0xb61f3c00,0x3b64b9a8,0x3bd9b9a8,0xb872b61f,0xb23eb9a8,0xbaa73b64
.long 0x39a88000,0x39a8bc00,0x39a88000,0x39a8bc00,0xb23e39a8,0x3aa7b61f,0xbbd939a8,0xb8723b64
.long 0xbb643c00,0xb61f39a8,0x3b64bc00,0x361fb9a8,0xbaa739a8,0xbbd93b64,0xb87239a8,0xb23e361f
.long 0x80008000,0x80008000,0x0,0x80000000,0x3aa7b9a8,0x3bd9bb64,0x3872b9a8,0x323eb61f
.long 0x3b64bc00,0x361fb9a8,0xbb643c00,0xb61f39a8,0x323eb9a8,0xbaa7361f,0x3bd9b9a8,0x3872bb64
.long 0xb9a88000,0xb9a83c00,0xb9a88000,0xb9a83c00,0xbbd939a8,0x3872361f,0x323e39a8,0x3aa7bb64
.long 0xb61f3c00,0x3b64b9a8,0x361fbc00,0xbb6439a8,0x387239a8,0xb23ebb64,0xbaa739a8,0x3bd9b61f
.long 0x3c008000,0xbc008000,0x3c000000,0xbc008000,0x3872b9a8,0xb23e3b64,0xbaa7b9a8,0x3bd9361f
.long 0xb61fbc00,0x3b6439a8,0x361f3c00,0xbb64b9a8,0xbbd9b9a8,0x3872b61f,0x323eb9a8,0x3aa73b64
.long 0xb9a88000,0xb9a8bc00,0xb9a88000,0xb9a8bc00,0x323e39a8,0xbaa7b61f,0x3bd939a8,0x38723b64
.long 0x3b643c00,0x361f39a8,0xbb64bc00,0xb61fb9a8,0x3aa739a8,0x3bd93b64,0x387239a8,0x323e361f
.long 0x80008000,0x80008000,0x80008000,0x80008000,0x323e8000,0x3872361f,0x3bd93c00,0x3aa73b64
.long 0xb61f8000,0xbb64b9a8,0x361f8000,0x3b6439a8,0x38728000,0x3bd93b64,0xbaa7bc00,0x323eb61f
.long 0xb9a88000,0xb9a8bc00,0xb9a88000,0xb9a8bc00,0x3aa78000,0x323e3b64,0x38723c00,0xbbd9b61f
.long 0xbb648000,0x361fb9a8,0x3b648000,0xb61f39a8,0x3bd98000,0xbaa7361f,0xb23ebc00,0x38723b64
.long 0xbc008000,0x3c008000,0xbc000000,0x3c000000,0x3bd98000,0xbaa7b61f,0xb23e3c00,0x3872bb64
.long 0xbb640000,0x361f39a8,0x3b648000,0xb61fb9a8,0x3aa78000,0x323ebb64,0x3872bc00,0xbbd9361f
.long 0xb9a80000,0xb9a83c00,0xb9a80000,0xb9a83c00,0x38720000,0x3bd9bb64,0xbaa73c00,0x323e361f
.long 0xb61f0000,0xbb6439a8,0x361f8000,0x3b64b9a8,0x323e8000,0x3872b61f,0x3bd9bc00,0x3aa7bb64
.long 0x0,0x80000000,0x80000000,0x80008000,0xb23e0000,0xb872361f,0xbbd93c00,0xbaa73b64
.long 0x361f0000,0x3b64b9a8,0xb61f8000,0xbb6439a8,0xb8728000,0xbbd93b64,0x3aa7bc00,0xb23eb61f
.long 0x39a80000,0x39a8bc00,0x39a80000,0x39a8bc00,0xbaa78000,0xb23e3b64,0xb8723c00,0x3bd9b61f
.long 0x3b640000,0xb61fb9a8,0xbb648000,0x361f39a8,0xbbd98000,0x3aa7361f,0x323ebc00,0xb8723b64
.long 0x3c000000,0xbc008000,0x3c000000,0xbc000000,0xbbd98000,0x3aa7b61f,0x323e3c00,0xb872bb64
.long 0x3b648000,0xb61f39a8,0xbb648000,0x361fb9a8,0xbaa78000,0xb23ebb64,0xb872bc00,0x3bd9361f
.long 0x39a80000,0x39a83c00,0x39a88000,0x39a83c00,0xb8728000,0xbbd9bb64,0x3aa73c00,0xb23e361f
.long 0x361f0000,0x3b6439a8,0xb61f8000,0xbb64b9a8,0xb23e8000,0xb872b61f,0xbbd9bc00,0xbaa7bb64
.long 0x80008000,0x80008000,0x80008000,0x80008000,0x3aa739a8,0x3bd93b64,0x387239a8,0x323e361f
.long 0xbb64bc00,0xb61fb9a8,0x3b643c00,0x361f39a8,0x323e39a8,0xbaa7b61f,0x3bd939a8,0x38723b64
.long 0x39a88000,0x39a83c00,0x39a88000,0x39a83c00,0xbbd9b9a8,0x3872b61f,0x323eb9a8,0x3aa73b64
.long 0x361f3c00,0xbb64b9a8,0xb61fbc00,0x3b6439a8,0x3872b9a8,0xb23e3b64,0xbaa7b9a8,0x3bd9361f
.long 0xbc000000,0x3c008000,0xbc000000,0x3c008000,0x387239a8,0xb23ebb64,0xbaa739a8,0x3bd9b61f
.long 0x361fbc00,0xbb6439a8,0xb61f3c00,0x3b64b9a8,0xbbd939a8,0x3872361f,0x323e39a8,0x3aa7bb64
.long 0x39a88000,0x39a8bc00,0x39a88000,0x39a8bc00,0x323eb9a8,0xbaa7361f,0x3bd9b9a8,0x3872bb64
.long 0xbb643c00,0xb61f39a8,0x3b64bc00,0x361fb9a8,0x3aa7b9a8,0x3bd9bb64,0x3872b9a8,0x323eb61f
.long 0x80000000,0x80000000,0x80000000,0x80000000,0xbaa739a8,0xbbd93b64,0xb87239a8,0xb23e361f
.long 0x3b64bc00,0x361fb9a8,0xbb643c00,0xb61f39a8,0xb23e39a8,0x3aa7b61f,0xbbd939a8,0xb8723b64
.long 0xb9a88000,0xb9a83c00,0xb9a88000,0xb9a83c00,0x3bd9b9a8,0xb872b61f,0xb23eb9a8,0xbaa73b64
.long 0xb61f3c00,0x3b64b9a8,0x361fbc00,0xbb6439a8,0xb872b9a8,0x323e3b64,0x3aa7b9a8,0xbbd9361f
.long 0x3c000000,0xbc008000,0x3c008000,0xbc008000,0xb87239a8,0x323ebb64,0x3aa739a8,0xbbd9b61f
.long 0xb61fbc00,0x3b6439a8,0x361f3c00,0xbb64b9a8,0x3bd939a8,0xb872361f,0xb23e39a8,0xbaa7bb64
.long 0xb9a88000,0xb9a8bc00,0xb9a88000,0xb9a8bc00,0xb23eb9a8,0x3aa7361f,0xbbd9b9a8,0xb872bb64
.long 0x3b643c00,0x361f39a8,0xbb64bc00,0xb61fb9a8,0xbaa7b9a8,0xbbd9bb64,0xb872b9a8,0xb23eb61f
.long 0x3bf63c00,0x3ba83bd9,0x391339a8,0x378b3872,0x3ba83c00,0x39133aa7,0xbb0eb9a8,0xbbf6bbd9
.long 0x3b0e3c00,0x2e463872,0xb4a5b9a8,0x3913323e,0x3a2f3c00,0xb78b323e,0x3bf639a8,0x34a53aa7
.long 0x39133c00,0xbb0eb23e,0xae4639a8,0xbba8baa7,0x378b3c00,0xbbf6b872,0xbba8b9a8,0x3a2fb23e
.long 0x34a53c00,0xba2fbaa7,0x378bb9a8,0x2e463bd9,0x2e463c00,0xb4a5bbd9,0x3a2f39a8,0xbb0eb872
.long 0xae463c00,0x34a5bbd9,0xba2f39a8,0x3b0eb872,0xb4a53c00,0x3a2fbaa7,0xb78bb9a8,0xae463bd9
.long 0xb78b3c00,0x3bf6b872,0x3ba8b9a8,0xba2fb23e,0xb9133c00,0x3b0eb23e,0x2e4639a8,0x3ba8baa7
.long 0xba2f3c00,0x378b323e,0xbbf639a8,0xb4a53aa7,0xbb0e3c00,0xae463872,0x34a5b9a8,0xb913323e
.long 0xbba83c00,0xb9133aa7,0x3b0eb9a8,0x3bf6bbd9,0xbbf63c00,0xbba83bd9,0xb91339a8,0xb78b3872
.long 0xbbf63c00,0xbba83bd9,0xb91339a8,0xb78b3872,0xbba83c00,0xb9133aa7,0x3b0eb9a8,0x3bf6bbd9
.long 0xbb0e3c00,0xae463872,0x34a5b9a8,0xb913323e,0xba2f3c00,0x378b323e,0xbbf639a8,0xb4a53aa7
.long 0xb9133c00,0x3b0eb23e,0x2e4639a8,0x3ba8baa7,0xb78b3c00,0x3bf6b872,0x3ba8b9a8,0xba2fb23e
.long 0xb4a53c00,0x3a2fbaa7,0xb78bb9a8,0xae463bd9,0xae463c00,0x34a5bbd9,0xba2f39a8,0x3b0eb872
.long 0x2e463c00,0xb4a5bbd9,0x3a2f39a8,0xbb0eb872,0x34a53c00,0xba2fbaa7,0x378bb9a8,0x2e463bd9
.long 0x378b3c00,0xbbf6b872,0xbba8b9a8,0x3a2fb23e,0x39133c00,0xbb0eb23e,0xae4639a8,0xbba8baa7
.long 0x3a2f3c00,0xb78b323e,0x3bf639a8,0x34a53aa7,0x3b0e3c00,0x2e463872,0xb4a5b9a8,0x3913323e
.long 0x3ba83c00,0x39133aa7,0xbb0eb9a8,0xbbf6bbd9,0x3bf63c00,0x3ba83bd9,0x391339a8,0x378b3872
.long 0x3b0e3b64,0x3a2f3aa7,0x34a5361f,0x2e46323e,0x2e46361f,0xb78bb23e,0xba2fbb64,0xb4a5b872
.long 0xba2fb61f,0xbba8bbd9,0x3bf63b64,0x378b3aa7,0xbba8bb64,0x2e46b872,0xbb0eb61f,0xb913bbd9
.long 0xb4a5bb64,0x3bf63872,0x378bb61f,0x3a2f3bd9,0x3913b61f,0x34a53bd9,0x2e463b64,0xbb0ebaa7
.long 0x3bf6361f,0xbb0e323e,0xb913bb64,0x3ba83872,0x378b3b64,0xb913baa7,0x3ba8361f,0xbbf6b23e
.long 0xb78b3b64,0x3913baa7,0xbba8361f,0x3bf6b23e,0xbbf6361f,0x3b0e323e,0x3913bb64,0xbba83872
.long 0xb913b61f,0xb4a53bd9,0xae463b64,0x3b0ebaa7,0x34a5bb64,0xbbf63872,0xb78bb61f,0xba2f3bd9
.long 0x3ba8bb64,0xae46b872,0x3b0eb61f,0x3913bbd9,0x3a2fb61f,0x3ba8bbd9,0xbbf63b64,0xb78b3aa7
.long 0xae46361f,0x378bb23e,0x3a2fbb64,0x34a5b872,0xbb0e3b64,0xba2f3aa7,0xb4a5361f,0xae46323e
.long 0xbb0e3b64,0xba2f3aa7,0xb4a5361f,0xae46323e,0xae46361f,0x378bb23e,0x3a2fbb64,0x34a5b872
.long 0x3a2fb61f,0x3ba8bbd9,0xbbf63b64,0xb78b3aa7,0x3ba8bb64,0xae46b872,0x3b0eb61f,0x3913bbd9
.long 0x34a5bb64,0xbbf63872,0xb78bb61f,0xba2f3bd9,0xb913b61f,0xb4a53bd9,0xae463b64,0x3b0ebaa7
.long 0xbbf6361f,0x3b0e323e,0x3913bb64,0xbba83872,0xb78b3b64,0x3913baa7,0xbba8361f,0x3bf6b23e
.long 0x378b3b64,0xb913baa7,0x3ba8361f,0xbbf6b23e,0x3bf6361f,0xbb0e323e,0xb913bb64,0x3ba83872
.long 0x3913b61f,0x34a53bd9,0x2e463b64,0xbb0ebaa7,0xb4a5bb64,0x3bf63872,0x378bb61f,0x3a2f3bd9
.long 0xbba8bb64,0x2e46b872,0xbb0eb61f,0xb913bbd9,0xba2fb61f,0xbba8bbd9,0x3bf63b64,0x378b3aa7
.long 0x2e46361f,0xb78bb23e,0xba2fbb64,0xb4a5b872,0x3b0e3b64,0x3a2f3aa7,0x34a5361f,0x2e46323e
.long 0xae460000,0xb4a5b23e,0xba2fb9a8,0xbb0ebaa7,0x34a50000,0x3a2f3872,0x378b39a8,0xae46323e
.long 0xb78b0000,0xbbf6baa7,0x3ba839a8,0x3a2f3bd9,0x39130000,0x3b0e3bd9,0xae46b9a8,0x3ba83872
.long 0xba2f0000,0xb78bbbd9,0xbbf6b9a8,0x34a5b872,0x3b0e8000,0xae463aa7,0xb4a539a8,0xb913bbd9
.long 0xbba80000,0x3913b872,0x3b0e39a8,0xbbf6b23e,0x3bf68000,0xbba8323e,0x3913b9a8,0xb78b3aa7
.long 0xbbf60000,0x3ba8323e,0xb913b9a8,0x378b3aa7,0x3ba88000,0xb913b872,0xbb0e39a8,0x3bf6b23e
.long 0xbb0e0000,0x2e463aa7,0x34a539a8,0x3913bbd9,0x3a2f8000,0x378bbbd9,0x3bf6b9a8,0xb4a5b872
.long 0xb9130000,0xbb0e3bd9,0x2e46b9a8,0xbba83872,0x378b8000,0x3bf6baa7,0xbba839a8,0xba2f3bd9
.long 0xb4a50000,0xba2f3872,0xb78b39a8,0x2e46323e,0x2e468000,0x34a5b23e,0x3a2fb9a8,0x3b0ebaa7
.long 0x2e460000,0x34a5b23e,0x3a2fb9a8,0x3b0ebaa7,0xb4a58000,0xba2f3872,0xb78b39a8,0x2e46323e
.long 0x378b0000,0x3bf6baa7,0xbba839a8,0xba2f3bd9,0xb9138000,0xbb0e3bd9,0x2e46b9a8,0xbba83872
.long 0x3a2f0000,0x378bbbd9,0x3bf6b9a8,0xb4a5b872,0xbb0e8000,0x2e463aa7,0x34a539a8,0x3913bbd9
.long 0x3ba80000,0xb913b872,0xbb0e39a8,0x3bf6b23e,0xbbf60000,0x3ba8323e,0xb913b9a8,0x378b3aa7
.long 0x3bf60000,0xbba8323e,0x3913b9a8,0xb78b3aa7,0xbba88000,0x3913b872,0x3b0e39a8,0xbbf6b23e
.long 0x3b0e0000,0xae463aa7,0xb4a539a8,0xb913bbd9,0xba2f0000,0xb78bbbd9,0xbbf6b9a8,0x34a5b872
.long 0x39130000,0x3b0e3bd9,0xae46b9a8,0x3ba83872,0xb78b8000,0xbbf6baa7,0x3ba839a8,0x3a2f3bd9
.long 0x34a50000,0x3a2f3872,0x378b39a8,0xae46323e,0xae460000,0xb4a5b23e,0xba2fb9a8,0xbb0ebaa7
.long 0xb78bb61f,0xb913b872,0xbba8bb64,0xbbf6bbd9,0x3bf63b64,0x3b0e3bd9,0xb913b61f,0xbba8baa7
.long 0xb913bb64,0x34a5b23e,0xae46361f,0xbb0eb872,0xb4a5361f,0xbbf6baa7,0x378b3b64,0xba2fb23e
.long 0x3ba8361f,0x2e463aa7,0x3b0e3b64,0xb913323e,0xba2fbb64,0x3ba8323e,0x3bf6361f,0xb78b3872
.long 0xae463b64,0xb78bbbd9,0x3a2fb61f,0xb4a53aa7,0x3b0eb61f,0xba2f3872,0x34a5bb64,0xae463bd9
.long 0xbb0eb61f,0x3a2f3872,0xb4a5bb64,0x2e463bd9,0x2e463b64,0x378bbbd9,0xba2fb61f,0x34a53aa7
.long 0x3a2fbb64,0xbba8323e,0xbbf6361f,0x378b3872,0xbba8361f,0xae463aa7,0xbb0e3b64,0x3913323e
.long 0x34a5361f,0x3bf6baa7,0xb78b3b64,0x3a2fb23e,0x3913bb64,0xb4a5b23e,0x2e46361f,0x3b0eb872
.long 0xbbf63b64,0xbb0e3bd9,0x3913b61f,0x3ba8baa7,0x378bb61f,0x3913b872,0x3ba8bb64,0x3bf6bbd9
.long 0x378bb61f,0x3913b872,0x3ba8bb64,0x3bf6bbd9,0xbbf63b64,0xbb0e3bd9,0x3913b61f,0x3ba8baa7
.long 0x3913bb64,0xb4a5b23e,0x2e46361f,0x3b0eb872,0x34a5361f,0x3bf6baa7,0xb78b3b64,0x3a2fb23e
.long 0xbba8361f,0xae463aa7,0xbb0e3b64,0x3913323e,0x3a2fbb64,0xbba8323e,0xbbf6361f,0x378b3872
.long 0x2e463b64,0x378bbbd9,0xba2fb61f,0x34a53aa7,0xbb0eb61f,0x3a2f3872,0xb4a5bb64,0x2e463bd9
.long 0x3b0eb61f,0xba2f3872,0x34a5bb64,0xae463bd9,0xae463b64,0xb78bbbd9,0x3a2fb61f,0xb4a53aa7
.long 0xba2fbb64,0x3ba8323e,0x3bf6361f,0xb78b3872,0x3ba8361f,0x2e463aa7,0x3b0e3b64,0xb913323e
.long 0xb4a5361f,0xbbf6baa7,0x378b3b64,0xba2fb23e,0xb913bb64,0x34a5b23e,0xae46361f,0xbb0eb872
.long 0x3bf63b64,0x3b0e3bd9,0xb913b61f,0xbba8baa7,0xb78bb61f,0xb913b872,0xbba8bb64,0xbbf6bbd9
.long 0x2e460000,0x34a5323e,0x3a2f39a8,0x3b0e3aa7,0x34a50000,0x3a2f3872,0x378b39a8,0xae46323e
.long 0x378b0000,0x3bf63aa7,0xbba8b9a8,0xba2fbbd9,0x39130000,0x3b0e3bd9,0xae46b9a8,0x3ba83872
.long 0x3a2f0000,0x378b3bd9,0x3bf639a8,0xb4a53872,0x3b0e0000,0xae463aa7,0xb4a539a8,0xb913bbd9
.long 0x3ba80000,0xb9133872,0xbb0eb9a8,0x3bf6323e,0x3bf60000,0xbba8323e,0x3913b9a8,0xb78b3aa7
.long 0x3bf60000,0xbba8b23e,0x391339a8,0xb78bbaa7,0x3ba80000,0xb913b872,0xbb0e39a8,0x3bf6b23e
.long 0x3b0e0000,0xae46baa7,0xb4a5b9a8,0xb9133bd9,0x3a2f0000,0x378bbbd9,0x3bf6b9a8,0xb4a5b872
.long 0x39130000,0x3b0ebbd9,0xae4639a8,0x3ba8b872,0x378b0000,0x3bf6baa7,0xbba839a8,0xba2f3bd9
.long 0x34a50000,0x3a2fb872,0x378bb9a8,0xae46b23e,0x2e460000,0x34a5b23e,0x3a2fb9a8,0x3b0ebaa7
.long 0xae460000,0xb4a5323e,0xba2f39a8,0xbb0e3aa7,0xb4a50000,0xba2f3872,0xb78b39a8,0x2e46323e
.long 0xb78b0000,0xbbf63aa7,0x3ba8b9a8,0x3a2fbbd9,0xb9130000,0xbb0e3bd9,0x2e46b9a8,0xbba83872
.long 0xba2f0000,0xb78b3bd9,0xbbf639a8,0x34a53872,0xbb0e0000,0x2e463aa7,0x34a539a8,0x3913bbd9
.long 0xbba80000,0x39133872,0x3b0eb9a8,0xbbf6323e,0xbbf60000,0x3ba8323e,0xb913b9a8,0x378b3aa7
.long 0xbbf60000,0x3ba8b23e,0xb91339a8,0x378bbaa7,0xbba80000,0x3913b872,0x3b0e39a8,0xbbf6b23e
.long 0xbb0e0000,0x2e46baa7,0x34a5b9a8,0x39133bd9,0xba2f0000,0xb78bbbd9,0xbbf6b9a8,0x34a5b872
.long 0xb9130000,0xbb0ebbd9,0x2e4639a8,0xbba8b872,0xb78b0000,0xbbf6baa7,0x3ba839a8,0x3a2f3bd9
.long 0xb4a50000,0xba2fb872,0xb78bb9a8,0x2e46b23e,0xae460000,0xb4a5b23e,0xba2fb9a8,0xbb0ebaa7
.long 0x378b361f,0x39133872,0x3ba83b64,0x3bf63bd9,0x3bf63b64,0x3b0e3bd9,0xb913b61f,0xbba8baa7
.long 0x39133b64,0xb4a5323e,0x2e46b61f,0x3b0e3872,0xb4a5361f,0xbbf6baa7,0x378b3b64,0xba2fb23e
.long 0xbba8b61f,0xae46baa7,0xbb0ebb64,0x3913b23e,0xba2fbb64,0x3ba8323e,0x3bf6361f,0xb78b3872
.long 0x2e46bb64,0x378b3bd9,0xba2f361f,0x34a5baa7,0x3b0eb61f,0xba2f3872,0x34a5bb64,0xae463bd9
.long 0x3b0e361f,0xba2fb872,0x34a53b64,0xae46bbd9,0x2e463b64,0x378bbbd9,0xba2fb61f,0x34a53aa7
.long 0xba2f3b64,0x3ba8b23e,0x3bf6b61f,0xb78bb872,0xbba8361f,0xae463aa7,0xbb0e3b64,0x3913323e
.long 0xb4a5b61f,0xbbf63aa7,0x378bbb64,0xba2f323e,0x3913bb64,0xb4a5b23e,0x2e46361f,0x3b0eb872
.long 0x3bf6bb64,0x3b0ebbd9,0xb913361f,0xbba83aa7,0x378bb61f,0x3913b872,0x3ba8bb64,0x3bf6bbd9
.long 0xb78b361f,0xb9133872,0xbba83b64,0xbbf63bd9,0xbbf63b64,0xbb0e3bd9,0x3913b61f,0x3ba8baa7
.long 0xb9133b64,0x34a5323e,0xae46b61f,0xbb0e3872,0x34a5361f,0x3bf6baa7,0xb78b3b64,0x3a2fb23e
.long 0x3ba8b61f,0x2e46baa7,0x3b0ebb64,0xb913b23e,0x3a2fbb64,0xbba8323e,0xbbf6361f,0x378b3872
.long 0xae46bb64,0xb78b3bd9,0x3a2f361f,0xb4a5baa7,0xbb0eb61f,0x3a2f3872,0xb4a5bb64,0x2e463bd9
.long 0xbb0e361f,0x3a2fb872,0xb4a53b64,0x2e46bbd9,0xae463b64,0xb78bbbd9,0x3a2fb61f,0xb4a53aa7
.long 0x3a2f3b64,0xbba8b23e,0xbbf6b61f,0x378bb872,0x3ba8361f,0x2e463aa7,0x3b0e3b64,0xb913323e
.long 0x34a5b61f,0x3bf63aa7,0xb78bbb64,0x3a2f323e,0xb913bb64,0x34a5b23e,0xae46361f,0xbb0eb872
.long 0xbbf6bb64,0xbb0ebbd9,0x3913361f,0x3ba83aa7,0xb78bb61f,0xb913b872,0xbba8bb64,0xbbf6bbd9
.long 0x3bf63c00,0x3ba83bd9,0x391339a8,0x378b3872,0xbba8bc00,0xb913baa7,0x3b0e39a8,0x3bf63bd9
.long 0x3b0e3c00,0x2e463872,0xb4a5b9a8,0x3913323e,0xba2fbc00,0x378bb23e,0xbbf6b9a8,0xb4a5baa7
.long 0x39133c00,0xbb0eb23e,0xae4639a8,0xbba8baa7,0xb78bbc00,0x3bf63872,0x3ba839a8,0xba2f323e
.long 0x34a53c00,0xba2fbaa7,0x378bb9a8,0x2e463bd9,0xae46bc00,0x34a53bd9,0xba2fb9a8,0x3b0e3872
.long 0xae463c00,0x34a5bbd9,0xba2f39a8,0x3b0eb872,0x34a5bc00,0xba2f3aa7,0x378b39a8,0x2e46bbd9
.long 0xb78b3c00,0x3bf6b872,0x3ba8b9a8,0xba2fb23e,0x3913bc00,0xbb0e323e,0xae46b9a8,0xbba83aa7
.long 0xba2f3c00,0x378b323e,0xbbf639a8,0xb4a53aa7,0x3b0ebc00,0x2e46b872,0xb4a539a8,0x3913b23e
.long 0xbba83c00,0xb9133aa7,0x3b0eb9a8,0x3bf6bbd9,0x3bf6bc00,0x3ba8bbd9,0x3913b9a8,0x378bb872
.long 0xbbf63c00,0xbba83bd9,0xb91339a8,0xb78b3872,0x3ba8bc00,0x3913baa7,0xbb0e39a8,0xbbf63bd9
.long 0xbb0e3c00,0xae463872,0x34a5b9a8,0xb913323e,0x3a2fbc00,0xb78bb23e,0x3bf6b9a8,0x34a5baa7
.long 0xb9133c00,0x3b0eb23e,0x2e4639a8,0x3ba8baa7,0x378bbc00,0xbbf63872,0xbba839a8,0x3a2f323e
.long 0xb4a53c00,0x3a2fbaa7,0xb78bb9a8,0xae463bd9,0x2e46bc00,0xb4a53bd9,0x3a2fb9a8,0xbb0e3872
.long 0x2e463c00,0xb4a5bbd9,0x3a2f39a8,0xbb0eb872,0xb4a5bc00,0x3a2f3aa7,0xb78b39a8,0xae46bbd9
.long 0x378b3c00,0xbbf6b872,0xbba8b9a8,0x3a2fb23e,0xb913bc00,0x3b0e323e,0x2e46b9a8,0x3ba83aa7
.long 0x3a2f3c00,0xb78b323e,0x3bf639a8,0x34a53aa7,0xbb0ebc00,0xae46b872,0x34a539a8,0xb913b23e
.long 0x3ba83c00,0x39133aa7,0xbb0eb9a8,0xbbf6bbd9,0xbbf6bc00,0xbba8bbd9,0xb913b9a8,0xb78bb872
.long 0x3b0e3b64,0x3a2f3aa7,0x34a5361f,0x2e46323e,0xae46b61f,0x378b323e,0x3a2f3b64,0x34a53872
.long 0xba2fb61f,0xbba8bbd9,0x3bf63b64,0x378b3aa7,0x3ba83b64,0xae463872,0x3b0e361f,0x39133bd9
.long 0xb4a5bb64,0x3bf63872,0x378bb61f,0x3a2f3bd9,0xb913361f,0xb4a5bbd9,0xae46bb64,0x3b0e3aa7
.long 0x3bf6361f,0xbb0e323e,0xb913bb64,0x3ba83872,0xb78bbb64,0x39133aa7,0xbba8b61f,0x3bf6323e
.long 0xb78b3b64,0x3913baa7,0xbba8361f,0x3bf6b23e,0x3bf6b61f,0xbb0eb23e,0xb9133b64,0x3ba8b872
.long 0xb913b61f,0xb4a53bd9,0xae463b64,0x3b0ebaa7,0xb4a53b64,0x3bf6b872,0x378b361f,0x3a2fbbd9
.long 0x3ba8bb64,0xae46b872,0x3b0eb61f,0x3913bbd9,0xba2f361f,0xbba83bd9,0x3bf6bb64,0x378bbaa7
.long 0xae46361f,0x378bb23e,0x3a2fbb64,0x34a5b872,0x3b0ebb64,0x3a2fbaa7,0x34a5b61f,0x2e46b23e
.long 0xbb0e3b64,0xba2f3aa7,0xb4a5361f,0xae46323e,0x2e46b61f,0xb78b323e,0xba2f3b64,0xb4a53872
.long 0x3a2fb61f,0x3ba8bbd9,0xbbf63b64,0xb78b3aa7,0xbba83b64,0x2e463872,0xbb0e361f,0xb9133bd9
.long 0x34a5bb64,0xbbf63872,0xb78bb61f,0xba2f3bd9,0x3913361f,0x34a5bbd9,0x2e46bb64,0xbb0e3aa7
.long 0xbbf6361f,0x3b0e323e,0x3913bb64,0xbba83872,0x378bbb64,0xb9133aa7,0x3ba8b61f,0xbbf6323e
.long 0x378b3b64,0xb913baa7,0x3ba8361f,0xbbf6b23e,0xbbf6b61f,0x3b0eb23e,0x39133b64,0xbba8b872
.long 0x3913b61f,0x34a53bd9,0x2e463b64,0xbb0ebaa7,0x34a53b64,0xbbf6b872,0xb78b361f,0xba2fbbd9
.long 0xbba8bb64,0x2e46b872,0xbb0eb61f,0xb913bbd9,0x3a2f361f,0x3ba83bd9,0xbbf6bb64,0xb78bbaa7
.long 0x2e46361f,0xb78bb23e,0xba2fbb64,0xb4a5b872,0xbb0ebb64,0xba2fbaa7,0xb4a5b61f,0xae46b23e
.long 0xae468000,0xb4a5b23e,0xba2fb9a8,0xbb0ebaa7,0xb4a58000,0xba2fb872,0xb78bb9a8,0x2e46b23e
.long 0xb78b8000,0xbbf6baa7,0x3ba839a8,0x3a2f3bd9,0xb9138000,0xbb0ebbd9,0x2e4639a8,0xbba8b872
.long 0xba2f8000,0xb78bbbd9,0xbbf6b9a8,0x34a5b872,0xbb0e8000,0x2e46baa7,0x34a5b9a8,0x39133bd9
.long 0xbba88000,0x3913b872,0x3b0e39a8,0xbbf6b23e,0xbbf68000,0x3ba8b23e,0xb91339a8,0x378bbaa7
.long 0xbbf68000,0x3ba8323e,0xb913b9a8,0x378b3aa7,0xbba88000,0x39133872,0x3b0eb9a8,0xbbf6323e
.long 0xbb0e8000,0x2e463aa7,0x34a539a8,0x3913bbd9,0xba2f8000,0xb78b3bd9,0xbbf639a8,0x34a53872
.long 0xb9138000,0xbb0e3bd9,0x2e46b9a8,0xbba83872,0xb78b8000,0xbbf63aa7,0x3ba8b9a8,0x3a2fbbd9
.long 0xb4a58000,0xba2f3872,0xb78b39a8,0x2e46323e,0xae468000,0xb4a5323e,0xba2f39a8,0xbb0e3aa7
.long 0x2e468000,0x34a5b23e,0x3a2fb9a8,0x3b0ebaa7,0x34a58000,0x3a2fb872,0x378bb9a8,0xae46b23e
.long 0x378b8000,0x3bf6baa7,0xbba839a8,0xba2f3bd9,0x39138000,0x3b0ebbd9,0xae4639a8,0x3ba8b872
.long 0x3a2f8000,0x378bbbd9,0x3bf6b9a8,0xb4a5b872,0x3b0e8000,0xae46baa7,0xb4a5b9a8,0xb9133bd9
.long 0x3ba88000,0xb913b872,0xbb0e39a8,0x3bf6b23e,0x3bf68000,0xbba8b23e,0x391339a8,0xb78bbaa7
.long 0x3bf68000,0xbba8323e,0x3913b9a8,0xb78b3aa7,0x3ba88000,0xb9133872,0xbb0eb9a8,0x3bf6323e
.long 0x3b0e8000,0xae463aa7,0xb4a539a8,0xb913bbd9,0x3a2f8000,0x378b3bd9,0x3bf639a8,0xb4a53872
.long 0x39138000,0x3b0e3bd9,0xae46b9a8,0x3ba83872,0x378b8000,0x3bf63aa7,0xbba8b9a8,0xba2fbbd9
.long 0x34a58000,0x3a2f3872,0x378b39a8,0xae46323e,0x2e468000,0x34a5323e,0x3a2f39a8,0x3b0e3aa7
.long 0xb78bb61f,0xb913b872,0xbba8bb64,0xbbf6bbd9,0xbbf6bb64,0xbb0ebbd9,0x3913361f,0x3ba83aa7
.long 0xb913bb64,0x34a5b23e,0xae46361f,0xbb0eb872,0x34a5b61f,0x3bf63aa7,0xb78bbb64,0x3a2f323e
.long 0x3ba8361f,0x2e463aa7,0x3b0e3b64,0xb913323e,0x3a2f3b64,0xbba8b23e,0xbbf6b61f,0x378bb872
.long 0xae463b64,0xb78bbbd9,0x3a2fb61f,0xb4a53aa7,0xbb0e361f,0x3a2fb872,0xb4a53b64,0x2e46bbd9
.long 0xbb0eb61f,0x3a2f3872,0xb4a5bb64,0x2e463bd9,0xae46bb64,0xb78b3bd9,0x3a2f361f,0xb4a5baa7
.long 0x3a2fbb64,0xbba8323e,0xbbf6361f,0x378b3872,0x3ba8b61f,0x2e46baa7,0x3b0ebb64,0xb913b23e
.long 0x34a5361f,0x3bf6baa7,0xb78b3b64,0x3a2fb23e,0xb9133b64,0x34a5323e,0xae46b61f,0xbb0e3872
.long 0xbbf63b64,0xbb0e3bd9,0x3913b61f,0x3ba8baa7,0xb78b361f,0xb9133872,0xbba83b64,0xbbf63bd9
.long 0x378bb61f,0x3913b872,0x3ba8bb64,0x3bf6bbd9,0x3bf6bb64,0x3b0ebbd9,0xb913361f,0xbba83aa7
.long 0x3913bb64,0xb4a5b23e,0x2e46361f,0x3b0eb872,0xb4a5b61f,0xbbf63aa7,0x378bbb64,0xba2f323e
.long 0xbba8361f,0xae463aa7,0xbb0e3b64,0x3913323e,0xba2f3b64,0x3ba8b23e,0x3bf6b61f,0xb78bb872
.long 0x2e463b64,0x378bbbd9,0xba2fb61f,0x34a53aa7,0x3b0e361f,0xba2fb872,0x34a53b64,0xae46bbd9
.long 0x3b0eb61f,0xba2f3872,0x34a5bb64,0xae463bd9,0x2e46bb64,0x378b3bd9,0xba2f361f,0x34a5baa7
.long 0xba2fbb64,0x3ba8323e,0x3bf6361f,0xb78b3872,0xbba8b61f,0xae46baa7,0xbb0ebb64,0x3913b23e
.long 0xb4a5361f,0xbbf6baa7,0x378b3b64,0xba2fb23e,0x39133b64,0xb4a5323e,0x2e46b61f,0x3b0e3872
.long 0x3bf63b64,0x3b0e3bd9,0xb913b61f,0xbba8baa7,0x378b361f,0x39133872,0x3ba83b64,0x3bf63bd9
.long 0xbbf6bc00,0xbba8bbd9,0xb913b9a8,0xb78bb872,0x3ba83c00,0x39133aa7,0xbb0eb9a8,0xbbf6bbd9
.long 0xbb0ebc00,0xae46b872,0x34a539a8,0xb913b23e,0x3a2f3c00,0xb78b323e,0x3bf639a8,0x34a53aa7
.long 0xb913bc00,0x3b0e323e,0x2e46b9a8,0x3ba83aa7,0x378b3c00,0xbbf6b872,0xbba8b9a8,0x3a2fb23e
.long 0xb4a5bc00,0x3a2f3aa7,0xb78b39a8,0xae46bbd9,0x2e463c00,0xb4a5bbd9,0x3a2f39a8,0xbb0eb872
.long 0x2e46bc00,0xb4a53bd9,0x3a2fb9a8,0xbb0e3872,0xb4a53c00,0x3a2fbaa7,0xb78bb9a8,0xae463bd9
.long 0x378bbc00,0xbbf63872,0xbba839a8,0x3a2f323e,0xb9133c00,0x3b0eb23e,0x2e4639a8,0x3ba8baa7
.long 0x3a2fbc00,0xb78bb23e,0x3bf6b9a8,0x34a5baa7,0xbb0e3c00,0xae463872,0x34a5b9a8,0xb913323e
.long 0x3ba8bc00,0x3913baa7,0xbb0e39a8,0xbbf63bd9,0xbbf63c00,0xbba83bd9,0xb91339a8,0xb78b3872
.long 0x3bf6bc00,0x3ba8bbd9,0x3913b9a8,0x378bb872,0xbba83c00,0xb9133aa7,0x3b0eb9a8,0x3bf6bbd9
.long 0x3b0ebc00,0x2e46b872,0xb4a539a8,0x3913b23e,0xba2f3c00,0x378b323e,0xbbf639a8,0xb4a53aa7
.long 0x3913bc00,0xbb0e323e,0xae46b9a8,0xbba83aa7,0xb78b3c00,0x3bf6b872,0x3ba8b9a8,0xba2fb23e
.long 0x34a5bc00,0xba2f3aa7,0x378b39a8,0x2e46bbd9,0xae463c00,0x34a5bbd9,0xba2f39a8,0x3b0eb872
.long 0xae46bc00,0x34a53bd9,0xba2fb9a8,0x3b0e3872,0x34a53c00,0xba2fbaa7,0x378bb9a8,0x2e463bd9
.long 0xb78bbc00,0x3bf63872,0x3ba839a8,0xba2f323e,0x39133c00,0xbb0eb23e,0xae4639a8,0xbba8baa7
.long 0xba2fbc00,0x378bb23e,0xbbf6b9a8,0xb4a5baa7,0x3b0e3c00,0x2e463872,0xb4a5b9a8,0x3913323e
.long 0xbba8bc00,0xb913baa7,0x3b0e39a8,0x3bf63bd9,0x3bf63c00,0x3ba83bd9,0x391339a8,0x378b3872
.long 0xbb0ebb64,0xba2fbaa7,0xb4a5b61f,0xae46b23e,0x2e46361f,0xb78bb23e,0xba2fbb64,0xb4a5b872
.long 0x3a2f361f,0x3ba83bd9,0xbbf6bb64,0xb78bbaa7,0xbba8bb64,0x2e46b872,0xbb0eb61f,0xb913bbd9
.long 0x34a53b64,0xbbf6b872,0xb78b361f,0xba2fbbd9,0x3913b61f,0x34a53bd9,0x2e463b64,0xbb0ebaa7
.long 0xbbf6b61f,0x3b0eb23e,0x39133b64,0xbba8b872,0x378b3b64,0xb913baa7,0x3ba8361f,0xbbf6b23e
.long 0x378bbb64,0xb9133aa7,0x3ba8b61f,0xbbf6323e,0xbbf6361f,0x3b0e323e,0x3913bb64,0xbba83872
.long 0x3913361f,0x34a5bbd9,0x2e46bb64,0xbb0e3aa7,0x34a5bb64,0xbbf63872,0xb78bb61f,0xba2f3bd9
.long 0xbba83b64,0x2e463872,0xbb0e361f,0xb9133bd9,0x3a2fb61f,0x3ba8bbd9,0xbbf63b64,0xb78b3aa7
.long 0x2e46b61f,0xb78b323e,0xba2f3b64,0xb4a53872,0xbb0e3b64,0xba2f3aa7,0xb4a5361f,0xae46323e
.long 0x3b0ebb64,0x3a2fbaa7,0x34a5b61f,0x2e46b23e,0xae46361f,0x378bb23e,0x3a2fbb64,0x34a5b872
.long 0xba2f361f,0xbba83bd9,0x3bf6bb64,0x378bbaa7,0x3ba8bb64,0xae46b872,0x3b0eb61f,0x3913bbd9
.long 0xb4a53b64,0x3bf6b872,0x378b361f,0x3a2fbbd9,0xb913b61f,0xb4a53bd9,0xae463b64,0x3b0ebaa7
.long 0x3bf6b61f,0xbb0eb23e,0xb9133b64,0x3ba8b872,0xb78b3b64,0x3913baa7,0xbba8361f,0x3bf6b23e
.long 0xb78bbb64,0x39133aa7,0xbba8b61f,0x3bf6323e,0x3bf6361f,0xbb0e323e,0xb913bb64,0x3ba83872
.long 0xb913361f,0xb4a5bbd9,0xae46bb64,0x3b0e3aa7,0xb4a5bb64,0x3bf63872,0x378bb61f,0x3a2f3bd9
.long 0x3ba83b64,0xae463872,0x3b0e361f,0x39133bd9,0xba2fb61f,0xbba8bbd9,0x3bf63b64,0x378b3aa7
.long 0xae46b61f,0x378b323e,0x3a2f3b64,0x34a53872,0x3b0e3b64,0x3a2f3aa7,0x34a5361f,0x2e46323e
.long 0x3c003c00,0x3c003c00,0x3c003c00,0x3c003c00,0x3ba83bf6,0x3a2f3b0e,0xb4a5ae46,0xb913b78b
.long 0x3aa73bd9,0x323e3872,0xbaa7bbd9,0xb23eb872,0x39133ba8,0xb78b2e46,0x3a2f34a5,0x3b0e3bf6
.long 0x361f3b64,0xbb64b61f,0x361f3b64,0xbb64b61f,0x2e463b0e,0xbba8ba2f,0xbbf6b78b,0x34a5b913
.long 0xb23e3aa7,0xb872bbd9,0x323ebaa7,0x38723bd9,0xb78b3a2f,0x2e46bba8,0x3b0e3913,0xbbf6b4a5
.long 0xb9a839a8,0x39a8b9a8,0xb9a839a8,0x39a8b9a8,0xbb0e3913,0x3bf6b4a5,0xb78bba2f,0x2e463ba8
.long 0xbbd93872,0x3aa7323e,0x3bd9b872,0xbaa7b23e,0xbbf6378b,0x34a53913,0xae463b0e,0x3ba8ba2f
.long 0xbb64361f,0xb61f3b64,0xbb64361f,0xb61f3b64,0xba2f34a5,0xbb0e3bf6,0x3913bba8,0xb78bae46
.long 0xb872323e,0xbbd93aa7,0x3872b23e,0x3bd9baa7,0xb4a52e46,0xb913378b,0xbba83bf6,0xba2f3b0e
.long 0x0,0x0,0x80000000,0x80000000,0x34a5ae46,0x3913b78b,0x3ba8bbf6,0x3a2fbb0e
.long 0x3872b23e,0x3bd9baa7,0xb872323e,0xbbd93aa7,0x3a2fb4a5,0x3b0ebbf6,0xb9133ba8,0x378b2e46
.long 0x3b64b61f,0x361fbb64,0x3b64b61f,0x361fbb64,0x3bf6b78b,0xb4a5b913,0x2e46bb0e,0xbba83a2f
.long 0x3bd9b872,0xbaa7b23e,0xbbd93872,0x3aa7323e,0x3b0eb913,0xbbf634a5,0x378b3a2f,0xae46bba8
.long 0x39a8b9a8,0xb9a839a8,0x39a8b9a8,0xb9a839a8,0x378bba2f,0xae463ba8,0xbb0eb913,0x3bf634a5
.long 0x323ebaa7,0x38723bd9,0xb23e3aa7,0xb872bbd9,0xae46bb0e,0x3ba83a2f,0x3bf6378b,0xb4a53913
.long 0xb61fbb64,0x3b64361f,0xb61fbb64,0x3b64361f,0xb913bba8,0x378bae46,0xba2fb4a5,0xbb0ebbf6
.long 0xbaa7bbd9,0xb23eb872,0x3aa73bd9,0x323e3872,0xbba8bbf6,0xba2fbb0e,0x34a52e46,0x3913378b
.long 0x3c003c00,0x3c003c00,0x3c003c00,0x3c003c00,0x378b3913,0x2e4634a5,0xbb0eba2f,0xbbf6bba8
.long 0xb872b23e,0xbbd9baa7,0x3872323e,0x3bd93aa7,0xbbf6bb0e,0xb4a5ba2f,0xae46378b,0xbba8b913
.long 0xb61fbb64,0x3b64361f,0xb61fbb64,0x3b64361f,0x3913b4a5,0x378b3bf6,0x3a2f3ba8,0xbb0eae46
.long 0x3bd93872,0xbaa7323e,0xbbd9b872,0x3aa7b23e,0x34a53bf6,0xb913bb0e,0x3ba8ae46,0xba2f378b
.long 0xb9a839a8,0x39a8b9a8,0xb9a839a8,0x39a8b9a8,0xbba8ae46,0x3a2f378b,0x34a5bbf6,0xb9133b0e
.long 0xb23ebaa7,0xb8723bd9,0x323e3aa7,0x3872bbd9,0x3a2fbba8,0xbb0e2e46,0xb913b4a5,0xb78b3bf6
.long 0x3b64b61f,0x361fbb64,0x3b64b61f,0x361fbb64,0x2e46378b,0x3ba8b913,0xbbf63b0e,0xb4a53a2f
.long 0xbaa73bd9,0xb23e3872,0x3aa7bbd9,0x323eb872,0xbb0e3a2f,0xbbf63ba8,0xb78b3913,0xae4634a5
.long 0x80000000,0x80000000,0x80000000,0x80000000,0x3b0eba2f,0x3bf6bba8,0x378bb913,0x2e46b4a5
.long 0x3aa7bbd9,0x323eb872,0xbaa73bd9,0xb23e3872,0xae46b78b,0xbba83913,0x3bf6bb0e,0x34a5ba2f
.long 0xbb64361f,0xb61f3b64,0xbb64361f,0xb61f3b64,0xba2f3ba8,0x3b0eae46,0x391334a5,0x378bbbf6
.long 0x323e3aa7,0x3872bbd9,0xb23ebaa7,0xb8723bd9,0x3ba82e46,0xba2fb78b,0xb4a53bf6,0x3913bb0e
.long 0x39a8b9a8,0xb9a839a8,0x39a8b9a8,0xb9a839a8,0xb4a5bbf6,0x39133b0e,0xbba82e46,0x3a2fb78b
.long 0xbbd9b872,0x3aa7b23e,0x3bd93872,0xbaa7323e,0xb91334a5,0xb78bbbf6,0xba2fbba8,0x3b0e2e46
.long 0x361f3b64,0xbb64b61f,0x361f3b64,0xbb64b61f,0x3bf63b0e,0x34a53a2f,0x2e46b78b,0x3ba83913
.long 0x3872323e,0x3bd93aa7,0xb872b23e,0xbbd9baa7,0xb78bb913,0xae46b4a5,0x3b0e3a2f,0x3bf63ba8
.long 0x3c003c00,0x3c003c00,0x3c003c00,0x3c003c00,0xbba8bbf6,0xba2fbb0e,0x34a52e46,0x3913378b
.long 0x3aa73bd9,0x323e3872,0xbaa7bbd9,0xb23eb872,0xb913bba8,0x378bae46,0xba2fb4a5,0xbb0ebbf6
.long 0x361f3b64,0xbb64b61f,0x361f3b64,0xbb64b61f,0xae46bb0e,0x3ba83a2f,0x3bf6378b,0xb4a53913
.long 0xb23e3aa7,0xb872bbd9,0x323ebaa7,0x38723bd9,0x378bba2f,0xae463ba8,0xbb0eb913,0x3bf634a5
.long 0xb9a839a8,0x39a8b9a8,0xb9a839a8,0x39a8b9a8,0x3b0eb913,0xbbf634a5,0x378b3a2f,0xae46bba8
.long 0xbbd93872,0x3aa7323e,0x3bd9b872,0xbaa7b23e,0x3bf6b78b,0xb4a5b913,0x2e46bb0e,0xbba83a2f
.long 0xbb64361f,0xb61f3b64,0xbb64361f,0xb61f3b64,0x3a2fb4a5,0x3b0ebbf6,0xb9133ba8,0x378b2e46
.long 0xb872323e,0xbbd93aa7,0x3872b23e,0x3bd9baa7,0x34a5ae46,0x3913b78b,0x3ba8bbf6,0x3a2fbb0e
.long 0x80000000,0x80000000,0x80000000,0x0,0xb4a52e46,0xb913378b,0xbba83bf6,0xba2f3b0e
.long 0x3872b23e,0x3bd9baa7,0xb872323e,0xbbd93aa7,0xba2f34a5,0xbb0e3bf6,0x3913bba8,0xb78bae46
.long 0x3b64b61f,0x361fbb64,0x3b64b61f,0x361fbb64,0xbbf6378b,0x34a53913,0xae463b0e,0x3ba8ba2f
.long 0x3bd9b872,0xbaa7b23e,0xbbd93872,0x3aa7323e,0xbb0e3913,0x3bf6b4a5,0xb78bba2f,0x2e463ba8
.long 0x39a8b9a8,0xb9a839a8,0x39a8b9a8,0xb9a839a8,0xb78b3a2f,0x2e46bba8,0x3b0e3913,0xbbf6b4a5
.long 0x323ebaa7,0x38723bd9,0xb23e3aa7,0xb872bbd9,0x2e463b0e,0xbba8ba2f,0xbbf6b78b,0x34a5b913
.long 0xb61fbb64,0x3b64361f,0xb61fbb64,0x3b64361f,0x39133ba8,0xb78b2e46,0x3a2f34a5,0x3b0e3bf6
.long 0xbaa7bbd9,0xb23eb872,0x3aa73bd9,0x323e3872,0x3ba83bf6,0x3a2f3b0e,0xb4a5ae46,0xb913b78b
.long 0x3c003c00,0x3c003c00,0x3c003c00,0x3c003c00,0xb78bb913,0xae46b4a5,0x3b0e3a2f,0x3bf63ba8
.long 0xb872b23e,0xbbd9baa7,0x3872323e,0x3bd93aa7,0x3bf63b0e,0x34a53a2f,0x2e46b78b,0x3ba83913
.long 0xb61fbb64,0x3b64361f,0xb61fbb64,0x3b64361f,0xb91334a5,0xb78bbbf6,0xba2fbba8,0x3b0e2e46
.long 0x3bd93872,0xbaa7323e,0xbbd9b872,0x3aa7b23e,0xb4a5bbf6,0x39133b0e,0xbba82e46,0x3a2fb78b
.long 0xb9a839a8,0x39a8b9a8,0xb9a839a8,0x39a8b9a8,0x3ba82e46,0xba2fb78b,0xb4a53bf6,0x3913bb0e
.long 0xb23ebaa7,0xb8723bd9,0x323e3aa7,0x3872bbd9,0xba2f3ba8,0x3b0eae46,0x391334a5,0x378bbbf6
.long 0x3b64b61f,0x361fbb64,0x3b64b61f,0x361fbb64,0xae46b78b,0xbba83913,0x3bf6bb0e,0x34a5ba2f
.long 0xbaa73bd9,0xb23e3872,0x3aa7bbd9,0x323eb872,0x3b0eba2f,0x3bf6bba8,0x378bb913,0x2e46b4a5
.long 0x80000000,0x0,0x80000000,0x0,0xbb0e3a2f,0xbbf63ba8,0xb78b3913,0xae4634a5
.long 0x3aa7bbd9,0x323eb872,0xbaa73bd9,0xb23e3872,0x2e46378b,0x3ba8b913,0xbbf63b0e,0xb4a53a2f
.long 0xbb64361f,0xb61f3b64,0xbb64361f,0xb61f3b64,0x3a2fbba8,0xbb0e2e46,0xb913b4a5,0xb78b3bf6
.long 0x323e3aa7,0x3872bbd9,0xb23ebaa7,0xb8723bd9,0xbba8ae46,0x3a2f378b,0x34a5bbf6,0xb9133b0e
.long 0x39a8b9a8,0xb9a839a8,0x39a8b9a8,0xb9a839a8,0x34a53bf6,0xb913bb0e,0x3ba8ae46,0xba2f378b
.long 0xbbd9b872,0x3aa7b23e,0x3bd93872,0xbaa7323e,0x3913b4a5,0x378b3bf6,0x3a2f3ba8,0xbb0eae46
.long 0x361f3b64,0xbb64b61f,0x361f3b64,0xbb64b61f,0xbbf6bb0e,0xb4a5ba2f,0xae46378b,0xbba8b913
.long 0x3872323e,0x3bd93aa7,0xb872b23e,0xbbd9baa7,0x378b3913,0x2e4634a5,0xbb0eba2f,0xbbf6bba8
.long 0x0,0x0,0x0,0x0,0x34a52e46,0x3913378b,0x3ba83bf6,0x3a2f3b0e
.long 0x3872323e,0x3bd93aa7,0xb872b23e,0xbbd9baa7,0x3a2f34a5,0x3b0e3bf6,0xb913bba8,0x378bae46
.long 0x3b64361f,0x361f3b64,0x3b64361f,0x361f3b64,0x3bf6378b,0xb4a53913,0x2e463b0e,0xbba8ba2f
.long 0x3bd93872,0xbaa7323e,0xbbd9b872,0x3aa7b23e,0x3b0e3913,0xbbf6b4a5,0x378bba2f,0xae463ba8
.long 0x39a839a8,0xb9a8b9a8,0x39a839a8,0xb9a8b9a8,0x378b3a2f,0xae46bba8,0xbb0e3913,0x3bf6b4a5
.long 0x323e3aa7,0x3872bbd9,0xb23ebaa7,0xb8723bd9,0xae463b0e,0x3ba8ba2f,0x3bf6b78b,0xb4a5b913
.long 0xb61f3b64,0x3b64b61f,0xb61f3b64,0x3b64b61f,0xb9133ba8,0x378b2e46,0xba2f34a5,0xbb0e3bf6
.long 0xbaa73bd9,0xb23e3872,0x3aa7bbd9,0x323eb872,0xbba83bf6,0xba2f3b0e,0x34a5ae46,0x3913b78b
.long 0xbc003c00,0xbc003c00,0xbc003c00,0xbc003c00,0xbba83bf6,0xba2f3b0e,0x34a5ae46,0x3913b78b
.long 0xbaa73bd9,0xb23e3872,0x3aa7bbd9,0x323eb872,0xb9133ba8,0x378b2e46,0xba2f34a5,0xbb0e3bf6
.long 0xb61f3b64,0x3b64b61f,0xb61f3b64,0x3b64b61f,0xae463b0e,0x3ba8ba2f,0x3bf6b78b,0xb4a5b913
.long 0x323e3aa7,0x3872bbd9,0xb23ebaa7,0xb8723bd9,0x378b3a2f,0xae46bba8,0xbb0e3913,0x3bf6b4a5
.long 0x39a839a8,0xb9a8b9a8,0x39a839a8,0xb9a8b9a8,0x3b0e3913,0xbbf6b4a5,0x378bba2f,0xae463ba8
.long 0x3bd93872,0xbaa7323e,0xbbd9b872,0x3aa7b23e,0x3bf6378b,0xb4a53913,0x2e463b0e,0xbba8ba2f
.long 0x3b64361f,0x361f3b64,0x3b64361f,0x361f3b64,0x3a2f34a5,0x3b0e3bf6,0xb913bba8,0x378bae46
.long 0x3872323e,0x3bd93aa7,0xb872b23e,0xbbd9baa7,0x34a52e46,0x3913378b,0x3ba83bf6,0x3a2f3b0e
.long 0x0,0x0,0x0,0x0,0x3b0e3a2f,0x3bf63ba8,0x378b3913,0x2e4634a5
.long 0x3aa73bd9,0x323e3872,0xbaa7bbd9,0xb23eb872,0xae46378b,0xbba8b913,0x3bf63b0e,0x34a53a2f
.long 0xbb64b61f,0xb61fbb64,0xbb64b61f,0xb61fbb64,0xba2fbba8,0x3b0e2e46,0x3913b4a5,0x378b3bf6
.long 0x323ebaa7,0x38723bd9,0xb23e3aa7,0xb872bbd9,0x3ba8ae46,0xba2f378b,0xb4a5bbf6,0x39133b0e
.long 0x39a839a8,0xb9a8b9a8,0x39a839a8,0xb9a8b9a8,0xb4a53bf6,0x3913bb0e,0xbba8ae46,0x3a2f378b
.long 0xbbd93872,0x3aa7323e,0x3bd9b872,0xbaa7b23e,0xb913b4a5,0xb78b3bf6,0xba2f3ba8,0x3b0eae46
.long 0x361fbb64,0xbb64361f,0x361fbb64,0xbb64361f,0x3bf6bb0e,0x34a5ba2f,0x2e46378b,0x3ba8b913
.long 0x3872b23e,0x3bd9baa7,0xb872323e,0xbbd93aa7,0xb78b3913,0xae4634a5,0x3b0eba2f,0x3bf6bba8
.long 0xbc003c00,0xbc003c00,0xbc003c00,0xbc003c00,0xb78b3913,0xae4634a5,0x3b0eba2f,0x3bf6bba8
.long 0x3872b23e,0x3bd9baa7,0xb872323e,0xbbd93aa7,0x3bf6bb0e,0x34a5ba2f,0x2e46378b,0x3ba8b913
.long 0x361fbb64,0xbb64361f,0x361fbb64,0xbb64361f,0xb913b4a5,0xb78b3bf6,0xba2f3ba8,0x3b0eae46
.long 0xbbd93872,0x3aa7323e,0x3bd9b872,0xbaa7b23e,0xb4a53bf6,0x3913bb0e,0xbba8ae46,0x3a2f378b
.long 0x39a839a8,0xb9a8b9a8,0x39a839a8,0xb9a8b9a8,0x3ba8ae46,0xba2f378b,0xb4a5bbf6,0x39133b0e
.long 0x323ebaa7,0x38723bd9,0xb23e3aa7,0xb872bbd9,0xba2fbba8,0x3b0e2e46,0x3913b4a5,0x378b3bf6
.long 0xbb64b61f,0xb61fbb64,0xbb64b61f,0xb61fbb64,0xae46378b,0xbba8b913,0x3bf63b0e,0x34a53a2f
.long 0x3aa73bd9,0x323e3872,0xbaa7bbd9,0xb23eb872,0x3b0e3a2f,0x3bf63ba8,0x378b3913,0x2e4634a5
.long 0x0,0x0,0x0,0x0,0xb4a5ae46,0xb913b78b,0xbba8bbf6,0xba2fbb0e
.long 0x3872323e,0x3bd93aa7,0xb872b23e,0xbbd9baa7,0xba2fb4a5,0xbb0ebbf6,0x39133ba8,0xb78b2e46
.long 0x3b64361f,0x361f3b64,0x3b64361f,0x361f3b64,0xbbf6b78b,0x34a5b913,0xae46bb0e,0x3ba83a2f
.long 0x3bd93872,0xbaa7323e,0xbbd9b872,0x3aa7b23e,0xbb0eb913,0x3bf634a5,0xb78b3a2f,0x2e46bba8
.long 0x39a839a8,0xb9a8b9a8,0x39a839a8,0xb9a8b9a8,0xb78bba2f,0x2e463ba8,0x3b0eb913,0xbbf634a5
.long 0x323e3aa7,0x3872bbd9,0xb23ebaa7,0xb8723bd9,0x2e46bb0e,0xbba83a2f,0xbbf6378b,0x34a53913
.long 0xb61f3b64,0x3b64b61f,0xb61f3b64,0x3b64b61f,0x3913bba8,0xb78bae46,0x3a2fb4a5,0x3b0ebbf6
.long 0xbaa73bd9,0xb23e3872,0x3aa7bbd9,0x323eb872,0x3ba8bbf6,0x3a2fbb0e,0xb4a52e46,0xb913378b
.long 0xbc003c00,0xbc003c00,0xbc003c00,0xbc003c00,0x3ba8bbf6,0x3a2fbb0e,0xb4a52e46,0xb913378b
.long 0xbaa73bd9,0xb23e3872,0x3aa7bbd9,0x323eb872,0x3913bba8,0xb78bae46,0x3a2fb4a5,0x3b0ebbf6
.long 0xb61f3b64,0x3b64b61f,0xb61f3b64,0x3b64b61f,0x2e46bb0e,0xbba83a2f,0xbbf6378b,0x34a53913
.long 0x323e3aa7,0x3872bbd9,0xb23ebaa7,0xb8723bd9,0xb78bba2f,0x2e463ba8,0x3b0eb913,0xbbf634a5
.long 0x39a839a8,0xb9a8b9a8,0x39a839a8,0xb9a8b9a8,0xbb0eb913,0x3bf634a5,0xb78b3a2f,0x2e46bba8
.long 0x3bd93872,0xbaa7323e,0xbbd9b872,0x3aa7b23e,0xbbf6b78b,0x34a5b913,0xae46bb0e,0x3ba83a2f
.long 0x3b64361f,0x361f3b64,0x3b64361f,0x361f3b64,0xba2fb4a5,0xbb0ebbf6,0x39133ba8,0xb78b2e46
.long 0x3872323e,0x3bd93aa7,0xb872b23e,0xbbd9baa7,0xb4a5ae46,0xb913b78b,0xbba8bbf6,0xba2fbb0e
.long 0x0,0x0,0x0,0x0,0xbb0eba2f,0xbbf6bba8,0xb78bb913,0xae46b4a5
.long 0x3aa73bd9,0x323e3872,0xbaa7bbd9,0xb23eb872,0x2e46b78b,0x3ba83913,0xbbf6bb0e,0xb4a5ba2f
.long 0xbb64b61f,0xb61fbb64,0xbb64b61f,0xb61fbb64,0x3a2f3ba8,0xbb0eae46,0xb91334a5,0xb78bbbf6
.long 0x323ebaa7,0x38723bd9,0xb23e3aa7,0xb872bbd9,0xbba82e46,0x3a2fb78b,0x34a53bf6,0xb913bb0e
.long 0x39a839a8,0xb9a8b9a8,0x39a839a8,0xb9a8b9a8,0x34a5bbf6,0xb9133b0e,0x3ba82e46,0xba2fb78b
.long 0xbbd93872,0x3aa7323e,0x3bd9b872,0xbaa7b23e,0x391334a5,0x378bbbf6,0x3a2fbba8,0xbb0e2e46
.long 0x361fbb64,0xbb64361f,0x361fbb64,0xbb64361f,0xbbf63b0e,0xb4a53a2f,0xae46b78b,0xbba83913
.long 0x3872b23e,0x3bd9baa7,0xb872323e,0xbbd93aa7,0x378bb913,0x2e46b4a5,0xbb0e3a2f,0xbbf63ba8
.long 0xbc003c00,0xbc003c00,0xbc003c00,0xbc003c00,0x378bb913,0x2e46b4a5,0xbb0e3a2f,0xbbf63ba8
.long 0x3872b23e,0x3bd9baa7,0xb872323e,0xbbd93aa7,0xbbf63b0e,0xb4a53a2f,0xae46b78b,0xbba83913
.long 0x361fbb64,0xbb64361f,0x361fbb64,0xbb64361f,0x391334a5,0x378bbbf6,0x3a2fbba8,0xbb0e2e46
.long 0xbbd93872,0x3aa7323e,0x3bd9b872,0xbaa7b23e,0x34a5bbf6,0xb9133b0e,0x3ba82e46,0xba2fb78b
.long 0x39a839a8,0xb9a8b9a8,0x39a839a8,0xb9a8b9a8,0xbba82e46,0x3a2fb78b,0x34a53bf6,0xb913bb0e
.long 0x323ebaa7,0x38723bd9,0xb23e3aa7,0xb872bbd9,0x3a2f3ba8,0xbb0eae46,0xb91334a5,0xb78bbbf6
.long 0xbb64b61f,0xb61fbb64,0xbb64b61f,0xb61fbb64,0x2e46b78b,0x3ba83913,0xbbf6bb0e,0xb4a5ba2f
.long 0x3aa73bd9,0x323e3872,0xbaa7bbd9,0xb23eb872,0xbb0eba2f,0xbbf6bba8,0xb78bb913,0xae46b4a5
.long 0x80008000,0x80008000,0x80008000,0x80008000,0xb4a5ae46,0xb913b78b,0xbba8bbf6,0xba2fbb0e
.long 0xb872b23e,0xbbd9baa7,0x3872323e,0x3bd93aa7,0xba2fb4a5,0xbb0ebbf6,0x39133ba8,0xb78b2e46
.long 0xbb64b61f,0xb61fbb64,0xbb64b61f,0xb61fbb64,0xbbf6b78b,0x34a5b913,0xae46bb0e,0x3ba83a2f
.long 0xbbd9b872,0x3aa7b23e,0x3bd93872,0xbaa7323e,0xbb0eb913,0x3bf634a5,0xb78b3a2f,0x2e46bba8
.long 0xb9a8b9a8,0x39a839a8,0xb9a8b9a8,0x39a839a8,0xb78bba2f,0x2e463ba8,0x3b0eb913,0xbbf634a5
.long 0xb23ebaa7,0xb8723bd9,0x323e3aa7,0x3872bbd9,0x2e46bb0e,0xbba83a2f,0xbbf6378b,0x34a53913
.long 0x361fbb64,0xbb64361f,0x361fbb64,0xbb64361f,0x3913bba8,0xb78bae46,0x3a2fb4a5,0x3b0ebbf6
.long 0x3aa7bbd9,0x323eb872,0xbaa73bd9,0xb23e3872,0x3ba8bbf6,0x3a2fbb0e,0xb4a52e46,0xb913378b
.long 0x3c00bc00,0x3c00bc00,0x3c00bc00,0x3c00bc00,0x3ba8bbf6,0x3a2fbb0e,0xb4a52e46,0xb913378b
.long 0x3aa7bbd9,0x323eb872,0xbaa73bd9,0xb23e3872,0x3913bba8,0xb78bae46,0x3a2fb4a5,0x3b0ebbf6
.long 0x361fbb64,0xbb64361f,0x361fbb64,0xbb64361f,0x2e46bb0e,0xbba83a2f,0xbbf6378b,0x34a53913
.long 0xb23ebaa7,0xb8723bd9,0x323e3aa7,0x3872bbd9,0xb78bba2f,0x2e463ba8,0x3b0eb913,0xbbf634a5
.long 0xb9a8b9a8,0x39a839a8,0xb9a8b9a8,0x39a839a8,0xbb0eb913,0x3bf634a5,0xb78b3a2f,0x2e46bba8
.long 0xbbd9b872,0x3aa7b23e,0x3bd93872,0xbaa7323e,0xbbf6b78b,0x34a5b913,0xae46bb0e,0x3ba83a2f
.long 0xbb64b61f,0xb61fbb64,0xbb64b61f,0xb61fbb64,0xba2fb4a5,0xbb0ebbf6,0x39133ba8,0xb78b2e46
.long 0xb872b23e,0xbbd9baa7,0x3872323e,0x3bd93aa7,0xb4a5ae46,0xb913b78b,0xbba8bbf6,0xba2fbb0e
.long 0x80008000,0x80008000,0x80008000,0x80008000,0xbb0eba2f,0xbbf6bba8,0xb78bb913,0xae46b4a5
.long 0xbaa7bbd9,0xb23eb872,0x3aa73bd9,0x323e3872,0x2e46b78b,0x3ba83913,0xbbf6bb0e,0xb4a5ba2f
.long 0x3b64361f,0x361f3b64,0x3b64361f,0x361f3b64,0x3a2f3ba8,0xbb0eae46,0xb91334a5,0xb78bbbf6
.long 0xb23e3aa7,0xb872bbd9,0x323ebaa7,0x38723bd9,0xbba82e46,0x3a2fb78b,0x34a53bf6,0xb913bb0e
.long 0xb9a8b9a8,0x39a839a8,0xb9a8b9a8,0x39a839a8,0x34a5bbf6,0xb9133b0e,0x3ba82e46,0xba2fb78b
.long 0x3bd9b872,0xbaa7b23e,0xbbd93872,0x3aa7323e,0x391334a5,0x378bbbf6,0x3a2fbba8,0xbb0e2e46
.long 0xb61f3b64,0x3b64b61f,0xb61f3b64,0x3b64b61f,0xbbf63b0e,0xb4a53a2f,0xae46b78b,0xbba83913
.long 0xb872323e,0xbbd93aa7,0x3872b23e,0x3bd9baa7,0x378bb913,0x2e46b4a5,0xbb0e3a2f,0xbbf63ba8
.long 0x3c00bc00,0x3c00bc00,0x3c00bc00,0x3c00bc00,0x378bb913,0x2e46b4a5,0xbb0e3a2f,0xbbf63ba8
.long 0xb872323e,0xbbd93aa7,0x3872b23e,0x3bd9baa7,0xbbf63b0e,0xb4a53a2f,0xae46b78b,0xbba83913
.long 0xb61f3b64,0x3b64b61f,0xb61f3b64,0x3b64b61f,0x391334a5,0x378bbbf6,0x3a2fbba8,0xbb0e2e46
.long 0x3bd9b872,0xbaa7b23e,0xbbd93872,0x3aa7323e,0x34a5bbf6,0xb9133b0e,0x3ba82e46,0xba2fb78b
.long 0xb9a8b9a8,0x39a839a8,0xb9a8b9a8,0x39a839a8,0xbba82e46,0x3a2fb78b,0x34a53bf6,0xb913bb0e
.long 0xb23e3aa7,0xb872bbd9,0x323ebaa7,0x38723bd9,0x3a2f3ba8,0xbb0eae46,0xb91334a5,0xb78bbbf6
.long 0x3b64361f,0x361f3b64,0x3b64361f,0x361f3b64,0x2e46b78b,0x3ba83913,0xbbf6bb0e,0xb4a5ba2f
.long 0xbaa7bbd9,0xb23eb872,0x3aa73bd9,0x323e3872,0xbb0eba2f,0xbbf6bba8,0xb78bb913,0xae46b4a5
.long 0x80008000,0x80008000,0x80008000,0x80008000,0x34a52e46,0x3913378b,0x3ba83bf6,0x3a2f3b0e
.long 0xb872b23e,0xbbd9baa7,0x3872323e,0x3bd93aa7,0x3a2f34a5,0x3b0e3bf6,0xb913bba8,0x378bae46
.long 0xbb64b61f,0xb61fbb64,0xbb64b61f,0xb61fbb64,0x3bf6378b,0xb4a53913,0x2e463b0e,0xbba8ba2f
.long 0xbbd9b872,0x3aa7b23e,0x3bd93872,0xbaa7323e,0x3b0e3913,0xbbf6b4a5,0x378bba2f,0xae463ba8
.long 0xb9a8b9a8,0x39a839a8,0xb9a8b9a8,0x39a839a8,0x378b3a2f,0xae46bba8,0xbb0e3913,0x3bf6b4a5
.long 0xb23ebaa7,0xb8723bd9,0x323e3aa7,0x3872bbd9,0xae463b0e,0x3ba8ba2f,0x3bf6b78b,0xb4a5b913
.long 0x361fbb64,0xbb64361f,0x361fbb64,0xbb64361f,0xb9133ba8,0x378b2e46,0xba2f34a5,0xbb0e3bf6
.long 0x3aa7bbd9,0x323eb872,0xbaa73bd9,0xb23e3872,0xbba83bf6,0xba2f3b0e,0x34a5ae46,0x3913b78b
.long 0x3c00bc00,0x3c00bc00,0x3c00bc00,0x3c00bc00,0xbba83bf6,0xba2f3b0e,0x34a5ae46,0x3913b78b
.long 0x3aa7bbd9,0x323eb872,0xbaa73bd9,0xb23e3872,0xb9133ba8,0x378b2e46,0xba2f34a5,0xbb0e3bf6
.long 0x361fbb64,0xbb64361f,0x361fbb64,0xbb64361f,0xae463b0e,0x3ba8ba2f,0x3bf6b78b,0xb4a5b913
.long 0xb23ebaa7,0xb8723bd9,0x323e3aa7,0x3872bbd9,0x378b3a2f,0xae46bba8,0xbb0e3913,0x3bf6b4a5
.long 0xb9a8b9a8,0x39a839a8,0xb9a8b9a8,0x39a839a8,0x3b0e3913,0xbbf6b4a5,0x378bba2f,0xae463ba8
.long 0xbbd9b872,0x3aa7b23e,0x3bd93872,0xbaa7323e,0x3bf6378b,0xb4a53913,0x2e463b0e,0xbba8ba2f
.long 0xbb64b61f,0xb61fbb64,0xbb64b61f,0xb61fbb64,0x3a2f34a5,0x3b0e3bf6,0xb913bba8,0x378bae46
.long 0xb872b23e,0xbbd9baa7,0x3872323e,0x3bd93aa7,0x34a52e46,0x3913378b,0x3ba83bf6,0x3a2f3b0e
.long 0x80008000,0x80008000,0x80008000,0x80008000,0x3b0e3a2f,0x3bf63ba8,0x378b3913,0x2e4634a5
.long 0xbaa7bbd9,0xb23eb872,0x3aa73bd9,0x323e3872,0xae46378b,0xbba8b913,0x3bf63b0e,0x34a53a2f
.long 0x3b64361f,0x361f3b64,0x3b64361f,0x361f3b64,0xba2fbba8,0x3b0e2e46,0x3913b4a5,0x378b3bf6
.long 0xb23e3aa7,0xb872bbd9,0x323ebaa7,0x38723bd9,0x3ba8ae46,0xba2f378b,0xb4a5bbf6,0x39133b0e
.long 0xb9a8b9a8,0x39a839a8,0xb9a8b9a8,0x39a839a8,0xb4a53bf6,0x3913bb0e,0xbba8ae46,0x3a2f378b
.long 0x3bd9b872,0xbaa7b23e,0xbbd93872,0x3aa7323e,0xb913b4a5,0xb78b3bf6,0xba2f3ba8,0x3b0eae46
.long 0xb61f3b64,0x3b64b61f,0xb61f3b64,0x3b64b61f,0x3bf6bb0e,0x34a5ba2f,0x2e46378b,0x3ba8b913
.long 0xb872323e,0xbbd93aa7,0x3872b23e,0x3bd9baa7,0xb78b3913,0xae4634a5,0x3b0eba2f,0x3bf6bba8
.long 0x3c00bc00,0x3c00bc00,0x3c00bc00,0x3c00bc00,0xb78b3913,0xae4634a5,0x3b0eba2f,0x3bf6bba8
.long 0xb872323e,0xbbd93aa7,0x3872b23e,0x3bd9baa7,0x3bf6bb0e,0x34a5ba2f,0x2e46378b,0x3ba8b913
.long 0xb61f3b64,0x3b64b61f,0xb61f3b64,0x3b64b61f,0xb913b4a5,0xb78b3bf6,0xba2f3ba8,0x3b0eae46
.long 0x3bd9b872,0xbaa7b23e,0xbbd93872,0x3aa7323e,0xb4a53bf6,0x3913bb0e,0xbba8ae46,0x3a2f378b
.long 0xb9a8b9a8,0x39a839a8,0xb9a8b9a8,0x39a839a8,0x3ba8ae46,0xba2f378b,0xb4a5bbf6,0x39133b0e
.long 0xb23e3aa7,0xb872bbd9,0x323ebaa7,0x38723bd9,0xba2fbba8,0x3b0e2e46,0x3913b4a5,0x378b3bf6
.long 0x3b64361f,0x361f3b64,0x3b64361f,0x361f3b64,0xae46378b,0xbba8b913,0x3bf63b0e,0x34a53a2f
.long 0xbaa7bbd9,0xb23eb872,0x3aa73bd9,0x323e3872,0x3b0e3a2f,0x3bf63ba8,0x378b3913,0x2e4634a5
.long 0x3f800000,0x3f7fffb1,0x3f7ffec4,0x3f7ffd39,0x3f800000,0x3f7ffd39,0x3f7ff4e6,0x3f7fe705
.long 0x3f800000,0x3f7ff84a,0x3f7fe129,0x3f7fba9e,0x3f800000,0x3f7ff0e3,0x3f7fc38f,0x3f7f7808
.long 0x3f800000,0x3f7fe705,0x3f7f9c18,0x3f7f1f49,0x3f800000,0x3f7fdaaf,0x3f7f6ac7,0x3f7eb069
.long 0x3f800000,0x3f7fcbe2,0x3f7f2f9d,0x3f7e2b72,0x3f800000,0x3f7fba9e,0x3f7eea9d,0x3f7d906e
.long 0x3f800000,0x3f7fa6e3,0x3f7e9bc9,0x3f7cdf6c,0x3f800000,0x3f7f90b1,0x3f7e4323,0x3f7c187a
.long 0x3f800000,0x3f7f7808,0x3f7de0b1,0x3f7b3bab,0x3f800000,0x3f7f5ce9,0x3f7d7474,0x3f7a4910
.long 0x3f800000,0x3f7f3f54,0x3f7cfe73,0x3f7940c0,0x3f800000,0x3f7f1f49,0x3f7c7eb0,0x3f7822d1
.long 0x3f800000,0x3f7efcc9,0x3f7bf531,0x3f76ef5b,0x3f800000,0x3f7ed7d4,0x3f7b61fc,0x3f75a67b
.long 0x3f800000,0x3f7eb069,0x3f7ac516,0x3f74484b,0x3f800000,0x3f7e868b,0x3f7a1e84,0x3f72d4eb
.long 0x3f800000,0x3f7e5a38,0x3f796e4e,0x3f714c7a,0x3f800000,0x3f7e2b72,0x3f78b47b,0x3f6faf1b
.long 0x3f800000,0x3f7dfa38,0x3f77f110,0x3f6dfcf2,0x3f800000,0x3f7dc68c,0x3f772417,0x3f6c3624
.long 0x3f800000,0x3f7d906e,0x3f764d97,0x3f6a5ad9,0x3f800000,0x3f7d57de,0x3f756d97,0x3f686b39
.long 0x3f800000,0x3f7d1cdd,0x3f748422,0x3f666771,0x3f800000,0x3f7cdf6c,0x3f73913f,0x3f644fac
.long 0x3f800000,0x3f7c9f8a,0x3f7294f8,0x3f62241a,0x3f800000,0x3f7c5d3a,0x3f718f57,0x3f5fe4e9
.long 0x3f800000,0x3f7c187a,0x3f708066,0x3f5d924d,0x3f800000,0x3f7bd14d,0x3f6f6830,0x3f5b2c79
.long 0x3f800000,0x3f7b87b2,0x3f6e46be,0x3f58b3a1,0x3f800000,0x3f7b3bab,0x3f6d1c1d,0x3f5627fe
.long 0x3f7ffb11,0x3f7ff84a,0x3f7ff4e6,0x3f7ff0e3,0x3f7fd397,0x3f7fba9e,0x3f7f9c18,0x3f7f7808
.long 0x3f7f84ab,0x3f7f3f54,0x3f7eea9d,0x3f7e868b,0x3f7f0e58,0x3f7e868b,0x3f7de0b1,0x3f7d1cdd
.long 0x3f7e70b0,0x3f7d906e,0x3f7c7eb0,0x3f7b3bab,0x3f7dabcc,0x3f7c5d3a,0x3f7ac516,0x3f78e3d6
.long 0x3f7cbfc9,0x3f7aed37,0x3f78b47b,0x3f76167a,0x3f7baccd,0x3f7940c0,0x3f764d97,0x3f72d4eb
.long 0x3f7a7302,0x3f77583a,0x3f73913f,0x3f6f20b0,0x3f791298,0x3f75341d,0x3f708066,0x3f6afb8c
.long 0x3f778bc5,0x3f72d4eb,0x3f6d1c1d,0x3f666771,0x3f75dec6,0x3f703b37,0x3f696591,0x3f61668a
.long 0x3f740bdd,0x3f6d67a1,0x3f655e0b,0x3f5bfb34,0x3f721352,0x3f6a5ad9,0x3f6106f2,0x3f5627fe
.long 0x3f6ff573,0x3f671599,0x3f5c61c7,0x3f4fefa8,0x3f6db293,0x3f6398ac,0x3f577026,0x3f495521
.long 0x3f6b4b0c,0x3f5fe4e9,0x3f5233c6,0x3f425b89,0x3f68bf3c,0x3f5bfb34,0x3f4cae79,0x3f3b0629
.long 0x3f660f88,0x3f57dc7f,0x3f46e22a,0x3f33587a,0x3f633c5a,0x3f5389c7,0x3f40d0da,0x3f2b561b
.long 0x3f604621,0x3f4f0417,0x3f3a7ca4,0x3f2302d3,0x3f5d2d53,0x3f4a4c87,0x3f33e7bc,0x3f1a6293
.long 0x3f59f26a,0x3f456439,0x3f2d1469,0x3f11796b,0x3f5695e5,0x3f404c5c,0x3f26050a,0x3f084b92
.long 0x3f531849,0x3f3b0629,0x3f1ebc12,0x3efdbabb,0x3f4f7a1f,0x3f3592e7,0x3f173c07,0x3eea6681
.long 0x3f4bbbf8,0x3f2ff3e6,0x3f0f8784,0x3ed6a399,0x3f47de65,0x3f2a2a80,0x3f07a136,0x3ec27b55
.long 0x3f43e200,0x3f24381a,0x3eff17b2,0x3eadf73c,0x3f3fc767,0x3f1e1e22,0x3eee9479,0x3e9920fe
.long 0x3f3b8f3b,0x3f17de12,0x3eddbe79,0x3e840270,0x3f373a23,0x3f11796b,0x3ecc9b8b,0x3e5d4b1a
.long 0x3f7fec43,0x3f7fe705,0x3f7fe129,0x3f7fdaaf,0x3f7f4e6d,0x3f7f1f49,0x3f7eea9d,0x3f7eb069
.long 0x3f7e1324,0x3f7d906e,0x3f7cfe73,0x3f7c5d3a,0x3f7c3b28,0x3f7b3bab,0x3f7a1e84,0x3f78e3d6
.long 0x3f79c79d,0x3f7822d1,0x3f764d97,0x3f74484b,0x3f76ba07,0x3f74484b,0x3f718f57,0x3f6e8ff8
.long 0x3f731447,0x3f6faf1b,0x3f6be858,0x3f67c187,0x3f6ed89e,0x3f6a5ad9,0x3f655e0b,0x3f5fe4e9
.long 0x3f6a09a7,0x3f644fac,0x3f5df6be,0x3f570348,0x3f64aa59,0x3f5d924d,0x3f55b993,0x3f4d26fd
.long 0x3f5ebe05,0x3f5627fe,0x3f4cae79,0x3f425b89,0x3f584853,0x3f4e1689,0x3f42de29,0x3f36ad7f
.long 0x3f514d3d,0x3f456439,0x3f385216,0x3f2a2a80,0x3f49d112,0x3f3c17d9,0x3f2d1469,0x3f1ce11f
.long 0x3f41d870,0x3f3238aa,0x3f212ff9,0x3f0ee0db,0x3f396842,0x3f27ce61,0x3f14b039,0x3f003a06
.long 0x3f3085bb,0x3f1ce11f,0x3f07a136,0x3ee1fb6a,0x3f273656,0x3f11796b,0x3ef41f07,0x3ec27b55
.long 0x3f1d7fd1,0x3f05a02c,0x3ed8106b,0x3ea21887,0x3f13682a,0x3ef2bd43,0x3ebb31a0,0x3e80f8c0
.long 0x3f08f59b,0x3ed97cb9,0x3e9d9e78,0x3e3e853e,0x3efc5d27,0x3ebf926f,0x3e7ee6e1,0x3df475c0
.long 0x3ee63375,0x3ea5129f,0x3e419b37,0x3d55880e,0x3ecf7bca,0x3e8a11f7,0x3e039502,0xbc7b514b
.long 0x3eb8442a,0x3e5d4b1a,0x3d8a200a,0xbda973ba,0x3ea09ae5,0x3e25c58c,0x3bc90f88,0xbe195be0
.long 0x3e888e93,0x3ddb7d37,0xbd621469,0xbe5d4b1a,0x3e605c13,0x3d55880e,0xbdee3876,0xbe901c2c
.long 0x3e2f10a2,0xbb490fc6,0xbe354098,0xbeb0eacb,0x3dfab273,0xbd6ea038,0xbe72b651,0xbed0eb2a
.long 0x3d96a905,0xbde7fa9a,0xbe97a117,0xbeeff7fb,0x3cc90ab0,0xbe2bf804,0xbeb554ec,0xbf06f686
.long 0x3f7fd397,0x3f7fcbe2,0x3f7fc38f,0x3f7fba9e,0x3f7e70b0,0x3f7e2b72,0x3f7de0b1,0x3f7d906e
.long 0x3f7baccd,0x3f7aed37,0x3f7a1e84,0x3f7940c0,0x3f778bc5,0x3f76167a,0x3f748422,0x3f72d4eb
.long 0x3f721352,0x3f6faf1b,0x3f6d1c1d,0x3f6a5ad9,0x3f6b4b0c,0x3f67c187,0x3f63f473,0x3f5fe4e9
.long 0x3f633c5a,0x3f5e5aa6,0x3f591e6a,0x3f5389c7,0x3f59f26a,0x3f5389c7,0x3f4cae79,0x3f456439
.long 0x3f4f7a1f,0x3f476085,0x3f3ebc1b,0x3f3592e7,0x3f43e200,0x3f39f2ac,0x3f2f61a5,0x3f24381a
.long 0x3f373a23,0x3f2b561b,0x3f1ebc12,0x3f11796b,0x3f299415,0x3f1ba299,0x3f0cead0,0x3efafef7
.long 0x3f1b02c6,0x3f0af1b7,0x3ef41f07,0x3ed0eb2a,0x3f0b9a6b,0x3ef2bd43,0x3ecc9b8b,0x3ea5129f
.long 0x3ef6e0cb,0x3ece0bea,0x3ea395c5,0x3e6fa8b2,0x3ed53641,0x3ea80b1f,0x3e72b651,0x3e1324ca
.long 0x3eb263ef,0x3e80f8c0,0x3e1c76de,0x3d55880e,0x3e8e9a22,0x3e3228d4,0x3d8a200a,0xbd2351cb
.long 0x3e541501,0x3dc27c39,0xbc96c9b6,0xbe06b26e,0x3e09cf86,0x3c7b514b,0xbdd53db9,0xbe636c83
.long 0x3d7b2b74,0xbd83db0a,0xbe419b37,0xbe9f1cdf,0xbc490e90,0xbe1324ca,0xbe8b9507,0xbecb2aae
.long 0xbdafb680,0xbe636c83,0xbeb554ec,0xbef58035,0xbe22abb6,0xbe9920fe,0xbeddbe79,0xbf0ee0db
.long 0xbe6c9a7f,0xbebf926f,0xbf0242b1,0xbf21cbfb,0xbe9aa086,0xbee4cbfe,0xbf14b039,0xbf33587a
.long 0xbebe1d4a,0xbf044889,0xbf26050a,0xbf436051,0xbee0924f,0xbf1553b7,0xbf36206c,0xbf51c0c2
.long 0xbf00e7e4,0xbf256bcb,0xbf44e3f5,0xbf5e5aa6,0xbf10d3cd,0xbf34768f,0xbf5233c6,0xbf6912ae
.long 0xbf1ff6cb,0xbf425b89,0xbf5df6be,0xbf71d19f,0xbf2e3bde,0xbf4f0417,0xbf6816a8,0xbf788486
.long 0x3f7fb10f,0x3f7fa6e3,0x3f7f9c18,0x3f7f90b1,0x3f7d3aac,0x3f7cdf6c,0x3f7c7eb0,0x3f7c187a
.long 0x3f7853f8,0x3f77583a,0x3f764d97,0x3f75341d,0x3f710908,0x3f6f20b0,0x3f6d1c1d,0x3f6afb8c
.long 0x3f676bd8,0x3f644fac,0x3f6106f2,0x3f5d924d,0x3f5b941a,0x3f570348,0x3f5233c6,0x3f4d26fd
.long 0x3f4d9f02,0x3f476085,0x3f40d0da,0x3f39f2ac,0x3f3daef9,0x3f3592e7,0x3f2d1469,0x3f24381a
.long 0x3f2beb4a,0x3f21cbfb,0x3f173c07,0x3f0c42c9,0x3f187fc0,0x3f0c42c9,0x3eff17b2,0x3ee4cbfe
.long 0x3f039c3d,0x3eea6681,0x3ecc9b8b,0x3eadf73c,0x3edae880,0x3eb9bb1e,0x3e97a117,0x3e698bba
.long 0x3eac7cd4,0x3e870ada,0x3e419b37,0x3de7fa9a,0x3e78cfcc,0x3e25c58c,0x3da3308c,0xbb490fc6
.long 0x3e164083,0x3d6ea038,0xbcfb49ba,0xbdf475c0,0x3d48fb30,0xbd3c6dd5,0xbe1008b7,0xbe6fa8b2
.long 0xbd48fb30,0xbe195be0,0xbe7ee6e1,0xbeb0eacb,0xbe164083,0xbe80f8c0,0xbeb554ec,0xbee79a5d
.long 0xbe78cfcc,0xbeb3dca5,0xbee900b7,0xbf0d9281,0xbeac7cd4,0xbee4cbfe,0xbf0cead0,0xbf256bcb
.long 0xbedae880,0xbf099f4e,0xbf239da9,0xbf3b0629,0xbf039c3d,0xbf1f599f,0xbf385216,0xbf4e1689
.long 0xbf187fc0,0xbf33587a,0xbf4ac77f,0xbf5e5aa6,0xbf2beb4a,0xbf456439,0xbf5ac450,0xbf6b99fb
.long 0xbf3daef9,0xbf554aa4,0xbf6816a8,0xbf75a67b,0xbf4d9f02,0xbf62df7b,0xbf7294f8,0xbf7c5d3a
.long 0xbf5b941a,0xbf6dfcf2,0xbf7a1e84,0xbf7fa6e3,0xbf676bd8,0xbf76841b,0xbf7e9bc9,0xbf7f7808
.long 0xbf710908,0xbf7c5d3a,0xbf7ffec4,0xbf7bd14d,0xbf7853f8,0xbf7f7808,0xbf7e4323,0xbf74bf62
.long 0xbf7d3aac,0xbf7fcbe2,0xbf796e4e,0xbf6a5ad9,0xbf7fb10f,0xbf7d57de,0xbf718f57,0xbf5cc7d1
.long 0x3f7f84ab,0x3f7f7808,0x3f7f6ac7,0x3f7f5ce9,0x3f7baccd,0x3f7b3bab,0x3f7ac516,0x3f7a4910
.long 0x3f740bdd,0x3f72d4eb,0x3f718f57,0x3f703b37,0x3f68bf3c,0x3f666771,0x3f63f473,0x3f61668a
.long 0x3f59f26a,0x3f5627fe,0x3f5233c6,0x3f4e1689,0x3f47de65,0x3f425b89,0x3f3ca003,0x3f36ad7f
.long 0x3f32c8c9,0x3f2b561b,0x3f239da9,0x3f1ba299,0x3f1b02c6,0x3f11796b,0x3f07a136,0x3efafef7
.long 0x3f00e7e4,0x3eea6681,0x3ed25a09,0x3eb9bb1e,0x3ec9b953,0x3eadf73c,0x3e919ddd,0x3e698bba
.long 0x3e8e9a22,0x3e5d4b1a,0x3e1c76de,0x3db5f8da,0x3e22abb6,0x3db5f8da,0x3c96c9b6,0xbd55880e
.long 0x3d16c32c,0xbd2351cb,0xbdee3876,0xbe44b0b9,0xbdafb680,0xbe2bf804,0xbe7ee6e1,0xbea80b1f
.long 0xbe541501,0xbe9620d2,0xbec1071e,0xbeea6681,0xbea68f12,0xbed3c867,0xbeff17b2,0xbf140c5f
.long 0xbee0924f,0xbf06f686,0xbf1c420c,0xbf2ff3e6,0xbf0b9a6b,0xbf21cbfb,0xbf36206c,0xbf485bca
.long 0xbf24d225,0xbf39f2ac,0xbf4cae79,0xbf5cc7d1,0xbf3b8f3b,0xbf4f0417,0xbf5f8327,0xbf6cd007
.long 0xbf4f7a1f,0xbf60a6cf,0xbf6e46be,0xbf7822d1,0xbf604621,0xbf6e8ff8,0xbf78b47b,0xbf7e868b
.long 0xbf6db293,0xbf788486,0xbf7e9bc9,0xbf7fdaaf,0xbf778bc5,0xbf7e5a38,0xbf7fe129,0xbf7c187a
.long 0xbf7dabcc,0xbf7ff84a,0xbf7c7eb0,0xbf73530e,0xbf7ffb11,0xbf7d57de,0xbf748422,0xbf65b710
.long 0xbf7e70b0,0xbf76841b,0xbf6816a8,0xbf5389c7,0xbf791298,0xbf6b99fb,0xbf577026,0xbf3d27b8
.long 0xbf6ff573,0xbf5cc7d1,0xbf42de29,0xbf2302d3,0xbf633c5a,0xbf4a4c87,0xbf2ac082,0xbf05a02c
.long 0xbf531849,0xbf34768f,0xbf0f8784,0xbecb2aae,0xbf3fc767,0xbf1ba299,0xbee363fa,0xbe870ada
.long 0x3f7f4e6d,0x3f7f3f54,0x3f7f2f9d,0x3f7f1f49,0x3f79c79d,0x3f7940c0,0x3f78b47b,0x3f7822d1
.long 0x3f6ed89e,0x3f6d67a1,0x3f6be858,0x3f6a5ad9,0x3f5ebe05,0x3f5bfb34,0x3f591e6a,0x3f5627fe
.long 0x3f49d112,0x3f456439,0x3f40d0da,0x3f3c17d9,0x3f3085bb,0x3f2a2a80,0x3f239da9,0x3f1ce11f
.long 0x3f13682a,0x3f0af1b7,0x3f0242b1,0x3ef2bd43,0x3ee63375,0x3ed0eb2a,0x3ebb31a0,0x3ea5129f
.long 0x3ea09ae5,0x3e870ada,0x3e5a3997,0x3e25c58c,0x3e2f10a2,0x3de7fa9a,0x3d621469,0xbb490fc6
.long 0x3cc90ab0,0xbd2351cb,0xbdd53db9,0xbe2bf804,0xbdfab273,0xbe44b0b9,0xbe8586ce,0xbea80b1f
.long 0xbe888e93,0xbeadf73c,0xbed25a09,0xbef58035,0xbecf7bca,0xbef58035,0xbf0cead0,0xbf1e1e22
.long 0xbf08f59b,0xbf1ba299,0xbf2d1469,0xbf3d27b8,0xbf273656,0xbf38dd65,0xbf48d8b3,0xbf570348
.long 0xbf41d870,0xbf51c0c2,0xbf5f8327,0xbf6afb8c,0xbf584853,0xbf65b710,0xbf708066,0xbf788486
.long 0xbf6a09a7,0xbf74484b,0xbf7b61fc,0xbf7f3f54,0xbf76ba07,0xbf7d1cdd,0xbf7fe129,0xbf7efcc9
.long 0xbf7e1324,0xbf7fffb1,0xbf7de0b1,0xbf77beb7,0xbf7fec43,0xbf7cdf6c,0xbf756d97,0xbf69b7e4
.long 0xbf7c3b28,0xbf73ced9,0xbf66becc,0xbf554aa4,0xbf731447,0xbf650479,0xbf5233c6,0xbf3b0629
.long 0xbf64aa59,0xbf50d937,0xbf385216,0xbf1ba299,0xbf514d3d,0xbf37c655,0xbf19c200,0xbeeff7fb
.long 0xbf396842,0xbf1a6293,0xbeee9479,0xbea21887,0xbf1d7fd1,0xbef2bd43,0xbea395c5,0xbe1f917b
.long 0xbefc5d27,0xbeab0201,0xbe28defc,0x3c16cb58,0xbeb8442a,0xbe3e853e,0xbbc90f88,0x3e3228d4
.long 0xbe605c13,0xbd0a342f,0x3e1c76de,0x3eab0201,0xbd96a905,0x3df475c0,0x3e9d9e78,0x3ef840c8
.long 0x3f7f0e58,0x3f7efcc9,0x3f7eea9d,0x3f7ed7d4,0x3f778bc5,0x3f76ef5b,0x3f764d97,0x3f75a67b
.long 0x3f68bf3c,0x3f671599,0x3f655e0b,0x3f6398ac,0x3f531849,0x3f4fefa8,0x3f4cae79,0x3f495521
.long 0x3f373a23,0x3f3238aa,0x3f2d1469,0x3f27ce61,0x3f15f6d9,0x3f0ee0db,0x3f07a136,0x3f003a06
.long 0x3ee0924f,0x3ece0bea,0x3ebb31a0,0x3ea80b1f,0x3e8e9a22,0x3e6fa8b2,0x3e419b37,0x3e1324ca
.long 0x3de1bc2e,0x3d6ea038,0x3bc90f88,0xbd3c6dd5,0xbd7b2b74,0xbdf475c0,0xbe354098,0xbe6fa8b2
.long 0xbe6c9a7f,0xbe9620d2,0xbeb554ec,0xbed3c867,0xbec9b953,0xbeea6681,0xbf04f484,0xbf140c5f
.long 0xbf0b9a6b,0xbf1ba299,0xbf2ac082,0xbf38dd65,0xbf2e3bde,0xbf3d27b8,0xbf4ac77f,0xbf570348
.long 0xbf4bbbf8,0xbf58b3a1,0xbf63f473,0xbf6d67a1,0xbf633c5a,0xbf6d67a1,0xbf756d97,0xbf7b3bab
.long 0xbf740bdd,0xbf7a9c59,0xbf7e9bc9,0xbf7fffb1,0xbf7dabcc,0xbf7fe705,0xbf7f2f9d,0xbf7b87b2
.long 0xbf7fd397,0xbf7d1cdd,0xbf772417,0xbf6dfcf2,0xbf7a7302,0xbf725470,0xbf66becc,0xbf57dc7f
.long 0xbf6db293,0xbf5fe4e9,0xbf4e8d90,0xbf39f2ac,0xbf59f26a,0xbf466354,0xbf2f61a5,0xbf1553b7
.long 0xbf3fc767,0xbf269de3,0xbf0a48ad,0xbed6a399,0xbf1ff6cb,0xbf019573,0xbec1071e,0xbe75c35a
.long 0xbef6e0cb,0xbeb0eacb,0xbe4dee60,0xbd55880e,0xbea68f12,0xbe3228d4,0xbc96c9b6,0x3e0cec4a
.long 0xbe22abb6,0x3b490fc6,0x3e28defc,0x3ea5129f,0x3c490e90,0x3e3857ec,0x3eaf713a,0x3efdbabb
.long 0x3e3b6ecf,0x3eb3dca5,0x3f0242b1,0x3f269de3,0x3eb263ef,0x3f02ef9f,0x3f286605,0x3f485bca
.long 0x3f00e7e4,0x3f27ce61,0x3f48d8b3,0x3f62df7b,0x3f24d225,0x3f476085,0x3f628210,0x3f75341d
.long 0x0,0x3b490fc6,0x3bc90f88,0x3c16cb58,0x0,0x3c16cb58,0x3c96c9b6,0x3ce22a7a
.long 0x0,0x3c7b514b,0x3cfb49ba,0x3d3c6dd5,0x0,0x3cafea69,0x3d2fe007,0x3d83db0a
.long 0x0,0x3ce22a7a,0x3d621469,0x3da973ba,0x0,0x3d0a342f,0x3d8a200a,0x3dcefdb7
.long 0x0,0x3d2351cb,0x3da3308c,0x3df475c0,0x0,0x3d3c6dd5,0x3dbc3ac3,0x3e0cec4a
.long 0x0,0x3d55880e,0x3dd53db9,0x3e1f917b,0x0,0x3d6ea038,0x3dee3876,0x3e3228d4
.long 0x0,0x3d83db0a,0x3e039502,0x3e44b0b9,0x0,0x3d9064b4,0x3e1008b7,0x3e57278f
.long 0x0,0x3d9cecf9,0x3e1c76de,0x3e698bba,0x0,0x3da973ba,0x3e28defc,0x3e7bdba4
.long 0x0,0x3db5f8da,0x3e354098,0x3e870ada,0x0,0x3dc27c39,0x3e419b37,0x3e901c2c
.long 0x0,0x3dcefdb7,0x3e4dee60,0x3e9920fe,0x0,0x3ddb7d37,0x3e5a3997,0x3ea21887
.long 0x0,0x3de7fa9a,0x3e667c66,0x3eab0201,0x0,0x3df475c0,0x3e72b651,0x3eb3dca5
.long 0x0,0x3e007745,0x3e7ee6e1,0x3ebca7af,0x0,0x3e06b26e,0x3e8586ce,0x3ec5625c
.long 0x0,0x3e0cec4a,0x3e8b9507,0x3ece0bea,0x0,0x3e1324ca,0x3e919ddd,0x3ed6a399
.long 0x0,0x3e195be0,0x3e97a117,0x3edf28a9,0x0,0x3e1f917b,0x3e9d9e78,0x3ee79a5d
.long 0x0,0x3e25c58c,0x3ea395c5,0x3eeff7fb,0x0,0x3e2bf804,0x3ea986c4,0x3ef840c8
.long 0x0,0x3e3228d4,0x3eaf713a,0x3f003a06,0x0,0x3e3857ec,0x3eb554ec,0x3f044889
.long 0x0,0x3e3e853e,0x3ebb31a0,0x3f084b92,0x0,0x3e44b0b9,0x3ec1071e,0x3f0c42c9
.long 0x3c490e90,0x3c7b514b,0x3c96c9b6,0x3cafea69,0x3d16c32c,0x3d3c6dd5,0x3d621469,0x3d83db0a
.long 0x3d7b2b74,0x3d9cecf9,0x3dbc3ac3,0x3ddb7d37,0x3dafb680,0x3ddb7d37,0x3e039502,0x3e195be0
.long 0x3de1bc2e,0x3e0cec4a,0x3e28defc,0x3e44b0b9,0x3e09cf86,0x3e2bf804,0x3e4dee60,0x3e6fa8b2
.long 0x3e22abb6,0x3e4ada4f,0x3e72b651,0x3e8d17c0,0x3e3b6ecf,0x3e698bba,0x3e8b9507,0x3ea21887
.long 0x3e541501,0x3e840270,0x3e9d9e78,0x3eb6ccc3,0x3e6c9a7f,0x3e931f35,0x3eaf713a,0x3ecb2aae
.long 0x3e827dc0,0x3ea21887,0x3ec1071e,0x3edf28a9,0x3e8e9a22,0x3eb0eacb,0x3ed25a09,0x3ef2bd43
.long 0x3e9aa086,0x3ebf926f,0x3ee363fa,0x3f02ef9f,0x3ea68f12,0x3ece0bea,0x3ef41f07,0x3f0c42c9
.long 0x3eb263ef,0x3edc53c1,0x3f0242b1,0x3f1553b7,0x3ebe1d4a,0x3eea6681,0x3f0a48ad,0x3f1e1e22
.long 0x3ec9b953,0x3ef840c8,0x3f121eb0,0x3f269de3,0x3ed53641,0x3f02ef9f,0x3f19c200,0x3f2ecef7
.long 0x3ee0924f,0x3f099f4e,0x3f212ff9,0x3f36ad7f,0x3eebcbbb,0x3f102dd5,0x3f286605,0x3f3e35c5
.long 0x3ef6e0cb,0x3f16999f,0x3f2f61a5,0x3f456439,0x3f00e7e4,0x3f1ce11f,0x3f36206c,0x3f4c3578
.long 0x3f064b82,0x3f2302d3,0x3f3ca003,0x3f52a649,0x3f0b9a6b,0x3f28fd41,0x3f42de29,0x3f58b3a1
.long 0x3f10d3cd,0x3f2ecef7,0x3f48d8b3,0x3f5e5aa6,0x3f15f6d9,0x3f34768f,0x3f4e8d90,0x3f6398ac
.long 0x3f1b02c6,0x3f39f2ac,0x3f53fac3,0x3f686b39,0x3f1ff6cb,0x3f3f41fc,0x3f591e6a,0x3f6cd007
.long 0x3f24d225,0x3f446337,0x3f5df6be,0x3f70c501,0x3f299415,0x3f495521,0x3f628210,0x3f74484b
.long 0x3f2e3bde,0x3f4e1689,0x3f66becc,0x3f77583a,0x3f32c8c9,0x3f52a649,0x3f6aab7b,0x3f79f35e
.long 0x3cc90ab0,0x3ce22a7a,0x3cfb49ba,0x3d0a342f,0x3d96a905,0x3da973ba,0x3dbc3ac3,0x3dcefdb7
.long 0x3dfab273,0x3e0cec4a,0x3e1c76de,0x3e2bf804,0x3e2f10a2,0x3e44b0b9,0x3e5a3997,0x3e6fa8b2
.long 0x3e605c13,0x3e7bdba4,0x3e8b9507,0x3e9920fe,0x3e888e93,0x3e9920fe,0x3ea986c4,0x3eb9bb1e
.long 0x3ea09ae5,0x3eb3dca5,0x3ec6d529,0x3ed97cb9,0x3eb8442a,0x3ece0bea,0x3ee363fa,0x3ef840c8
.long 0x3ecf7bca,0x3ee79a5d,0x3eff17b2,0x3f0af1b7,0x3ee63375,0x3f003a06,0x3f0cead0,0x3f19210f
.long 0x3efc5d27,0x3f0c42c9,0x3f19c200,0x3f269de3,0x3f08f59b,0x3f17de12,0x3f26050a,0x3f33587a
.long 0x3f13682a,0x3f2302d3,0x3f31a81d,0x3f3f41fc,0x3f1d7fd1,0x3f2da859,0x3f3ca003,0x3f4a4c87
.long 0x3f273656,0x3f37c655,0x3f46e22a,0x3f546b3b,0x3f3085bb,0x3f4154e1,0x3f5064af,0x3f5d924d
.long 0x3f396842,0x3f4a4c87,0x3f591e6a,0x3f65b710,0x3f41d870,0x3f52a649,0x3f6106f2,0x3f6cd007
.long 0x3f49d112,0x3f5a5ba0,0x3f6816a8,0x3f72d4eb,0x3f514d3d,0x3f61668a,0x3f6e46be,0x3f77beb7
.long 0x3f584853,0x3f67c187,0x3f73913f,0x3f7b87b2,0x3f5ebe05,0x3f6d67a1,0x3f77f110,0x3f7e2b72
.long 0x3f64aa59,0x3f725470,0x3f7b61fc,0x3f7fa6e3,0x3f6a09a7,0x3f76841b,0x3f7de0b1,0x3f7ff84a
.long 0x3f6ed89e,0x3f79f35e,0x3f7f6ac7,0x3f7f1f49,0x3f731447,0x3f7c9f8a,0x3f7ffec4,0x3f7d1cdd
.long 0x3f76ba07,0x3f7e868b,0x3f7f9c18,0x3f79f35e,0x3f79c79d,0x3f7fa6e3,0x3f7e4323,0x3f75a67b
.long 0x3f7c3b28,0x3f7fffb1,0x3f7bf531,0x3f703b37,0x3f7e1324,0x3f7f90b1,0x3f78b47b,0x3f69b7e4
.long 0x3f7f4e6d,0x3f7e5a38,0x3f748422,0x3f62241a,0x3f7fec43,0x3f7c5d3a,0x3f6f6830,0x3f5988ad
.long 0x3d16c32c,0x3d2351cb,0x3d2fe007,0x3d3c6dd5,0x3de1bc2e,0x3df475c0,0x3e039502,0x3e0cec4a
.long 0x3e3b6ecf,0x3e4ada4f,0x3e5a3997,0x3e698bba,0x3e827dc0,0x3e8d17c0,0x3e97a117,0x3ea21887
.long 0x3ea68f12,0x3eb3dca5,0x3ec1071e,0x3ece0bea,0x3ec9b953,0x3ed97cb9,0x3ee900b7,0x3ef840c8
.long 0x3eebcbbb,0x3efdbabb,0x3f07a136,0x3f102dd5,0x3f064b82,0x3f102dd5,0x3f19c200,0x3f2302d3
.long 0x3f15f6d9,0x3f209393,0x3f2ac082,0x3f34768f,0x3f24d225,0x3f2ff3e6,0x3f3a7ca4,0x3f446337
.long 0x3f32c8c9,0x3f3e35c5,0x3f48d8b3,0x3f52a649,0x3f3fc767,0x3f4b41fa,0x3f55b993,0x3f5f20db
.long 0x3f4bbbf8,0x3f570348,0x3f6106f2,0x3f69b7e4,0x3f5695e5,0x3f61668a,0x3f6aab7b,0x3f725470
.long 0x3f604621,0x3f6a5ad9,0x3f7294f8,0x3f78e3d6,0x3f68bf3c,0x3f71d19f,0x3f78b47b,0x3f7d57de
.long 0x3f6ff573,0x3f77beb7,0x3f7cfe73,0x3f7fa6e3,0x3f75dec6,0x3f7c187a,0x3f7f6ac7,0x3f7fcbe2
.long 0x3f7a7302,0x3f7ed7d4,0x3f7ff4e6,0x3f7dc68c,0x3f7dabcc,0x3f7ff84a,0x3f7e9bc9,0x3f799b43
.long 0x3f7f84ab,0x3f7f7808,0x3f7b61fc,0x3f73530e,0x3f7ffb11,0x3f7d57de,0x3f764d97,0x3f6afb8c
.long 0x3f7f0e58,0x3f799b43,0x3f6f6830,0x3f60a6cf,0x3f7cbfc9,0x3f74484b,0x3f66becc,0x3f546b3b
.long 0x3f791298,0x3f6d67a1,0x3f5c61c7,0x3f466354,0x3f740bdd,0x3f650479,0x3f5064af,0x3f36ad7f
.long 0x3f6db293,0x3f5b2c79,0x3f42de29,0x3f256bcb,0x3f660f88,0x3f4fefa8,0x3f33e7bc,0x3f12c39a
.long 0x3f5d2d53,0x3f436051,0x3f239da9,0x3efdbabb,0x3f531849,0x3f3592e7,0x3f121eb0,0x3ed3c867
.long 0x3f47de65,0x3f269de3,0x3eff17b2,0x3ea80b1f,0x3f3b8f3b,0x3f16999f,0x3ed8106b,0x3e75c35a
.long 0x3d48fb30,0x3d55880e,0x3d621469,0x3d6ea038,0x3e164083,0x3e1f917b,0x3e28defc,0x3e3228d4
.long 0x3e78cfcc,0x3e840270,0x3e8b9507,0x3e931f35,0x3eac7cd4,0x3eb6ccc3,0x3ec1071e,0x3ecb2aae
.long 0x3edae880,0x3ee79a5d,0x3ef41f07,0x3f003a06,0x3f039c3d,0x3f0af1b7,0x3f121eb0,0x3f19210f
.long 0x3f187fc0,0x3f209393,0x3f286605,0x3f2ff3e6,0x3f2beb4a,0x3f34768f,0x3f3ca003,0x3f446337
.long 0x3f3daef9,0x3f466354,0x3f4e8d90,0x3f5627fe,0x3f4d9f02,0x3f5627fe,0x3f5df6be,0x3f650479
.long 0x3f5b941a,0x3f6398ac,0x3f6aab7b,0x3f70c501,0x3f676bd8,0x3f6e8ff8,0x3f748422,0x3f7940c0
.long 0x3f710908,0x3f76ef5b,0x3f7b61fc,0x3f7e5a38,0x3f7853f8,0x3f7c9f8a,0x3f7f2f9d,0x3f7fffb1
.long 0x3f7d3aac,0x3f7f90b1,0x3f7fe129,0x3f7e2b72,0x3f7fb10f,0x3f7fba9e,0x3f7d7474,0x3f78e3d6
.long 0x3f7fb10f,0x3f7d1cdd,0x3f77f110,0x3f703b37,0x3f7d3aac,0x3f77beb7,0x3f6f6830,0x3f644fac
.long 0x3f7853f8,0x3f6faf1b,0x3f63f473,0x3f554aa4,0x3f710908,0x3f650479,0x3f55b993,0x3f436051
.long 0x3f676bd8,0x3f57dc7f,0x3f44e3f5,0x3f2ecef7,0x3f5b941a,0x3f485bca,0x3f31a81d,0x3f17de12
.long 0x3f4d9f02,0x3f36ad7f,0x3f1c420c,0x3efdbabb,0x3f3daef9,0x3f2302d3,0x3f04f484,0x3ec8477c
.long 0x3f2beb4a,0x3f0d9281,0x3ed8106b,0x3e901c2c,0x3f187fc0,0x3eed3063,0x3ea395c5,0x3e2bf804
.long 0x3f039c3d,0x3ebca7af,0x3e5a3997,0x3d55880e,0x3edae880,0x3e8a11f7,0x3dd53db9,0xbd83db0a
.long 0x3eac7cd4,0x3e2bf804,0xbbc90f88,0xbe3857ec,0x3e78cfcc,0x3d83db0a,0xbdee3876,0xbe9620d2
.long 0x3e164083,0xbd2351cb,0xbe667c66,0xbece0bea,0x3d48fb30,0xbe1324ca,0xbea986c4,0xbf019573
.long 0x3d7b2b74,0x3d83db0a,0x3d8a200a,0x3d9064b4,0x3e3b6ecf,0x3e44b0b9,0x3e4dee60,0x3e57278f
.long 0x3e9aa086,0x3ea21887,0x3ea986c4,0x3eb0eacb,0x3ed53641,0x3edf28a9,0x3ee900b7,0x3ef2bd43
.long 0x3f064b82,0x3f0c42c9,0x3f121eb0,0x3f17de12,0x3f1ff6cb,0x3f269de3,0x3f2d1469,0x3f33587a
.long 0x3f373a23,0x3f3e35c5,0x3f44e3f5,0x3f4b41fa,0x3f4bbbf8,0x3f52a649,0x3f591e6a,0x3f5f20db
.long 0x3f5d2d53,0x3f6398ac,0x3f696591,0x3f6e8ff8,0x3f6b4b0c,0x3f70c501,0x3f756d97,0x3f7940c0
.long 0x3f75dec6,0x3f79f35e,0x3f7cfe73,0x3f7efcc9,0x3f7cbfc9,0x3f7efcc9,0x3f7ff4e6,0x3f7fa6e3
.long 0x3f7fd397,0x3f7fcbe2,0x3f7e4323,0x3f7b3bab,0x3f7f0e58,0x3f7c5d3a,0x3f77f110,0x3f71d19f
.long 0x3f7a7302,0x3f74bf62,0x3f6d1c1d,0x3f6398ac,0x3f721352,0x3f6912ae,0x3f5df6be,0x3f50d937
.long 0x3f660f88,0x3f5988ad,0x3f4ac77f,0x3f39f2ac,0x3f5695e5,0x3f466354,0x3f33e7bc,0x3f1f599f
.long 0x3f43e200,0x3f2ff3e6,0x3f19c200,0x3f019573,0x3f2e3bde,0x3f16999f,0x3ef9a02d,0x3ec27b55
.long 0x3f15f6d9,0x3ef58035,0x3ebb31a0,0x3e7bdba4,0x3ef6e0cb,0x3eb9bb1e,0x3e72b651,0x3ddb7d37
.long 0x3ebe1d4a,0x3e75c35a,0x3dd53db9,0xbd0a342f,0x3e827dc0,0x3de7fa9a,0xbcfb49ba,0xbe3228d4
.long 0x3e09cf86,0xbc7b514b,0xbe28defc,0xbe9f1cdf,0x3c490e90,0xbe1324ca,0xbe97a117,0xbee1fb6a
.long 0xbde1bc2e,0xbe8a11f7,0xbed8106b,0xbf102dd5,0xbe6c9a7f,0xbec8477c,0xbf0a48ad,0xbf2c800f
.long 0xbeb263ef,0xbf019573,0xbf26050a,0xbf456439,0xbeebcbbb,0xbf1ce11f,0xbf3ebc1b,0xbf5a5ba0
.long 0xbf10d3cd,0xbf3592e7,0xbf53fac3,0xbf6afb8c,0xbf299415,0xbf4b41fa,0xbf655e0b,0xbf76ef5b
.long 0x3d96a905,0x3d9cecf9,0x3da3308c,0x3da973ba,0x3e605c13,0x3e698bba,0x3e72b651,0x3e7bdba4
.long 0x3eb8442a,0x3ebf926f,0x3ec6d529,0x3ece0bea,0x3efc5d27,0x3f02ef9f,0x3f07a136,0x3f0c42c9
.long 0x3f1d7fd1,0x3f2302d3,0x3f286605,0x3f2da859,0x3f396842,0x3f3f41fc,0x3f44e3f5,0x3f4a4c87
.long 0x3f514d3d,0x3f570348,0x3f5c61c7,0x3f61668a,0x3f64aa59,0x3f69b7e4,0x3f6e46be,0x3f725470
.long 0x3f731447,0x3f76ef5b,0x3f7a1e84,0x3f7c9f8a,0x3f7c3b28,0x3f7e5a38,0x3f7f9c18,0x3f7fffb1
.long 0x3f7fec43,0x3f7fcbe2,0x3f7e9bc9,0x3f7c5d3a,0x3f7e1324,0x3f7b3bab,0x3f772417,0x3f71d19f
.long 0x3f76ba07,0x3f70c501,0x3f696591,0x3f60a6cf,0x3f6a09a7,0x3f60a6cf,0x3f55b993,0x3f495521
.long 0x3f584853,0x3f4b41fa,0x3f3ca003,0x3f2c800f,0x3f41d870,0x3f311722,0x3f1ebc12,0x3f0af1b7
.long 0x3f273656,0x3f12c39a,0x3ef9a02d,0x3ecb2aae,0x3f08f59b,0x3ee1fb6a,0x3eaf713a,0x3e75c35a
.long 0x3ecf7bca,0x3e9920fe,0x3e419b37,0x3d9cecf9,0x3e888e93,0x3e195be0,0x3cfb49ba,0xbdb5f8da
.long 0x3dfab273,0xbb490fc6,0xbe039502,0xbe80f8c0,0xbcc90ab0,0xbe1f917b,0xbe919ddd,0xbed0eb2a
.long 0xbe2f10a2,0xbe9c1faf,0xbeddbe79,0xbf0d9281,0xbea09ae5,0xbee4cbfe,0xbf121eb0,0xbf2ecef7
.long 0xbee63375,0xbf140c5f,0xbf31a81d,0xbf4b41fa,0xbf13682a,0xbf3238aa,0xbf4cae79,0xbf62241a
.long 0xbf3085bb,0xbf4c3578,0xbf628210,0xbf72d4eb,0xbf49d112,0xbf61668a,0xbf7294f8,0xbf7cdf6c
.long 0xbf5ebe05,0xbf714c7a,0xbf7c7eb0,0xbf7ffd39,0xbf6ed89e,0xbf7b87b2,0xbf7ffec4,0xbf7c187a
.long 0xbf79c79d,0xbf7fdaaf,0xbf7cfe73,0xbf714c7a,0xbf7f4e6d,0xbf7e2b72,0xbf73913f,0xbf5fe4e9
.long 0x3dafb680,0x3db5f8da,0x3dbc3ac3,0x3dc27c39,0x3e827dc0,0x3e870ada,0x3e8b9507,0x3e901c2c
.long 0x3ed53641,0x3edc53c1,0x3ee363fa,0x3eea6681,0x3f10d3cd,0x3f1553b7,0x3f19c200,0x3f1e1e22
.long 0x3f32c8c9,0x3f37c655,0x3f3ca003,0x3f4154e1,0x3f4f7a1f,0x3f546b3b,0x3f591e6a,0x3f5d924d
.long 0x3f660f88,0x3f6a5ad9,0x3f6e46be,0x3f71d19f,0x3f75dec6,0x3f78e3d6,0x3f7b61fc,0x3f7d57de
.long 0x3f7e70b0,0x3f7f90b1,0x3f7ffec4,0x3f7fba9e,0x3f7f84ab,0x3f7e2b72,0x3f7bf531,0x3f78e3d6
.long 0x3f791298,0x3f74bf62,0x3f6f6830,0x3f6912ae,0x3f6b4b0c,0x3f6398ac,0x3f5ac450,0x3f50d937
.long 0x3f5695e5,0x3f4b41fa,0x3f3ebc1b,0x3f311722,0x3f3b8f3b,0x3f2c800f,0x3f1c420c,0x3f0af1b7
.long 0x3f1b02c6,0x3f084b92,0x3ee900b7,0x3ebf926f,0x3eebcbbb,0x3ebf926f,0x3e919ddd,0x3e44b0b9
.long 0x3e9aa086,0x3e5101f1,0x3dd53db9,0x3b490fc6,0x3e09cf86,0x3ce22a7a,0xbda3308c,0xbe3e853e
.long 0xbd16c32c,0xbe195be0,0xbe8586ce,0xbebca7af,0xbe541501,0xbea5129f,0xbeddbe79,0xbf099f4e
.long 0xbebe1d4a,0xbef840c8,0xbf173c07,0xbf2ff3e6,0xbf064b82,0xbf21cbfb,0xbf3a7ca4,0xbf4fefa8
.long 0xbf299415,0xbf425b89,0xbf577026,0xbf686b39,0xbf47de65,0xbf5cc7d1,0xbf6d1c1d,0xbf788486
.long 0xbf604621,0xbf703b37,0xbf7ac516,0xbf7fa6e3,0xbf721352,0xbf7c187a,0xbf7ff4e6,0xbf7d906e
.long 0xbf7cbfc9,0xbf7fffb1,0xbf7c7eb0,0xbf725470,0xbf7ffb11,0xbf7bd14d,0xbf708066,0xbf5e5aa6
.long 0xbf7baccd,0xbf6faf1b,0xbf5c61c7,0xbf425b89,0xbf6ff573,0xbf5bfb34,0xbf40d0da,0xbf1f599f
.long 0xbf5d2d53,0xbf4154e1,0xbf1ebc12,0xbeed3063,0xbf43e200,0xbf209393,0xbeee9479,0xbe931f35
.long 0x3e000000,0x3e000000,0x3e000000,0x3e000000,0x3dffffb1,0x3dfffd39,0x3dfff84a,0x3dfff0e3
.long 0x3dfffec4,0x3dfff4e6,0x3dffe129,0x3dffc38f,0x3dfffd39,0x3dffe705,0x3dffba9e,0x3dff7808
.long 0x3dfffb11,0x3dffd397,0x3dff84ab,0x3dff0e58,0x3dfff84a,0x3dffba9e,0x3dff3f54,0x3dfe868b
.long 0x3dfff4e6,0x3dff9c18,0x3dfeea9d,0x3dfde0b1,0x3dfff0e3,0x3dff7808,0x3dfe868b,0x3dfd1cdd
.long 0x3dffec43,0x3dff4e6d,0x3dfe1324,0x3dfc3b28,0x3dffe705,0x3dff1f49,0x3dfd906e,0x3dfb3bab
.long 0x3dffe129,0x3dfeea9d,0x3dfcfe73,0x3dfa1e84,0x3dffdaaf,0x3dfeb069,0x3dfc5d3a,0x3df8e3d6
.long 0x3dffd397,0x3dfe70b0,0x3dfbaccd,0x3df78bc5,0x3dffcbe2,0x3dfe2b72,0x3dfaed37,0x3df6167a
.long 0x3dffc38f,0x3dfde0b1,0x3dfa1e84,0x3df48422,0x3dffba9e,0x3dfd906e,0x3df940c0,0x3df2d4eb
.long 0x3dffb10f,0x3dfd3aac,0x3df853f8,0x3df10908,0x3dffa6e3,0x3dfcdf6c,0x3df7583a,0x3def20b0
.long 0x3dff9c18,0x3dfc7eb0,0x3df64d97,0x3ded1c1d,0x3dff90b1,0x3dfc187a,0x3df5341d,0x3deafb8c
.long 0x3dff84ab,0x3dfbaccd,0x3df40bdd,0x3de8bf3c,0x3dff7808,0x3dfb3bab,0x3df2d4eb,0x3de66771
.long 0x3dff6ac7,0x3dfac516,0x3df18f57,0x3de3f473,0x3dff5ce9,0x3dfa4910,0x3df03b37,0x3de1668a
.long 0x3dff4e6d,0x3df9c79d,0x3deed89e,0x3ddebe05,0x3dff3f54,0x3df940c0,0x3ded67a1,0x3ddbfb34
.long 0x3dff2f9d,0x3df8b47b,0x3debe858,0x3dd91e6a,0x3dff1f49,0x3df822d1,0x3dea5ad9,0x3dd627fe
.long 0x3dff0e58,0x3df78bc5,0x3de8bf3c,0x3dd31849,0x3dfefcc9,0x3df6ef5b,0x3de71599,0x3dcfefa8
.long 0x3dfeea9d,0x3df64d97,0x3de55e0b,0x3dccae79,0x3dfed7d4,0x3df5a67b,0x3de398ac,0x3dc95521
.long 0x3e000000,0x3e000000,0x3e000000,0x3e000000,0x3dffe705,0x3dffdaaf,0x3dffcbe2,0x3dffba9e
.long 0x3dff9c18,0x3dff6ac7,0x3dff2f9d,0x3dfeea9d,0x3dff1f49,0x3dfeb069,0x3dfe2b72,0x3dfd906e
.long 0x3dfe70b0,0x3dfdabcc,0x3dfcbfc9,0x3dfbaccd,0x3dfd906e,0x3dfc5d3a,0x3dfaed37,0x3df940c0
.long 0x3dfc7eb0,0x3dfac516,0x3df8b47b,0x3df64d97,0x3dfb3bab,0x3df8e3d6,0x3df6167a,0x3df2d4eb
.long 0x3df9c79d,0x3df6ba07,0x3df31447,0x3deed89e,0x3df822d1,0x3df4484b,0x3defaf1b,0x3dea5ad9
.long 0x3df64d97,0x3df18f57,0x3debe858,0x3de55e0b,0x3df4484b,0x3dee8ff8,0x3de7c187,0x3ddfe4e9
.long 0x3df21352,0x3deb4b0c,0x3de33c5a,0x3dd9f26a,0x3defaf1b,0x3de7c187,0x3dde5aa6,0x3dd389c7
.long 0x3ded1c1d,0x3de3f473,0x3dd91e6a,0x3dccae79,0x3dea5ad9,0x3ddfe4e9,0x3dd389c7,0x3dc56439
.long 0x3de76bd8,0x3ddb941a,0x3dcd9f02,0x3dbdaef9,0x3de44fac,0x3dd70348,0x3dc76085,0x3db592e7
.long 0x3de106f2,0x3dd233c6,0x3dc0d0da,0x3dad1469,0x3ddd924d,0x3dcd26fd,0x3db9f2ac,0x3da4381a
.long 0x3dd9f26a,0x3dc7de65,0x3db2c8c9,0x3d9b02c6,0x3dd627fe,0x3dc25b89,0x3dab561b,0x3d91796b
.long 0x3dd233c6,0x3dbca003,0x3da39da9,0x3d87a136,0x3dce1689,0x3db6ad7f,0x3d9ba299,0x3d7afef7
.long 0x3dc9d112,0x3db085bb,0x3d93682a,0x3d663375,0x3dc56439,0x3daa2a80,0x3d8af1b7,0x3d50eb2a
.long 0x3dc0d0da,0x3da39da9,0x3d8242b1,0x3d3b31a0,0x3dbc17d9,0x3d9ce11f,0x3d72bd43,0x3d25129f
.long 0x3db73a23,0x3d95f6d9,0x3d60924f,0x3d0e9a22,0x3db238aa,0x3d8ee0db,0x3d4e0bea,0x3cefa8b2
.long 0x3dad1469,0x3d87a136,0x3d3b31a0,0x3cc19b37,0x3da7ce61,0x3d803a06,0x3d280b1f,0x3c9324ca
.long 0x3e000000,0x3e000000,0x3e000000,0x3e000000,0x3dffa6e3,0x3dff90b1,0x3dff7808,0x3dff5ce9
.long 0x3dfe9bc9,0x3dfe4323,0x3dfde0b1,0x3dfd7474,0x3dfcdf6c,0x3dfc187a,0x3dfb3bab,0x3dfa4910
.long 0x3dfa7302,0x3df91298,0x3df78bc5,0x3df5dec6,0x3df7583a,0x3df5341d,0x3df2d4eb,0x3df03b37
.long 0x3df3913f,0x3df08066,0x3ded1c1d,0x3de96591,0x3def20b0,0x3deafb8c,0x3de66771,0x3de1668a
.long 0x3dea09a7,0x3de4aa59,0x3ddebe05,0x3dd84853,0x3de44fac,0x3ddd924d,0x3dd627fe,0x3dce1689
.long 0x3dddf6be,0x3dd5b993,0x3dccae79,0x3dc2de29,0x3dd70348,0x3dcd26fd,0x3dc25b89,0x3db6ad7f
.long 0x3dcf7a1f,0x3dc3e200,0x3db73a23,0x3da99415,0x3dc76085,0x3db9f2ac,0x3dab561b,0x3d9ba299
.long 0x3dbebc1b,0x3daf61a5,0x3d9ebc12,0x3d8cead0,0x3db592e7,0x3da4381a,0x3d91796b,0x3d7afef7
.long 0x3dabeb4a,0x3d987fc0,0x3d839c3d,0x3d5ae880,0x3da1cbfb,0x3d8c42c9,0x3d6a6681,0x3d39bb1e
.long 0x3d973c07,0x3d7f17b2,0x3d4c9b8b,0x3d17a117,0x3d8c42c9,0x3d64cbfe,0x3d2df73c,0x3ce98bba
.long 0x3d80e7e4,0x3d49b953,0x3d0e9a22,0x3ca2abb6,0x3d6a6681,0x3d2df73c,0x3cdd4b1a,0x3c35f8da
.long 0x3d525a09,0x3d119ddd,0x3c9c76de,0x3b16c9b6,0x3d39bb1e,0x3ce98bba,0x3c35f8da,0xbbd5880e
.long 0x3d209ae5,0x3caf10a2,0x3b490ab0,0xbc7ab273,0x3d070ada,0x3c67fa9a,0xbba351cb,0xbcc4b0b9
.long 0x3cda3997,0x3be21469,0xbc553db9,0xbd0586ce,0x3ca5c58c,0xb9c90fc6,0xbcabf804,0xbd280b1f
.long 0x3c61bc2e,0xbbfb2b74,0xbcec9a7f,0xbd49b953,0x3beea038,0xbc7475c0,0xbd1620d2,0xbd6a6681
.long 0x3a490f88,0xbcb54098,0xbd3554ec,0xbd84f484,0xbbbc6dd5,0xbcefa8b2,0xbd53c867,0xbd940c5f
.long 0x3e000000,0x3e000000,0x3e000000,0x3e000000,0x3dff3f54,0x3dff1f49,0x3dfefcc9,0x3dfed7d4
.long 0x3dfcfe73,0x3dfc7eb0,0x3dfbf531,0x3dfb61fc,0x3df940c0,0x3df822d1,0x3df6ef5b,0x3df5a67b
.long 0x3df40bdd,0x3df21352,0x3deff573,0x3dedb293,0x3ded67a1,0x3dea5ad9,0x3de71599,0x3de398ac
.long 0x3de55e0b,0x3de106f2,0x3ddc61c7,0x3dd77026,0x3ddbfb34,0x3dd627fe,0x3dcfefa8,0x3dc95521
.long 0x3dd14d3d,0x3dc9d112,0x3dc1d870,0x3db96842,0x3dc56439,0x3dbc17d9,0x3db238aa,0x3da7ce61
.long 0x3db85216,0x3dad1469,0x3da12ff9,0x3d94b039,0x3daa2a80,0x3d9ce11f,0x3d8ee0db,0x3d803a06
.long 0x3d9b02c6,0x3d8b9a6b,0x3d76e0cb,0x3d553641,0x3d8af1b7,0x3d72bd43,0x3d4e0bea,0x3d280b1f
.long 0x3d741f07,0x3d4c9b8b,0x3d2395c5,0x3cf2b651,0x3d50eb2a,0x3d25129f,0x3cefa8b2,0x3c9324ca
.long 0x3d2c7cd4,0x3cf8cfcc,0x3c964083,0x3bc8fb30,0x3d070ada,0x3ca5c58c,0x3beea038,0xbbbc6dd5
.long 0x3cc19b37,0x3c23308c,0xbb7b49ba,0xbc9008b7,0x3c67fa9a,0xb9c90fc6,0xbc7475c0,0xbcefa8b2
.long 0x3b96c32c,0xbc2fb680,0xbcd41501,0xbd268f12,0xbba351cb,0xbcabf804,0xbd1620d2,0xbd53c867
.long 0xbc6e3876,0xbcfee6e1,0xbd41071e,0xbd7f17b2,0xbcc4b0b9,0xbd280b1f,0xbd6a6681,0xbd940c5f
.long 0xbd088e93,0xbd4f7bca,0xbd88f59b,0xbda73656,0xbd2df73c,0xbd758035,0xbd9ba299,0xbdb8dd65
.long 0xbd525a09,0xbd8cead0,0xbdad1469,0xbdc8d8b3,0xbd758035,0xbd9e1e22,0xbdbd27b8,0xbdd70348
.long 0xbd8b9a6b,0xbdae3bde,0xbdcbbbf8,0xbde33c5a,0xbd9ba299,0xbdbd27b8,0xbdd8b3a1,0xbded67a1
.long 0xbdaac082,0xbdcac77f,0xbde3f473,0xbdf56d97,0xbdb8dd65,0xbdd70348,0xbded67a1,0xbdfb3bab
.long 0x3e000000,0x3e000000,0x3e000000,0x3e000000,0x3dfeb069,0x3dfe868b,0x3dfe5a38,0x3dfe2b72
.long 0x3dfac516,0x3dfa1e84,0x3df96e4e,0x3df8b47b,0x3df4484b,0x3df2d4eb,0x3df14c7a,0x3defaf1b
.long 0x3deb4b0c,0x3de8bf3c,0x3de60f88,0x3de33c5a,0x3ddfe4e9,0x3ddbfb34,0x3dd7dc7f,0x3dd389c7
.long 0x3dd233c6,0x3dccae79,0x3dc6e22a,0x3dc0d0da,0x3dc25b89,0x3dbb0629,0x3db3587a,0x3dab561b
.long 0x3db085bb,0x3da73656,0x3d9d7fd1,0x3d93682a,0x3d9ce11f,0x3d91796b,0x3d85a02c,0x3d72bd43
.long 0x3d87a136,0x3d741f07,0x3d58106b,0x3d3b31a0,0x3d61fb6a,0x3d427b55,0x3d221887,0x3d00f8c0
.long 0x3d3263ef,0x3d0e9a22,0x3cd41501,0x3c89cf86,0x3d00f8c0,0x3cb228d4,0x3c427c39,0x3afb514b
.long 0x3c9c76de,0x3c0a200a,0xbb16c9b6,0xbc553db9,0x3bd5880e,0xbba351cb,0xbc86b26e,0xbce36c83
.long 0xbbc8fb30,0xbc964083,0xbcf8cfcc,0xbd2c7cd4,0xbc995be0,0xbd00f8c0,0xbd33dca5,0xbd64cbfe
.long 0xbcfee6e1,0xbd3554ec,0xbd6900b7,0xbd8cead0,0xbd30eacb,0xbd679a5d,0xbd8d9281,0xbda56bcb
.long 0xbd60924f,0xbd8b9a6b,0xbda4d225,0xbdbb8f3b,0xbd86f686,0xbda1cbfb,0xbdb9f2ac,0xbdcf0417
.long 0xbd9c420c,0xbdb6206c,0xbdccae79,0xbddf8327,0xbdaff3e6,0xbdc85bca,0xbddcc7d1,0xbdecd007
.long 0xbdc1d870,0xbdd84853,0xbdea09a7,0xbdf6ba07,0xbdd1c0c2,0xbde5b710,0xbdf4484b,0xbdfd1cdd
.long 0xbddf8327,0xbdf08066,0xbdfb61fc,0xbdffe129,0xbdeafb8c,0xbdf88486,0xbdff3f54,0xbdfefcc9
.long 0xbdf40bdd,0xbdfdabcc,0xbdffd397,0xbdfa7302,0xbdfa9c59,0xbdffe705,0xbdfd1cdd,0xbdf25470
.long 0xbdfe9bc9,0xbdff2f9d,0xbdf72417,0xbde6becc,0xbdffffb1,0xbdfb87b2,0xbdedfcf2,0xbdd7dc7f
.long 0x3e000000,0x3e000000,0x3e000000,0x3e000000,0x3dfdfa38,0x3dfdc68c,0x3dfd906e,0x3dfd57de
.long 0x3df7f110,0x3df72417,0x3df64d97,0x3df56d97,0x3dedfcf2,0x3dec3624,0x3dea5ad9,0x3de86b39
.long 0x3de04621,0x3ddd2d53,0x3dd9f26a,0x3dd695e5,0x3dcf0417,0x3dca4c87,0x3dc56439,0x3dc04c5c
.long 0x3dba7ca4,0x3db3e7bc,0x3dad1469,0x3da6050a,0x3da302d3,0x3d9a6293,0x3d91796b,0x3d884b92
.long 0x3d88f59b,0x3d7c5d27,0x3d663375,0x3d4f7bca,0x3d597cb9,0x3d3f926f,0x3d25129f,0x3d0a11f7
.long 0x3d1d9e78,0x3cfee6e1,0x3cc19b37,0x3c839502,0x3cbe853e,0x3c7475c0,0x3bd5880e,0xbafb514b
.long 0x3bfb2b74,0xbac90e90,0xbc2fb680,0xbca2abb6,0xbc03db0a,0xbc9324ca,0xbce36c83,0xbd1920fe
.long 0xbcc19b37,0xbd0b9507,0xbd3554ec,0xbd5dbe79,0xbd1f1cdf,0xbd4b2aae,0xbd758035,0xbd8ee0db
.long 0xbd5ae880,0xbd839c3d,0xbd987fc0,0xbdabeb4a,0xbd899f4e,0xbd9f599f,0xbdb3587a,0xbdc56439
.long 0xbda39da9,0xbdb85216,0xbdcac77f,0xbddac450,0xbdbb0629,0xbdce1689,0xbdde5aa6,0xbdeb99fb
.long 0xbdcf7a1f,0xbde04621,0xbdedb293,0xbdf78bc5,0xbde0a6cf,0xbdee8ff8,0xbdf88486,0xbdfe5a38
.long 0xbdee46be,0xbdf8b47b,0xbdfe9bc9,0xbdffe129,0xbdf822d1,0xbdfe868b,0xbdffdaaf,0xbdfc187a
.long 0xbdfe1324,0xbdffec43,0xbdfc3b28,0xbdf31447,0xbdffffb1,0xbdfcdf6c,0xbdf3ced9,0xbde50479
.long 0xbdfde0b1,0xbdf56d97,0xbde6becc,0xbdd233c6,0xbdf7beb7,0xbde9b7e4,0xbdd54aa4,0xbdbb0629
.long 0xbdedb293,0xbdd9f26a,0xbdbfc767,0xbd9ff6cb,0xbddfe4e9,0xbdc66354,0xbda69de3,0xbd819573
.long 0xbdce8d90,0xbdaf61a5,0xbd8a48ad,0xbd41071e,0xbdb9f2ac,0xbd9553b7,0xbd56a399,0xbcf5c35a
.long 0x3e000000,0x3e000000,0x3e000000,0x3e000000,0x3dfd1cdd,0x3dfcdf6c,0x3dfc9f8a,0x3dfc5d3a
.long 0x3df48422,0x3df3913f,0x3df294f8,0x3df18f57,0x3de66771,0x3de44fac,0x3de2241a,0x3ddfe4e9
.long 0x3dd31849,0x3dcf7a1f,0x3dcbbbf8,0x3dc7de65,0x3dbb0629,0x3db592e7,0x3daff3e6,0x3daa2a80
.long 0x3d9ebc12,0x3d973c07,0x3d8f8784,0x3d87a136,0x3d7dbabb,0x3d6a6681,0x3d56a399,0x3d427b55
.long 0x3d38442a,0x3d209ae5,0x3d088e93,0x3ce05c13,0x3cdd4b1a,0x3ca5c58c,0x3c5b7d37,0x3bd5880e
.long 0x3c0a200a,0x3a490f88,0xbbe21469,0xbc6e3876,0xbc2973ba,0xbc995be0,0xbcdd4b1a,0xbd101c2c
.long 0xbcec9a7f,0xbd1aa086,0xbd3e1d4a,0xbd60924f,0xbd3f926f,0xbd64cbfe,0xbd844889,0xbd9553b7
.long 0xbd8242b1,0xbd94b039,0xbda6050a,0xbdb6206c,0xbda1cbfb,0xbdb3587a,0xbdc36051,0xbdd1c0c2
.long 0xbdbdaef9,0xbdcd9f02,0xbddb941a,0xbde76bd8,0xbdd54aa4,0xbde2df7b,0xbdedfcf2,0xbdf6841b
.long 0xbde816a8,0xbdf294f8,0xbdfa1e84,0xbdfe9bc9,0xbdf5a67b,0xbdfc5d3a,0xbdffa6e3,0xbdff7808
.long 0xbdfdabcc,0xbdfffb11,0xbdfe70b0,0xbdf91298,0xbdfff84a,0xbdfd57de,0xbdf6841b,0xbdeb99fb
.long 0xbdfc7eb0,0xbdf48422,0xbde816a8,0xbdd77026,0xbdf3530e,0xbde5b710,0xbdd389c7,0xbdbd27b8
.long 0xbde4aa59,0xbdd14d3d,0xbdb96842,0xbd9d7fd1,0xbdd0d937,0xbdb7c655,0xbd9a6293,0xbd72bd43
.long 0xbdb85216,0xbd99c200,0xbd6e9479,0xbd2395c5,0xbd9ba299,0xbd6ff7fb,0xbd221887,0xbc9f917b
.long 0xbd76e0cb,0xbd268f12,0xbca2abb6,0x3ac90e90,0xbd30eacb,0xbcb228d4,0x39c90fc6,0x3cb857ec
.long 0xbccdee60,0xbb16c9b6,0x3ca8defc,0x3d2f713a,0xbbd5880e,0x3c8cec4a,0x3d25129f,0x3d7dbabb
.long 0x3e000000,0x3e000000,0x3e000000,0x3e000000,0x3dfc187a,0x3dfbd14d,0x3dfb87b2,0x3dfb3bab
.long 0x3df08066,0x3def6830,0x3dee46be,0x3ded1c1d,0x3ddd924d,0x3ddb2c79,0x3dd8b3a1,0x3dd627fe
.long 0x3dc3e200,0x3dbfc767,0x3dbb8f3b,0x3db73a23,0x3da4381a,0x3d9e1e22,0x3d97de12,0x3d91796b
.long 0x3d7f17b2,0x3d6e9479,0x3d5dbe79,0x3d4c9b8b,0x3d2df73c,0x3d1920fe,0x3d040270,0x3cdd4b1a
.long 0x3caf10a2,0x3c7ab273,0x3c16a905,0x3b490ab0,0xb9c90fc6,0xbbeea038,0xbc67fa9a,0xbcabf804
.long 0xbcb54098,0xbcf2b651,0xbd17a117,0xbd3554ec,0xbd30eacb,0xbd50eb2a,0xbd6ff7fb,0xbd86f686
.long 0xbd80e7e4,0xbd90d3cd,0xbd9ff6cb,0xbdae3bde,0xbda56bcb,0xbdb4768f,0xbdc25b89,0xbdcf0417
.long 0xbdc4e3f5,0xbdd233c6,0xbdddf6be,0xbde816a8,0xbdde5aa6,0xbde912ae,0xbdf1d19f,0xbdf88486
.long 0xbdf10908,0xbdf853f8,0xbdfd3aac,0xbdffb10f,0xbdfc5d3a,0xbdff7808,0xbdffcbe2,0xbdfd57de
.long 0xbdfffec4,0xbdfe4323,0xbdf96e4e,0xbdf18f57,0xbdfbd14d,0xbdf4bf62,0xbdea5ad9,0xbddcc7d1
.long 0xbdeff573,0xbde33c5a,0xbdd31849,0xbdbfc767,0xbddcc7d1,0xbdca4c87,0xbdb4768f,0xbd9ba299
.long 0xbdc2de29,0xbdaac082,0xbd8f8784,0xbd6363fa,0xbda302d3,0xbd85a02c,0xbd4b2aae,0xbd070ada
.long 0xbd7c5d27,0xbd38442a,0xbce05c13,0xbc16a905,0xbd2b0201,0xbcbe853e,0xbb8a342f,0x3c7475c0
.long 0xbca8defc,0xba490f88,0x3c9c76de,0x3d1d9e78,0x3a96cb58,0x3cb228d4,0x3d2b0201,0x3d7840c8
.long 0x3cbb6ecf,0x3d3263ef,0x3d80e7e4,0x3da4d225,0x3d33dca5,0x3d82ef9f,0x3da7ce61,0x3dc76085
.long 0x3d8242b1,0x3da86605,0x3dc8d8b3,0x3de28210,0x3da69de3,0x3dc85bca,0x3de2df7b,0x3df5341d
.long 0x0,0x0,0x0,0x0,0x39c90fc6,0x3a96cb58,0x3afb514b,0x3b2fea69
.long 0x3a490f88,0x3b16c9b6,0x3b7b49ba,0x3bafe007,0x3a96cb58,0x3b622a7a,0x3bbc6dd5,0x3c03db0a
.long 0x3ac90e90,0x3b96c32c,0x3bfb2b74,0x3c2fb680,0x3afb514b,0x3bbc6dd5,0x3c1cecf9,0x3c5b7d37
.long 0x3b16c9b6,0x3be21469,0x3c3c3ac3,0x3c839502,0x3b2fea69,0x3c03db0a,0x3c5b7d37,0x3c995be0
.long 0x3b490ab0,0x3c16a905,0x3c7ab273,0x3caf10a2,0x3b622a7a,0x3c2973ba,0x3c8cec4a,0x3cc4b0b9
.long 0x3b7b49ba,0x3c3c3ac3,0x3c9c76de,0x3cda3997,0x3b8a342f,0x3c4efdb7,0x3cabf804,0x3cefa8b2
.long 0x3b96c32c,0x3c61bc2e,0x3cbb6ecf,0x3d027dc0,0x3ba351cb,0x3c7475c0,0x3ccada4f,0x3d0d17c0
.long 0x3bafe007,0x3c839502,0x3cda3997,0x3d17a117,0x3bbc6dd5,0x3c8cec4a,0x3ce98bba,0x3d221887
.long 0x3bc8fb30,0x3c964083,0x3cf8cfcc,0x3d2c7cd4,0x3bd5880e,0x3c9f917b,0x3d040270,0x3d36ccc3
.long 0x3be21469,0x3ca8defc,0x3d0b9507,0x3d41071e,0x3beea038,0x3cb228d4,0x3d131f35,0x3d4b2aae
.long 0x3bfb2b74,0x3cbb6ecf,0x3d1aa086,0x3d553641,0x3c03db0a,0x3cc4b0b9,0x3d221887,0x3d5f28a9
.long 0x3c0a200a,0x3ccdee60,0x3d2986c4,0x3d6900b7,0x3c1064b4,0x3cd7278f,0x3d30eacb,0x3d72bd43
.long 0x3c16a905,0x3ce05c13,0x3d38442a,0x3d7c5d27,0x3c1cecf9,0x3ce98bba,0x3d3f926f,0x3d82ef9f
.long 0x3c23308c,0x3cf2b651,0x3d46d529,0x3d87a136,0x3c2973ba,0x3cfbdba4,0x3d4e0bea,0x3d8c42c9
.long 0x3c2fb680,0x3d027dc0,0x3d553641,0x3d90d3cd,0x3c35f8da,0x3d070ada,0x3d5c53c1,0x3d9553b7
.long 0x3c3c3ac3,0x3d0b9507,0x3d6363fa,0x3d99c200,0x3c427c39,0x3d101c2c,0x3d6a6681,0x3d9e1e22
.long 0x0,0x0,0x0,0x0,0x3b622a7a,0x3b8a342f,0x3ba351cb,0x3bbc6dd5
.long 0x3be21469,0x3c0a200a,0x3c23308c,0x3c3c3ac3,0x3c2973ba,0x3c4efdb7,0x3c7475c0,0x3c8cec4a
.long 0x3c61bc2e,0x3c89cf86,0x3ca2abb6,0x3cbb6ecf,0x3c8cec4a,0x3cabf804,0x3ccada4f,0x3ce98bba
.long 0x3ca8defc,0x3ccdee60,0x3cf2b651,0x3d0b9507,0x3cc4b0b9,0x3cefa8b2,0x3d0d17c0,0x3d221887
.long 0x3ce05c13,0x3d088e93,0x3d209ae5,0x3d38442a,0x3cfbdba4,0x3d1920fe,0x3d33dca5,0x3d4e0bea
.long 0x3d0b9507,0x3d2986c4,0x3d46d529,0x3d6363fa,0x3d1920fe,0x3d39bb1e,0x3d597cb9,0x3d7840c8
.long 0x3d268f12,0x3d49b953,0x3d6bcbbb,0x3d864b82,0x3d33dca5,0x3d597cb9,0x3d7dbabb,0x3d902dd5
.long 0x3d41071e,0x3d6900b7,0x3d87a136,0x3d99c200,0x3d4e0bea,0x3d7840c8,0x3d902dd5,0x3da302d3
.long 0x3d5ae880,0x3d839c3d,0x3d987fc0,0x3dabeb4a,0x3d679a5d,0x3d8af1b7,0x3da09393,0x3db4768f
.long 0x3d741f07,0x3d921eb0,0x3da86605,0x3dbca003,0x3d803a06,0x3d99210f,0x3daff3e6,0x3dc46337
.long 0x3d864b82,0x3d9ff6cb,0x3db73a23,0x3dcbbbf8,0x3d8c42c9,0x3da69de3,0x3dbe35c5,0x3dd2a649
.long 0x3d921eb0,0x3dad1469,0x3dc4e3f5,0x3dd91e6a,0x3d97de12,0x3db3587a,0x3dcb41fa,0x3ddf20db
.long 0x3d9d7fd1,0x3db96842,0x3dd14d3d,0x3de4aa59,0x3da302d3,0x3dbf41fc,0x3dd70348,0x3de9b7e4
.long 0x3da86605,0x3dc4e3f5,0x3ddc61c7,0x3dee46be,0x3dada859,0x3dca4c87,0x3de1668a,0x3df25470
.long 0x3db2c8c9,0x3dcf7a1f,0x3de60f88,0x3df5dec6,0x3db7c655,0x3dd46b3b,0x3dea5ad9,0x3df8e3d6
.long 0x3dbca003,0x3dd91e6a,0x3dee46be,0x3dfb61fc,0x3dc154e1,0x3ddd924d,0x3df1d19f,0x3dfd57de
.long 0x0,0x0,0x0,0x0,0x3bd5880e,0x3beea038,0x3c03db0a,0x3c1064b4
.long 0x3c553db9,0x3c6e3876,0x3c839502,0x3c9008b7,0x3c9f917b,0x3cb228d4,0x3cc4b0b9,0x3cd7278f
.long 0x3cd41501,0x3cec9a7f,0x3d027dc0,0x3d0e9a22,0x3d040270,0x3d131f35,0x3d221887,0x3d30eacb
.long 0x3d1d9e78,0x3d2f713a,0x3d41071e,0x3d525a09,0x3d36ccc3,0x3d4b2aae,0x3d5f28a9,0x3d72bd43
.long 0x3d4f7bca,0x3d663375,0x3d7c5d27,0x3d88f59b,0x3d679a5d,0x3d803a06,0x3d8c42c9,0x3d97de12
.long 0x3d7f17b2,0x3d8cead0,0x3d99c200,0x3da6050a,0x3d8af1b7,0x3d99210f,0x3da69de3,0x3db3587a
.long 0x3d95f6d9,0x3da4d225,0x3db2c8c9,0x3dbfc767,0x3da09393,0x3daff3e6,0x3dbe35c5,0x3dcb41fa
.long 0x3daac082,0x3dba7ca4,0x3dc8d8b3,0x3dd5b993,0x3db4768f,0x3dc46337,0x3dd2a649,0x3ddf20db
.long 0x3dbdaef9,0x3dcd9f02,0x3ddb941a,0x3de76bd8,0x3dc66354,0x3dd627fe,0x3de398ac,0x3dee8ff8
.long 0x3dce8d90,0x3dddf6be,0x3deaab7b,0x3df48422,0x3dd627fe,0x3de50479,0x3df0c501,0x3df940c0
.long 0x3ddd2d53,0x3deb4b0c,0x3df5dec6,0x3dfcbfc9,0x3de398ac,0x3df0c501,0x3df9f35e,0x3dfefcc9
.long 0x3de96591,0x3df56d97,0x3dfcfe73,0x3dfff4e6,0x3dee8ff8,0x3df940c0,0x3dfefcc9,0x3dffa6e3
.long 0x3df31447,0x3dfc3b28,0x3dffec43,0x3dfe1324,0x3df6ef5b,0x3dfe5a38,0x3dffcbe2,0x3dfb3bab
.long 0x3dfa1e84,0x3dff9c18,0x3dfe9bc9,0x3df72417,0x3dfc9f8a,0x3dffffb1,0x3dfc5d3a,0x3df1d19f
.long 0x3dfe70b0,0x3dff84ab,0x3df91298,0x3deb4b0c,0x3dff90b1,0x3dfe2b72,0x3df4bf62,0x3de398ac
.long 0x3dfffec4,0x3dfbf531,0x3def6830,0x3ddac450,0x3dffba9e,0x3df8e3d6,0x3de912ae,0x3dd0d937
.long 0x0,0x0,0x0,0x0,0x3c1cecf9,0x3c2973ba,0x3c35f8da,0x3c427c39
.long 0x3c9c76de,0x3ca8defc,0x3cb54098,0x3cc19b37,0x3ce98bba,0x3cfbdba4,0x3d070ada,0x3d101c2c
.long 0x3d1aa086,0x3d268f12,0x3d3263ef,0x3d3e1d4a,0x3d3f926f,0x3d4e0bea,0x3d5c53c1,0x3d6a6681
.long 0x3d6363fa,0x3d741f07,0x3d8242b1,0x3d8a48ad,0x3d82ef9f,0x3d8c42c9,0x3d9553b7,0x3d9e1e22
.long 0x3d93682a,0x3d9d7fd1,0x3da73656,0x3db085bb,0x3da302d3,0x3dada859,0x3db7c655,0x3dc154e1
.long 0x3db1a81d,0x3dbca003,0x3dc6e22a,0x3dd064af,0x3dbf41fc,0x3dca4c87,0x3dd46b3b,0x3ddd924d
.long 0x3dcbbbf8,0x3dd695e5,0x3de04621,0x3de8bf3c,0x3dd70348,0x3de1668a,0x3dea5ad9,0x3df1d19f
.long 0x3de106f2,0x3deaab7b,0x3df294f8,0x3df8b47b,0x3de9b7e4,0x3df25470,0x3df8e3d6,0x3dfd57de
.long 0x3df10908,0x3df853f8,0x3dfd3aac,0x3dffb10f,0x3df6ef5b,0x3dfc9f8a,0x3dff90b1,0x3dffba9e
.long 0x3dfb61fc,0x3dff2f9d,0x3dffe129,0x3dfd7474,0x3dfe5a38,0x3dffffb1,0x3dfe2b72,0x3df8e3d6
.long 0x3dffd397,0x3dff0e58,0x3dfa7302,0x3df21352,0x3dffcbe2,0x3dfc5d3a,0x3df4bf62,0x3de912ae
.long 0x3dfe4323,0x3df7f110,0x3ded1c1d,0x3dddf6be,0x3dfb3bab,0x3df1d19f,0x3de398ac,0x3dd0d937
.long 0x3df6ba07,0x3dea09a7,0x3dd84853,0x3dc1d870,0x3df0c501,0x3de0a6cf,0x3dcb41fa,0x3db11722
.long 0x3de96591,0x3dd5b993,0x3dbca003,0x3d9ebc12,0x3de0a6cf,0x3dc95521,0x3dac800f,0x3d8af1b7
.long 0x3dd695e5,0x3dbb8f3b,0x3d9b02c6,0x3d6bcbbb,0x3dcb41fa,0x3dac800f,0x3d884b92,0x3d3f926f
.long 0x3dbebc1b,0x3d9c420c,0x3d6900b7,0x3d119ddd,0x3db11722,0x3d8af1b7,0x3d3f926f,0x3cc4b0b9
.long 0x0,0x0,0x0,0x0,0x3c4efdb7,0x3c5b7d37,0x3c67fa9a,0x3c7475c0
.long 0x3ccdee60,0x3cda3997,0x3ce67c66,0x3cf2b651,0x3d1920fe,0x3d221887,0x3d2b0201,0x3d33dca5
.long 0x3d49b953,0x3d553641,0x3d60924f,0x3d6bcbbb,0x3d7840c8,0x3d82ef9f,0x3d899f4e,0x3d902dd5
.long 0x3d921eb0,0x3d99c200,0x3da12ff9,0x3da86605,0x3da69de3,0x3daecef7,0x3db6ad7f,0x3dbe35c5
.long 0x3db96842,0x3dc1d870,0x3dc9d112,0x3dd14d3d,0x3dca4c87,0x3dd2a649,0x3dda5ba0,0x3de1668a
.long 0x3dd91e6a,0x3de106f2,0x3de816a8,0x3dee46be,0x3de5b710,0x3decd007,0x3df2d4eb,0x3df7beb7
.long 0x3deff573,0x3df5dec6,0x3dfa7302,0x3dfdabcc,0x3df7beb7,0x3dfc187a,0x3dfed7d4,0x3dfff84a
.long 0x3dfcfe73,0x3dff6ac7,0x3dfff4e6,0x3dfe9bc9,0x3dffa6e3,0x3dffcbe2,0x3dfdc68c,0x3df99b43
.long 0x3dffb10f,0x3dfd3aac,0x3df853f8,0x3df10908,0x3dfd1cdd,0x3df7beb7,0x3defaf1b,0x3de50479
.long 0x3df7f110,0x3def6830,0x3de3f473,0x3dd5b993,0x3df03b37,0x3de44fac,0x3dd54aa4,0x3dc36051
.long 0x3de60f88,0x3dd695e5,0x3dc3e200,0x3dae3bde,0x3dd988ad,0x3dc66354,0x3daff3e6,0x3d96999f
.long 0x3dcac77f,0x3db3e7bc,0x3d99c200,0x3d79a02d,0x3db9f2ac,0x3d9f599f,0x3d819573,0x3d427b55
.long 0x3da73656,0x3d88f59b,0x3d4f7bca,0x3d088e93,0x3d92c39a,0x3d61fb6a,0x3d1920fe,0x3c995be0
.long 0x3d79a02d,0x3d2f713a,0x3cc19b37,0x3b7b49ba,0x3d4b2aae,0x3cf5c35a,0x3c1cecf9,0xbc35f8da
.long 0x3d1aa086,0x3c89cf86,0xbb96c32c,0xbcd41501,0x3cd101f1,0x3b622a7a,0xbc995be0,0xbd25129f
.long 0x3c553db9,0xbc23308c,0xbd0586ce,0xbd5dbe79,0x39c90fc6,0xbcbe853e,0xbd3ca7af,0xbd899f4e
.long 0x0,0x0,0x0,0x0,0x3c807745,0x3c86b26e,0x3c8cec4a,0x3c9324ca
.long 0x3cfee6e1,0x3d0586ce,0x3d0b9507,0x3d119ddd,0x3d3ca7af,0x3d45625c,0x3d4e0bea,0x3d56a399
.long 0x3d76e0cb,0x3d80e7e4,0x3d864b82,0x3d8b9a6b,0x3d96999f,0x3d9ce11f,0x3da302d3,0x3da8fd41
.long 0x3daf61a5,0x3db6206c,0x3dbca003,0x3dc2de29,0x3dc56439,0x3dcc3578,0x3dd2a649,0x3dd8b3a1
.long 0x3dd84853,0x3ddebe05,0x3de4aa59,0x3dea09a7,0x3de7c187,0x3ded67a1,0x3df25470,0x3df6841b
.long 0x3df3913f,0x3df7f110,0x3dfb61fc,0x3dfde0b1,0x3dfb87b2,0x3dfe2b72,0x3dffa6e3,0x3dfff84a
.long 0x3dff84ab,0x3dfffb11,0x3dff0e58,0x3dfcbfc9,0x3dff7808,0x3dfd57de,0x3df99b43,0x3df4484b
.long 0x3dfb61fc,0x3df64d97,0x3def6830,0x3de6becc,0x3df3530e,0x3deafb8c,0x3de0a6cf,0x3dd46b3b
.long 0x3de76bd8,0x3ddb941a,0x3dcd9f02,0x3dbdaef9,0x3dd7dc7f,0x3dc85bca,0x3db6ad7f,0x3da302d3
.long 0x3dc4e3f5,0x3db1a81d,0x3d9c420c,0x3d84f484,0x3daecef7,0x3d97de12,0x3d7dbabb,0x3d48477c
.long 0x3d95f6d9,0x3d76e0cb,0x3d3e1d4a,0x3d027dc0,0x3d758035,0x3d39bb1e,0x3cf5c35a,0x3c67fa9a
.long 0x3d3b31a0,0x3cf2b651,0x3c553db9,0xbb7b49ba,0x3cfbdba4,0x3c5b7d37,0xbb8a342f,0xbcb228d4
.long 0x3c7ab273,0xbb490ab0,0xbcaf10a2,0xbd209ae5,0xb9c90fc6,0xbc9f917b,0xbd1c1faf,0xbd64cbfe
.long 0xbc839502,0xbd119ddd,0xbd5dbe79,0xbd921eb0,0xbd00f8c0,0xbd50eb2a,0xbd8d9281,0xbdaecef7
.long 0xbd3e1d4a,0xbd864b82,0xbda99415,0xbdc7de65,0xbd7840c8,0xbda1cbfb,0xbdc25b89,0xbddcc7d1
.long 0xbd973c07,0xbdba7ca4,0xbdd77026,0xbded1c1d,0xbdaff3e6,0xbdcfefa8,0xbde86b39,0xbdf88486
.long 0x0,0x0,0x0,0x0,0x3c995be0,0x3c9f917b,0x3ca5c58c,0x3cabf804
.long 0x3d17a117,0x3d1d9e78,0x3d2395c5,0x3d2986c4,0x3d5f28a9,0x3d679a5d,0x3d6ff7fb,0x3d7840c8
.long 0x3d90d3cd,0x3d95f6d9,0x3d9b02c6,0x3d9ff6cb,0x3daecef7,0x3db4768f,0x3db9f2ac,0x3dbf41fc
.long 0x3dc8d8b3,0x3dce8d90,0x3dd3fac3,0x3dd91e6a,0x3dde5aa6,0x3de398ac,0x3de86b39,0x3decd007
.long 0x3deed89e,0x3df31447,0x3df6ba07,0x3df9c79d,0x3df9f35e,0x3dfc9f8a,0x3dfe868b,0x3dffa6e3
.long 0x3dff6ac7,0x3dfffec4,0x3dff9c18,0x3dfe4323,0x3dff1f49,0x3dfd1cdd,0x3df9f35e,0x3df5a67b
.long 0x3df91298,0x3df40bdd,0x3dedb293,0x3de60f88,0x3ded67a1,0x3de50479,0x3ddb2c79,0x3dcfefa8
.long 0x3ddc61c7,0x3dd064af,0x3dc2de29,0x3db3e7bc,0x3dc66354,0x3db6ad7f,0x3da56bcb,0x3d92c39a
.long 0x3dabeb4a,0x3d987fc0,0x3d839c3d,0x3d5ae880,0x3d8d9281,0x3d6d3063,0x3d3ca7af,0x3d0a11f7
.long 0x3d58106b,0x3d2395c5,0x3cda3997,0x3c553db9,0x3d101c2c,0x3cabf804,0x3bd5880e,0xbc03db0a
.long 0x3c89cf86,0x3ac90e90,0xbc61bc2e,0xbcec9a7f,0xbafb514b,0xbc9324ca,0xbd0a11f7,0xbd48477c
.long 0xbca8defc,0xbd17a117,0xbd58106b,0xbd8a48ad,0xbd1f1cdf,0xbd61fb6a,0xbd902dd5,0xbdac800f
.long 0xbd663375,0xbd93682a,0xbdb085bb,0xbdc9d112,0xbd940c5f,0xbdb238aa,0xbdcc3578,0xbde1668a
.long 0xbdb1a81d,0xbdccae79,0xbde28210,0xbdf294f8,0xbdcb41fa,0xbde2241a,0xbdf2d4eb,0xbdfcdf6c
.long 0xbde04621,0xbdf21352,0xbdfcbfc9,0xbdfffb11,0xbdf03b37,0xbdfc187a,0xbdffffb1,0xbdfbd14d
.long 0xbdfac516,0xbdfff4e6,0xbdfc7eb0,0xbdf08066,0xbdffa6e3,0xbdfd906e,0xbdf25470,0xbdde5aa6
.long 0x0,0x0,0x0,0x0,0x3cb228d4,0x3cb857ec,0x3cbe853e,0x3cc4b0b9
.long 0x3d2f713a,0x3d3554ec,0x3d3b31a0,0x3d41071e,0x3d803a06,0x3d844889,0x3d884b92,0x3d8c42c9
.long 0x3da4d225,0x3da99415,0x3dae3bde,0x3db2c8c9,0x3dc46337,0x3dc95521,0x3dce1689,0x3dd2a649
.long 0x3dddf6be,0x3de28210,0x3de6becc,0x3deaab7b,0x3df0c501,0x3df4484b,0x3df7583a,0x3df9f35e
.long 0x3dfc3b28,0x3dfe1324,0x3dff4e6d,0x3dffec43,0x3dffffb1,0x3dff90b1,0x3dfe5a38,0x3dfc5d3a
.long 0x3dfbf531,0x3df8b47b,0x3df48422,0x3def6830,0x3df03b37,0x3de9b7e4,0x3de2241a,0x3dd988ad
.long 0x3ddd2d53,0x3dd31849,0x3dc7de65,0x3dbb8f3b,0x3dc36051,0x3db592e7,0x3da69de3,0x3d96999f
.long 0x3da39da9,0x3d921eb0,0x3d7f17b2,0x3d58106b,0x3d7dbabb,0x3d53c867,0x3d280b1f,0x3cf5c35a
.long 0x3d2c7cd4,0x3cf8cfcc,0x3c964083,0x3bc8fb30,0x3cabf804,0x3c03db0a,0xbba351cb,0xbc9324ca
.long 0xba490f88,0xbc6e3876,0xbce67c66,0xbd2986c4,0xbcb857ec,0xbd1620d2,0xbd4e0bea,0xbd819573
.long 0xbd3263ef,0xbd6bcbbb,0xbd90d3cd,0xbda99415,0xbd819573,0xbd9ce11f,0xbdb592e7,0xbdcb41fa
.long 0xbda6050a,0xbdbebc1b,0xbdd3fac3,0xbde55e0b,0xbdc56439,0xbdda5ba0,0xbdeafb8c,0xbdf6ef5b
.long 0xbddebe05,0xbdeed89e,0xbdf9c79d,0xbdff4e6d,0xbdf14c7a,0xbdfb87b2,0xbdffdaaf,0xbdfe2b72
.long 0xbdfc7eb0,0xbdfffec4,0xbdfcfe73,0xbdf3913f,0xbdfffd39,0xbdfc187a,0xbdf14c7a,0xbddfe4e9
.long 0xbdfbaccd,0xbdeff573,0xbddd2d53,0xbdc3e200,0xbdefaf1b,0xbddbfb34,0xbdc154e1,0xbda09393
.long 0xbddc61c7,0xbdc0d0da,0xbd9ebc12,0xbd6e9479,0xbdc25b89,0xbd9f599f,0xbd6d3063,0xbd131f35
.long 0x0,0x0,0x0,0x0,0x0,0x0,0x0,0x0
.long 0x0,0x0,0x0,0x0,0x0,0x0,0x0,0x0
.long 0x0,0x0,0x0,0x0,0x0,0x0,0x0,0x0
.long 0x0,0x0,0x0,0x0,0x0,0x0,0x0,0x0
.long 0x0,0x0,0x0,0x0,0x0,0x0,0x0,0x0
.long 0x0,0x0,0x0,0x0,0x0,0x0,0x0,0x0
.long 0x0,0x0,0x0,0x0,0x0,0x0,0x0,0x0
.long 0x0,0x0,0x0,0x0,0x0,0x0,0x0,0x0
.long 0x0,0x0,0x0,0x0,0x0,0x0,0x0,0x0
.long 0x0,0x0,0x0,0x0,0x0,0x0,0x0,0x0
.long 0x0,0x0,0x0,0x0,0x0,0x0,0x0,0x0
.long 0x0,0x0,0x0,0x0,0x0,0x0,0x0,0x0
.long 0x0,0x0,0x0,0x0,0x0,0x0,0x0,0x0
.long 0x0,0x0,0x0,0x0,0x0,0x0,0x0,0x0
.long 0x0,0x0,0x0,0x0,0x0,0x0,0x0,0x0
.long 0x0,0x0,0x0,0x0,0x0,0x0,0x0,0x0
.long 0x0,0x0,0x0,0x0,0x0,0x0,0x0,0x0
.long 0x0,0x0,0x0,0x0,0x0,0x0,0x0,0x0
.long 0x0,0x0,0x0,0x0,0x0,0x0,0x0,0x0
.long 0x0,0x0,0x0,0x0,0x0,0x0,0x0,0x0
.long 0x0,0x0,0x0,0x0,0x0,0x0,0x0,0x0
.long 0x0,0x0,0x0,0x0,0x0,0x0,0x0,0x0
.long 0x0,0x0,0x0,0x0,0x0,0x0,0x0,0x0
.long 0x0,0x0,0x0,0x0,0x0,0x0,0x0,0x0
.long 0x0,0x0,0x0,0x0,0x0,0x0,0x0,0x0
.long 0x0,0x0,0x0,0x0,0x0,0x0,0x0,0x0
.long 0x0,0x0,0x0,0x0,0x0,0x0,0x0,0x0
.long 0x0,0x0,0x0,0x0,0x0,0x0,0x0,0x0
.long 0x0,0x0,0x0,0x0,0x0,0x0,0x0,0x0
.long 0x0,0x0,0x0,0x0,0x0,0x0,0x0,0x0
.long 0x0,0x0,0x0,0x0,0x0,0x0,0x0,0x0
.long 0x0,0x0,0x0,0x0,0x0,0x0,0x0,0x0
.long 0x0,0x0,0x0,0x0,0x0,0x0,0x0,0x0
.long 0x0,0x0,0x0,0x0,0x0,0x0,0x0,0x0
.long 0x0,0x0,0x0,0x0,0x0,0x0,0x0,0x0
.long 0x0,0x0,0x0,0x0,0x0,0x0,0x0,0x0
.long 0x0,0x0,0x0,0x0,0x0,0x0,0x0,0x0
.long 0x0,0x0,0x0,0x0,0x0,0x0,0x0,0x0
.long 0x0,0x0,0x0,0x0,0x0,0x0,0x0,0x0
.long 0x0,0x0,0x0,0x0,0x0,0x0,0x0,0x0
.long 0x0,0x0,0x0,0x0,0x0,0x0,0x0,0x0
.long 0x0,0x0,0x0,0x0,0x0,0x0,0x0,0x0
.long 0x0,0x0,0x0,0x0,0x0,0x0,0x0,0x0
.long 0x0,0x0,0x0,0x0,0x0,0x0,0x0,0x0
.long 0x0,0x0,0x0,0x0,0x0,0x0,0x0,0x0
.long 0x0,0x0,0x0,0x0,0x0,0x0,0x0,0x0
.long 0x0,0x0,0x0,0x0,0x0,0x0,0x0,0x0
.long 0x0,0x0,0x0,0x0,0x0,0x0,0x0,0x0
.long 0x0,0x0,0x0,0x0,0x0,0x0,0x0,0x0
.long 0x0,0x0,0x0,0x0,0x0,0x0,0x0,0x0
.long 0x0,0x0,0x0,0x0,0x0,0x0,0x0,0x0
.long 0x0,0x0,0x0,0x0,0x0,0x0,0x0,0x0
.long 0x0,0x0,0x0,0x0,0x0,0x0,0x0,0x0
.long 0x0,0x0,0x0,0x0,0x0,0x0,0x0,0x0
.long 0x0,0x0,0x0,0x0,0x0,0x0,0x0,0x0
.long 0x0,0x0,0x0,0x0,0x0,0x0,0x0,0x0
.long 0x0,0x0,0x0,0x0,0x0,0x0,0x0,0x0
.long 0x0,0x0,0x0,0x0,0x0,0x0,0x0,0x0
.long 0x0,0x0,0x0,0x0,0x0,0x0,0x0,0x0
.long 0x0,0x0,0x0,0x0,0x0,0x0,0x0,0x0
.long 0x0,0x0,0x0,0x0,0x0,0x0,0x0,0x0
.long 0x0,0x0,0x0,0x0,0x0,0x0,0x0,0x0
.long 0x0,0x0,0x0,0x0,0x0,0x0,0x0,0x0
.long 0x0,0x0,0x0,0x0,0x0,0x0,0x0,0x0
.set c0_0, 15360
.set c0_1, 15360
.set c0_2, 15360
.set c0_3, 15359
.set c0_4, 15358
.set c0_5, 15357
.set c0_6, 15356
.set c0_7, 15354
.set c0_8, 15352
.set c0_9, 15350
.set c0_10, 15348
.set c0_11, 15345
.set c0_12, 15342
.set c0_13, 15339
.set c0_14, 15336
.set c0_15, 15333
.set c0_16, 15329
.set c0_17, 15325
.set c0_18, 15321
.set c0_19, 15316
.set c0_20, 15311
.set c0_21, 15307
.set c0_22, 15301
.set c0_23, 15296
.set c0_24, 15290
.set c0_25, 15284
.set c0_26, 15278
.set c0_27, 15272
.set c0_28, 15265
.set c0_29, 15258
.set c0_30, 15251
.set c0_31, 15244
.set c0_32, 15236
.set c0_33, 15229
.set c0_34, 15221
.set c0_35, 15213
.set c0_36, 15204
.set c0_37, 15195
.set c0_38, 15187
.set c0_39, 15177
.set c0_40, 15168
.set c0_41, 15159
.set c0_42, 15149
.set c0_43, 15139
.set c0_44, 15129
.set c0_45, 15118
.set c0_46, 15108
.set c0_47, 15097
.set c0_48, 15086
.set c0_49, 15074
.set c0_50, 15063
.set c0_51, 15051
.set c0_52, 15039
.set c0_53, 15027
.set c0_54, 15015
.set c0_55, 15002
.set c0_56, 14990
.set c0_57, 14977
.set c0_58, 14964
.set c0_59, 14950
.set c0_60, 14937
.set c0_61, 14923
.set c0_62, 14909
.set c0_63, 14895
.set c0_64, 14881
.set c0_65, 14866
.set c0_66, 14852
.set c0_67, 14837
.set c0_68, 14822
.set c0_69, 14807
.set c0_70, 14791
.set c0_71, 14776
.set c0_72, 14760
.set c0_73, 14744
.set c0_74, 14728
.set c0_75, 14712
.set c0_76, 14696
.set c0_77, 14679
.set c0_78, 14662
.set c0_79, 14645
.set c0_80, 14628
.set c0_81, 14611
.set c0_82, 14594
.set c0_83, 14576
.set c0_84, 14559
.set c0_85, 14541
.set c0_86, 14523
.set c0_87, 14505
.set c0_88, 14487
.set c0_89, 14468
.set c0_90, 14450
.set c0_91, 14431
.set c0_92, 14412
.set c0_93, 14393
.set c0_94, 14374
.set c0_95, 14355
.set c0_96, 14336
.set c0_97, 14297
.set c0_98, 14258
.set c0_99, 14219
.set c0_100, 14179
.set c0_101, 14140
.set c0_102, 14100
.set c0_103, 14059
.set c0_104, 14019
.set c0_105, 13978
.set c0_106, 13938
.set c0_107, 13897
.set c0_108, 13855
.set c0_109, 13814
.set c0_110, 13773
.set c0_111, 13731
.set c0_112, 13689
.set c0_113, 13647
.set c0_114, 13605
.set c0_115, 13562
.set c0_116, 13520
.set c0_117, 13477
.set c0_118, 13434
.set c0_119, 13391
.set c0_120, 13348
.set c0_121, 13298
.set c0_122, 13211
.set c0_123, 13124
.set c0_124, 13037
.set c0_125, 12950
.set c0_126, 12862
.set c0_127, 12774
.set c0_128, 12687
.set c0_129, 12598
.set c0_130, 12510
.set c0_131, 12422
.set c0_132, 12333
.set c0_133, 12201
.set c0_134, 12024
.set c0_135, 11846
.set c0_136, 11668
.set c0_137, 11490
.set c0_138, 11312
.set c0_139, 11002
.set c0_140, 10645
.set c0_141, 10288
.set c0_142, 9622
.set c0_143, 8598
.set c0_144, 0
.set c0_145, 41366
.set c0_146, 42390
.set c0_147, 43056
.set c0_148, 43413
.set c0_149, 43770
.set c0_150, 44080
.set c0_151, 44258
.set c0_152, 44436
.set c0_153, 44614
.set c0_154, 44792
.set c0_155, 44969
.set c0_156, 45101
.set c0_157, 45190
.set c0_158, 45278
.set c0_159, 45366
.set c0_160, 45455
.set c0_161, 45542
.set c0_162, 45630
.set c0_163, 45718
.set c0_164, 45805
.set c0_165, 45892
.set c0_166, 45979
.set c0_167, 46066
.set c0_168, 46116
.set c0_169, 46159
.set c0_170, 46202
.set c0_171, 46245
.set c0_172, 46288
.set c0_173, 46330
.set c0_174, 46373
.set c0_175, 46415
.set c0_176, 46457
.set c0_177, 46499
.set c0_178, 46541
.set c0_179, 46582
.set c0_180, 46623
.set c0_181, 46665
.set c0_182, 46706
.set c0_183, 46746
.set c0_184, 46787
.set c0_185, 46827
.set c0_186, 46868
.set c0_187, 46908
.set c0_188, 46947
.set c0_189, 46987
.set c0_190, 47026
.set c0_191, 47065
.set c0_192, 47104
.set c0_193, 47123
.set c0_194, 47142
.set c0_195, 47161
.set c0_196, 47180
.set c0_197, 47199
.set c0_198, 47218
.set c0_199, 47236
.set c0_200, 47255
.set c0_201, 47273
.set c0_202, 47291
.set c0_203, 47309
.set c0_204, 47327
.set c0_205, 47344
.set c0_206, 47362
.set c0_207, 47379
.set c0_208, 47396
.set c0_209, 47413
.set c0_210, 47430
.set c0_211, 47447
.set c0_212, 47464
.set c0_213, 47480
.set c0_214, 47496
.set c0_215, 47512
.set c0_216, 47528
.set c0_217, 47544
.set c0_218, 47559
.set c0_219, 47575
.set c0_220, 47590
.set c0_221, 47605
.set c0_222, 47620
.set c0_223, 47634
.set c0_224, 47649
.set c0_225, 47663
.set c0_226, 47677
.set c0_227, 47691
.set c0_228, 47705
.set c0_229, 47718
.set c0_230, 47732
.set c0_231, 47745
.set c0_232, 47758
.set c0_233, 47770
.set c0_234, 47783
.set c0_235, 47795
.set c0_236, 47807
.set c0_237, 47819
.set c0_238, 47831
.set c0_239, 47842
.set c0_240, 47854
.set c0_241, 47865
.set c0_242, 47876
.set c0_243, 47886
.set c0_244, 47897
.set c0_245, 47907
.set c0_246, 47917
.set c0_247, 47927
.set c0_248, 47936
.set c0_249, 47945
.set c0_250, 47955
.set c0_251, 47963
.set c0_252, 47972
.set c0_253, 47981
.set c0_254, 47989
.set c0_255, 47997
.set c0_256, 48004
.set c0_257, 48012
.set c0_258, 48019
.set c0_259, 48026
.set c0_260, 48033
.set c0_261, 48040
.set c0_262, 48046
.set c0_263, 48052
.set c0_264, 48058
.set c0_265, 48064
.set c0_266, 48069
.set c0_267, 48075
.set c0_268, 48079
.set c0_269, 48084
.set c0_270, 48089
.set c0_271, 48093
.set c0_272, 48097
.set c0_273, 48101
.set c0_274, 48104
.set c0_275, 48107
.set c0_276, 48110
.set c0_277, 48113
.set c0_278, 48116
.set c0_279, 48118
.set c0_280, 48120
.set c0_281, 48122
.set c0_282, 48124
.set c0_283, 48125
.set c0_284, 48126
.set c0_285, 48127
.set c0_286, 48128
.set c0_287, 48128
.set c0_288, 48128
.set c0_289, 48128
.set c0_290, 48128
.set c0_291, 48127
.set c0_292, 48126
.set c0_293, 48125
.set c0_294, 48124
.set c0_295, 48122
.set c0_296, 48120
.set c0_297, 48118
.set c0_298, 48116
.set c0_299, 48113
.set c0_300, 48110
.set c0_301, 48107
.set c0_302, 48104
.set c0_303, 48101
.set c0_304, 48097
.set c0_305, 48093
.set c0_306, 48089
.set c0_307, 48084
.set c0_308, 48079
.set c0_309, 48075
.set c0_310, 48069
.set c0_311, 48064
.set c0_312, 48058
.set c0_313, 48052
.set c0_314, 48046
.set c0_315, 48040
.set c0_316, 48033
.set c0_317, 48026
.set c0_318, 48019
.set c0_319, 48012
.set c0_320, 48004
.set c0_321, 47997
.set c0_322, 47989
.set c0_323, 47981
.set c0_324, 47972
.set c0_325, 47963
.set c0_326, 47955
.set c0_327, 47945
.set c0_328, 47936
.set c0_329, 47927
.set c0_330, 47917
.set c0_331, 47907
.set c0_332, 47897
.set c0_333, 47886
.set c0_334, 47876
.set c0_335, 47865
.set c0_336, 47854
.set c0_337, 47842
.set c0_338, 47831
.set c0_339, 47819
.set c0_340, 47807
.set c0_341, 47795
.set c0_342, 47783
.set c0_343, 47770
.set c0_344, 47758
.set c0_345, 47745
.set c0_346, 47732
.set c0_347, 47718
.set c0_348, 47705
.set c0_349, 47691
.set c0_350, 47677
.set c0_351, 47663
.set c0_352, 47649
.set c0_353, 47634
.set c0_354, 47620
.set c0_355, 47605
.set c0_356, 47590
.set c0_357, 47575
.set c0_358, 47559
.set c0_359, 47544
.set c0_360, 47528
.set c0_361, 47512
.set c0_362, 47496
.set c0_363, 47480
.set c0_364, 47464
.set c0_365, 47447
.set c0_366, 47430
.set c0_367, 47413
.set c0_368, 47396
.set c0_369, 47379
.set c0_370, 47362
.set c0_371, 47344
.set c0_372, 47327
.set c0_373, 47309
.set c0_374, 47291
.set c0_375, 47273
.set c0_376, 47255
.set c0_377, 47236
.set c0_378, 47218
.set c0_379, 47199
.set c0_380, 47180
.set c0_381, 47161
.set c0_382, 47142
.set c0_383, 47123
.set c0_384, 47104
.set c0_385, 47065
.set c0_386, 47026
.set c0_387, 46987
.set c0_388, 46947
.set c0_389, 46908
.set c0_390, 46868
.set c0_391, 46827
.set c0_392, 46787
.set c0_393, 46746
.set c0_394, 46706
.set c0_395, 46665
.set c0_396, 46623
.set c0_397, 46582
.set c0_398, 46541
.set c0_399, 46499
.set c0_400, 46457
.set c0_401, 46415
.set c0_402, 46373
.set c0_403, 46330
.set c0_404, 46288
.set c0_405, 46245
.set c0_406, 46202
.set c0_407, 46159
.set c0_408, 46116
.set c0_409, 46066
.set c0_410, 45979
.set c0_411, 45892
.set c0_412, 45805
.set c0_413, 45718
.set c0_414, 45630
.set c0_415, 45542
.set c0_416, 45455
.set c0_417, 45366
.set c0_418, 45278
.set c0_419, 45190
.set c0_420, 45101
.set c0_421, 44969
.set c0_422, 44792
.set c0_423, 44614
.set c0_424, 44436
.set c0_425, 44258
.set c0_426, 44080
.set c0_427, 43770
.set c0_428, 43413
.set c0_429, 43056
.set c0_430, 42390
.set c0_431, 41366
.set c0_432, 0
.set c0_433, 8598
.set c0_434, 9622
.set c0_435, 10288
.set c0_436, 10645
.set c0_437, 11002
.set c0_438, 11312
.set c0_439, 11490
.set c0_440, 11668
.set c0_441, 11846
.set c0_442, 12024
.set c0_443, 12201
.set c0_444, 12333
.set c0_445, 12422
.set c0_446, 12510
.set c0_447, 12598
.set c0_448, 12687
.set c0_449, 12774
.set c0_450, 12862
.set c0_451, 12950
.set c0_452, 13037
.set c0_453, 13124
.set c0_454, 13211
.set c0_455, 13298
.set c0_456, 13348
.set c0_457, 13391
.set c0_458, 13434
.set c0_459, 13477
.set c0_460, 13520
.set c0_461, 13562
.set c0_462, 13605
.set c0_463, 13647
.set c0_464, 13689
.set c0_465, 13731
.set c0_466, 13773
.set c0_467, 13814
.set c0_468, 13855
.set c0_469, 13897
.set c0_470, 13938
.set c0_471, 13978
.set c0_472, 14019
.set c0_473, 14059
.set c0_474, 14100
.set c0_475, 14140
.set c0_476, 14179
.set c0_477, 14219
.set c0_478, 14258
.set c0_479, 14297
.set c0_480, 14336
.set c0_481, 14355
.set c0_482, 14374
.set c0_483, 14393
.set c0_484, 14412
.set c0_485, 14431
.set c0_486, 14450
.set c0_487, 14468
.set c0_488, 14487
.set c0_489, 14505
.set c0_490, 14523
.set c0_491, 14541
.set c0_492, 14559
.set c0_493, 14576
.set c0_494, 14594
.set c0_495, 14611
.set c0_496, 14628
.set c0_497, 14645
.set c0_498, 14662
.set c0_499, 14679
.set c0_500, 14696
.set c0_501, 14712
.set c0_502, 14728
.set c0_503, 14744
.set c0_504, 14760
.set c0_505, 14776
.set c0_506, 14791
.set c0_507, 14807
.set c0_508, 14822
.set c0_509, 14837
.set c0_510, 14852
.set c0_511, 14866
.set c0_512, 14881
.set c0_513, 14895
.set c0_514, 14909
.set c0_515, 14923
.set c0_516, 14937
.set c0_517, 14950
.set c0_518, 14964
.set c0_519, 14977
.set c0_520, 14990
.set c0_521, 15002
.set c0_522, 15015
.set c0_523, 15027
.set c0_524, 15039
.set c0_525, 15051
.set c0_526, 15063
.set c0_527, 15074
.set c0_528, 15086
.set c0_529, 15097
.set c0_530, 15108
.set c0_531, 15118
.set c0_532, 15129
.set c0_533, 15139
.set c0_534, 15149
.set c0_535, 15159
.set c0_536, 15168
.set c0_537, 15177
.set c0_538, 15187
.set c0_539, 15195
.set c0_540, 15204
.set c0_541, 15213
.set c0_542, 15221
.set c0_543, 15229
.set c0_544, 15236
.set c0_545, 15244
.set c0_546, 15251
.set c0_547, 15258
.set c0_548, 15265
.set c0_549, 15272
.set c0_550, 15278
.set c0_551, 15284
.set c0_552, 15290
.set c0_553, 15296
.set c0_554, 15301
.set c0_555, 15307
.set c0_556, 15311
.set c0_557, 15316
.set c0_558, 15321
.set c0_559, 15325
.set c0_560, 15329
.set c0_561, 15333
.set c0_562, 15336
.set c0_563, 15339
.set c0_564, 15342
.set c0_565, 15345
.set c0_566, 15348
.set c0_567, 15350
.set c0_568, 15352
.set c0_569, 15354
.set c0_570, 15356
.set c0_571, 15357
.set c0_572, 15358
.set c0_573, 15359
.set c0_574, 15360
.set c0_575, 15360
.set sk_0, 0
.set so_0, 0
.set sk_1, 288
.set so_1, 0
.set sk_2, 2
.set so_2, 0
.set sk_3, 2
.set so_3, 144
.set sk_4, 4
.set so_4, 0
.set sk_5, 4
.set so_5, 144
.set sk_6, 6
.set so_6, 0
.set sk_7, 6
.set so_7, 144
.set sk_8, 8
.set so_8, 0
.set sk_9, 8
.set so_9, 144
.set sk_10, 10
.set so_10, 0
.set sk_11, 10
.set so_11, 144
.set sk_12, 12
.set so_12, 0
.set sk_13, 12
.set so_13, 144
.set sk_14, 14
.set so_14, 0
.set sk_15, 14
.set so_15, 144
.set sk_16, 16
.set so_16, 0
.set sk_17, 16
.set so_17, 144
.set sk_18, 18
.set so_18, 0
.set sk_19, 18
.set so_19, 144
.set sk_20, 20
.set so_20, 0
.set sk_21, 20
.set so_21, 144
.set sk_22, 22
.set so_22, 0
.set sk_23, 22
.set so_23, 144
.set sk_24, 24
.set so_24, 0
.set sk_25, 24
.set so_25, 144
.set sk_26, 26
.set so_26, 0
.set sk_27, 26
.set so_27, 144
.set sk_28, 28
.set so_28, 0
.set sk_29, 28
.set so_29, 144
.set sk_30, 30
.set so_30, 0
.set sk_31, 30
.set so_31, 144
.set sk_32, 32
.set so_32, 0
.set sk_33, 32
.set so_33, 144
.set sk_34, 34
.set so_34, 0
.set sk_35, 34
.set so_35, 144
.set sk_36, 36
.set so_36, 0
.set sk_37, 36
.set so_37, 144
.set sk_38, 38
.set so_38, 0
.set sk_39, 38
.set so_39, 144
.set sk_40, 40
.set so_40, 0
.set sk_41, 40
.set so_41, 144
.set sk_42, 42
.set so_42, 0
.set sk_43, 42
.set so_43, 144
.set sk_44, 44
.set so_44, 0
.set sk_45, 44
.set so_45, 144
.set sk_46, 46
.set so_46, 0
.set sk_47, 46
.set so_47, 144
.set sk_48, 48
.set so_48, 0
.set sk_49, 48
.set so_49, 144
.set sk_50, 50
.set so_50, 0
.set sk_51, 50
.set so_51, 144
.set sk_52, 52
.set so_52, 0
.set sk_53, 52
.set so_53, 144
.set sk_54, 54
.set so_54, 0
.set sk_55, 54
.set so_55, 144
.set sk_56, 56
.set so_56, 0
.set sk_57, 56
.set so_57, 144
.set sk_58, 58
.set so_58, 0
.set sk_59, 58
.set so_59, 144
.set sk_60, 60
.set so_60, 0
.set sk_61, 60
.set so_61, 144
.set sk_62, 62
.set so_62, 0
.set sk_63, 62
.set so_63, 144
.set sk_64, 64
.set so_64, 0
.set sk_65, 64
.set so_65, 144
.set sk_66, 66
.set so_66, 0
.set sk_67, 66
.set so_67, 144
.set sk_68, 68
.set so_68, 0
.set sk_69, 68
.set so_69, 144
.set sk_70, 70
.set so_70, 0
.set sk_71, 70
.set so_71, 144
.set sk_72, 72
.set so_72, 0
.set sk_73, 72
.set so_73, 144
.set sk_74, 74
.set so_74, 0
.set sk_75, 74
.set so_75, 144
.set sk_76, 76
.set so_76, 0
.set sk_77, 76
.set so_77, 144
.set sk_78, 78
.set so_78, 0
.set sk_79, 78
.set so_79, 144
.set sk_80, 80
.set so_80, 0
.set sk_81, 80
.set so_81, 144
.set sk_82, 82
.set so_82, 0
.set sk_83, 82
.set so_83, 144
.set sk_84, 84
.set so_84, 0
.set sk_85, 84
.set so_85, 144
.set sk_86, 86
.set so_86, 0
.set sk_87, 86
.set so_87, 144
.set sk_88, 88
.set so_88, 0
.set sk_89, 88
.set so_89, 144
.set sk_90, 90
.set so_90, 0
.set sk_91, 90
.set so_91, 144
.set sk_92, 92
.set so_92, 0
.set sk_93, 92
.set so_93, 144
.set sk_94, 94
.set so_94, 0
.set sk_95, 94
.set so_95, 144
.set sk_96, 96
.set so_96, 0
.set sk_97, 96
.set so_97, 144
.set sk_98, 98
.set so_98, 0
.set sk_99, 98
.set so_99, 144
.set sk_100, 100
.set so_100, 0
.set sk_101, 100
.set so_101, 144
.set sk_102, 102
.set so_102, 0
.set sk_103, 102
.set so_103, 144
.set sk_104, 104
.set so_104, 0
.set sk_105, 104
.set so_105, 144
.set sk_106, 106
.set so_106, 0
.set sk_107, 106
.set so_107, 144
.set sk_108, 108
.set so_108, 0
.set sk_109, 108
.set so_109, 144
.set sk_110, 110
.set so_110, 0
.set sk_111, 110
.set so_111, 144
.set sk_112, 112
.set so_112, 0
.set sk_113, 112
.set so_113, 144
.set sk_114, 114
.set so_114, 0
.set sk_115, 114
.set so_115, 144
.set sk_116, 116
.set so_116, 0
.set sk_117, 116
.set so_117, 144
.set sk_118, 118
.set so_118, 0
.set sk_119, 118
.set so_119, 144
.set sk_120, 120
.set so_120, 0
.set sk_121, 120
.set so_121, 144
.set sk_122, 122
.set so_122, 0
.set sk_123, 122
.set so_123, 144
.set sk_124, 124
.set so_124, 0
.set sk_125, 124
.set so_125, 144
.set sk_126, 126
.set so_126, 0
.set sk_127, 126
.set so_127, 144
.set sk_128, 128
.set so_128, 0
.set sk_129, 128
.set so_129, 144
.set sk_130, 130
.set so_130, 0
.set sk_131, 130
.set so_131, 144
.set sk_132, 132
.set so_132, 0
.set sk_133, 132
.set so_133, 144
.set sk_134, 134
.set so_134, 0
.set sk_135, 134
.set so_135, 144
.set sk_136, 136
.set so_136, 0
.set sk_137, 136
.set so_137, 144
.set sk_138, 138
.set so_138, 0
.set sk_139, 138
.set so_139, 144
.set sk_140, 140
.set so_140, 0
.set sk_141, 140
.set so_141, 144
.set sk_142, 142
.set so_142, 0
.set sk_143, 142
.set so_143, 144
.set sk_144, 144
.set so_144, 0
.set sk_145, 144
.set so_145, 144
.set sk_146, 146
.set so_146, 0
.set sk_147, 146
.set so_147, 144
.set sk_148, 148
.set so_148, 0
.set sk_149, 148
.set so_149, 144
.set sk_150, 150
.set so_150, 0
.set sk_151, 150
.set so_151, 144
.set sk_152, 152
.set so_152, 0
.set sk_153, 152
.set so_153, 144
.set sk_154, 154
.set so_154, 0
.set sk_155, 154
.set so_155, 144
.set sk_156, 156
.set so_156, 0
.set sk_157, 156
.set so_157, 144
.set sk_158, 158
.set so_158, 0
.set sk_159, 158
.set so_159, 144
.set sk_160, 160
.set so_160, 0
.set sk_161, 160
.set so_161, 144
.set sk_162, 162
.set so_162, 0
.set sk_163, 162
.set so_163, 144
.set sk_164, 164
.set so_164, 0
.set sk_165, 164
.set so_165, 144
.set sk_166, 166
.set so_166, 0
.set sk_167, 166
.set so_167, 144
.set sk_168, 168
.set so_168, 0
.set sk_169, 168
.set so_169, 144
.set sk_170, 170
.set so_170, 0
.set sk_171, 170
.set so_171, 144
.set sk_172, 172
.set so_172, 0
.set sk_173, 172
.set so_173, 144
.set sk_174, 174
.set so_174, 0
.set sk_175, 174
.set so_175, 144
.set sk_176, 176
.set so_176, 0
.set sk_177, 176
.set so_177, 144
.set sk_178, 178
.set so_178, 0
.set sk_179, 178
.set so_179, 144
.set sk_180, 180
.set so_180, 0
.set sk_181, 180
.set so_181, 144
.set sk_182, 182
.set so_182, 0
.set sk_183, 182
.set so_183, 144
.set sk_184, 184
.set so_184, 0
.set sk_185, 184
.set so_185, 144
.set sk_186, 186
.set so_186, 0
.set sk_187, 186
.set so_187, 144
.set sk_188, 188
.set so_188, 0
.set sk_189, 188
.set so_189, 144
.set sk_190, 190
.set so_190, 0
.set sk_191, 190
.set so_191, 144
.set sk_192, 192
.set so_192, 0
.set sk_193, 192
.set so_193, 144
.set sk_194, 194
.set so_194, 0
.set sk_195, 194
.set so_195, 144
.set sk_196, 196
.set so_196, 0
.set sk_197, 196
.set so_197, 144
.set sk_198, 198
.set so_198, 0
.set sk_199, 198
.set so_199, 144
.set sk_200, 200
.set so_200, 0
.set sk_201, 200
.set so_201, 144
.set sk_202, 202
.set so_202, 0
.set sk_203, 202
.set so_203, 144
.set sk_204, 204
.set so_204, 0
.set sk_205, 204
.set so_205, 144
.set sk_206, 206
.set so_206, 0
.set sk_207, 206
.set so_207, 144
.set sk_208, 208
.set so_208, 0
.set sk_209, 208
.set so_209, 144
.set sk_210, 210
.set so_210, 0
.set sk_211, 210
.set so_211, 144
.set sk_212, 212
.set so_212, 0
.set sk_213, 212
.set so_213, 144
.set sk_214, 214
.set so_214, 0
.set sk_215, 214
.set so_215, 144
.set sk_216, 216
.set so_216, 0
.set sk_217, 216
.set so_217, 144
.set sk_218, 218
.set so_218, 0
.set sk_219, 218
.set so_219, 144
.set sk_220, 220
.set so_220, 0
.set sk_221, 220
.set so_221, 144
.set sk_222, 222
.set so_222, 0
.set sk_223, 222
.set so_223, 144
.set sk_224, 224
.set so_224, 0
.set sk_225, 224
.set so_225, 144
.set sk_226, 226
.set so_226, 0
.set sk_227, 226
.set so_227, 144
.set sk_228, 228
.set so_228, 0
.set sk_229, 228
.set so_229, 144
.set sk_230, 230
.set so_230, 0
.set sk_231, 230
.set so_231, 144
.set sk_232, 232
.set so_232, 0
.set sk_233, 232
.set so_233, 144
.set sk_234, 234
.set so_234, 0
.set sk_235, 234
.set so_235, 144
.set sk_236, 236
.set so_236, 0
.set sk_237, 236
.set so_237, 144
.set sk_238, 238
.set so_238, 0
.set sk_239, 238
.set so_239, 144
.set sk_240, 240
.set so_240, 0
.set sk_241, 240
.set so_241, 144
.set sk_242, 242
.set so_242, 0
.set sk_243, 242
.set so_243, 144
.set sk_244, 244
.set so_244, 0
.set sk_245, 244
.set so_245, 144
.set sk_246, 246
.set so_246, 0
.set sk_247, 246
.set so_247, 144
.set sk_248, 248
.set so_248, 0
.set sk_249, 248
.set so_249, 144
.set sk_250, 250
.set so_250, 0
.set sk_251, 250
.set so_251, 144
.set sk_252, 252
.set so_252, 0
.set sk_253, 252
.set so_253, 144
.set sk_254, 254
.set so_254, 0
.set sk_255, 254
.set so_255, 144
.set sk_256, 256
.set so_256, 0
.set sk_257, 256
.set so_257, 144
.set sk_258, 258
.set so_258, 0
.set sk_259, 258
.set so_259, 144
.set sk_260, 260
.set so_260, 0
.set sk_261, 260
.set so_261, 144
.set sk_262, 262
.set so_262, 0
.set sk_263, 262
.set so_263, 144
.set sk_264, 264
.set so_264, 0
.set sk_265, 264
.set so_265, 144
.set sk_266, 266
.set so_266, 0
.set sk_267, 266
.set so_267, 144
.set sk_268, 268
.set so_268, 0
.set sk_269, 268
.set so_269, 144
.set sk_270, 270
.set so_270, 0
.set sk_271, 270
.set so_271, 144
.set sk_272, 272
.set so_272, 0
.set sk_273, 272
.set so_273, 144
.set sk_274, 274
.set so_274, 0
.set sk_275, 274
.set so_275, 144
.set sk_276, 276
.set so_276, 0
.set sk_277, 276
.set so_277, 144
.set sk_278, 278
.set so_278, 0
.set sk_279, 278
.set so_279, 144
.set sk_280, 280
.set so_280, 0
.set sk_281, 280
.set so_281, 144
.set sk_282, 282
.set so_282, 0
.set sk_283, 282
.set so_283, 144
.set sk_284, 284
.set so_284, 0
.set sk_285, 284
.set so_285, 144
.set sk_286, 286
.set so_286, 0
.set sk_287, 286
.set so_287, 144
.set sk_288, 1
.set so_288, 0
.set sk_289, 1
.set so_289, 144
.set sk_290, 3
.set so_290, 0
.set sk_291, 3
.set so_291, 144
.set sk_292, 5
.set so_292, 0
.set sk_293, 5
.set so_293, 144
.set sk_294, 7
.set so_294, 0
.set sk_295, 7
.set so_295, 144
.set sk_296, 9
.set so_296, 0
.set sk_297, 9
.set so_297, 144
.set sk_298, 11
.set so_298, 0
.set sk_299, 11
.set so_299, 144
.set sk_300, 13
.set so_300, 0
.set sk_301, 13
.set so_301, 144
.set sk_302, 15
.set so_302, 0
.set sk_303, 15
.set so_303, 144
.set sk_304, 17
.set so_304, 0
.set sk_305, 17
.set so_305, 144
.set sk_306, 19
.set so_306, 0
.set sk_307, 19
.set so_307, 144
.set sk_308, 21
.set so_308, 0
.set sk_309, 21
.set so_309, 144
.set sk_310, 23
.set so_310, 0
.set sk_311, 23
.set so_311, 144
.set sk_312, 25
.set so_312, 0
.set sk_313, 25
.set so_313, 144
.set sk_314, 27
.set so_314, 0
.set sk_315, 27
.set so_315, 144
.set sk_316, 29
.set so_316, 0
.set sk_317, 29
.set so_317, 144
.set sk_318, 31
.set so_318, 0
.set sk_319, 31
.set so_319, 144
.set sk_320, 33
.set so_320, 0
.set sk_321, 33
.set so_321, 144
.set sk_322, 35
.set so_322, 0
.set sk_323, 35
.set so_323, 144
.set sk_324, 37
.set so_324, 0
.set sk_325, 37
.set so_325, 144
.set sk_326, 39
.set so_326, 0
.set sk_327, 39
.set so_327, 144
.set sk_328, 41
.set so_328, 0
.set sk_329, 41
.set so_329, 144
.set sk_330, 43
.set so_330, 0
.set sk_331, 43
.set so_331, 144
.set sk_332, 45
.set so_332, 0
.set sk_333, 45
.set so_333, 144
.set sk_334, 47
.set so_334, 0
.set sk_335, 47
.set so_335, 144
.set sk_336, 49
.set so_336, 0
.set sk_337, 49
.set so_337, 144
.set sk_338, 51
.set so_338, 0
.set sk_339, 51
.set so_339, 144
.set sk_340, 53
.set so_340, 0
.set sk_341, 53
.set so_341, 144
.set sk_342, 55
.set so_342, 0
.set sk_343, 55
.set so_343, 144
.set sk_344, 57
.set so_344, 0
.set sk_345, 57
.set so_345, 144
.set sk_346, 59
.set so_346, 0
.set sk_347, 59
.set so_347, 144
.set sk_348, 61
.set so_348, 0
.set sk_349, 61
.set so_349, 144
.set sk_350, 63
.set so_350, 0
.set sk_351, 63
.set so_351, 144
.set sk_352, 65
.set so_352, 0
.set sk_353, 65
.set so_353, 144
.set sk_354, 67
.set so_354, 0
.set sk_355, 67
.set so_355, 144
.set sk_356, 69
.set so_356, 0
.set sk_357, 69
.set so_357, 144
.set sk_358, 71
.set so_358, 0
.set sk_359, 71
.set so_359, 144
.set sk_360, 73
.set so_360, 0
.set sk_361, 73
.set so_361, 144
.set sk_362, 75
.set so_362, 0
.set sk_363, 75
.set so_363, 144
.set sk_364, 77
.set so_364, 0
.set sk_365, 77
.set so_365, 144
.set sk_366, 79
.set so_366, 0
.set sk_367, 79
.set so_367, 144
.set sk_368, 81
.set so_368, 0
.set sk_369, 81
.set so_369, 144
.set sk_370, 83
.set so_370, 0
.set sk_371, 83
.set so_371, 144
.set sk_372, 85
.set so_372, 0
.set sk_373, 85
.set so_373, 144
.set sk_374, 87
.set so_374, 0
.set sk_375, 87
.set so_375, 144
.set sk_376, 89
.set so_376, 0
.set sk_377, 89
.set so_377, 144
.set sk_378, 91
.set so_378, 0
.set sk_379, 91
.set so_379, 144
.set sk_380, 93
.set so_380, 0
.set sk_381, 93
.set so_381, 144
.set sk_382, 95
.set so_382, 0
.set sk_383, 95
.set so_383, 144
.set sk_384, 97
.set so_384, 0
.set sk_385, 97
.set so_385, 144
.set sk_386, 99
.set so_386, 0
.set sk_387, 99
.set so_387, 144
.set sk_388, 101
.set so_388, 0
.set sk_389, 101
.set so_389, 144
.set sk_390, 103
.set so_390, 0
.set sk_391, 103
.set so_391, 144
.set sk_392, 105
.set so_392, 0
.set sk_393, 105
.set so_393, 144
.set sk_394, 107
.set so_394, 0
.set sk_395, 107
.set so_395, 144
.set sk_396, 109
.set so_396, 0
.set sk_397, 109
.set so_397, 144
.set sk_398, 111
.set so_398, 0
.set sk_399, 111
.set so_399, 144
.set sk_400, 113
.set so_400, 0
.set sk_401, 113
.set so_401, 144
.set sk_402, 115
.set so_402, 0
.set sk_403, 115
.set so_403, 144
.set sk_404, 117
.set so_404, 0
.set sk_405, 117
.set so_405, 144
.set sk_406, 119
.set so_406, 0
.set sk_407, 119
.set so_407, 144
.set sk_408, 121
.set so_408, 0
.set sk_409, 121
.set so_409, 144
.set sk_410, 123
.set so_410, 0
.set sk_411, 123
.set so_411, 144
.set sk_412, 125
.set so_412, 0
.set sk_413, 125
.set so_413, 144
.set sk_414, 127
.set so_414, 0
.set sk_415, 127
.set so_415, 144
.set sk_416, 129
.set so_416, 0
.set sk_417, 129
.set so_417, 144
.set sk_418, 131
.set so_418, 0
.set sk_419, 131
.set so_419, 144
.set sk_420, 133
.set so_420, 0
.set sk_421, 133
.set so_421, 144
.set sk_422, 135
.set so_422, 0
.set sk_423, 135
.set so_423, 144
.set sk_424, 137
.set so_424, 0
.set sk_425, 137
.set so_425, 144
.set sk_426, 139
.set so_426, 0
.set sk_427, 139
.set so_427, 144
.set sk_428, 141
.set so_428, 0
.set sk_429, 141
.set so_429, 144
.set sk_430, 143
.set so_430, 0
.set sk_431, 143
.set so_431, 144
.set sk_432, 145
.set so_432, 0
.set sk_433, 145
.set so_433, 144
.set sk_434, 147
.set so_434, 0
.set sk_435, 147
.set so_435, 144
.set sk_436, 149
.set so_436, 0
.set sk_437, 149
.set so_437, 144
.set sk_438, 151
.set so_438, 0
.set sk_439, 151
.set so_439, 144
.set sk_440, 153
.set so_440, 0
.set sk_441, 153
.set so_441, 144
.set sk_442, 155
.set so_442, 0
.set sk_443, 155
.set so_443, 144
.set sk_444, 157
.set so_444, 0
.set sk_445, 157
.set so_445, 144
.set sk_446, 159
.set so_446, 0
.set sk_447, 159
.set so_447, 144
.set sk_448, 161
.set so_448, 0
.set sk_449, 161
.set so_449, 144
.set sk_450, 163
.set so_450, 0
.set sk_451, 163
.set so_451, 144
.set sk_452, 165
.set so_452, 0
.set sk_453, 165
.set so_453, 144
.set sk_454, 167
.set so_454, 0
.set sk_455, 167
.set so_455, 144
.set sk_456, 169
.set so_456, 0
.set sk_457, 169
.set so_457, 144
.set sk_458, 171
.set so_458, 0
.set sk_459, 171
.set so_459, 144
.set sk_460, 173
.set so_460, 0
.set sk_461, 173
.set so_461, 144
.set sk_462, 175
.set so_462, 0
.set sk_463, 175
.set so_463, 144
.set sk_464, 177
.set so_464, 0
.set sk_465, 177
.set so_465, 144
.set sk_466, 179
.set so_466, 0
.set sk_467, 179
.set so_467, 144
.set sk_468, 181
.set so_468, 0
.set sk_469, 181
.set so_469, 144
.set sk_470, 183
.set so_470, 0
.set sk_471, 183
.set so_471, 144
.set sk_472, 185
.set so_472, 0
.set sk_473, 185
.set so_473, 144
.set sk_474, 187
.set so_474, 0
.set sk_475, 187
.set so_475, 144
.set sk_476, 189
.set so_476, 0
.set sk_477, 189
.set so_477, 144
.set sk_478, 191
.set so_478, 0
.set sk_479, 191
.set so_479, 144
.set sk_480, 193
.set so_480, 0
.set sk_481, 193
.set so_481, 144
.set sk_482, 195
.set so_482, 0
.set sk_483, 195
.set so_483, 144
.set sk_484, 197
.set so_484, 0
.set sk_485, 197
.set so_485, 144
.set sk_486, 199
.set so_486, 0
.set sk_487, 199
.set so_487, 144
.set sk_488, 201
.set so_488, 0
.set sk_489, 201
.set so_489, 144
.set sk_490, 203
.set so_490, 0
.set sk_491, 203
.set so_491, 144
.set sk_492, 205
.set so_492, 0
.set sk_493, 205
.set so_493, 144
.set sk_494, 207
.set so_494, 0
.set sk_495, 207
.set so_495, 144
.set sk_496, 209
.set so_496, 0
.set sk_497, 209
.set so_497, 144
.set sk_498, 211
.set so_498, 0
.set sk_499, 211
.set so_499, 144
.set sk_500, 213
.set so_500, 0
.set sk_501, 213
.set so_501, 144
.set sk_502, 215
.set so_502, 0
.set sk_503, 215
.set so_503, 144
.set sk_504, 217
.set so_504, 0
.set sk_505, 217
.set so_505, 144
.set sk_506, 219
.set so_506, 0
.set sk_507, 219
.set so_507, 144
.set sk_508, 221
.set so_508, 0
.set sk_509, 221
.set so_509, 144
.set sk_510, 223
.set so_510, 0
.set sk_511, 223
.set so_511, 144
.set sk_512, 225
.set so_512, 0
.set sk_513, 225
.set so_513, 144
.set sk_514, 227
.set so_514, 0
.set sk_515, 227
.set so_515, 144
.set sk_516, 229
.set so_516, 0
.set sk_517, 229
.set so_517, 144
.set sk_518, 231
.set so_518, 0
.set sk_519, 231
.set so_519, 144
.set sk_520, 233
.set so_520, 0
.set sk_521, 233
.set so_521, 144
.set sk_522, 235
.set so_522, 0
.set sk_523, 235
.set so_523, 144
.set sk_524, 237
.set so_524, 0
.set sk_525, 237
.set so_525, 144
.set sk_526, 239
.set so_526, 0
.set sk_527, 239
.set so_527, 144
.set sk_528, 241
.set so_528, 0
.set sk_529, 241
.set so_529, 144
.set sk_530, 243
.set so_530, 0
.set sk_531, 243
.set so_531, 144
.set sk_532, 245
.set so_532, 0
.set sk_533, 245
.set so_533, 144
.set sk_534, 247
.set so_534, 0
.set sk_535, 247
.set so_535, 144
.set sk_536, 249
.set so_536, 0
.set sk_537, 249
.set so_537, 144
.set sk_538, 251
.set so_538, 0
.set sk_539, 251
.set so_539, 144
.set sk_540, 253
.set so_540, 0
.set sk_541, 253
.set so_541, 144
.set sk_542, 255
.set so_542, 0
.set sk_543, 255
.set so_543, 144
.set sk_544, 257
.set so_544, 0
.set sk_545, 257
.set so_545, 144
.set sk_546, 259
.set so_546, 0
.set sk_547, 259
.set so_547, 144
.set sk_548, 261
.set so_548, 0
.set sk_549, 261
.set so_549, 144
.set sk_550, 263
.set so_550, 0
.set sk_551, 263
.set so_551, 144
.set sk_552, 265
.set so_552, 0
.set sk_553, 265
.set so_553, 144
.set sk_554, 267
.set so_554, 0
.set sk_555, 267
.set so_555, 144
.set sk_556, 269
.set so_556, 0
.set sk_557, 269
.set so_557, 144
.set sk_558, 271
.set so_558, 0
.set sk_559, 271
.set so_559, 144
.set sk_560, 273
.set so_560, 0
.set sk_561, 273
.set so_561, 144
.set sk_562, 275
.set so_562, 0
.set sk_563, 275
.set so_563, 144
.set sk_564, 277
.set so_564, 0
.set sk_565, 277
.set so_565, 144
.set sk_566, 279
.set so_566, 0
.set sk_567, 279
.set so_567, 144
.set sk_568, 281
.set so_568, 0
.set sk_569, 281
.set so_569, 144
.set sk_570, 283
.set so_570, 0
.set sk_571, 283
.set so_571, 144
.set sk_572, 285
.set so_572, 0
.set sk_573, 285
.set so_573, 144
.set sk_574, 287
.set so_574, 0
.set sk_575, 287
.set so_575, 144
.altmacro
.macro EH idx
.short c0_\idx
.endm
.macro GETK slot
.set curk, sk_\slot
.set curo, so_\slot
.endm
.macro TFFRAG
 .set g_, 0
 .rept 4
  .set j_, 0
  .rept 16
   GETK %(16*st_+j_)
   .set n_, 32*s_+8*g_
   .rept 8
    EH %((n_*curk+curo)%576)
    .set n_, n_+1
   .endr
   .set j_, j_+1
  .endr
  .set g_, g_+1
 .endr
.endm
.macro TIFRAG
 .set g_, 0
 .rept 4
  .set i_, 0
  .rept 16
   .set sl_, par_*288+(4*s_+g_)*8
   .rept 8
    GETK %(sl_)
    EH %(((16*nt_+i_)*curk+curo)%576)
    .set sl_, sl_+1
   .endr
   .set i_, i_+1
  .endr
  .set g_, g_+1
 .endr
.endm
.p2align 8
tab_tf:
.set st_, 0
.rept 36
 .set s_, 0
 .rept 9
  TFFRAG
  .set s_, s_+1
 .endr
 .set st_, st_+1
.endr
.set sk_1, 0
.set so_1, 144
.p2align 8
tab_ti:
.set nt_, 0
.rept 18
 .set par_, 0
 .rept 2
  .set s_, 0
  .rept 9
   TIFRAG
   .set s_, s_+1
  .endr
  .set par_, par_+1
 .endr
 .set nt_, nt_+1
.endr
.noaltmacro
```
